```python
import torch

def _softmax(x, axis=-1):
    return torch.softmax(x, dim=axis)
def _gelu(x):
    return torch.nn.functional.gelu(x, approximate="tanh")
def _silu(x):
    return torch.nn.functional.silu(x)
def _sigmoid(x):
    return torch.sigmoid(x)
def _layernorm(x, axis=-1, eps=1e-5):
    m = x.mean(dim=axis, keepdim=True)
    v = x.var(dim=axis, keepdim=True, unbiased=False)
    return (x - m) / torch.sqrt(v + eps)
def _scatter_add(tgt, idx, src, axis=0):
    return tgt.clone().index_add_(axis, idx, src)
def _segment_sum(src, seg, n):
    out = torch.zeros((n,) + src.shape[1:], dtype=src.dtype)
    return out.index_add_(0, seg, src)
def _pad(x, pw):
    flat = tuple(v for pair in reversed(pw) for v in pair)
    return torch.nn.functional.pad(x, flat)

kernel_name = 'concat_heads__gqa_block_cached__mha_block_cached__near_ridge'

def setup_inputs():

    _w = (lambda a: (lambda t: t.to(torch.bfloat16) if t.is_floating_point() else t)(torch.as_tensor(a)))
    def _A_setup():
        B, Sq, D = 16, 80, 448
        Hq, Hkv, Sk, Dh = 16, 8, 1024, 256
        assert Hq % Hkv == 0, (Hq, Hkv)
        return {
            "x": _w((lambda *s: torch.randn(*s, dtype=torch.bfloat16) * 0.8)(B, Sq, D)),
            "k_cache": _w((lambda *s: torch.randn(*s, dtype=torch.bfloat16) * 0.8)(B, Hkv, Sk, Dh)),
            "v_cache": _w((lambda *s: torch.randn(*s, dtype=torch.bfloat16) * 0.05)(B, Hkv, Sk, Dh)),
            "wq": _w((lambda *s: torch.randn(*s, dtype=torch.bfloat16) * 0.8)(D, Hq * Dh) * (D ** -0.5)),
            "wo": _w((lambda *s: torch.randn(*s, dtype=torch.bfloat16) * 0.05)(Hq * Dh, D) * ((Hq * Dh) ** -0.5)),
        }
    _A_in = _A_setup()

    def _B_setup():
        B, Sq, D = 16, 80, 448
        H, Sk, Dh = 16, 1024, 256
        return {
            "x": _w((lambda *s: torch.randn(*s, dtype=torch.bfloat16) * 0.8)(B, Sq, D)),
            "k_cache": _w((lambda *s: torch.randn(*s, dtype=torch.bfloat16) * 0.8)(B, H, Sk, Dh)),
            "v_cache": _w((lambda *s: torch.randn(*s, dtype=torch.bfloat16) * 0.05)(B, H, Sk, Dh)),
            "wq": _w((lambda *s: torch.randn(*s, dtype=torch.bfloat16) * 0.8)(D, H * Dh) * (D ** -0.5)),
            "wo": _w((lambda *s: torch.randn(*s, dtype=torch.bfloat16) * 0.05)(H * Dh, D) * ((H * Dh) ** -0.5)),
        }
    _B_in = _B_setup()

    return {
        "A_x": _A_in["x"],
        "A_k_cache": _A_in["k_cache"],
        "A_v_cache": _A_in["v_cache"],
        "A_wq": _A_in["wq"],
        "A_wo": _A_in["wo"],
        "B_x": _B_in["x"],
        "B_k_cache": _B_in["k_cache"],
        "B_v_cache": _B_in["v_cache"],
        "B_wq": _B_in["wq"],
        "B_wo": _B_in["wo"],
    }

def reference(A_x, A_k_cache, A_v_cache, A_wq, A_wo, B_x, B_k_cache, B_v_cache, B_wq, B_wo):
    def _A_ref(x, k_cache, v_cache, wq, wo):
        B, Sq, D = x.shape
        Hq, Dh = 16, 256
        Hkv = k_cache.shape[1]
        rep = Hq // Hkv
        q = (lambda x, *d: x.permute(*d))((x @ wq).reshape(B, Sq, Hq, Dh), 0, 2, 1, 3)
        k = (lambda x, n, axis: torch.repeat_interleave(x, n, dim=axis))(k_cache, rep, axis=1)
        v = (lambda x, n, axis: torch.repeat_interleave(x, n, dim=axis))(v_cache, rep, axis=1)
        scores = torch.einsum("bhqd,bhkd->bhqk", q, k) * (Dh ** -0.5)
        p = _softmax(scores, axis=-1)
        o = torch.einsum("bhqk,bhkd->bhqd", p, v)
        return (lambda x, *d: x.permute(*d))(o, 0, 2, 1, 3).reshape(B, Sq, Hq * Dh) @ wo

    def _B_ref(x, k_cache, v_cache, wq, wo):
        B, Sq, D = x.shape
        H, Dh = 16, 256
        q = (lambda x, *d: x.permute(*d))((x @ wq).reshape(B, Sq, H, Dh), 0, 2, 1, 3)
        scores = torch.einsum("bhqd,bhkd->bhqk", q, k_cache) * (Dh ** -0.5)
        p = _softmax(scores, axis=-1)
        o = torch.einsum("bhqk,bhkd->bhqd", p, v_cache)
        return (lambda x, *d: x.permute(*d))(o, 0, 2, 1, 3).reshape(B, Sq, H * Dh) @ wo

    a = _A_ref(A_x, A_k_cache, A_v_cache, A_wq, A_wo)
    b = _B_ref(B_x, B_k_cache, B_v_cache, B_wq, B_wo)
    return torch.concatenate([a, b], axis=-1)
```

```asm
; @launch grid=(256,1,1) block=(256,1,1) lds=163840
.amdgcn_target "amdgcn-amd-amdhsa--gfx950"
.text
.globl concat_heads__gqa_block_cached__mha_block_cached__near_ridge_kernel
.p2align 8
.type concat_heads__gqa_block_cached__mha_block_cached__near_ridge_kernel,@function
concat_heads__gqa_block_cached__mha_block_cached__near_ridge_kernel:
  s_cmp_ge_u32 s2, 256
  s_cbranch_scc1 L_end
  s_getpc_b64 s[4:5]
L_pc:
  s_lshr_b32 s6, s2, 3
  s_lshl_b32 s6, s6, 12
  v_lshlrev_b32 v1, 4, v0
  v_add_u32 v1, s6, v1
  v_min_u32 v1, L_codeend-L_pc-16, v1
  v_mov_b32 v3, s5
  v_add_co_u32 v2, vcc, s4, v1
  s_nop 1
  v_addc_co_u32 v3, vcc, 0, v3, vcc
  global_load_dwordx4 v[216:219], v[2:3], off
  s_load_dwordx16 s[36:51], s[0:1], 0
  s_load_dwordx4 s[52:55], s[0:1], 64
  s_load_dwordx4 s[96:99], s[0:1], 80
  s_load_dwordx2 s[56:57], s[0:1], 96
  v_lshrrev_b32 v1, 6, v0
  v_and_b32 v0, 63, v0
  v_readfirstlane_b32 s58, v1
  s_and_b32 s62, s2, 7
  s_lshr_b32 s4, s2, 3
  s_and_b32 s63, s4, 1
  s_lshr_b32 s61, s4, 1
  s_lshr_b32 s59, s58, 1
  s_and_b32 s60, s58, 1
  v_and_b32 v249, 15, v0
  v_lshrrev_b32 v250, 4, v0
  v_lshlrev_b32 v248, 4, v0
  v_lshrrev_b32 v1, 2, v0
  v_mul_u32_u24 v1, 896, v1
  v_and_b32 v2, 3, v0
  v_lshlrev_b32 v2, 4, v2
  v_add_u32 v205, v1, v2
  v_add_u32 v5, 0, v250
  v_lshlrev_b32 v5, 1, v5
  v_xor_b32 v5, v5, v249
  v_lshlrev_b32 v5, 4, v5
  v_lshlrev_b32 v7, 13, v250
  v_add_u32 v5, v5, v7
  v_add_u32 v200, 0, v5
  v_add_u32 v5, 0, v250
  v_lshlrev_b32 v5, 1, v5
  v_xor_b32 v5, v5, v249
  v_lshlrev_b32 v5, 4, v5
  v_lshlrev_b32 v7, 13, v250
  v_add_u32 v5, v5, v7
  v_add_u32 v201, 31744, v5
  v_add_u32 v5, 4, v250
  v_lshlrev_b32 v5, 1, v5
  v_xor_b32 v5, v5, v249
  v_lshlrev_b32 v5, 4, v5
  v_lshlrev_b32 v7, 13, v250
  v_add_u32 v5, v5, v7
  v_add_u32 v202, 63488, v5
  v_add_u32 v5, 4, v250
  v_lshlrev_b32 v5, 1, v5
  v_xor_b32 v5, v5, v249
  v_lshlrev_b32 v5, 4, v5
  v_lshlrev_b32 v7, 13, v250
  v_add_u32 v5, v5, v7
  v_add_u32 v203, 95232, v5
  v_lshrrev_b32 v2, 5, v0
  v_and_b32 v3, 31, v0
  v_lshlrev_b32 v3, 4, v3
  v_lshlrev_b32 v4, 9, v2
  v_lshlrev_b32 v5, 4, v2
  v_xor_b32 v5, v5, v3
  v_xor_b32 v6, 0, v5
  v_add_u32 v236, v4, v6
  v_xor_b32 v6, 32, v5
  v_add_u32 v237, v4, v6
  v_xor_b32 v6, 64, v5
  v_add_u32 v238, v4, v6
  v_xor_b32 v6, 96, v5
  v_add_u32 v239, v4, v6
  v_xor_b32 v6, 128, v5
  v_add_u32 v240, v4, v6
  v_xor_b32 v6, 160, v5
  v_add_u32 v241, v4, v6
  v_xor_b32 v6, 192, v5
  v_add_u32 v242, v4, v6
  v_xor_b32 v6, 224, v5
  v_add_u32 v243, v4, v6
  v_lshlrev_b32 v5, 5, v2
  v_xor_b32 v5, v5, v3
  v_xor_b32 v6, 0, v5
  v_add_u32 v244, v4, v6
  v_xor_b32 v6, 64, v5
  v_add_u32 v245, v4, v6
  v_xor_b32 v6, 128, v5
  v_add_u32 v246, v4, v6
  v_xor_b32 v6, 192, v5
  v_add_u32 v247, v4, v6
  s_waitcnt lgkmcnt(0)
  s_cmp_eq_u32 s63, 0
  s_cselect_b32 s16, s36, s46
  s_cselect_b32 s17, s37, s47
  s_cselect_b32 s20, s42, s52
  s_cselect_b32 s21, s43, s53
  s_cselect_b32 s8, s38, s48
  s_cselect_b32 s9, s39, s49
  s_cselect_b32 s12, s40, s50
  s_cselect_b32 s13, s41, s51
  s_cselect_b32 s24, s44, s54
  s_cselect_b32 s25, s45, s55
  s_mul_i32 s5, s61, 71680
  s_add_u32 s16, s16, s5
  s_addc_u32 s17, s17, 0
  s_mov_b32 s18, 71680
  s_mov_b32 s19, 0x20000
  s_lshl_b32 s4, s62, 1
  s_add_u32 s4, s4, s59
  s_lshl_b32 s5, s61, 3
  s_add_u32 s5, s5, s62
  s_lshl_b32 s6, s61, 4
  s_add_u32 s6, s6, s4
  s_cmp_eq_u32 s63, 0
  s_cselect_b32 s5, s5, s6
  s_lshl_b32 s5, s5, 19
  s_add_u32 s8, s8, s5
  s_addc_u32 s9, s9, 0
  s_add_u32 s12, s12, s5
  s_addc_u32 s13, s13, 0
  s_mov_b32 s10, 524288
  s_mov_b32 s11, 0x20000
  s_mov_b32 s14, 524288
  s_mov_b32 s15, 0x20000
  s_lshl_b32 s5, s4, 9
  s_add_u32 s20, s20, s5
  s_addc_u32 s21, s21, 0
  s_sub_u32 s22, 3670016, s5
  s_mov_b32 s23, 0x20000
  s_cmp_ge_u32 s61, 14
  s_cselect_b32 s5, 14, 0
  s_sub_u32 s64, s61, s5
  s_mul_i32 s7, s59, 49152
  s_add_u32 s86, s7, 81920
  s_lshl_b32 s85, s59, 13
  s_add_u32 s85, s85, 16384
  s_mov_b32 s87, s64
  s_mov_b32 s81, s64
  s_lshl_b32 s5, s60, 13
  s_lshl_b32 s6, s59, 15
  s_add_u32 s66, s6, s5
  s_add_u32 s67, s7, s5
  s_add_u32 s67, s67, 65536
  s_add_u32 s68, s5, 32768
  s_add_u32 s70, s5, 16384
  s_cmp_eq_u32 s60, 1
  s_cbranch_scc1 L_q1
L_q0:
  s_mul_i32 s83, s59, 43008
  s_mul_i32 s84, s59, 3072
  s_mul_i32 s5, s62, 458752
  s_add_u32 s24, s24, s5
  s_addc_u32 s25, s25, 0
  s_mov_b32 s26, 458752
  s_mov_b32 s27, 0x20000
  s_lshl_b32 s5, s63, 4
  s_add_u32 s79, s5, s61
  s_lshl_b32 s5, s79, 3
  s_add_u32 s5, s5, s62
  s_mul_i32 s5, s5, 71680
  s_add_u32 s28, s56, s5
  s_addc_u32 s29, s57, 0
  s_mov_b32 s30, 71680
  s_mov_b32 s31, 0x20000
  s_add_u32 s32, s56, 0x2000000
  s_addc_u32 s33, s57, 0
  s_mov_b32 s34, 32768
  s_mov_b32 s35, 0x20000
  s_lshl_b32 s5, s79, 3
  s_add_u32 s5, s5, s62
  s_lshl_b32 s5, s5, 7
  v_mov_b32 v9, s5
  v_mov_b32 v10, 0
  buffer_store_dword v10, v9, s[32:35], 0 offen sc1
  s_and_b32 s65, s61, 7
  s_mul_i32 s90, s58, 7168
  s_mov_b32 s72, 0x3db8aa3b
  s_mov_b32 s73, 0x42b17218
  s_mul_i32 s5, s59, s63
  s_lshl_b32 s6, s59, 15
  s_mul_i32 s7, s59, 49152
  v_lshlrev_b32 v1, 9, v249
  v_add_u32 v1, s6, v1
  v_and_b32 v5, 3, v249
  v_xor_b32 v5, v5, v250
  v_lshlrev_b32 v5, 4, v5
  v_add_u32 v1, v1, v5
  v_lshrrev_b32 v6, 2, v249
  v_xor_b32 v5, 0, v6
  v_lshlrev_b32 v5, 6, v5
  v_add_u32 v224, v1, v5
  v_xor_b32 v5, 1, v6
  v_lshlrev_b32 v5, 6, v5
  v_add_u32 v225, v1, v5
  v_xor_b32 v5, 2, v6
  v_lshlrev_b32 v5, 6, v5
  v_add_u32 v226, v1, v5
  v_xor_b32 v5, 3, v6
  v_lshlrev_b32 v5, 6, v5
  v_add_u32 v227, v1, v5
  v_lshlrev_b32 v1, 2, v250
  v_add_u32 v1, v1, v6
  v_and_b32 v7, 7, v1
  v_lshlrev_b32 v1, 9, v1
  v_and_b32 v8, 3, v249
  v_lshlrev_b32 v8, 3, v8
  v_add_u32 v1, v1, v8
  v_add_u32 v1, s7, v1
  v_add_u32 v1, 65536, v1
  v_xor_b32 v5, 0, v7
  v_lshlrev_b32 v5, 5, v5
  v_add_u32 v228, v1, v5
  v_xor_b32 v5, 1, v7
  v_lshlrev_b32 v5, 5, v5
  v_add_u32 v229, v1, v5
  v_xor_b32 v5, 2, v7
  v_lshlrev_b32 v5, 5, v5
  v_add_u32 v230, v1, v5
  v_xor_b32 v5, 3, v7
  v_lshlrev_b32 v5, 5, v5
  v_add_u32 v231, v1, v5
  v_xor_b32 v5, 4, v7
  v_lshlrev_b32 v5, 5, v5
  v_add_u32 v232, v1, v5
  v_xor_b32 v5, 5, v7
  v_lshlrev_b32 v5, 5, v5
  v_add_u32 v233, v1, v5
  v_xor_b32 v5, 6, v7
  v_lshlrev_b32 v5, 5, v5
  v_add_u32 v234, v1, v5
  v_xor_b32 v5, 7, v7
  v_lshlrev_b32 v5, 5, v5
  v_add_u32 v235, v1, v5
  v_lshlrev_b32 v1, 3, v250
  v_add_u32 v1, v1, v6
  v_lshlrev_b32 v1, 8, v1
  v_add_u32 v1, s86, v1
  v_and_b32 v7, 1, v250
  v_lshlrev_b32 v7, 2, v7
  v_add_u32 v7, v7, v6
  v_lshlrev_b32 v7, 1, v7
  v_and_b32 v8, 3, v249
  v_add_u32 v5, 0, v8
  v_xor_b32 v5, v5, v7
  v_lshlrev_b32 v5, 4, v5
  v_add_u32 v192, v1, v5
  v_add_u32 v5, 4, v8
  v_xor_b32 v5, v5, v7
  v_lshlrev_b32 v5, 4, v5
  v_add_u32 v193, v1, v5
  v_add_u32 v5, 8, v8
  v_xor_b32 v5, v5, v7
  v_lshlrev_b32 v5, 4, v5
  v_add_u32 v194, v1, v5
  v_add_u32 v5, 12, v8
  v_xor_b32 v5, v5, v7
  v_lshlrev_b32 v5, 4, v5
  v_add_u32 v195, v1, v5
  s_sub_u32 s5, s85, s86
  v_add_u32 v208, s5, v192
  v_add_u32 v209, s5, v193
  v_add_u32 v210, s5, v194
  v_add_u32 v211, s5, v195
  v_lshlrev_b32 v1, 6, v249
  v_lshlrev_b32 v5, 4, v250
  v_add_u32 v1, v1, v5
  s_mul_i32 s5, s60, 3072
  s_add_u32 s5, s5, 49152
  v_add_u32 v206, s5, v1
  s_barrier
  ds_read_b128 a[0:3], v206 offset:0
  ds_read_b128 a[4:7], v206 offset:1024
  ds_read_b128 a[8:11], v206 offset:2048
  ds_read_b64_tr_b16 a[24:25], v192 offset:0
  ds_read_b64_tr_b16 a[26:27], v192 offset:1024
  ds_read_b64_tr_b16 a[28:29], v192 offset:8
  ds_read_b64_tr_b16 a[30:31], v192 offset:1032
  ds_read_b64_tr_b16 a[32:33], v193 offset:0
  ds_read_b64_tr_b16 a[34:35], v193 offset:1024
  ds_read_b64_tr_b16 a[36:37], v193 offset:8
  ds_read_b64_tr_b16 a[38:39], v193 offset:1032
  ds_read_b64_tr_b16 a[40:41], v194 offset:0
  ds_read_b64_tr_b16 a[42:43], v194 offset:1024
  ds_read_b64_tr_b16 a[44:45], v194 offset:8
  ds_read_b64_tr_b16 a[46:47], v194 offset:1032
  ds_read_b64_tr_b16 a[48:49], v195 offset:0
  ds_read_b64_tr_b16 a[50:51], v195 offset:1024
  ds_read_b64_tr_b16 a[52:53], v195 offset:8
  ds_read_b64_tr_b16 a[54:55], v195 offset:1032
  s_waitcnt lgkmcnt(8)
  v_mfma_f32_16x16x32_bf16 v[0:3], a[24:27], a[0:3], 0
  v_mfma_f32_16x16x32_bf16 v[64:67], a[24:27], a[4:7], 0
  v_mfma_f32_16x16x32_bf16 v[128:131], a[24:27], a[8:11], 0
  v_mfma_f32_16x16x32_bf16 v[4:7], a[28:31], a[0:3], 0
  v_mfma_f32_16x16x32_bf16 v[68:71], a[28:31], a[4:7], 0
  v_mfma_f32_16x16x32_bf16 v[132:135], a[28:31], a[8:11], 0
  v_mfma_f32_16x16x32_bf16 v[8:11], a[32:35], a[0:3], 0
  v_mfma_f32_16x16x32_bf16 v[72:75], a[32:35], a[4:7], 0
  v_mfma_f32_16x16x32_bf16 v[136:139], a[32:35], a[8:11], 0
  v_mfma_f32_16x16x32_bf16 v[12:15], a[36:39], a[0:3], 0
  v_mfma_f32_16x16x32_bf16 v[76:79], a[36:39], a[4:7], 0
  v_mfma_f32_16x16x32_bf16 v[140:143], a[36:39], a[8:11], 0
  s_waitcnt lgkmcnt(0)
  s_barrier
  v_mfma_f32_16x16x32_bf16 v[16:19], a[40:43], a[0:3], 0
  ds_read_b64_tr_b16 a[24:25], v192 offset:8192
  ds_read_b64_tr_b16 a[26:27], v192 offset:9216
  v_mfma_f32_16x16x32_bf16 v[80:83], a[40:43], a[4:7], 0
  ds_read_b64_tr_b16 a[28:29], v192 offset:8200
  ds_read_b64_tr_b16 a[30:31], v192 offset:9224
  v_mfma_f32_16x16x32_bf16 v[144:147], a[40:43], a[8:11], 0
  ds_read_b64_tr_b16 a[32:33], v193 offset:8192
  ds_read_b64_tr_b16 a[34:35], v193 offset:9216
  v_mfma_f32_16x16x32_bf16 v[20:23], a[44:47], a[0:3], 0
  ds_read_b64_tr_b16 a[36:37], v193 offset:8200
  ds_read_b64_tr_b16 a[38:39], v193 offset:9224
  v_mfma_f32_16x16x32_bf16 v[84:87], a[44:47], a[4:7], 0
  ds_read_b64_tr_b16 a[56:57], v194 offset:8192
  ds_read_b64_tr_b16 a[58:59], v194 offset:9216
  v_mfma_f32_16x16x32_bf16 v[148:151], a[44:47], a[8:11], 0
  ds_read_b64_tr_b16 a[60:61], v194 offset:8200
  ds_read_b64_tr_b16 a[62:63], v194 offset:9224
  v_mfma_f32_16x16x32_bf16 v[24:27], a[48:51], a[0:3], 0
  ds_read_b64_tr_b16 a[64:65], v195 offset:8192
  ds_read_b64_tr_b16 a[66:67], v195 offset:9216
  v_mfma_f32_16x16x32_bf16 v[88:91], a[48:51], a[4:7], 0
  ds_read_b64_tr_b16 a[68:69], v195 offset:8200
  ds_read_b64_tr_b16 a[70:71], v195 offset:9224
  v_mfma_f32_16x16x32_bf16 v[152:155], a[48:51], a[8:11], 0
  v_mfma_f32_16x16x32_bf16 v[28:31], a[52:55], a[0:3], 0
  v_mfma_f32_16x16x32_bf16 v[92:95], a[52:55], a[4:7], 0
  v_mfma_f32_16x16x32_bf16 v[156:159], a[52:55], a[8:11], 0
  s_waitcnt lgkmcnt(8)
  v_mfma_f32_16x16x32_bf16 v[32:35], a[24:27], a[0:3], 0
  v_mfma_f32_16x16x32_bf16 v[96:99], a[24:27], a[4:7], 0
  s_add_u32 m0, s66, 0
  v_mfma_f32_16x16x32_bf16 v[160:163], a[24:27], a[8:11], 0
  s_mov_b32 s78, 0
  v_mfma_f32_16x16x32_bf16 v[36:39], a[28:31], a[0:3], 0
  buffer_load_dwordx4 v236, s[8:11], s78 offen offset:0 nt lds
  v_mfma_f32_16x16x32_bf16 v[100:103], a[28:31], a[4:7], 0
  buffer_load_dwordx4 v237, s[8:11], s78 offen offset:1024 nt lds
  v_mfma_f32_16x16x32_bf16 v[164:167], a[28:31], a[8:11], 0
  buffer_load_dwordx4 v238, s[8:11], s78 offen offset:2048 nt lds
  v_mfma_f32_16x16x32_bf16 v[40:43], a[32:35], a[0:3], 0
  buffer_load_dwordx4 v239, s[8:11], s78 offen offset:3072 nt lds
  v_mfma_f32_16x16x32_bf16 v[104:107], a[32:35], a[4:7], 0
  v_mfma_f32_16x16x32_bf16 v[168:171], a[32:35], a[8:11], 0
  v_mfma_f32_16x16x32_bf16 v[44:47], a[36:39], a[0:3], 0
  v_mfma_f32_16x16x32_bf16 v[108:111], a[36:39], a[4:7], 0
  v_mfma_f32_16x16x32_bf16 v[172:175], a[36:39], a[8:11], 0
  s_waitcnt lgkmcnt(0)
  s_barrier
  v_mfma_f32_16x16x32_bf16 v[48:51], a[56:59], a[0:3], 0
  ds_read_b128 a[12:15], v206 offset:5120
  ds_read_b128 a[16:19], v206 offset:6144
  v_mfma_f32_16x16x32_bf16 v[112:115], a[56:59], a[4:7], 0
  ds_read_b128 a[20:23], v206 offset:7168
  ds_read_b64_tr_b16 a[24:25], v192 offset:16384
  v_mfma_f32_16x16x32_bf16 v[176:179], a[56:59], a[8:11], 0
  ds_read_b64_tr_b16 a[26:27], v192 offset:17408
  ds_read_b64_tr_b16 a[28:29], v192 offset:16392
  v_mfma_f32_16x16x32_bf16 v[52:55], a[60:63], a[0:3], 0
  ds_read_b64_tr_b16 a[30:31], v192 offset:17416
  ds_read_b64_tr_b16 a[32:33], v193 offset:16384
  v_mfma_f32_16x16x32_bf16 v[116:119], a[60:63], a[4:7], 0
  ds_read_b64_tr_b16 a[34:35], v193 offset:17408
  ds_read_b64_tr_b16 a[36:37], v193 offset:16392
  v_mfma_f32_16x16x32_bf16 v[180:183], a[60:63], a[8:11], 0
  ds_read_b64_tr_b16 a[38:39], v193 offset:17416
  ds_read_b64_tr_b16 a[40:41], v194 offset:16384
  v_mfma_f32_16x16x32_bf16 v[56:59], a[64:67], a[0:3], 0
  ds_read_b64_tr_b16 a[42:43], v194 offset:17408
  ds_read_b64_tr_b16 a[44:45], v194 offset:16392
  v_mfma_f32_16x16x32_bf16 v[120:123], a[64:67], a[4:7], 0
  ds_read_b64_tr_b16 a[46:47], v194 offset:17416
  ds_read_b64_tr_b16 a[48:49], v195 offset:16384
  v_mfma_f32_16x16x32_bf16 v[184:187], a[64:67], a[8:11], 0
  ds_read_b64_tr_b16 a[50:51], v195 offset:17408
  ds_read_b64_tr_b16 a[52:53], v195 offset:16392
  v_mfma_f32_16x16x32_bf16 v[60:63], a[68:71], a[0:3], 0
  ds_read_b64_tr_b16 a[54:55], v195 offset:17416
  v_mfma_f32_16x16x32_bf16 v[124:127], a[68:71], a[4:7], 0
  v_mfma_f32_16x16x32_bf16 v[188:191], a[68:71], a[8:11], 0
  s_waitcnt lgkmcnt(8)
  v_mfma_f32_16x16x32_bf16 v[0:3], a[24:27], a[12:15], v[0:3]
  v_mfma_f32_16x16x32_bf16 v[64:67], a[24:27], a[16:19], v[64:67]
  v_mfma_f32_16x16x32_bf16 v[128:131], a[24:27], a[20:23], v[128:131]
  v_mfma_f32_16x16x32_bf16 v[4:7], a[28:31], a[12:15], v[4:7]
  v_mfma_f32_16x16x32_bf16 v[68:71], a[28:31], a[16:19], v[68:71]
  v_mfma_f32_16x16x32_bf16 v[132:135], a[28:31], a[20:23], v[132:135]
  v_mfma_f32_16x16x32_bf16 v[8:11], a[32:35], a[12:15], v[8:11]
  v_mfma_f32_16x16x32_bf16 v[72:75], a[32:35], a[16:19], v[72:75]
  v_mfma_f32_16x16x32_bf16 v[136:139], a[32:35], a[20:23], v[136:139]
  v_mfma_f32_16x16x32_bf16 v[12:15], a[36:39], a[12:15], v[12:15]
  v_mfma_f32_16x16x32_bf16 v[76:79], a[36:39], a[16:19], v[76:79]
  v_mfma_f32_16x16x32_bf16 v[140:143], a[36:39], a[20:23], v[140:143]
  s_waitcnt lgkmcnt(0)
  s_barrier
  v_mfma_f32_16x16x32_bf16 v[16:19], a[40:43], a[12:15], v[16:19]
  ds_read_b64_tr_b16 a[24:25], v192 offset:24576
  ds_read_b64_tr_b16 a[26:27], v192 offset:25600
  v_mfma_f32_16x16x32_bf16 v[80:83], a[40:43], a[16:19], v[80:83]
  ds_read_b64_tr_b16 a[28:29], v192 offset:24584
  ds_read_b64_tr_b16 a[30:31], v192 offset:25608
  v_mfma_f32_16x16x32_bf16 v[144:147], a[40:43], a[20:23], v[144:147]
  ds_read_b64_tr_b16 a[32:33], v193 offset:24576
  ds_read_b64_tr_b16 a[34:35], v193 offset:25600
  v_mfma_f32_16x16x32_bf16 v[20:23], a[44:47], a[12:15], v[20:23]
  ds_read_b64_tr_b16 a[36:37], v193 offset:24584
  ds_read_b64_tr_b16 a[38:39], v193 offset:25608
  v_mfma_f32_16x16x32_bf16 v[84:87], a[44:47], a[16:19], v[84:87]
  ds_read_b64_tr_b16 a[56:57], v194 offset:24576
  ds_read_b64_tr_b16 a[58:59], v194 offset:25600
  v_mfma_f32_16x16x32_bf16 v[148:151], a[44:47], a[20:23], v[148:151]
  ds_read_b64_tr_b16 a[60:61], v194 offset:24584
  ds_read_b64_tr_b16 a[62:63], v194 offset:25608
  v_mfma_f32_16x16x32_bf16 v[24:27], a[48:51], a[12:15], v[24:27]
  ds_read_b64_tr_b16 a[64:65], v195 offset:24576
  ds_read_b64_tr_b16 a[66:67], v195 offset:25600
  v_mfma_f32_16x16x32_bf16 v[88:91], a[48:51], a[16:19], v[88:91]
  ds_read_b64_tr_b16 a[68:69], v195 offset:24584
  ds_read_b64_tr_b16 a[70:71], v195 offset:25608
  v_mfma_f32_16x16x32_bf16 v[152:155], a[48:51], a[20:23], v[152:155]
  v_mfma_f32_16x16x32_bf16 v[28:31], a[52:55], a[12:15], v[28:31]
  v_mfma_f32_16x16x32_bf16 v[92:95], a[52:55], a[16:19], v[92:95]
  v_mfma_f32_16x16x32_bf16 v[156:159], a[52:55], a[20:23], v[156:159]
  s_waitcnt lgkmcnt(8)
  v_mfma_f32_16x16x32_bf16 v[32:35], a[24:27], a[12:15], v[32:35]
  v_mfma_f32_16x16x32_bf16 v[96:99], a[24:27], a[16:19], v[96:99]
  s_add_u32 m0, s66, 4096
  v_mfma_f32_16x16x32_bf16 v[160:163], a[24:27], a[20:23], v[160:163]
  s_mov_b32 s78, 4096
  v_mfma_f32_16x16x32_bf16 v[36:39], a[28:31], a[12:15], v[36:39]
  buffer_load_dwordx4 v240, s[8:11], s78 offen offset:0 nt lds
  v_mfma_f32_16x16x32_bf16 v[100:103], a[28:31], a[16:19], v[100:103]
  buffer_load_dwordx4 v241, s[8:11], s78 offen offset:1024 nt lds
  v_mfma_f32_16x16x32_bf16 v[164:167], a[28:31], a[20:23], v[164:167]
  buffer_load_dwordx4 v242, s[8:11], s78 offen offset:2048 nt lds
  v_mfma_f32_16x16x32_bf16 v[40:43], a[32:35], a[12:15], v[40:43]
  buffer_load_dwordx4 v243, s[8:11], s78 offen offset:3072 nt lds
  v_mfma_f32_16x16x32_bf16 v[104:107], a[32:35], a[16:19], v[104:107]
  v_mfma_f32_16x16x32_bf16 v[168:171], a[32:35], a[20:23], v[168:171]
  v_mfma_f32_16x16x32_bf16 v[44:47], a[36:39], a[12:15], v[44:47]
  v_mfma_f32_16x16x32_bf16 v[108:111], a[36:39], a[16:19], v[108:111]
  v_mfma_f32_16x16x32_bf16 v[172:175], a[36:39], a[20:23], v[172:175]
  s_waitcnt lgkmcnt(0)
  s_barrier
  v_mfma_f32_16x16x32_bf16 v[48:51], a[56:59], a[12:15], v[48:51]
  ds_read_b128 a[0:3], v206 offset:10240
  ds_read_b128 a[4:7], v206 offset:11264
  v_mfma_f32_16x16x32_bf16 v[112:115], a[56:59], a[16:19], v[112:115]
  ds_read_b128 a[8:11], v206 offset:12288
  ds_read_b64_tr_b16 a[24:25], v192 offset:0
  v_mfma_f32_16x16x32_bf16 v[176:179], a[56:59], a[20:23], v[176:179]
  ds_read_b64_tr_b16 a[26:27], v192 offset:1024
  ds_read_b64_tr_b16 a[28:29], v192 offset:8
  v_mfma_f32_16x16x32_bf16 v[52:55], a[60:63], a[12:15], v[52:55]
  ds_read_b64_tr_b16 a[30:31], v192 offset:1032
  ds_read_b64_tr_b16 a[32:33], v193 offset:0
  v_mfma_f32_16x16x32_bf16 v[116:119], a[60:63], a[16:19], v[116:119]
  ds_read_b64_tr_b16 a[34:35], v193 offset:1024
  ds_read_b64_tr_b16 a[36:37], v193 offset:8
  v_mfma_f32_16x16x32_bf16 v[180:183], a[60:63], a[20:23], v[180:183]
  ds_read_b64_tr_b16 a[38:39], v193 offset:1032
  ds_read_b64_tr_b16 a[40:41], v194 offset:0
  v_mfma_f32_16x16x32_bf16 v[56:59], a[64:67], a[12:15], v[56:59]
  ds_read_b64_tr_b16 a[42:43], v194 offset:1024
  ds_read_b64_tr_b16 a[44:45], v194 offset:8
  v_mfma_f32_16x16x32_bf16 v[120:123], a[64:67], a[16:19], v[120:123]
  ds_read_b64_tr_b16 a[46:47], v194 offset:1032
  ds_read_b64_tr_b16 a[48:49], v195 offset:0
  v_mfma_f32_16x16x32_bf16 v[184:187], a[64:67], a[20:23], v[184:187]
  ds_read_b64_tr_b16 a[50:51], v195 offset:1024
  ds_read_b64_tr_b16 a[52:53], v195 offset:8
  v_mfma_f32_16x16x32_bf16 v[60:63], a[68:71], a[12:15], v[60:63]
  ds_read_b64_tr_b16 a[54:55], v195 offset:1032
  v_mfma_f32_16x16x32_bf16 v[124:127], a[68:71], a[16:19], v[124:127]
  v_mfma_f32_16x16x32_bf16 v[188:191], a[68:71], a[20:23], v[188:191]
  s_waitcnt lgkmcnt(8)
  v_mfma_f32_16x16x32_bf16 v[0:3], a[24:27], a[0:3], v[0:3]
  v_mfma_f32_16x16x32_bf16 v[64:67], a[24:27], a[4:7], v[64:67]
  v_mfma_f32_16x16x32_bf16 v[128:131], a[24:27], a[8:11], v[128:131]
  v_mfma_f32_16x16x32_bf16 v[4:7], a[28:31], a[0:3], v[4:7]
  v_mfma_f32_16x16x32_bf16 v[68:71], a[28:31], a[4:7], v[68:71]
  v_mfma_f32_16x16x32_bf16 v[132:135], a[28:31], a[8:11], v[132:135]
  v_mfma_f32_16x16x32_bf16 v[8:11], a[32:35], a[0:3], v[8:11]
  v_mfma_f32_16x16x32_bf16 v[72:75], a[32:35], a[4:7], v[72:75]
  v_mfma_f32_16x16x32_bf16 v[136:139], a[32:35], a[8:11], v[136:139]
  v_mfma_f32_16x16x32_bf16 v[12:15], a[36:39], a[0:3], v[12:15]
  v_mfma_f32_16x16x32_bf16 v[76:79], a[36:39], a[4:7], v[76:79]
  v_mfma_f32_16x16x32_bf16 v[140:143], a[36:39], a[8:11], v[140:143]
  s_waitcnt lgkmcnt(0)
  s_barrier
  v_mfma_f32_16x16x32_bf16 v[16:19], a[40:43], a[0:3], v[16:19]
  ds_read_b64_tr_b16 a[24:25], v192 offset:8192
  ds_read_b64_tr_b16 a[26:27], v192 offset:9216
  v_mfma_f32_16x16x32_bf16 v[80:83], a[40:43], a[4:7], v[80:83]
  ds_read_b64_tr_b16 a[28:29], v192 offset:8200
  ds_read_b64_tr_b16 a[30:31], v192 offset:9224
  v_mfma_f32_16x16x32_bf16 v[144:147], a[40:43], a[8:11], v[144:147]
  ds_read_b64_tr_b16 a[32:33], v193 offset:8192
  ds_read_b64_tr_b16 a[34:35], v193 offset:9216
  v_mfma_f32_16x16x32_bf16 v[20:23], a[44:47], a[0:3], v[20:23]
  ds_read_b64_tr_b16 a[36:37], v193 offset:8200
  ds_read_b64_tr_b16 a[38:39], v193 offset:9224
  v_mfma_f32_16x16x32_bf16 v[84:87], a[44:47], a[4:7], v[84:87]
  ds_read_b64_tr_b16 a[56:57], v194 offset:8192
  ds_read_b64_tr_b16 a[58:59], v194 offset:9216
  v_mfma_f32_16x16x32_bf16 v[148:151], a[44:47], a[8:11], v[148:151]
  ds_read_b64_tr_b16 a[60:61], v194 offset:8200
  ds_read_b64_tr_b16 a[62:63], v194 offset:9224
  v_mfma_f32_16x16x32_bf16 v[24:27], a[48:51], a[0:3], v[24:27]
  ds_read_b64_tr_b16 a[64:65], v195 offset:8192
  ds_read_b64_tr_b16 a[66:67], v195 offset:9216
  v_mfma_f32_16x16x32_bf16 v[88:91], a[48:51], a[4:7], v[88:91]
  ds_read_b64_tr_b16 a[68:69], v195 offset:8200
  ds_read_b64_tr_b16 a[70:71], v195 offset:9224
  v_mfma_f32_16x16x32_bf16 v[152:155], a[48:51], a[8:11], v[152:155]
  v_mfma_f32_16x16x32_bf16 v[28:31], a[52:55], a[0:3], v[28:31]
  v_mfma_f32_16x16x32_bf16 v[92:95], a[52:55], a[4:7], v[92:95]
  v_mfma_f32_16x16x32_bf16 v[156:159], a[52:55], a[8:11], v[156:159]
  s_waitcnt lgkmcnt(8)
  v_mfma_f32_16x16x32_bf16 v[32:35], a[24:27], a[0:3], v[32:35]
  v_mfma_f32_16x16x32_bf16 v[96:99], a[24:27], a[4:7], v[96:99]
  s_add_u32 m0, s66, 8192
  v_mfma_f32_16x16x32_bf16 v[160:163], a[24:27], a[8:11], v[160:163]
  s_mov_b32 s78, 8192
  v_mfma_f32_16x16x32_bf16 v[36:39], a[28:31], a[0:3], v[36:39]
  buffer_load_dwordx4 v236, s[8:11], s78 offen offset:0 nt lds
  v_mfma_f32_16x16x32_bf16 v[100:103], a[28:31], a[4:7], v[100:103]
  buffer_load_dwordx4 v237, s[8:11], s78 offen offset:1024 nt lds
  v_mfma_f32_16x16x32_bf16 v[164:167], a[28:31], a[8:11], v[164:167]
  buffer_load_dwordx4 v238, s[8:11], s78 offen offset:2048 nt lds
  v_mfma_f32_16x16x32_bf16 v[40:43], a[32:35], a[0:3], v[40:43]
  buffer_load_dwordx4 v239, s[8:11], s78 offen offset:3072 nt lds
  v_mfma_f32_16x16x32_bf16 v[104:107], a[32:35], a[4:7], v[104:107]
  v_mfma_f32_16x16x32_bf16 v[168:171], a[32:35], a[8:11], v[168:171]
  v_mfma_f32_16x16x32_bf16 v[44:47], a[36:39], a[0:3], v[44:47]
  v_mfma_f32_16x16x32_bf16 v[108:111], a[36:39], a[4:7], v[108:111]
  v_mfma_f32_16x16x32_bf16 v[172:175], a[36:39], a[8:11], v[172:175]
  s_waitcnt lgkmcnt(0)
  s_barrier
  v_mfma_f32_16x16x32_bf16 v[48:51], a[56:59], a[0:3], v[48:51]
  ds_read_b128 a[12:15], v206 offset:0
  ds_read_b128 a[16:19], v206 offset:1024
  v_mfma_f32_16x16x32_bf16 v[112:115], a[56:59], a[4:7], v[112:115]
  ds_read_b128 a[20:23], v206 offset:2048
  ds_read_b64_tr_b16 a[24:25], v192 offset:16384
  v_mfma_f32_16x16x32_bf16 v[176:179], a[56:59], a[8:11], v[176:179]
  ds_read_b64_tr_b16 a[26:27], v192 offset:17408
  ds_read_b64_tr_b16 a[28:29], v192 offset:16392
  v_mfma_f32_16x16x32_bf16 v[52:55], a[60:63], a[0:3], v[52:55]
  ds_read_b64_tr_b16 a[30:31], v192 offset:17416
  ds_read_b64_tr_b16 a[32:33], v193 offset:16384
  v_mfma_f32_16x16x32_bf16 v[116:119], a[60:63], a[4:7], v[116:119]
  ds_read_b64_tr_b16 a[34:35], v193 offset:17408
  ds_read_b64_tr_b16 a[36:37], v193 offset:16392
  v_mfma_f32_16x16x32_bf16 v[180:183], a[60:63], a[8:11], v[180:183]
  ds_read_b64_tr_b16 a[38:39], v193 offset:17416
  ds_read_b64_tr_b16 a[40:41], v194 offset:16384
  v_mfma_f32_16x16x32_bf16 v[56:59], a[64:67], a[0:3], v[56:59]
  ds_read_b64_tr_b16 a[42:43], v194 offset:17408
  ds_read_b64_tr_b16 a[44:45], v194 offset:16392
  v_mfma_f32_16x16x32_bf16 v[120:123], a[64:67], a[4:7], v[120:123]
  ds_read_b64_tr_b16 a[46:47], v194 offset:17416
  ds_read_b64_tr_b16 a[48:49], v195 offset:16384
  v_mfma_f32_16x16x32_bf16 v[184:187], a[64:67], a[8:11], v[184:187]
  ds_read_b64_tr_b16 a[50:51], v195 offset:17408
  ds_read_b64_tr_b16 a[52:53], v195 offset:16392
  v_mfma_f32_16x16x32_bf16 v[60:63], a[68:71], a[0:3], v[60:63]
  ds_read_b64_tr_b16 a[54:55], v195 offset:17416
  v_mfma_f32_16x16x32_bf16 v[124:127], a[68:71], a[4:7], v[124:127]
  v_mfma_f32_16x16x32_bf16 v[188:191], a[68:71], a[8:11], v[188:191]
  s_waitcnt lgkmcnt(8)
  v_mfma_f32_16x16x32_bf16 v[0:3], a[24:27], a[12:15], v[0:3]
  v_mfma_f32_16x16x32_bf16 v[64:67], a[24:27], a[16:19], v[64:67]
  v_mfma_f32_16x16x32_bf16 v[128:131], a[24:27], a[20:23], v[128:131]
  v_mfma_f32_16x16x32_bf16 v[4:7], a[28:31], a[12:15], v[4:7]
  v_mfma_f32_16x16x32_bf16 v[68:71], a[28:31], a[16:19], v[68:71]
  v_mfma_f32_16x16x32_bf16 v[132:135], a[28:31], a[20:23], v[132:135]
  v_mfma_f32_16x16x32_bf16 v[8:11], a[32:35], a[12:15], v[8:11]
  v_mfma_f32_16x16x32_bf16 v[72:75], a[32:35], a[16:19], v[72:75]
  v_mfma_f32_16x16x32_bf16 v[136:139], a[32:35], a[20:23], v[136:139]
  v_mfma_f32_16x16x32_bf16 v[12:15], a[36:39], a[12:15], v[12:15]
  v_mfma_f32_16x16x32_bf16 v[76:79], a[36:39], a[16:19], v[76:79]
  v_mfma_f32_16x16x32_bf16 v[140:143], a[36:39], a[20:23], v[140:143]
  s_waitcnt lgkmcnt(0)
  s_barrier
  v_mfma_f32_16x16x32_bf16 v[16:19], a[40:43], a[12:15], v[16:19]
  ds_read_b64_tr_b16 a[24:25], v192 offset:24576
  ds_read_b64_tr_b16 a[26:27], v192 offset:25600
  v_mfma_f32_16x16x32_bf16 v[80:83], a[40:43], a[16:19], v[80:83]
  ds_read_b64_tr_b16 a[28:29], v192 offset:24584
  ds_read_b64_tr_b16 a[30:31], v192 offset:25608
  v_mfma_f32_16x16x32_bf16 v[144:147], a[40:43], a[20:23], v[144:147]
  ds_read_b64_tr_b16 a[32:33], v193 offset:24576
  ds_read_b64_tr_b16 a[34:35], v193 offset:25600
  v_mfma_f32_16x16x32_bf16 v[20:23], a[44:47], a[12:15], v[20:23]
  ds_read_b64_tr_b16 a[36:37], v193 offset:24584
  ds_read_b64_tr_b16 a[38:39], v193 offset:25608
  v_mfma_f32_16x16x32_bf16 v[84:87], a[44:47], a[16:19], v[84:87]
  ds_read_b64_tr_b16 a[56:57], v194 offset:24576
  ds_read_b64_tr_b16 a[58:59], v194 offset:25600
  v_mfma_f32_16x16x32_bf16 v[148:151], a[44:47], a[20:23], v[148:151]
  ds_read_b64_tr_b16 a[60:61], v194 offset:24584
  ds_read_b64_tr_b16 a[62:63], v194 offset:25608
  v_mfma_f32_16x16x32_bf16 v[24:27], a[48:51], a[12:15], v[24:27]
  ds_read_b64_tr_b16 a[64:65], v195 offset:24576
  ds_read_b64_tr_b16 a[66:67], v195 offset:25600
  v_mfma_f32_16x16x32_bf16 v[88:91], a[48:51], a[16:19], v[88:91]
  ds_read_b64_tr_b16 a[68:69], v195 offset:24584
  ds_read_b64_tr_b16 a[70:71], v195 offset:25608
  v_mfma_f32_16x16x32_bf16 v[152:155], a[48:51], a[20:23], v[152:155]
  v_mfma_f32_16x16x32_bf16 v[28:31], a[52:55], a[12:15], v[28:31]
  v_mfma_f32_16x16x32_bf16 v[92:95], a[52:55], a[16:19], v[92:95]
  v_mfma_f32_16x16x32_bf16 v[156:159], a[52:55], a[20:23], v[156:159]
  s_waitcnt lgkmcnt(8)
  v_mfma_f32_16x16x32_bf16 v[32:35], a[24:27], a[12:15], v[32:35]
  v_mfma_f32_16x16x32_bf16 v[96:99], a[24:27], a[16:19], v[96:99]
  s_add_u32 m0, s66, 12288
  v_mfma_f32_16x16x32_bf16 v[160:163], a[24:27], a[20:23], v[160:163]
  s_mov_b32 s78, 12288
  v_mfma_f32_16x16x32_bf16 v[36:39], a[28:31], a[12:15], v[36:39]
  buffer_load_dwordx4 v240, s[8:11], s78 offen offset:0 nt lds
  v_mfma_f32_16x16x32_bf16 v[100:103], a[28:31], a[16:19], v[100:103]
  buffer_load_dwordx4 v241, s[8:11], s78 offen offset:1024 nt lds
  v_mfma_f32_16x16x32_bf16 v[164:167], a[28:31], a[20:23], v[164:167]
  buffer_load_dwordx4 v242, s[8:11], s78 offen offset:2048 nt lds
  v_mfma_f32_16x16x32_bf16 v[40:43], a[32:35], a[12:15], v[40:43]
  buffer_load_dwordx4 v243, s[8:11], s78 offen offset:3072 nt lds
  v_mfma_f32_16x16x32_bf16 v[104:107], a[32:35], a[16:19], v[104:107]
  v_mfma_f32_16x16x32_bf16 v[168:171], a[32:35], a[20:23], v[168:171]
  v_mfma_f32_16x16x32_bf16 v[44:47], a[36:39], a[12:15], v[44:47]
  v_mfma_f32_16x16x32_bf16 v[108:111], a[36:39], a[16:19], v[108:111]
  v_mfma_f32_16x16x32_bf16 v[172:175], a[36:39], a[20:23], v[172:175]
  s_waitcnt lgkmcnt(0)
  s_barrier
  v_mfma_f32_16x16x32_bf16 v[48:51], a[56:59], a[12:15], v[48:51]
  ds_read_b128 a[0:3], v206 offset:5120
  ds_read_b128 a[4:7], v206 offset:6144
  v_mfma_f32_16x16x32_bf16 v[112:115], a[56:59], a[16:19], v[112:115]
  ds_read_b128 a[8:11], v206 offset:7168
  ds_read_b64_tr_b16 a[24:25], v192 offset:0
  v_mfma_f32_16x16x32_bf16 v[176:179], a[56:59], a[20:23], v[176:179]
  ds_read_b64_tr_b16 a[26:27], v192 offset:1024
  ds_read_b64_tr_b16 a[28:29], v192 offset:8
  v_mfma_f32_16x16x32_bf16 v[52:55], a[60:63], a[12:15], v[52:55]
  ds_read_b64_tr_b16 a[30:31], v192 offset:1032
  ds_read_b64_tr_b16 a[32:33], v193 offset:0
  v_mfma_f32_16x16x32_bf16 v[116:119], a[60:63], a[16:19], v[116:119]
  ds_read_b64_tr_b16 a[34:35], v193 offset:1024
  ds_read_b64_tr_b16 a[36:37], v193 offset:8
  v_mfma_f32_16x16x32_bf16 v[180:183], a[60:63], a[20:23], v[180:183]
  ds_read_b64_tr_b16 a[38:39], v193 offset:1032
  ds_read_b64_tr_b16 a[40:41], v194 offset:0
  v_mfma_f32_16x16x32_bf16 v[56:59], a[64:67], a[12:15], v[56:59]
  ds_read_b64_tr_b16 a[42:43], v194 offset:1024
  ds_read_b64_tr_b16 a[44:45], v194 offset:8
  v_mfma_f32_16x16x32_bf16 v[120:123], a[64:67], a[16:19], v[120:123]
  ds_read_b64_tr_b16 a[46:47], v194 offset:1032
  ds_read_b64_tr_b16 a[48:49], v195 offset:0
  v_mfma_f32_16x16x32_bf16 v[184:187], a[64:67], a[20:23], v[184:187]
  ds_read_b64_tr_b16 a[50:51], v195 offset:1024
  ds_read_b64_tr_b16 a[52:53], v195 offset:8
  v_mfma_f32_16x16x32_bf16 v[60:63], a[68:71], a[12:15], v[60:63]
  ds_read_b64_tr_b16 a[54:55], v195 offset:1032
  v_mfma_f32_16x16x32_bf16 v[124:127], a[68:71], a[16:19], v[124:127]
  v_mfma_f32_16x16x32_bf16 v[188:191], a[68:71], a[20:23], v[188:191]
  s_waitcnt lgkmcnt(8)
  v_mfma_f32_16x16x32_bf16 v[0:3], a[24:27], a[0:3], v[0:3]
  v_mfma_f32_16x16x32_bf16 v[64:67], a[24:27], a[4:7], v[64:67]
  v_mfma_f32_16x16x32_bf16 v[128:131], a[24:27], a[8:11], v[128:131]
  v_mfma_f32_16x16x32_bf16 v[4:7], a[28:31], a[0:3], v[4:7]
  v_mfma_f32_16x16x32_bf16 v[68:71], a[28:31], a[4:7], v[68:71]
  v_mfma_f32_16x16x32_bf16 v[132:135], a[28:31], a[8:11], v[132:135]
  v_mfma_f32_16x16x32_bf16 v[8:11], a[32:35], a[0:3], v[8:11]
  v_mfma_f32_16x16x32_bf16 v[72:75], a[32:35], a[4:7], v[72:75]
  v_mfma_f32_16x16x32_bf16 v[136:139], a[32:35], a[8:11], v[136:139]
  v_mfma_f32_16x16x32_bf16 v[12:15], a[36:39], a[0:3], v[12:15]
  v_mfma_f32_16x16x32_bf16 v[76:79], a[36:39], a[4:7], v[76:79]
  v_mfma_f32_16x16x32_bf16 v[140:143], a[36:39], a[8:11], v[140:143]
  s_waitcnt lgkmcnt(0)
  s_barrier
  v_mfma_f32_16x16x32_bf16 v[16:19], a[40:43], a[0:3], v[16:19]
  ds_read_b64_tr_b16 a[24:25], v192 offset:8192
  ds_read_b64_tr_b16 a[26:27], v192 offset:9216
  v_mfma_f32_16x16x32_bf16 v[80:83], a[40:43], a[4:7], v[80:83]
  ds_read_b64_tr_b16 a[28:29], v192 offset:8200
  ds_read_b64_tr_b16 a[30:31], v192 offset:9224
  v_mfma_f32_16x16x32_bf16 v[144:147], a[40:43], a[8:11], v[144:147]
  ds_read_b64_tr_b16 a[32:33], v193 offset:8192
  ds_read_b64_tr_b16 a[34:35], v193 offset:9216
  v_mfma_f32_16x16x32_bf16 v[20:23], a[44:47], a[0:3], v[20:23]
  ds_read_b64_tr_b16 a[36:37], v193 offset:8200
  ds_read_b64_tr_b16 a[38:39], v193 offset:9224
  v_mfma_f32_16x16x32_bf16 v[84:87], a[44:47], a[4:7], v[84:87]
  ds_read_b64_tr_b16 a[56:57], v194 offset:8192
  ds_read_b64_tr_b16 a[58:59], v194 offset:9216
  v_mfma_f32_16x16x32_bf16 v[148:151], a[44:47], a[8:11], v[148:151]
  ds_read_b64_tr_b16 a[60:61], v194 offset:8200
  ds_read_b64_tr_b16 a[62:63], v194 offset:9224
  v_mfma_f32_16x16x32_bf16 v[24:27], a[48:51], a[0:3], v[24:27]
  ds_read_b64_tr_b16 a[64:65], v195 offset:8192
  ds_read_b64_tr_b16 a[66:67], v195 offset:9216
  v_mfma_f32_16x16x32_bf16 v[88:91], a[48:51], a[4:7], v[88:91]
  ds_read_b64_tr_b16 a[68:69], v195 offset:8200
  ds_read_b64_tr_b16 a[70:71], v195 offset:9224
  v_mfma_f32_16x16x32_bf16 v[152:155], a[48:51], a[8:11], v[152:155]
  v_mfma_f32_16x16x32_bf16 v[28:31], a[52:55], a[0:3], v[28:31]
  v_mfma_f32_16x16x32_bf16 v[92:95], a[52:55], a[4:7], v[92:95]
  v_mfma_f32_16x16x32_bf16 v[156:159], a[52:55], a[8:11], v[156:159]
  s_waitcnt lgkmcnt(8)
  v_mfma_f32_16x16x32_bf16 v[32:35], a[24:27], a[0:3], v[32:35]
  v_mfma_f32_16x16x32_bf16 v[96:99], a[24:27], a[4:7], v[96:99]
  s_add_u32 m0, s67, 0
  v_mfma_f32_16x16x32_bf16 v[160:163], a[24:27], a[8:11], v[160:163]
  s_mov_b32 s78, 0
  v_mfma_f32_16x16x32_bf16 v[36:39], a[28:31], a[0:3], v[36:39]
  buffer_load_dwordx4 v244, s[12:15], s78 offen offset:0 nt lds
  v_mfma_f32_16x16x32_bf16 v[100:103], a[28:31], a[4:7], v[100:103]
  buffer_load_dwordx4 v245, s[12:15], s78 offen offset:1024 nt lds
  v_mfma_f32_16x16x32_bf16 v[164:167], a[28:31], a[8:11], v[164:167]
  buffer_load_dwordx4 v246, s[12:15], s78 offen offset:2048 nt lds
  v_mfma_f32_16x16x32_bf16 v[40:43], a[32:35], a[0:3], v[40:43]
  buffer_load_dwordx4 v247, s[12:15], s78 offen offset:3072 nt lds
  v_mfma_f32_16x16x32_bf16 v[104:107], a[32:35], a[4:7], v[104:107]
  v_mfma_f32_16x16x32_bf16 v[168:171], a[32:35], a[8:11], v[168:171]
  v_mfma_f32_16x16x32_bf16 v[44:47], a[36:39], a[0:3], v[44:47]
  v_mfma_f32_16x16x32_bf16 v[108:111], a[36:39], a[4:7], v[108:111]
  v_mfma_f32_16x16x32_bf16 v[172:175], a[36:39], a[8:11], v[172:175]
  s_waitcnt lgkmcnt(0)
  s_barrier
  v_mfma_f32_16x16x32_bf16 v[48:51], a[56:59], a[0:3], v[48:51]
  ds_read_b128 a[12:15], v206 offset:10240
  ds_read_b128 a[16:19], v206 offset:11264
  v_mfma_f32_16x16x32_bf16 v[112:115], a[56:59], a[4:7], v[112:115]
  ds_read_b128 a[20:23], v206 offset:12288
  ds_read_b64_tr_b16 a[24:25], v192 offset:16384
  v_mfma_f32_16x16x32_bf16 v[176:179], a[56:59], a[8:11], v[176:179]
  ds_read_b64_tr_b16 a[26:27], v192 offset:17408
  ds_read_b64_tr_b16 a[28:29], v192 offset:16392
  v_mfma_f32_16x16x32_bf16 v[52:55], a[60:63], a[0:3], v[52:55]
  ds_read_b64_tr_b16 a[30:31], v192 offset:17416
  ds_read_b64_tr_b16 a[32:33], v193 offset:16384
  v_mfma_f32_16x16x32_bf16 v[116:119], a[60:63], a[4:7], v[116:119]
  ds_read_b64_tr_b16 a[34:35], v193 offset:17408
  ds_read_b64_tr_b16 a[36:37], v193 offset:16392
  v_mfma_f32_16x16x32_bf16 v[180:183], a[60:63], a[8:11], v[180:183]
  ds_read_b64_tr_b16 a[38:39], v193 offset:17416
  ds_read_b64_tr_b16 a[40:41], v194 offset:16384
  v_mfma_f32_16x16x32_bf16 v[56:59], a[64:67], a[0:3], v[56:59]
  ds_read_b64_tr_b16 a[42:43], v194 offset:17408
  ds_read_b64_tr_b16 a[44:45], v194 offset:16392
  v_mfma_f32_16x16x32_bf16 v[120:123], a[64:67], a[4:7], v[120:123]
  ds_read_b64_tr_b16 a[46:47], v194 offset:17416
  ds_read_b64_tr_b16 a[48:49], v195 offset:16384
  v_mfma_f32_16x16x32_bf16 v[184:187], a[64:67], a[8:11], v[184:187]
  ds_read_b64_tr_b16 a[50:51], v195 offset:17408
  ds_read_b64_tr_b16 a[52:53], v195 offset:16392
  v_mfma_f32_16x16x32_bf16 v[60:63], a[68:71], a[0:3], v[60:63]
  ds_read_b64_tr_b16 a[54:55], v195 offset:17416
  v_mfma_f32_16x16x32_bf16 v[124:127], a[68:71], a[4:7], v[124:127]
  v_mfma_f32_16x16x32_bf16 v[188:191], a[68:71], a[8:11], v[188:191]
  s_waitcnt lgkmcnt(8)
  v_mfma_f32_16x16x32_bf16 v[0:3], a[24:27], a[12:15], v[0:3]
  v_mfma_f32_16x16x32_bf16 v[64:67], a[24:27], a[16:19], v[64:67]
  v_mfma_f32_16x16x32_bf16 v[128:131], a[24:27], a[20:23], v[128:131]
  v_mfma_f32_16x16x32_bf16 v[4:7], a[28:31], a[12:15], v[4:7]
  v_mfma_f32_16x16x32_bf16 v[68:71], a[28:31], a[16:19], v[68:71]
  v_mfma_f32_16x16x32_bf16 v[132:135], a[28:31], a[20:23], v[132:135]
  v_mfma_f32_16x16x32_bf16 v[8:11], a[32:35], a[12:15], v[8:11]
  v_mfma_f32_16x16x32_bf16 v[72:75], a[32:35], a[16:19], v[72:75]
  v_mfma_f32_16x16x32_bf16 v[136:139], a[32:35], a[20:23], v[136:139]
  v_mfma_f32_16x16x32_bf16 v[12:15], a[36:39], a[12:15], v[12:15]
  v_mfma_f32_16x16x32_bf16 v[76:79], a[36:39], a[16:19], v[76:79]
  v_mfma_f32_16x16x32_bf16 v[140:143], a[36:39], a[20:23], v[140:143]
  s_waitcnt lgkmcnt(0)
  s_barrier
  v_mfma_f32_16x16x32_bf16 v[16:19], a[40:43], a[12:15], v[16:19]
  ds_read_b64_tr_b16 a[24:25], v192 offset:24576
  ds_read_b64_tr_b16 a[26:27], v192 offset:25600
  v_mfma_f32_16x16x32_bf16 v[80:83], a[40:43], a[16:19], v[80:83]
  ds_read_b64_tr_b16 a[28:29], v192 offset:24584
  ds_read_b64_tr_b16 a[30:31], v192 offset:25608
  v_mfma_f32_16x16x32_bf16 v[144:147], a[40:43], a[20:23], v[144:147]
  ds_read_b64_tr_b16 a[32:33], v193 offset:24576
  ds_read_b64_tr_b16 a[34:35], v193 offset:25600
  v_mfma_f32_16x16x32_bf16 v[20:23], a[44:47], a[12:15], v[20:23]
  ds_read_b64_tr_b16 a[36:37], v193 offset:24584
  ds_read_b64_tr_b16 a[38:39], v193 offset:25608
  v_mfma_f32_16x16x32_bf16 v[84:87], a[44:47], a[16:19], v[84:87]
  ds_read_b64_tr_b16 a[56:57], v194 offset:24576
  ds_read_b64_tr_b16 a[58:59], v194 offset:25600
  v_mfma_f32_16x16x32_bf16 v[148:151], a[44:47], a[20:23], v[148:151]
  ds_read_b64_tr_b16 a[60:61], v194 offset:24584
  ds_read_b64_tr_b16 a[62:63], v194 offset:25608
  v_mfma_f32_16x16x32_bf16 v[24:27], a[48:51], a[12:15], v[24:27]
  ds_read_b64_tr_b16 a[64:65], v195 offset:24576
  ds_read_b64_tr_b16 a[66:67], v195 offset:25600
  v_mfma_f32_16x16x32_bf16 v[88:91], a[48:51], a[16:19], v[88:91]
  ds_read_b64_tr_b16 a[68:69], v195 offset:24584
  ds_read_b64_tr_b16 a[70:71], v195 offset:25608
  v_mfma_f32_16x16x32_bf16 v[152:155], a[48:51], a[20:23], v[152:155]
  v_mfma_f32_16x16x32_bf16 v[28:31], a[52:55], a[12:15], v[28:31]
  v_mfma_f32_16x16x32_bf16 v[92:95], a[52:55], a[16:19], v[92:95]
  v_mfma_f32_16x16x32_bf16 v[156:159], a[52:55], a[20:23], v[156:159]
  s_waitcnt lgkmcnt(8)
  v_mfma_f32_16x16x32_bf16 v[32:35], a[24:27], a[12:15], v[32:35]
  v_mfma_f32_16x16x32_bf16 v[96:99], a[24:27], a[16:19], v[96:99]
  s_add_u32 m0, s67, 4096
  v_mfma_f32_16x16x32_bf16 v[160:163], a[24:27], a[20:23], v[160:163]
  s_mov_b32 s78, 4096
  v_mfma_f32_16x16x32_bf16 v[36:39], a[28:31], a[12:15], v[36:39]
  buffer_load_dwordx4 v244, s[12:15], s78 offen offset:0 nt lds
  v_mfma_f32_16x16x32_bf16 v[100:103], a[28:31], a[16:19], v[100:103]
  buffer_load_dwordx4 v245, s[12:15], s78 offen offset:1024 nt lds
  v_mfma_f32_16x16x32_bf16 v[164:167], a[28:31], a[20:23], v[164:167]
  buffer_load_dwordx4 v246, s[12:15], s78 offen offset:2048 nt lds
  v_mfma_f32_16x16x32_bf16 v[40:43], a[32:35], a[12:15], v[40:43]
  buffer_load_dwordx4 v247, s[12:15], s78 offen offset:3072 nt lds
  v_mfma_f32_16x16x32_bf16 v[104:107], a[32:35], a[16:19], v[104:107]
  v_mfma_f32_16x16x32_bf16 v[168:171], a[32:35], a[20:23], v[168:171]
  v_mfma_f32_16x16x32_bf16 v[44:47], a[36:39], a[12:15], v[44:47]
  v_mfma_f32_16x16x32_bf16 v[108:111], a[36:39], a[16:19], v[108:111]
  v_mfma_f32_16x16x32_bf16 v[172:175], a[36:39], a[20:23], v[172:175]
  s_waitcnt lgkmcnt(0)
  s_barrier
  v_mfma_f32_16x16x32_bf16 v[48:51], a[56:59], a[12:15], v[48:51]
  ds_read_b128 a[0:3], v206 offset:0
  ds_read_b128 a[4:7], v206 offset:1024
  v_mfma_f32_16x16x32_bf16 v[112:115], a[56:59], a[16:19], v[112:115]
  ds_read_b128 a[8:11], v206 offset:2048
  ds_read_b64_tr_b16 a[24:25], v192 offset:0
  v_mfma_f32_16x16x32_bf16 v[176:179], a[56:59], a[20:23], v[176:179]
  ds_read_b64_tr_b16 a[26:27], v192 offset:1024
  ds_read_b64_tr_b16 a[28:29], v192 offset:8
  v_mfma_f32_16x16x32_bf16 v[52:55], a[60:63], a[12:15], v[52:55]
  ds_read_b64_tr_b16 a[30:31], v192 offset:1032
  ds_read_b64_tr_b16 a[32:33], v193 offset:0
  v_mfma_f32_16x16x32_bf16 v[116:119], a[60:63], a[16:19], v[116:119]
  ds_read_b64_tr_b16 a[34:35], v193 offset:1024
  ds_read_b64_tr_b16 a[36:37], v193 offset:8
  v_mfma_f32_16x16x32_bf16 v[180:183], a[60:63], a[20:23], v[180:183]
  ds_read_b64_tr_b16 a[38:39], v193 offset:1032
  ds_read_b64_tr_b16 a[40:41], v194 offset:0
  v_mfma_f32_16x16x32_bf16 v[56:59], a[64:67], a[12:15], v[56:59]
  ds_read_b64_tr_b16 a[42:43], v194 offset:1024
  ds_read_b64_tr_b16 a[44:45], v194 offset:8
  v_mfma_f32_16x16x32_bf16 v[120:123], a[64:67], a[16:19], v[120:123]
  ds_read_b64_tr_b16 a[46:47], v194 offset:1032
  ds_read_b64_tr_b16 a[48:49], v195 offset:0
  v_mfma_f32_16x16x32_bf16 v[184:187], a[64:67], a[20:23], v[184:187]
  ds_read_b64_tr_b16 a[50:51], v195 offset:1024
  ds_read_b64_tr_b16 a[52:53], v195 offset:8
  v_mfma_f32_16x16x32_bf16 v[60:63], a[68:71], a[12:15], v[60:63]
  ds_read_b64_tr_b16 a[54:55], v195 offset:1032
  v_mfma_f32_16x16x32_bf16 v[124:127], a[68:71], a[16:19], v[124:127]
  v_mfma_f32_16x16x32_bf16 v[188:191], a[68:71], a[20:23], v[188:191]
  s_waitcnt lgkmcnt(8)
  v_mfma_f32_16x16x32_bf16 v[0:3], a[24:27], a[0:3], v[0:3]
  v_mfma_f32_16x16x32_bf16 v[64:67], a[24:27], a[4:7], v[64:67]
  v_mfma_f32_16x16x32_bf16 v[128:131], a[24:27], a[8:11], v[128:131]
  v_mfma_f32_16x16x32_bf16 v[4:7], a[28:31], a[0:3], v[4:7]
  v_mfma_f32_16x16x32_bf16 v[68:71], a[28:31], a[4:7], v[68:71]
  v_mfma_f32_16x16x32_bf16 v[132:135], a[28:31], a[8:11], v[132:135]
  v_mfma_f32_16x16x32_bf16 v[8:11], a[32:35], a[0:3], v[8:11]
  v_mfma_f32_16x16x32_bf16 v[72:75], a[32:35], a[4:7], v[72:75]
  v_mfma_f32_16x16x32_bf16 v[136:139], a[32:35], a[8:11], v[136:139]
  v_mfma_f32_16x16x32_bf16 v[12:15], a[36:39], a[0:3], v[12:15]
  v_mfma_f32_16x16x32_bf16 v[76:79], a[36:39], a[4:7], v[76:79]
  v_mfma_f32_16x16x32_bf16 v[140:143], a[36:39], a[8:11], v[140:143]
  s_waitcnt lgkmcnt(0)
  s_barrier
  v_mfma_f32_16x16x32_bf16 v[16:19], a[40:43], a[0:3], v[16:19]
  ds_read_b64_tr_b16 a[24:25], v192 offset:8192
  ds_read_b64_tr_b16 a[26:27], v192 offset:9216
  v_mfma_f32_16x16x32_bf16 v[80:83], a[40:43], a[4:7], v[80:83]
  ds_read_b64_tr_b16 a[28:29], v192 offset:8200
  ds_read_b64_tr_b16 a[30:31], v192 offset:9224
  v_mfma_f32_16x16x32_bf16 v[144:147], a[40:43], a[8:11], v[144:147]
  ds_read_b64_tr_b16 a[32:33], v193 offset:8192
  ds_read_b64_tr_b16 a[34:35], v193 offset:9216
  v_mfma_f32_16x16x32_bf16 v[20:23], a[44:47], a[0:3], v[20:23]
  ds_read_b64_tr_b16 a[36:37], v193 offset:8200
  ds_read_b64_tr_b16 a[38:39], v193 offset:9224
  v_mfma_f32_16x16x32_bf16 v[84:87], a[44:47], a[4:7], v[84:87]
  ds_read_b64_tr_b16 a[56:57], v194 offset:8192
  ds_read_b64_tr_b16 a[58:59], v194 offset:9216
  v_mfma_f32_16x16x32_bf16 v[148:151], a[44:47], a[8:11], v[148:151]
  ds_read_b64_tr_b16 a[60:61], v194 offset:8200
  ds_read_b64_tr_b16 a[62:63], v194 offset:9224
  v_mfma_f32_16x16x32_bf16 v[24:27], a[48:51], a[0:3], v[24:27]
  ds_read_b64_tr_b16 a[64:65], v195 offset:8192
  ds_read_b64_tr_b16 a[66:67], v195 offset:9216
  v_mfma_f32_16x16x32_bf16 v[88:91], a[48:51], a[4:7], v[88:91]
  ds_read_b64_tr_b16 a[68:69], v195 offset:8200
  ds_read_b64_tr_b16 a[70:71], v195 offset:9224
  v_mfma_f32_16x16x32_bf16 v[152:155], a[48:51], a[8:11], v[152:155]
  v_mfma_f32_16x16x32_bf16 v[28:31], a[52:55], a[0:3], v[28:31]
  v_mfma_f32_16x16x32_bf16 v[92:95], a[52:55], a[4:7], v[92:95]
  v_mfma_f32_16x16x32_bf16 v[156:159], a[52:55], a[8:11], v[156:159]
  s_waitcnt lgkmcnt(8)
  v_mfma_f32_16x16x32_bf16 v[32:35], a[24:27], a[0:3], v[32:35]
  v_mfma_f32_16x16x32_bf16 v[96:99], a[24:27], a[4:7], v[96:99]
  s_add_u32 m0, s67, 8192
  v_mfma_f32_16x16x32_bf16 v[160:163], a[24:27], a[8:11], v[160:163]
  s_mov_b32 s78, 8192
  v_mfma_f32_16x16x32_bf16 v[36:39], a[28:31], a[0:3], v[36:39]
  buffer_load_dwordx4 v244, s[12:15], s78 offen offset:0 nt lds
  v_mfma_f32_16x16x32_bf16 v[100:103], a[28:31], a[4:7], v[100:103]
  buffer_load_dwordx4 v245, s[12:15], s78 offen offset:1024 nt lds
  v_mfma_f32_16x16x32_bf16 v[164:167], a[28:31], a[8:11], v[164:167]
  buffer_load_dwordx4 v246, s[12:15], s78 offen offset:2048 nt lds
  v_mfma_f32_16x16x32_bf16 v[40:43], a[32:35], a[0:3], v[40:43]
  buffer_load_dwordx4 v247, s[12:15], s78 offen offset:3072 nt lds
  v_mfma_f32_16x16x32_bf16 v[104:107], a[32:35], a[4:7], v[104:107]
  v_mfma_f32_16x16x32_bf16 v[168:171], a[32:35], a[8:11], v[168:171]
  v_mfma_f32_16x16x32_bf16 v[44:47], a[36:39], a[0:3], v[44:47]
  v_mfma_f32_16x16x32_bf16 v[108:111], a[36:39], a[4:7], v[108:111]
  v_mfma_f32_16x16x32_bf16 v[172:175], a[36:39], a[8:11], v[172:175]
  s_waitcnt lgkmcnt(0)
  s_barrier
  v_mfma_f32_16x16x32_bf16 v[48:51], a[56:59], a[0:3], v[48:51]
  ds_read_b128 a[12:15], v206 offset:5120
  ds_read_b128 a[16:19], v206 offset:6144
  v_mfma_f32_16x16x32_bf16 v[112:115], a[56:59], a[4:7], v[112:115]
  ds_read_b128 a[20:23], v206 offset:7168
  ds_read_b64_tr_b16 a[24:25], v192 offset:16384
  v_mfma_f32_16x16x32_bf16 v[176:179], a[56:59], a[8:11], v[176:179]
  ds_read_b64_tr_b16 a[26:27], v192 offset:17408
  ds_read_b64_tr_b16 a[28:29], v192 offset:16392
  v_mfma_f32_16x16x32_bf16 v[52:55], a[60:63], a[0:3], v[52:55]
  ds_read_b64_tr_b16 a[30:31], v192 offset:17416
  ds_read_b64_tr_b16 a[32:33], v193 offset:16384
  v_mfma_f32_16x16x32_bf16 v[116:119], a[60:63], a[4:7], v[116:119]
  ds_read_b64_tr_b16 a[34:35], v193 offset:17408
  ds_read_b64_tr_b16 a[36:37], v193 offset:16392
  v_mfma_f32_16x16x32_bf16 v[180:183], a[60:63], a[8:11], v[180:183]
  ds_read_b64_tr_b16 a[38:39], v193 offset:17416
  ds_read_b64_tr_b16 a[40:41], v194 offset:16384
  v_mfma_f32_16x16x32_bf16 v[56:59], a[64:67], a[0:3], v[56:59]
  ds_read_b64_tr_b16 a[42:43], v194 offset:17408
  ds_read_b64_tr_b16 a[44:45], v194 offset:16392
  v_mfma_f32_16x16x32_bf16 v[120:123], a[64:67], a[4:7], v[120:123]
  ds_read_b64_tr_b16 a[46:47], v194 offset:17416
  ds_read_b64_tr_b16 a[48:49], v195 offset:16384
  v_mfma_f32_16x16x32_bf16 v[184:187], a[64:67], a[8:11], v[184:187]
  ds_read_b64_tr_b16 a[50:51], v195 offset:17408
  ds_read_b64_tr_b16 a[52:53], v195 offset:16392
  v_mfma_f32_16x16x32_bf16 v[60:63], a[68:71], a[0:3], v[60:63]
  ds_read_b64_tr_b16 a[54:55], v195 offset:17416
  v_mfma_f32_16x16x32_bf16 v[124:127], a[68:71], a[4:7], v[124:127]
  v_mfma_f32_16x16x32_bf16 v[188:191], a[68:71], a[8:11], v[188:191]
  s_waitcnt lgkmcnt(8)
  v_mfma_f32_16x16x32_bf16 v[0:3], a[24:27], a[12:15], v[0:3]
  v_mfma_f32_16x16x32_bf16 v[64:67], a[24:27], a[16:19], v[64:67]
  v_mfma_f32_16x16x32_bf16 v[128:131], a[24:27], a[20:23], v[128:131]
  v_mfma_f32_16x16x32_bf16 v[4:7], a[28:31], a[12:15], v[4:7]
  v_mfma_f32_16x16x32_bf16 v[68:71], a[28:31], a[16:19], v[68:71]
  v_mfma_f32_16x16x32_bf16 v[132:135], a[28:31], a[20:23], v[132:135]
  v_mfma_f32_16x16x32_bf16 v[8:11], a[32:35], a[12:15], v[8:11]
  v_mfma_f32_16x16x32_bf16 v[72:75], a[32:35], a[16:19], v[72:75]
  v_mfma_f32_16x16x32_bf16 v[136:139], a[32:35], a[20:23], v[136:139]
  v_mfma_f32_16x16x32_bf16 v[12:15], a[36:39], a[12:15], v[12:15]
  v_mfma_f32_16x16x32_bf16 v[76:79], a[36:39], a[16:19], v[76:79]
  v_mfma_f32_16x16x32_bf16 v[140:143], a[36:39], a[20:23], v[140:143]
  s_waitcnt lgkmcnt(0)
  s_barrier
  v_mfma_f32_16x16x32_bf16 v[16:19], a[40:43], a[12:15], v[16:19]
  ds_read_b64_tr_b16 a[24:25], v192 offset:24576
  ds_read_b64_tr_b16 a[26:27], v192 offset:25600
  v_mfma_f32_16x16x32_bf16 v[80:83], a[40:43], a[16:19], v[80:83]
  ds_read_b64_tr_b16 a[28:29], v192 offset:24584
  ds_read_b64_tr_b16 a[30:31], v192 offset:25608
  v_mfma_f32_16x16x32_bf16 v[144:147], a[40:43], a[20:23], v[144:147]
  ds_read_b64_tr_b16 a[32:33], v193 offset:24576
  ds_read_b64_tr_b16 a[34:35], v193 offset:25600
  v_mfma_f32_16x16x32_bf16 v[20:23], a[44:47], a[12:15], v[20:23]
  ds_read_b64_tr_b16 a[36:37], v193 offset:24584
  ds_read_b64_tr_b16 a[38:39], v193 offset:25608
  v_mfma_f32_16x16x32_bf16 v[84:87], a[44:47], a[16:19], v[84:87]
  ds_read_b64_tr_b16 a[56:57], v194 offset:24576
  ds_read_b64_tr_b16 a[58:59], v194 offset:25600
  v_mfma_f32_16x16x32_bf16 v[148:151], a[44:47], a[20:23], v[148:151]
  ds_read_b64_tr_b16 a[60:61], v194 offset:24584
  ds_read_b64_tr_b16 a[62:63], v194 offset:25608
  v_mfma_f32_16x16x32_bf16 v[24:27], a[48:51], a[12:15], v[24:27]
  ds_read_b64_tr_b16 a[64:65], v195 offset:24576
  ds_read_b64_tr_b16 a[66:67], v195 offset:25600
  v_mfma_f32_16x16x32_bf16 v[88:91], a[48:51], a[16:19], v[88:91]
  ds_read_b64_tr_b16 a[68:69], v195 offset:24584
  ds_read_b64_tr_b16 a[70:71], v195 offset:25608
  v_mfma_f32_16x16x32_bf16 v[152:155], a[48:51], a[20:23], v[152:155]
  v_mfma_f32_16x16x32_bf16 v[28:31], a[52:55], a[12:15], v[28:31]
  v_mfma_f32_16x16x32_bf16 v[92:95], a[52:55], a[16:19], v[92:95]
  v_mfma_f32_16x16x32_bf16 v[156:159], a[52:55], a[20:23], v[156:159]
  s_waitcnt lgkmcnt(8)
  v_mfma_f32_16x16x32_bf16 v[32:35], a[24:27], a[12:15], v[32:35]
  v_mfma_f32_16x16x32_bf16 v[96:99], a[24:27], a[16:19], v[96:99]
  s_add_u32 m0, s67, 12288
  v_mfma_f32_16x16x32_bf16 v[160:163], a[24:27], a[20:23], v[160:163]
  s_mov_b32 s78, 12288
  v_mfma_f32_16x16x32_bf16 v[36:39], a[28:31], a[12:15], v[36:39]
  buffer_load_dwordx4 v244, s[12:15], s78 offen offset:0 nt lds
  v_mfma_f32_16x16x32_bf16 v[100:103], a[28:31], a[16:19], v[100:103]
  buffer_load_dwordx4 v245, s[12:15], s78 offen offset:1024 nt lds
  v_mfma_f32_16x16x32_bf16 v[164:167], a[28:31], a[20:23], v[164:167]
  buffer_load_dwordx4 v246, s[12:15], s78 offen offset:2048 nt lds
  v_mfma_f32_16x16x32_bf16 v[40:43], a[32:35], a[12:15], v[40:43]
  buffer_load_dwordx4 v247, s[12:15], s78 offen offset:3072 nt lds
  v_mfma_f32_16x16x32_bf16 v[104:107], a[32:35], a[16:19], v[104:107]
  v_mfma_f32_16x16x32_bf16 v[168:171], a[32:35], a[20:23], v[168:171]
  v_mfma_f32_16x16x32_bf16 v[44:47], a[36:39], a[12:15], v[44:47]
  v_mfma_f32_16x16x32_bf16 v[108:111], a[36:39], a[16:19], v[108:111]
  v_mfma_f32_16x16x32_bf16 v[172:175], a[36:39], a[20:23], v[172:175]
  s_waitcnt lgkmcnt(0)
  s_barrier
  v_mfma_f32_16x16x32_bf16 v[48:51], a[56:59], a[12:15], v[48:51]
  ds_read_b128 a[0:3], v206 offset:10240
  ds_read_b128 a[4:7], v206 offset:11264
  v_mfma_f32_16x16x32_bf16 v[112:115], a[56:59], a[16:19], v[112:115]
  ds_read_b128 a[8:11], v206 offset:12288
  ds_read_b64_tr_b16 a[24:25], v192 offset:0
  v_mfma_f32_16x16x32_bf16 v[176:179], a[56:59], a[20:23], v[176:179]
  ds_read_b64_tr_b16 a[26:27], v192 offset:1024
  ds_read_b64_tr_b16 a[28:29], v192 offset:8
  v_mfma_f32_16x16x32_bf16 v[52:55], a[60:63], a[12:15], v[52:55]
  ds_read_b64_tr_b16 a[30:31], v192 offset:1032
  ds_read_b64_tr_b16 a[32:33], v193 offset:0
  v_mfma_f32_16x16x32_bf16 v[116:119], a[60:63], a[16:19], v[116:119]
  ds_read_b64_tr_b16 a[34:35], v193 offset:1024
  ds_read_b64_tr_b16 a[36:37], v193 offset:8
  v_mfma_f32_16x16x32_bf16 v[180:183], a[60:63], a[20:23], v[180:183]
  ds_read_b64_tr_b16 a[38:39], v193 offset:1032
  ds_read_b64_tr_b16 a[40:41], v194 offset:0
  v_mfma_f32_16x16x32_bf16 v[56:59], a[64:67], a[12:15], v[56:59]
  ds_read_b64_tr_b16 a[42:43], v194 offset:1024
  ds_read_b64_tr_b16 a[44:45], v194 offset:8
  v_mfma_f32_16x16x32_bf16 v[120:123], a[64:67], a[16:19], v[120:123]
  ds_read_b64_tr_b16 a[46:47], v194 offset:1032
  ds_read_b64_tr_b16 a[48:49], v195 offset:0
  v_mfma_f32_16x16x32_bf16 v[184:187], a[64:67], a[20:23], v[184:187]
  ds_read_b64_tr_b16 a[50:51], v195 offset:1024
  ds_read_b64_tr_b16 a[52:53], v195 offset:8
  v_mfma_f32_16x16x32_bf16 v[60:63], a[68:71], a[12:15], v[60:63]
  ds_read_b64_tr_b16 a[54:55], v195 offset:1032
  v_mfma_f32_16x16x32_bf16 v[124:127], a[68:71], a[16:19], v[124:127]
  v_mfma_f32_16x16x32_bf16 v[188:191], a[68:71], a[20:23], v[188:191]
  s_waitcnt lgkmcnt(8)
  v_mfma_f32_16x16x32_bf16 v[0:3], a[24:27], a[0:3], v[0:3]
  v_mfma_f32_16x16x32_bf16 v[64:67], a[24:27], a[4:7], v[64:67]
  v_mfma_f32_16x16x32_bf16 v[128:131], a[24:27], a[8:11], v[128:131]
  v_mfma_f32_16x16x32_bf16 v[4:7], a[28:31], a[0:3], v[4:7]
  v_mfma_f32_16x16x32_bf16 v[68:71], a[28:31], a[4:7], v[68:71]
  v_mfma_f32_16x16x32_bf16 v[132:135], a[28:31], a[8:11], v[132:135]
  v_mfma_f32_16x16x32_bf16 v[8:11], a[32:35], a[0:3], v[8:11]
  v_mfma_f32_16x16x32_bf16 v[72:75], a[32:35], a[4:7], v[72:75]
  v_mfma_f32_16x16x32_bf16 v[136:139], a[32:35], a[8:11], v[136:139]
  v_mfma_f32_16x16x32_bf16 v[12:15], a[36:39], a[0:3], v[12:15]
  v_mfma_f32_16x16x32_bf16 v[76:79], a[36:39], a[4:7], v[76:79]
  v_mfma_f32_16x16x32_bf16 v[140:143], a[36:39], a[8:11], v[140:143]
  s_waitcnt lgkmcnt(0)
  s_barrier
  v_mfma_f32_16x16x32_bf16 v[16:19], a[40:43], a[0:3], v[16:19]
  ds_read_b64_tr_b16 a[24:25], v192 offset:8192
  ds_read_b64_tr_b16 a[26:27], v192 offset:9216
  v_mfma_f32_16x16x32_bf16 v[80:83], a[40:43], a[4:7], v[80:83]
  ds_read_b64_tr_b16 a[28:29], v192 offset:8200
  ds_read_b64_tr_b16 a[30:31], v192 offset:9224
  v_mfma_f32_16x16x32_bf16 v[144:147], a[40:43], a[8:11], v[144:147]
  ds_read_b64_tr_b16 a[32:33], v193 offset:8192
  ds_read_b64_tr_b16 a[34:35], v193 offset:9216
  v_mfma_f32_16x16x32_bf16 v[20:23], a[44:47], a[0:3], v[20:23]
  ds_read_b64_tr_b16 a[36:37], v193 offset:8200
  ds_read_b64_tr_b16 a[38:39], v193 offset:9224
  v_mfma_f32_16x16x32_bf16 v[84:87], a[44:47], a[4:7], v[84:87]
  ds_read_b64_tr_b16 a[56:57], v194 offset:8192
  ds_read_b64_tr_b16 a[58:59], v194 offset:9216
  v_mfma_f32_16x16x32_bf16 v[148:151], a[44:47], a[8:11], v[148:151]
  ds_read_b64_tr_b16 a[60:61], v194 offset:8200
  ds_read_b64_tr_b16 a[62:63], v194 offset:9224
  v_mfma_f32_16x16x32_bf16 v[24:27], a[48:51], a[0:3], v[24:27]
  ds_read_b64_tr_b16 a[64:65], v195 offset:8192
  ds_read_b64_tr_b16 a[66:67], v195 offset:9216
  v_mfma_f32_16x16x32_bf16 v[88:91], a[48:51], a[4:7], v[88:91]
  ds_read_b64_tr_b16 a[68:69], v195 offset:8200
  ds_read_b64_tr_b16 a[70:71], v195 offset:9224
  v_mfma_f32_16x16x32_bf16 v[152:155], a[48:51], a[8:11], v[152:155]
  v_mfma_f32_16x16x32_bf16 v[28:31], a[52:55], a[0:3], v[28:31]
  v_mfma_f32_16x16x32_bf16 v[92:95], a[52:55], a[4:7], v[92:95]
  v_mfma_f32_16x16x32_bf16 v[156:159], a[52:55], a[8:11], v[156:159]
  s_waitcnt lgkmcnt(8)
  v_mfma_f32_16x16x32_bf16 v[32:35], a[24:27], a[0:3], v[32:35]
  v_mfma_f32_16x16x32_bf16 v[96:99], a[24:27], a[4:7], v[96:99]
  s_cmp_eq_u32 s59, 1
  s_cbranch_scc1 L_only_e0
  s_add_u32 m0, s66, 16384
  s_mov_b32 s78, 16384
  buffer_load_dwordx4 v236, s[8:11], s78 offen offset:0 nt lds
  buffer_load_dwordx4 v237, s[8:11], s78 offen offset:1024 nt lds
  buffer_load_dwordx4 v238, s[8:11], s78 offen offset:2048 nt lds
  buffer_load_dwordx4 v239, s[8:11], s78 offen offset:3072 nt lds
L_only_e0:
  v_mfma_f32_16x16x32_bf16 v[160:163], a[24:27], a[8:11], v[160:163]
  v_mfma_f32_16x16x32_bf16 v[36:39], a[28:31], a[0:3], v[36:39]
  v_mfma_f32_16x16x32_bf16 v[100:103], a[28:31], a[4:7], v[100:103]
  v_mfma_f32_16x16x32_bf16 v[164:167], a[28:31], a[8:11], v[164:167]
  v_mfma_f32_16x16x32_bf16 v[40:43], a[32:35], a[0:3], v[40:43]
  v_mfma_f32_16x16x32_bf16 v[104:107], a[32:35], a[4:7], v[104:107]
  v_mfma_f32_16x16x32_bf16 v[168:171], a[32:35], a[8:11], v[168:171]
  v_mfma_f32_16x16x32_bf16 v[44:47], a[36:39], a[0:3], v[44:47]
  v_mfma_f32_16x16x32_bf16 v[108:111], a[36:39], a[4:7], v[108:111]
  v_mfma_f32_16x16x32_bf16 v[172:175], a[36:39], a[8:11], v[172:175]
  s_waitcnt lgkmcnt(0)
  s_barrier
  v_mfma_f32_16x16x32_bf16 v[48:51], a[56:59], a[0:3], v[48:51]
  ds_read_b128 a[12:15], v206 offset:0
  ds_read_b128 a[16:19], v206 offset:1024
  v_mfma_f32_16x16x32_bf16 v[112:115], a[56:59], a[4:7], v[112:115]
  ds_read_b128 a[20:23], v206 offset:2048
  ds_read_b64_tr_b16 a[24:25], v192 offset:16384
  v_mfma_f32_16x16x32_bf16 v[176:179], a[56:59], a[8:11], v[176:179]
  ds_read_b64_tr_b16 a[26:27], v192 offset:17408
  ds_read_b64_tr_b16 a[28:29], v192 offset:16392
  v_mfma_f32_16x16x32_bf16 v[52:55], a[60:63], a[0:3], v[52:55]
  ds_read_b64_tr_b16 a[30:31], v192 offset:17416
  ds_read_b64_tr_b16 a[32:33], v193 offset:16384
  v_mfma_f32_16x16x32_bf16 v[116:119], a[60:63], a[4:7], v[116:119]
  ds_read_b64_tr_b16 a[34:35], v193 offset:17408
  ds_read_b64_tr_b16 a[36:37], v193 offset:16392
  v_mfma_f32_16x16x32_bf16 v[180:183], a[60:63], a[8:11], v[180:183]
  ds_read_b64_tr_b16 a[38:39], v193 offset:17416
  ds_read_b64_tr_b16 a[40:41], v194 offset:16384
  v_mfma_f32_16x16x32_bf16 v[56:59], a[64:67], a[0:3], v[56:59]
  ds_read_b64_tr_b16 a[42:43], v194 offset:17408
  ds_read_b64_tr_b16 a[44:45], v194 offset:16392
  v_mfma_f32_16x16x32_bf16 v[120:123], a[64:67], a[4:7], v[120:123]
  ds_read_b64_tr_b16 a[46:47], v194 offset:17416
  ds_read_b64_tr_b16 a[48:49], v195 offset:16384
  v_mfma_f32_16x16x32_bf16 v[184:187], a[64:67], a[8:11], v[184:187]
  ds_read_b64_tr_b16 a[50:51], v195 offset:17408
  ds_read_b64_tr_b16 a[52:53], v195 offset:16392
  v_mfma_f32_16x16x32_bf16 v[60:63], a[68:71], a[0:3], v[60:63]
  ds_read_b64_tr_b16 a[54:55], v195 offset:17416
  v_mfma_f32_16x16x32_bf16 v[124:127], a[68:71], a[4:7], v[124:127]
  v_mfma_f32_16x16x32_bf16 v[188:191], a[68:71], a[8:11], v[188:191]
  s_waitcnt lgkmcnt(8)
  v_mfma_f32_16x16x32_bf16 v[0:3], a[24:27], a[12:15], v[0:3]
  v_mfma_f32_16x16x32_bf16 v[64:67], a[24:27], a[16:19], v[64:67]
  v_mfma_f32_16x16x32_bf16 v[128:131], a[24:27], a[20:23], v[128:131]
  v_mfma_f32_16x16x32_bf16 v[4:7], a[28:31], a[12:15], v[4:7]
  v_mfma_f32_16x16x32_bf16 v[68:71], a[28:31], a[16:19], v[68:71]
  v_mfma_f32_16x16x32_bf16 v[132:135], a[28:31], a[20:23], v[132:135]
  v_mfma_f32_16x16x32_bf16 v[8:11], a[32:35], a[12:15], v[8:11]
  v_mfma_f32_16x16x32_bf16 v[72:75], a[32:35], a[16:19], v[72:75]
  v_mfma_f32_16x16x32_bf16 v[136:139], a[32:35], a[20:23], v[136:139]
  v_mfma_f32_16x16x32_bf16 v[12:15], a[36:39], a[12:15], v[12:15]
  v_mfma_f32_16x16x32_bf16 v[76:79], a[36:39], a[16:19], v[76:79]
  v_mfma_f32_16x16x32_bf16 v[140:143], a[36:39], a[20:23], v[140:143]
  s_waitcnt lgkmcnt(0)
  s_barrier
  v_mfma_f32_16x16x32_bf16 v[16:19], a[40:43], a[12:15], v[16:19]
  ds_read_b64_tr_b16 a[24:25], v192 offset:24576
  ds_read_b64_tr_b16 a[26:27], v192 offset:25600
  v_mfma_f32_16x16x32_bf16 v[80:83], a[40:43], a[16:19], v[80:83]
  ds_read_b64_tr_b16 a[28:29], v192 offset:24584
  ds_read_b64_tr_b16 a[30:31], v192 offset:25608
  v_mfma_f32_16x16x32_bf16 v[144:147], a[40:43], a[20:23], v[144:147]
  ds_read_b64_tr_b16 a[32:33], v193 offset:24576
  ds_read_b64_tr_b16 a[34:35], v193 offset:25600
  v_mfma_f32_16x16x32_bf16 v[20:23], a[44:47], a[12:15], v[20:23]
  ds_read_b64_tr_b16 a[36:37], v193 offset:24584
  ds_read_b64_tr_b16 a[38:39], v193 offset:25608
  v_mfma_f32_16x16x32_bf16 v[84:87], a[44:47], a[16:19], v[84:87]
  ds_read_b64_tr_b16 a[56:57], v194 offset:24576
  ds_read_b64_tr_b16 a[58:59], v194 offset:25600
  v_mfma_f32_16x16x32_bf16 v[148:151], a[44:47], a[20:23], v[148:151]
  ds_read_b64_tr_b16 a[60:61], v194 offset:24584
  ds_read_b64_tr_b16 a[62:63], v194 offset:25608
  v_mfma_f32_16x16x32_bf16 v[24:27], a[48:51], a[12:15], v[24:27]
  ds_read_b64_tr_b16 a[64:65], v195 offset:24576
  ds_read_b64_tr_b16 a[66:67], v195 offset:25600
  v_mfma_f32_16x16x32_bf16 v[88:91], a[48:51], a[16:19], v[88:91]
  ds_read_b64_tr_b16 a[68:69], v195 offset:24584
  ds_read_b64_tr_b16 a[70:71], v195 offset:25608
  v_mfma_f32_16x16x32_bf16 v[152:155], a[48:51], a[20:23], v[152:155]
  v_mfma_f32_16x16x32_bf16 v[28:31], a[52:55], a[12:15], v[28:31]
  v_mfma_f32_16x16x32_bf16 v[92:95], a[52:55], a[16:19], v[92:95]
  v_mfma_f32_16x16x32_bf16 v[156:159], a[52:55], a[20:23], v[156:159]
  s_waitcnt lgkmcnt(8)
  v_mfma_f32_16x16x32_bf16 v[32:35], a[24:27], a[12:15], v[32:35]
  v_mfma_f32_16x16x32_bf16 v[96:99], a[24:27], a[16:19], v[96:99]
  s_cmp_eq_u32 s59, 1
  s_cbranch_scc1 L_only_e1
  s_add_u32 m0, s66, 20480
  s_mov_b32 s78, 20480
  buffer_load_dwordx4 v240, s[8:11], s78 offen offset:0 nt lds
  buffer_load_dwordx4 v241, s[8:11], s78 offen offset:1024 nt lds
  buffer_load_dwordx4 v242, s[8:11], s78 offen offset:2048 nt lds
  buffer_load_dwordx4 v243, s[8:11], s78 offen offset:3072 nt lds
L_only_e1:
  v_mfma_f32_16x16x32_bf16 v[160:163], a[24:27], a[20:23], v[160:163]
  v_mfma_f32_16x16x32_bf16 v[36:39], a[28:31], a[12:15], v[36:39]
  v_mfma_f32_16x16x32_bf16 v[100:103], a[28:31], a[16:19], v[100:103]
  v_mfma_f32_16x16x32_bf16 v[164:167], a[28:31], a[20:23], v[164:167]
  v_mfma_f32_16x16x32_bf16 v[40:43], a[32:35], a[12:15], v[40:43]
  v_mfma_f32_16x16x32_bf16 v[104:107], a[32:35], a[16:19], v[104:107]
  v_mfma_f32_16x16x32_bf16 v[168:171], a[32:35], a[20:23], v[168:171]
  v_mfma_f32_16x16x32_bf16 v[44:47], a[36:39], a[12:15], v[44:47]
  v_mfma_f32_16x16x32_bf16 v[108:111], a[36:39], a[16:19], v[108:111]
  v_mfma_f32_16x16x32_bf16 v[172:175], a[36:39], a[20:23], v[172:175]
  s_waitcnt lgkmcnt(0)
  s_barrier
  v_mfma_f32_16x16x32_bf16 v[48:51], a[56:59], a[12:15], v[48:51]
  ds_read_b128 a[0:3], v206 offset:5120
  ds_read_b128 a[4:7], v206 offset:6144
  v_mfma_f32_16x16x32_bf16 v[112:115], a[56:59], a[16:19], v[112:115]
  ds_read_b128 a[8:11], v206 offset:7168
  ds_read_b64_tr_b16 a[24:25], v192 offset:0
  v_mfma_f32_16x16x32_bf16 v[176:179], a[56:59], a[20:23], v[176:179]
  ds_read_b64_tr_b16 a[26:27], v192 offset:1024
  ds_read_b64_tr_b16 a[28:29], v192 offset:8
  v_mfma_f32_16x16x32_bf16 v[52:55], a[60:63], a[12:15], v[52:55]
  ds_read_b64_tr_b16 a[30:31], v192 offset:1032
  ds_read_b64_tr_b16 a[32:33], v193 offset:0
  v_mfma_f32_16x16x32_bf16 v[116:119], a[60:63], a[16:19], v[116:119]
  ds_read_b64_tr_b16 a[34:35], v193 offset:1024
  ds_read_b64_tr_b16 a[36:37], v193 offset:8
  v_mfma_f32_16x16x32_bf16 v[180:183], a[60:63], a[20:23], v[180:183]
  ds_read_b64_tr_b16 a[38:39], v193 offset:1032
  ds_read_b64_tr_b16 a[40:41], v194 offset:0
  v_mfma_f32_16x16x32_bf16 v[56:59], a[64:67], a[12:15], v[56:59]
  ds_read_b64_tr_b16 a[42:43], v194 offset:1024
  ds_read_b64_tr_b16 a[44:45], v194 offset:8
  v_mfma_f32_16x16x32_bf16 v[120:123], a[64:67], a[16:19], v[120:123]
  ds_read_b64_tr_b16 a[46:47], v194 offset:1032
  ds_read_b64_tr_b16 a[48:49], v195 offset:0
  v_mfma_f32_16x16x32_bf16 v[184:187], a[64:67], a[20:23], v[184:187]
  ds_read_b64_tr_b16 a[50:51], v195 offset:1024
  ds_read_b64_tr_b16 a[52:53], v195 offset:8
  v_mfma_f32_16x16x32_bf16 v[60:63], a[68:71], a[12:15], v[60:63]
  ds_read_b64_tr_b16 a[54:55], v195 offset:1032
  v_mfma_f32_16x16x32_bf16 v[124:127], a[68:71], a[16:19], v[124:127]
  v_mfma_f32_16x16x32_bf16 v[188:191], a[68:71], a[20:23], v[188:191]
  s_waitcnt lgkmcnt(8)
  v_mfma_f32_16x16x32_bf16 v[0:3], a[24:27], a[0:3], v[0:3]
  v_mfma_f32_16x16x32_bf16 v[64:67], a[24:27], a[4:7], v[64:67]
  v_mfma_f32_16x16x32_bf16 v[128:131], a[24:27], a[8:11], v[128:131]
  v_mfma_f32_16x16x32_bf16 v[4:7], a[28:31], a[0:3], v[4:7]
  v_mfma_f32_16x16x32_bf16 v[68:71], a[28:31], a[4:7], v[68:71]
  v_mfma_f32_16x16x32_bf16 v[132:135], a[28:31], a[8:11], v[132:135]
  v_mfma_f32_16x16x32_bf16 v[8:11], a[32:35], a[0:3], v[8:11]
  v_mfma_f32_16x16x32_bf16 v[72:75], a[32:35], a[4:7], v[72:75]
  v_mfma_f32_16x16x32_bf16 v[136:139], a[32:35], a[8:11], v[136:139]
  v_mfma_f32_16x16x32_bf16 v[12:15], a[36:39], a[0:3], v[12:15]
  v_mfma_f32_16x16x32_bf16 v[76:79], a[36:39], a[4:7], v[76:79]
  v_mfma_f32_16x16x32_bf16 v[140:143], a[36:39], a[8:11], v[140:143]
  s_waitcnt lgkmcnt(0)
  s_barrier
  v_mfma_f32_16x16x32_bf16 v[16:19], a[40:43], a[0:3], v[16:19]
  ds_read_b64_tr_b16 a[24:25], v192 offset:8192
  ds_read_b64_tr_b16 a[26:27], v192 offset:9216
  v_mfma_f32_16x16x32_bf16 v[80:83], a[40:43], a[4:7], v[80:83]
  ds_read_b64_tr_b16 a[28:29], v192 offset:8200
  ds_read_b64_tr_b16 a[30:31], v192 offset:9224
  v_mfma_f32_16x16x32_bf16 v[144:147], a[40:43], a[8:11], v[144:147]
  ds_read_b64_tr_b16 a[32:33], v193 offset:8192
  ds_read_b64_tr_b16 a[34:35], v193 offset:9216
  v_mfma_f32_16x16x32_bf16 v[20:23], a[44:47], a[0:3], v[20:23]
  ds_read_b64_tr_b16 a[36:37], v193 offset:8200
  ds_read_b64_tr_b16 a[38:39], v193 offset:9224
  v_mfma_f32_16x16x32_bf16 v[84:87], a[44:47], a[4:7], v[84:87]
  ds_read_b64_tr_b16 a[56:57], v194 offset:8192
  ds_read_b64_tr_b16 a[58:59], v194 offset:9216
  v_mfma_f32_16x16x32_bf16 v[148:151], a[44:47], a[8:11], v[148:151]
  ds_read_b64_tr_b16 a[60:61], v194 offset:8200
  ds_read_b64_tr_b16 a[62:63], v194 offset:9224
  v_mfma_f32_16x16x32_bf16 v[24:27], a[48:51], a[0:3], v[24:27]
  ds_read_b64_tr_b16 a[64:65], v195 offset:8192
  ds_read_b64_tr_b16 a[66:67], v195 offset:9216
  v_mfma_f32_16x16x32_bf16 v[88:91], a[48:51], a[4:7], v[88:91]
  ds_read_b64_tr_b16 a[68:69], v195 offset:8200
  ds_read_b64_tr_b16 a[70:71], v195 offset:9224
  v_mfma_f32_16x16x32_bf16 v[152:155], a[48:51], a[8:11], v[152:155]
  v_mfma_f32_16x16x32_bf16 v[28:31], a[52:55], a[0:3], v[28:31]
  v_mfma_f32_16x16x32_bf16 v[92:95], a[52:55], a[4:7], v[92:95]
  v_mfma_f32_16x16x32_bf16 v[156:159], a[52:55], a[8:11], v[156:159]
  s_waitcnt lgkmcnt(8)
  v_mfma_f32_16x16x32_bf16 v[32:35], a[24:27], a[0:3], v[32:35]
  v_mfma_f32_16x16x32_bf16 v[96:99], a[24:27], a[4:7], v[96:99]
  s_cmp_eq_u32 s59, 1
  s_cbranch_scc1 L_only_e2
  s_add_u32 m0, s66, 24576
  s_mov_b32 s78, 24576
  buffer_load_dwordx4 v236, s[8:11], s78 offen offset:0 nt lds
  buffer_load_dwordx4 v237, s[8:11], s78 offen offset:1024 nt lds
  buffer_load_dwordx4 v238, s[8:11], s78 offen offset:2048 nt lds
  buffer_load_dwordx4 v239, s[8:11], s78 offen offset:3072 nt lds
L_only_e2:
  v_mfma_f32_16x16x32_bf16 v[160:163], a[24:27], a[8:11], v[160:163]
  v_mfma_f32_16x16x32_bf16 v[36:39], a[28:31], a[0:3], v[36:39]
  v_mfma_f32_16x16x32_bf16 v[100:103], a[28:31], a[4:7], v[100:103]
  v_mfma_f32_16x16x32_bf16 v[164:167], a[28:31], a[8:11], v[164:167]
  v_mfma_f32_16x16x32_bf16 v[40:43], a[32:35], a[0:3], v[40:43]
  v_mfma_f32_16x16x32_bf16 v[104:107], a[32:35], a[4:7], v[104:107]
  v_mfma_f32_16x16x32_bf16 v[168:171], a[32:35], a[8:11], v[168:171]
  v_mfma_f32_16x16x32_bf16 v[44:47], a[36:39], a[0:3], v[44:47]
  v_mfma_f32_16x16x32_bf16 v[108:111], a[36:39], a[4:7], v[108:111]
  v_mfma_f32_16x16x32_bf16 v[172:175], a[36:39], a[8:11], v[172:175]
  s_waitcnt lgkmcnt(0)
  s_barrier
  v_mfma_f32_16x16x32_bf16 v[48:51], a[56:59], a[0:3], v[48:51]
  ds_read_b128 a[12:15], v206 offset:10240
  ds_read_b128 a[16:19], v206 offset:11264
  v_mfma_f32_16x16x32_bf16 v[112:115], a[56:59], a[4:7], v[112:115]
  ds_read_b128 a[20:23], v206 offset:12288
  ds_read_b64_tr_b16 a[24:25], v192 offset:16384
  v_mfma_f32_16x16x32_bf16 v[176:179], a[56:59], a[8:11], v[176:179]
  ds_read_b64_tr_b16 a[26:27], v192 offset:17408
  ds_read_b64_tr_b16 a[28:29], v192 offset:16392
  v_mfma_f32_16x16x32_bf16 v[52:55], a[60:63], a[0:3], v[52:55]
  ds_read_b64_tr_b16 a[30:31], v192 offset:17416
  ds_read_b64_tr_b16 a[32:33], v193 offset:16384
  v_mfma_f32_16x16x32_bf16 v[116:119], a[60:63], a[4:7], v[116:119]
  ds_read_b64_tr_b16 a[34:35], v193 offset:17408
  ds_read_b64_tr_b16 a[36:37], v193 offset:16392
  v_mfma_f32_16x16x32_bf16 v[180:183], a[60:63], a[8:11], v[180:183]
  ds_read_b64_tr_b16 a[38:39], v193 offset:17416
  ds_read_b64_tr_b16 a[40:41], v194 offset:16384
  v_mfma_f32_16x16x32_bf16 v[56:59], a[64:67], a[0:3], v[56:59]
  ds_read_b64_tr_b16 a[42:43], v194 offset:17408
  ds_read_b64_tr_b16 a[44:45], v194 offset:16392
  v_mfma_f32_16x16x32_bf16 v[120:123], a[64:67], a[4:7], v[120:123]
  ds_read_b64_tr_b16 a[46:47], v194 offset:17416
  ds_read_b64_tr_b16 a[48:49], v195 offset:16384
  v_mfma_f32_16x16x32_bf16 v[184:187], a[64:67], a[8:11], v[184:187]
  ds_read_b64_tr_b16 a[50:51], v195 offset:17408
  ds_read_b64_tr_b16 a[52:53], v195 offset:16392
  v_mfma_f32_16x16x32_bf16 v[60:63], a[68:71], a[0:3], v[60:63]
  ds_read_b64_tr_b16 a[54:55], v195 offset:17416
  v_mfma_f32_16x16x32_bf16 v[124:127], a[68:71], a[4:7], v[124:127]
  v_mfma_f32_16x16x32_bf16 v[188:191], a[68:71], a[8:11], v[188:191]
  s_waitcnt lgkmcnt(8)
  v_mfma_f32_16x16x32_bf16 v[0:3], a[24:27], a[12:15], v[0:3]
  v_mfma_f32_16x16x32_bf16 v[64:67], a[24:27], a[16:19], v[64:67]
  v_mfma_f32_16x16x32_bf16 v[128:131], a[24:27], a[20:23], v[128:131]
  v_mfma_f32_16x16x32_bf16 v[4:7], a[28:31], a[12:15], v[4:7]
  v_mfma_f32_16x16x32_bf16 v[68:71], a[28:31], a[16:19], v[68:71]
  v_mfma_f32_16x16x32_bf16 v[132:135], a[28:31], a[20:23], v[132:135]
  v_mfma_f32_16x16x32_bf16 v[8:11], a[32:35], a[12:15], v[8:11]
  v_mfma_f32_16x16x32_bf16 v[72:75], a[32:35], a[16:19], v[72:75]
  v_mfma_f32_16x16x32_bf16 v[136:139], a[32:35], a[20:23], v[136:139]
  v_mfma_f32_16x16x32_bf16 v[12:15], a[36:39], a[12:15], v[12:15]
  v_mfma_f32_16x16x32_bf16 v[76:79], a[36:39], a[16:19], v[76:79]
  v_mfma_f32_16x16x32_bf16 v[140:143], a[36:39], a[20:23], v[140:143]
  s_waitcnt lgkmcnt(0)
  s_barrier
  v_mfma_f32_16x16x32_bf16 v[16:19], a[40:43], a[12:15], v[16:19]
  ds_read_b64_tr_b16 a[24:25], v192 offset:24576
  ds_read_b64_tr_b16 a[26:27], v192 offset:25600
  v_mfma_f32_16x16x32_bf16 v[80:83], a[40:43], a[16:19], v[80:83]
  ds_read_b64_tr_b16 a[28:29], v192 offset:24584
  ds_read_b64_tr_b16 a[30:31], v192 offset:25608
  v_mfma_f32_16x16x32_bf16 v[144:147], a[40:43], a[20:23], v[144:147]
  ds_read_b64_tr_b16 a[32:33], v193 offset:24576
  ds_read_b64_tr_b16 a[34:35], v193 offset:25600
  v_mfma_f32_16x16x32_bf16 v[20:23], a[44:47], a[12:15], v[20:23]
  ds_read_b64_tr_b16 a[36:37], v193 offset:24584
  ds_read_b64_tr_b16 a[38:39], v193 offset:25608
  v_mfma_f32_16x16x32_bf16 v[84:87], a[44:47], a[16:19], v[84:87]
  ds_read_b64_tr_b16 a[56:57], v194 offset:24576
  ds_read_b64_tr_b16 a[58:59], v194 offset:25600
  v_mfma_f32_16x16x32_bf16 v[148:151], a[44:47], a[20:23], v[148:151]
  ds_read_b64_tr_b16 a[60:61], v194 offset:24584
  ds_read_b64_tr_b16 a[62:63], v194 offset:25608
  v_mfma_f32_16x16x32_bf16 v[24:27], a[48:51], a[12:15], v[24:27]
  ds_read_b64_tr_b16 a[64:65], v195 offset:24576
  ds_read_b64_tr_b16 a[66:67], v195 offset:25600
  v_mfma_f32_16x16x32_bf16 v[88:91], a[48:51], a[16:19], v[88:91]
  ds_read_b64_tr_b16 a[68:69], v195 offset:24584
  ds_read_b64_tr_b16 a[70:71], v195 offset:25608
  v_mfma_f32_16x16x32_bf16 v[152:155], a[48:51], a[20:23], v[152:155]
  v_mfma_f32_16x16x32_bf16 v[28:31], a[52:55], a[12:15], v[28:31]
  v_mfma_f32_16x16x32_bf16 v[92:95], a[52:55], a[16:19], v[92:95]
  v_mfma_f32_16x16x32_bf16 v[156:159], a[52:55], a[20:23], v[156:159]
  s_waitcnt lgkmcnt(8)
  v_mfma_f32_16x16x32_bf16 v[32:35], a[24:27], a[12:15], v[32:35]
  v_mfma_f32_16x16x32_bf16 v[96:99], a[24:27], a[16:19], v[96:99]
  s_cmp_eq_u32 s59, 1
  s_cbranch_scc1 L_only_e3
  s_add_u32 m0, s66, 28672
  s_mov_b32 s78, 28672
  buffer_load_dwordx4 v240, s[8:11], s78 offen offset:0 nt lds
  buffer_load_dwordx4 v241, s[8:11], s78 offen offset:1024 nt lds
  buffer_load_dwordx4 v242, s[8:11], s78 offen offset:2048 nt lds
  buffer_load_dwordx4 v243, s[8:11], s78 offen offset:3072 nt lds
L_only_e3:
  v_mfma_f32_16x16x32_bf16 v[160:163], a[24:27], a[20:23], v[160:163]
  v_mfma_f32_16x16x32_bf16 v[36:39], a[28:31], a[12:15], v[36:39]
  v_mfma_f32_16x16x32_bf16 v[100:103], a[28:31], a[16:19], v[100:103]
  v_mfma_f32_16x16x32_bf16 v[164:167], a[28:31], a[20:23], v[164:167]
  v_mfma_f32_16x16x32_bf16 v[40:43], a[32:35], a[12:15], v[40:43]
  v_mfma_f32_16x16x32_bf16 v[104:107], a[32:35], a[16:19], v[104:107]
  v_mfma_f32_16x16x32_bf16 v[168:171], a[32:35], a[20:23], v[168:171]
  v_mfma_f32_16x16x32_bf16 v[44:47], a[36:39], a[12:15], v[44:47]
  v_mfma_f32_16x16x32_bf16 v[108:111], a[36:39], a[16:19], v[108:111]
  v_mfma_f32_16x16x32_bf16 v[172:175], a[36:39], a[20:23], v[172:175]
  s_waitcnt lgkmcnt(0)
  s_barrier
  v_mfma_f32_16x16x32_bf16 v[48:51], a[56:59], a[12:15], v[48:51]
  ds_read_b128 a[0:3], v206 offset:0
  ds_read_b128 a[4:7], v206 offset:1024
  v_mfma_f32_16x16x32_bf16 v[112:115], a[56:59], a[16:19], v[112:115]
  ds_read_b128 a[8:11], v206 offset:2048
  ds_read_b64_tr_b16 a[24:25], v192 offset:0
  v_mfma_f32_16x16x32_bf16 v[176:179], a[56:59], a[20:23], v[176:179]
  ds_read_b64_tr_b16 a[26:27], v192 offset:1024
  ds_read_b64_tr_b16 a[28:29], v192 offset:8
  v_mfma_f32_16x16x32_bf16 v[52:55], a[60:63], a[12:15], v[52:55]
  ds_read_b64_tr_b16 a[30:31], v192 offset:1032
  ds_read_b64_tr_b16 a[32:33], v193 offset:0
  v_mfma_f32_16x16x32_bf16 v[116:119], a[60:63], a[16:19], v[116:119]
  ds_read_b64_tr_b16 a[34:35], v193 offset:1024
  ds_read_b64_tr_b16 a[36:37], v193 offset:8
  v_mfma_f32_16x16x32_bf16 v[180:183], a[60:63], a[20:23], v[180:183]
  ds_read_b64_tr_b16 a[38:39], v193 offset:1032
  ds_read_b64_tr_b16 a[40:41], v194 offset:0
  v_mfma_f32_16x16x32_bf16 v[56:59], a[64:67], a[12:15], v[56:59]
  ds_read_b64_tr_b16 a[42:43], v194 offset:1024
  ds_read_b64_tr_b16 a[44:45], v194 offset:8
  v_mfma_f32_16x16x32_bf16 v[120:123], a[64:67], a[16:19], v[120:123]
  ds_read_b64_tr_b16 a[46:47], v194 offset:1032
  ds_read_b64_tr_b16 a[48:49], v195 offset:0
  v_mfma_f32_16x16x32_bf16 v[184:187], a[64:67], a[20:23], v[184:187]
  ds_read_b64_tr_b16 a[50:51], v195 offset:1024
  ds_read_b64_tr_b16 a[52:53], v195 offset:8
  v_mfma_f32_16x16x32_bf16 v[60:63], a[68:71], a[12:15], v[60:63]
  ds_read_b64_tr_b16 a[54:55], v195 offset:1032
  v_mfma_f32_16x16x32_bf16 v[124:127], a[68:71], a[16:19], v[124:127]
  v_mfma_f32_16x16x32_bf16 v[188:191], a[68:71], a[20:23], v[188:191]
  s_waitcnt lgkmcnt(8)
  v_mfma_f32_16x16x32_bf16 v[0:3], a[24:27], a[0:3], v[0:3]
  v_mfma_f32_16x16x32_bf16 v[64:67], a[24:27], a[4:7], v[64:67]
  v_mfma_f32_16x16x32_bf16 v[128:131], a[24:27], a[8:11], v[128:131]
  v_mfma_f32_16x16x32_bf16 v[4:7], a[28:31], a[0:3], v[4:7]
  v_mfma_f32_16x16x32_bf16 v[68:71], a[28:31], a[4:7], v[68:71]
  v_mfma_f32_16x16x32_bf16 v[132:135], a[28:31], a[8:11], v[132:135]
  v_mfma_f32_16x16x32_bf16 v[8:11], a[32:35], a[0:3], v[8:11]
  v_mfma_f32_16x16x32_bf16 v[72:75], a[32:35], a[4:7], v[72:75]
  v_mfma_f32_16x16x32_bf16 v[136:139], a[32:35], a[8:11], v[136:139]
  v_mfma_f32_16x16x32_bf16 v[12:15], a[36:39], a[0:3], v[12:15]
  v_mfma_f32_16x16x32_bf16 v[76:79], a[36:39], a[4:7], v[76:79]
  v_mfma_f32_16x16x32_bf16 v[140:143], a[36:39], a[8:11], v[140:143]
  s_waitcnt lgkmcnt(0)
  s_barrier
  v_mfma_f32_16x16x32_bf16 v[16:19], a[40:43], a[0:3], v[16:19]
  ds_read_b64_tr_b16 a[24:25], v192 offset:8192
  ds_read_b64_tr_b16 a[26:27], v192 offset:9216
  v_mfma_f32_16x16x32_bf16 v[80:83], a[40:43], a[4:7], v[80:83]
  ds_read_b64_tr_b16 a[28:29], v192 offset:8200
  ds_read_b64_tr_b16 a[30:31], v192 offset:9224
  v_mfma_f32_16x16x32_bf16 v[144:147], a[40:43], a[8:11], v[144:147]
  ds_read_b64_tr_b16 a[32:33], v193 offset:8192
  ds_read_b64_tr_b16 a[34:35], v193 offset:9216
  v_mfma_f32_16x16x32_bf16 v[20:23], a[44:47], a[0:3], v[20:23]
  ds_read_b64_tr_b16 a[36:37], v193 offset:8200
  ds_read_b64_tr_b16 a[38:39], v193 offset:9224
  v_mfma_f32_16x16x32_bf16 v[84:87], a[44:47], a[4:7], v[84:87]
  ds_read_b64_tr_b16 a[56:57], v194 offset:8192
  ds_read_b64_tr_b16 a[58:59], v194 offset:9216
  v_mfma_f32_16x16x32_bf16 v[148:151], a[44:47], a[8:11], v[148:151]
  ds_read_b64_tr_b16 a[60:61], v194 offset:8200
  ds_read_b64_tr_b16 a[62:63], v194 offset:9224
  v_mfma_f32_16x16x32_bf16 v[24:27], a[48:51], a[0:3], v[24:27]
  ds_read_b64_tr_b16 a[64:65], v195 offset:8192
  ds_read_b64_tr_b16 a[66:67], v195 offset:9216
  v_mfma_f32_16x16x32_bf16 v[88:91], a[48:51], a[4:7], v[88:91]
  ds_read_b64_tr_b16 a[68:69], v195 offset:8200
  ds_read_b64_tr_b16 a[70:71], v195 offset:9224
  v_mfma_f32_16x16x32_bf16 v[152:155], a[48:51], a[8:11], v[152:155]
  v_mfma_f32_16x16x32_bf16 v[28:31], a[52:55], a[0:3], v[28:31]
  v_mfma_f32_16x16x32_bf16 v[92:95], a[52:55], a[4:7], v[92:95]
  v_mfma_f32_16x16x32_bf16 v[156:159], a[52:55], a[8:11], v[156:159]
  s_waitcnt lgkmcnt(8)
  v_mfma_f32_16x16x32_bf16 v[32:35], a[24:27], a[0:3], v[32:35]
  v_mfma_f32_16x16x32_bf16 v[96:99], a[24:27], a[4:7], v[96:99]
  v_mfma_f32_16x16x32_bf16 v[160:163], a[24:27], a[8:11], v[160:163]
  v_mfma_f32_16x16x32_bf16 v[36:39], a[28:31], a[0:3], v[36:39]
  v_mfma_f32_16x16x32_bf16 v[100:103], a[28:31], a[4:7], v[100:103]
  v_mfma_f32_16x16x32_bf16 v[164:167], a[28:31], a[8:11], v[164:167]
  v_mfma_f32_16x16x32_bf16 v[40:43], a[32:35], a[0:3], v[40:43]
  v_mfma_f32_16x16x32_bf16 v[104:107], a[32:35], a[4:7], v[104:107]
  v_mfma_f32_16x16x32_bf16 v[168:171], a[32:35], a[8:11], v[168:171]
  v_mfma_f32_16x16x32_bf16 v[44:47], a[36:39], a[0:3], v[44:47]
  v_mfma_f32_16x16x32_bf16 v[108:111], a[36:39], a[4:7], v[108:111]
  v_mfma_f32_16x16x32_bf16 v[172:175], a[36:39], a[8:11], v[172:175]
  s_waitcnt lgkmcnt(0)
  s_barrier
  v_mfma_f32_16x16x32_bf16 v[48:51], a[56:59], a[0:3], v[48:51]
  ds_read_b128 a[12:15], v206 offset:5120
  ds_read_b128 a[16:19], v206 offset:6144
  v_mfma_f32_16x16x32_bf16 v[112:115], a[56:59], a[4:7], v[112:115]
  ds_read_b128 a[20:23], v206 offset:7168
  ds_read_b64_tr_b16 a[24:25], v192 offset:16384
  v_mfma_f32_16x16x32_bf16 v[176:179], a[56:59], a[8:11], v[176:179]
  ds_read_b64_tr_b16 a[26:27], v192 offset:17408
  ds_read_b64_tr_b16 a[28:29], v192 offset:16392
  v_mfma_f32_16x16x32_bf16 v[52:55], a[60:63], a[0:3], v[52:55]
  ds_read_b64_tr_b16 a[30:31], v192 offset:17416
  ds_read_b64_tr_b16 a[32:33], v193 offset:16384
  v_mfma_f32_16x16x32_bf16 v[116:119], a[60:63], a[4:7], v[116:119]
  ds_read_b64_tr_b16 a[34:35], v193 offset:17408
  ds_read_b64_tr_b16 a[36:37], v193 offset:16392
  v_mfma_f32_16x16x32_bf16 v[180:183], a[60:63], a[8:11], v[180:183]
  ds_read_b64_tr_b16 a[38:39], v193 offset:17416
  ds_read_b64_tr_b16 a[40:41], v194 offset:16384
  v_mfma_f32_16x16x32_bf16 v[56:59], a[64:67], a[0:3], v[56:59]
  ds_read_b64_tr_b16 a[42:43], v194 offset:17408
  ds_read_b64_tr_b16 a[44:45], v194 offset:16392
  v_mfma_f32_16x16x32_bf16 v[120:123], a[64:67], a[4:7], v[120:123]
  ds_read_b64_tr_b16 a[46:47], v194 offset:17416
  ds_read_b64_tr_b16 a[48:49], v195 offset:16384
  v_mfma_f32_16x16x32_bf16 v[184:187], a[64:67], a[8:11], v[184:187]
  ds_read_b64_tr_b16 a[50:51], v195 offset:17408
  ds_read_b64_tr_b16 a[52:53], v195 offset:16392
  v_mfma_f32_16x16x32_bf16 v[60:63], a[68:71], a[0:3], v[60:63]
  ds_read_b64_tr_b16 a[54:55], v195 offset:17416
  v_mfma_f32_16x16x32_bf16 v[124:127], a[68:71], a[4:7], v[124:127]
  v_mfma_f32_16x16x32_bf16 v[188:191], a[68:71], a[8:11], v[188:191]
  s_waitcnt lgkmcnt(8)
  v_mfma_f32_16x16x32_bf16 v[0:3], a[24:27], a[12:15], v[0:3]
  v_mfma_f32_16x16x32_bf16 v[64:67], a[24:27], a[16:19], v[64:67]
  v_mfma_f32_16x16x32_bf16 v[128:131], a[24:27], a[20:23], v[128:131]
  v_mfma_f32_16x16x32_bf16 v[4:7], a[28:31], a[12:15], v[4:7]
  v_mfma_f32_16x16x32_bf16 v[68:71], a[28:31], a[16:19], v[68:71]
  v_mfma_f32_16x16x32_bf16 v[132:135], a[28:31], a[20:23], v[132:135]
  v_mfma_f32_16x16x32_bf16 v[8:11], a[32:35], a[12:15], v[8:11]
  v_mfma_f32_16x16x32_bf16 v[72:75], a[32:35], a[16:19], v[72:75]
  v_mfma_f32_16x16x32_bf16 v[136:139], a[32:35], a[20:23], v[136:139]
  v_mfma_f32_16x16x32_bf16 v[12:15], a[36:39], a[12:15], v[12:15]
  v_mfma_f32_16x16x32_bf16 v[76:79], a[36:39], a[16:19], v[76:79]
  v_mfma_f32_16x16x32_bf16 v[140:143], a[36:39], a[20:23], v[140:143]
  s_waitcnt lgkmcnt(0)
  s_barrier
  v_mfma_f32_16x16x32_bf16 v[16:19], a[40:43], a[12:15], v[16:19]
  ds_read_b64_tr_b16 a[24:25], v192 offset:24576
  ds_read_b64_tr_b16 a[26:27], v192 offset:25600
  v_mfma_f32_16x16x32_bf16 v[80:83], a[40:43], a[16:19], v[80:83]
  ds_read_b64_tr_b16 a[28:29], v192 offset:24584
  ds_read_b64_tr_b16 a[30:31], v192 offset:25608
  v_mfma_f32_16x16x32_bf16 v[144:147], a[40:43], a[20:23], v[144:147]
  ds_read_b64_tr_b16 a[32:33], v193 offset:24576
  ds_read_b64_tr_b16 a[34:35], v193 offset:25600
  v_mfma_f32_16x16x32_bf16 v[20:23], a[44:47], a[12:15], v[20:23]
  ds_read_b64_tr_b16 a[36:37], v193 offset:24584
  ds_read_b64_tr_b16 a[38:39], v193 offset:25608
  v_mfma_f32_16x16x32_bf16 v[84:87], a[44:47], a[16:19], v[84:87]
  ds_read_b64_tr_b16 a[56:57], v194 offset:24576
  ds_read_b64_tr_b16 a[58:59], v194 offset:25600
  v_mfma_f32_16x16x32_bf16 v[148:151], a[44:47], a[20:23], v[148:151]
  ds_read_b64_tr_b16 a[60:61], v194 offset:24584
  ds_read_b64_tr_b16 a[62:63], v194 offset:25608
  v_mfma_f32_16x16x32_bf16 v[24:27], a[48:51], a[12:15], v[24:27]
  ds_read_b64_tr_b16 a[64:65], v195 offset:24576
  ds_read_b64_tr_b16 a[66:67], v195 offset:25600
  v_mfma_f32_16x16x32_bf16 v[88:91], a[48:51], a[16:19], v[88:91]
  ds_read_b64_tr_b16 a[68:69], v195 offset:24584
  ds_read_b64_tr_b16 a[70:71], v195 offset:25608
  v_mfma_f32_16x16x32_bf16 v[152:155], a[48:51], a[20:23], v[152:155]
  v_mfma_f32_16x16x32_bf16 v[28:31], a[52:55], a[12:15], v[28:31]
  v_mfma_f32_16x16x32_bf16 v[92:95], a[52:55], a[16:19], v[92:95]
  v_mfma_f32_16x16x32_bf16 v[156:159], a[52:55], a[20:23], v[156:159]
  s_waitcnt lgkmcnt(8)
  v_mfma_f32_16x16x32_bf16 v[32:35], a[24:27], a[12:15], v[32:35]
  v_mfma_f32_16x16x32_bf16 v[96:99], a[24:27], a[16:19], v[96:99]
  s_cmp_eq_u32 s59, 0
  s_cbranch_scc1 L_only_l0
  s_add_u32 m0, s66, 16384
  s_mov_b32 s78, 16384
  buffer_load_dwordx4 v236, s[8:11], s78 offen offset:0 nt lds
  buffer_load_dwordx4 v237, s[8:11], s78 offen offset:1024 nt lds
  buffer_load_dwordx4 v238, s[8:11], s78 offen offset:2048 nt lds
  buffer_load_dwordx4 v239, s[8:11], s78 offen offset:3072 nt lds
L_only_l0:
  v_mfma_f32_16x16x32_bf16 v[160:163], a[24:27], a[20:23], v[160:163]
  s_cmp_eq_u32 s59, 0
  s_cbranch_scc1 L_only_l1
  s_add_u32 m0, s66, 20480
  s_mov_b32 s78, 20480
  buffer_load_dwordx4 v240, s[8:11], s78 offen offset:0 nt lds
  buffer_load_dwordx4 v241, s[8:11], s78 offen offset:1024 nt lds
  buffer_load_dwordx4 v242, s[8:11], s78 offen offset:2048 nt lds
  buffer_load_dwordx4 v243, s[8:11], s78 offen offset:3072 nt lds
L_only_l1:
  v_mfma_f32_16x16x32_bf16 v[36:39], a[28:31], a[12:15], v[36:39]
  s_cmp_eq_u32 s59, 0
  s_cbranch_scc1 L_only_l2
  s_add_u32 m0, s66, 24576
  s_mov_b32 s78, 24576
  buffer_load_dwordx4 v236, s[8:11], s78 offen offset:0 nt lds
  buffer_load_dwordx4 v237, s[8:11], s78 offen offset:1024 nt lds
  buffer_load_dwordx4 v238, s[8:11], s78 offen offset:2048 nt lds
  buffer_load_dwordx4 v239, s[8:11], s78 offen offset:3072 nt lds
L_only_l2:
  v_mfma_f32_16x16x32_bf16 v[100:103], a[28:31], a[16:19], v[100:103]
  s_cmp_eq_u32 s59, 0
  s_cbranch_scc1 L_only_l3
  s_add_u32 m0, s66, 28672
  s_mov_b32 s78, 28672
  buffer_load_dwordx4 v240, s[8:11], s78 offen offset:0 nt lds
  buffer_load_dwordx4 v241, s[8:11], s78 offen offset:1024 nt lds
  buffer_load_dwordx4 v242, s[8:11], s78 offen offset:2048 nt lds
  buffer_load_dwordx4 v243, s[8:11], s78 offen offset:3072 nt lds
L_only_l3:
  v_mfma_f32_16x16x32_bf16 v[164:167], a[28:31], a[20:23], v[164:167]
  v_mfma_f32_16x16x32_bf16 v[40:43], a[32:35], a[12:15], v[40:43]
  v_mfma_f32_16x16x32_bf16 v[104:107], a[32:35], a[16:19], v[104:107]
  v_mfma_f32_16x16x32_bf16 v[168:171], a[32:35], a[20:23], v[168:171]
  v_mfma_f32_16x16x32_bf16 v[44:47], a[36:39], a[12:15], v[44:47]
  v_mfma_f32_16x16x32_bf16 v[108:111], a[36:39], a[16:19], v[108:111]
  v_mfma_f32_16x16x32_bf16 v[172:175], a[36:39], a[20:23], v[172:175]
  s_waitcnt lgkmcnt(0)
  v_mfma_f32_16x16x32_bf16 v[48:51], a[56:59], a[12:15], v[48:51]
  v_mfma_f32_16x16x32_bf16 v[112:115], a[56:59], a[16:19], v[112:115]
  v_mfma_f32_16x16x32_bf16 v[176:179], a[56:59], a[20:23], v[176:179]
  v_mfma_f32_16x16x32_bf16 v[52:55], a[60:63], a[12:15], v[52:55]
  v_mfma_f32_16x16x32_bf16 v[116:119], a[60:63], a[16:19], v[116:119]
  v_mfma_f32_16x16x32_bf16 v[180:183], a[60:63], a[20:23], v[180:183]
  v_mfma_f32_16x16x32_bf16 v[56:59], a[64:67], a[12:15], v[56:59]
  v_mfma_f32_16x16x32_bf16 v[120:123], a[64:67], a[16:19], v[120:123]
  v_mfma_f32_16x16x32_bf16 v[184:187], a[64:67], a[20:23], v[184:187]
  v_mfma_f32_16x16x32_bf16 v[60:63], a[68:71], a[12:15], v[60:63]
  v_mfma_f32_16x16x32_bf16 v[124:127], a[68:71], a[16:19], v[124:127]
  v_mfma_f32_16x16x32_bf16 v[188:191], a[68:71], a[20:23], v[188:191]
  s_lshl_b32 s66, s59, 15
  s_mov_b32 s68, 32768
  s_mul_i32 s67, s59, 49152
  s_add_u32 s67, s67, 65536
  s_mov_b32 s70, 16384
  s_waitcnt vmcnt(16)
  s_barrier
  ds_read_b128 a[192:195], v224 offset:0
  ds_read_b128 a[196:199], v224 offset:8192
  ds_read_b128 a[200:203], v225 offset:0
  ds_read_b128 a[204:207], v225 offset:8192
  ds_read_b128 a[208:211], v226 offset:0
  ds_read_b128 a[212:215], v226 offset:8192
  ds_read_b128 a[216:219], v227 offset:0
  ds_read_b128 a[220:223], v227 offset:8192
  ds_read_b128 a[224:227], v224 offset:256
  ds_read_b128 a[228:231], v224 offset:8448
  ds_read_b128 a[232:235], v225 offset:256
  ds_read_b128 a[236:239], v225 offset:8448
  ds_read_b128 a[240:243], v226 offset:256
  ds_read_b128 a[244:247], v226 offset:8448
  ds_read_b128 a[248:251], v227 offset:256
  ds_read_b128 a[252:255], v227 offset:8448
  s_add_u32 m0, s67, 16384
  s_add_u32 s71, s70, 0
  buffer_load_dwordx4 v244, s[12:15], s71 offen offset:0 nt lds
  buffer_load_dwordx4 v245, s[12:15], s71 offen offset:1024 nt lds
  buffer_load_dwordx4 v246, s[12:15], s71 offen offset:2048 nt lds
  buffer_load_dwordx4 v247, s[12:15], s71 offen offset:3072 nt lds
  s_add_u32 m0, s67, 20480
  s_add_u32 s71, s70, 4096
  buffer_load_dwordx4 v244, s[12:15], s71 offen offset:0 nt lds
  buffer_load_dwordx4 v245, s[12:15], s71 offen offset:1024 nt lds
  buffer_load_dwordx4 v246, s[12:15], s71 offen offset:2048 nt lds
  buffer_load_dwordx4 v247, s[12:15], s71 offen offset:3072 nt lds
  s_add_u32 s70, s70, 16384
  v_cvt_pk_bf16_f32 v0, v0, v1
  v_cvt_pk_bf16_f32 v1, v2, v3
  v_cvt_pk_bf16_f32 v2, v4, v5
  v_cvt_pk_bf16_f32 v3, v6, v7
  v_cvt_pk_bf16_f32 v4, v8, v9
  v_cvt_pk_bf16_f32 v5, v10, v11
  v_cvt_pk_bf16_f32 v6, v12, v13
  v_cvt_pk_bf16_f32 v7, v14, v15
  v_cvt_pk_bf16_f32 v8, v16, v17
  v_cvt_pk_bf16_f32 v9, v18, v19
  v_cvt_pk_bf16_f32 v10, v20, v21
  v_cvt_pk_bf16_f32 v11, v22, v23
  v_cvt_pk_bf16_f32 v12, v24, v25
  v_cvt_pk_bf16_f32 v13, v26, v27
  v_cvt_pk_bf16_f32 v14, v28, v29
  v_cvt_pk_bf16_f32 v15, v30, v31
  v_cvt_pk_bf16_f32 v16, v32, v33
  v_cvt_pk_bf16_f32 v17, v34, v35
  v_cvt_pk_bf16_f32 v18, v36, v37
  v_cvt_pk_bf16_f32 v19, v38, v39
  v_cvt_pk_bf16_f32 v20, v40, v41
  v_cvt_pk_bf16_f32 v21, v42, v43
  v_cvt_pk_bf16_f32 v22, v44, v45
  v_cvt_pk_bf16_f32 v23, v46, v47
  v_cvt_pk_bf16_f32 v24, v48, v49
  v_cvt_pk_bf16_f32 v25, v50, v51
  v_cvt_pk_bf16_f32 v26, v52, v53
  v_cvt_pk_bf16_f32 v27, v54, v55
  v_cvt_pk_bf16_f32 v28, v56, v57
  v_cvt_pk_bf16_f32 v29, v58, v59
  v_cvt_pk_bf16_f32 v30, v60, v61
  v_cvt_pk_bf16_f32 v31, v62, v63
  v_cvt_pk_bf16_f32 v32, v64, v65
  v_cvt_pk_bf16_f32 v33, v66, v67
  v_cvt_pk_bf16_f32 v34, v68, v69
  v_cvt_pk_bf16_f32 v35, v70, v71
  v_cvt_pk_bf16_f32 v36, v72, v73
  v_cvt_pk_bf16_f32 v37, v74, v75
  v_cvt_pk_bf16_f32 v38, v76, v77
  v_cvt_pk_bf16_f32 v39, v78, v79
  v_cvt_pk_bf16_f32 v40, v80, v81
  v_cvt_pk_bf16_f32 v41, v82, v83
  v_cvt_pk_bf16_f32 v42, v84, v85
  v_cvt_pk_bf16_f32 v43, v86, v87
  v_cvt_pk_bf16_f32 v44, v88, v89
  v_cvt_pk_bf16_f32 v45, v90, v91
  v_cvt_pk_bf16_f32 v46, v92, v93
  v_cvt_pk_bf16_f32 v47, v94, v95
  v_cvt_pk_bf16_f32 v48, v96, v97
  v_cvt_pk_bf16_f32 v49, v98, v99
  v_cvt_pk_bf16_f32 v50, v100, v101
  v_cvt_pk_bf16_f32 v51, v102, v103
  v_cvt_pk_bf16_f32 v52, v104, v105
  v_cvt_pk_bf16_f32 v53, v106, v107
  v_cvt_pk_bf16_f32 v54, v108, v109
  v_cvt_pk_bf16_f32 v55, v110, v111
  v_cvt_pk_bf16_f32 v56, v112, v113
  v_cvt_pk_bf16_f32 v57, v114, v115
  v_cvt_pk_bf16_f32 v58, v116, v117
  v_cvt_pk_bf16_f32 v59, v118, v119
  v_cvt_pk_bf16_f32 v60, v120, v121
  v_cvt_pk_bf16_f32 v61, v122, v123
  v_cvt_pk_bf16_f32 v62, v124, v125
  v_cvt_pk_bf16_f32 v63, v126, v127
  v_cvt_pk_bf16_f32 v64, v128, v129
  v_cvt_pk_bf16_f32 v65, v130, v131
  v_cvt_pk_bf16_f32 v66, v132, v133
  v_cvt_pk_bf16_f32 v67, v134, v135
  v_cvt_pk_bf16_f32 v68, v136, v137
  v_cvt_pk_bf16_f32 v69, v138, v139
  v_cvt_pk_bf16_f32 v70, v140, v141
  v_cvt_pk_bf16_f32 v71, v142, v143
  v_cvt_pk_bf16_f32 v72, v144, v145
  v_cvt_pk_bf16_f32 v73, v146, v147
  v_cvt_pk_bf16_f32 v74, v148, v149
  v_cvt_pk_bf16_f32 v75, v150, v151
  v_cvt_pk_bf16_f32 v76, v152, v153
  v_cvt_pk_bf16_f32 v77, v154, v155
  v_cvt_pk_bf16_f32 v78, v156, v157
  v_cvt_pk_bf16_f32 v79, v158, v159
  v_cvt_pk_bf16_f32 v80, v160, v161
  v_cvt_pk_bf16_f32 v81, v162, v163
  v_cvt_pk_bf16_f32 v82, v164, v165
  v_cvt_pk_bf16_f32 v83, v166, v167
  v_cvt_pk_bf16_f32 v84, v168, v169
  v_cvt_pk_bf16_f32 v85, v170, v171
  v_cvt_pk_bf16_f32 v86, v172, v173
  v_cvt_pk_bf16_f32 v87, v174, v175
  v_cvt_pk_bf16_f32 v88, v176, v177
  v_cvt_pk_bf16_f32 v89, v178, v179
  v_cvt_pk_bf16_f32 v90, v180, v181
  v_cvt_pk_bf16_f32 v91, v182, v183
  v_cvt_pk_bf16_f32 v92, v184, v185
  v_cvt_pk_bf16_f32 v93, v186, v187
  v_cvt_pk_bf16_f32 v94, v188, v189
  v_cvt_pk_bf16_f32 v95, v190, v191
  s_branch L_att0
L_q1:
  s_mul_i32 s83, s59, 43008
  s_mul_i32 s84, s59, 3072
  s_lshl_b32 s82, s81, 6
  s_add_u32 s82, s82, s83
  s_add_u32 s81, s81, 1
  s_add_u32 m0, s84, 49152
  s_add_u32 s78, s82, 0
  buffer_load_dwordx4 v205, s[16:19], s78 offen lds
  s_add_u32 m0, s84, 50176
  s_add_u32 s78, s82, 14336
  buffer_load_dwordx4 v205, s[16:19], s78 offen lds
  s_cmp_eq_u32 s59, 1
  s_cbranch_scc1 L_xskip_1_0
  s_add_u32 m0, s84, 51200
  s_add_u32 s78, s82, 28672
  buffer_load_dwordx4 v205, s[16:19], s78 offen lds
L_xskip_1_0:
  s_cmp_eq_u32 s81, 14
  s_cselect_b32 s81, 0, s81
  s_lshl_b32 s88, s87, 18
  s_add_u32 m0, s86, 0
  s_add_u32 s89, s88, 0
  buffer_load_dwordx4 v200, s[20:23], s89 offen offset:0 lds
  buffer_load_dwordx4 v201, s[20:23], s89 offen offset:1024 lds
  buffer_load_dwordx4 v202, s[20:23], s89 offen offset:2048 lds
  buffer_load_dwordx4 v203, s[20:23], s89 offen offset:3072 lds
  s_add_u32 m0, s86, 4096
  s_add_u32 s89, s88, 131072
  buffer_load_dwordx4 v200, s[20:23], s89 offen offset:0 lds
  buffer_load_dwordx4 v201, s[20:23], s89 offen offset:1024 lds
  buffer_load_dwordx4 v202, s[20:23], s89 offen offset:2048 lds
  buffer_load_dwordx4 v203, s[20:23], s89 offen offset:3072 lds
  s_lshl_b32 s82, s81, 6
  s_add_u32 s82, s82, s83
  s_add_u32 s81, s81, 1
  s_add_u32 m0, s84, 54272
  s_add_u32 s78, s82, 0
  buffer_load_dwordx4 v205, s[16:19], s78 offen lds
  s_add_u32 m0, s84, 55296
  s_add_u32 s78, s82, 14336
  buffer_load_dwordx4 v205, s[16:19], s78 offen lds
  s_cmp_eq_u32 s59, 1
  s_cbranch_scc1 L_xskip_1_1
  s_add_u32 m0, s84, 56320
  s_add_u32 s78, s82, 28672
  buffer_load_dwordx4 v205, s[16:19], s78 offen lds
L_xskip_1_1:
  s_cmp_eq_u32 s81, 14
  s_cselect_b32 s81, 0, s81
  s_lshl_b32 s88, s87, 18
  s_add_u32 s88, s88, 256
  s_add_u32 s87, s87, 1
  s_add_u32 m0, s86, 8192
  s_add_u32 s89, s88, 0
  buffer_load_dwordx4 v200, s[20:23], s89 offen offset:0 lds
  buffer_load_dwordx4 v201, s[20:23], s89 offen offset:1024 lds
  buffer_load_dwordx4 v202, s[20:23], s89 offen offset:2048 lds
  buffer_load_dwordx4 v203, s[20:23], s89 offen offset:3072 lds
  s_add_u32 m0, s86, 12288
  s_add_u32 s89, s88, 131072
  buffer_load_dwordx4 v200, s[20:23], s89 offen offset:0 lds
  buffer_load_dwordx4 v201, s[20:23], s89 offen offset:1024 lds
  buffer_load_dwordx4 v202, s[20:23], s89 offen offset:2048 lds
  buffer_load_dwordx4 v203, s[20:23], s89 offen offset:3072 lds
  s_cmp_eq_u32 s87, 14
  s_cselect_b32 s87, 0, s87
  s_mul_i32 s5, s62, 458752
  s_add_u32 s24, s24, s5
  s_addc_u32 s25, s25, 0
  s_mov_b32 s26, 458752
  s_mov_b32 s27, 0x20000
  s_lshl_b32 s5, s63, 4
  s_add_u32 s79, s5, s61
  s_lshl_b32 s5, s79, 3
  s_add_u32 s5, s5, s62
  s_mul_i32 s5, s5, 71680
  s_add_u32 s28, s56, s5
  s_addc_u32 s29, s57, 0
  s_mov_b32 s30, 71680
  s_mov_b32 s31, 0x20000
  s_add_u32 s32, s56, 0x2000000
  s_addc_u32 s33, s57, 0
  s_mov_b32 s34, 32768
  s_mov_b32 s35, 0x20000
  s_lshl_b32 s5, s79, 3
  s_add_u32 s5, s5, s62
  s_lshl_b32 s5, s5, 7
  v_mov_b32 v9, s5
  v_mov_b32 v10, 0
  buffer_store_dword v10, v9, s[32:35], 0 offen sc1
  s_and_b32 s65, s61, 7
  s_mul_i32 s90, s58, 7168
  s_mov_b32 s72, 0x3db8aa3b
  s_mov_b32 s73, 0x42b17218
  s_mul_i32 s5, s59, s63
  s_lshl_b32 s6, s59, 15
  s_mul_i32 s7, s59, 49152
  v_lshlrev_b32 v1, 9, v249
  v_add_u32 v1, s6, v1
  v_and_b32 v5, 3, v249
  v_xor_b32 v5, v5, v250
  v_lshlrev_b32 v5, 4, v5
  v_add_u32 v1, v1, v5
  v_lshrrev_b32 v6, 2, v249
  v_xor_b32 v5, 0, v6
  v_lshlrev_b32 v5, 6, v5
  v_add_u32 v224, v1, v5
  v_xor_b32 v5, 1, v6
  v_lshlrev_b32 v5, 6, v5
  v_add_u32 v225, v1, v5
  v_xor_b32 v5, 2, v6
  v_lshlrev_b32 v5, 6, v5
  v_add_u32 v226, v1, v5
  v_xor_b32 v5, 3, v6
  v_lshlrev_b32 v5, 6, v5
  v_add_u32 v227, v1, v5
  v_lshlrev_b32 v1, 2, v250
  v_add_u32 v1, v1, v6
  v_and_b32 v7, 7, v1
  v_lshlrev_b32 v1, 9, v1
  v_and_b32 v8, 3, v249
  v_lshlrev_b32 v8, 3, v8
  v_add_u32 v1, v1, v8
  v_add_u32 v1, s7, v1
  v_add_u32 v1, 65536, v1
  v_xor_b32 v5, 0, v7
  v_lshlrev_b32 v5, 5, v5
  v_add_u32 v228, v1, v5
  v_xor_b32 v5, 1, v7
  v_lshlrev_b32 v5, 5, v5
  v_add_u32 v229, v1, v5
  v_xor_b32 v5, 2, v7
  v_lshlrev_b32 v5, 5, v5
  v_add_u32 v230, v1, v5
  v_xor_b32 v5, 3, v7
  v_lshlrev_b32 v5, 5, v5
  v_add_u32 v231, v1, v5
  v_xor_b32 v5, 4, v7
  v_lshlrev_b32 v5, 5, v5
  v_add_u32 v232, v1, v5
  v_xor_b32 v5, 5, v7
  v_lshlrev_b32 v5, 5, v5
  v_add_u32 v233, v1, v5
  v_xor_b32 v5, 6, v7
  v_lshlrev_b32 v5, 5, v5
  v_add_u32 v234, v1, v5
  v_xor_b32 v5, 7, v7
  v_lshlrev_b32 v5, 5, v5
  v_add_u32 v235, v1, v5
  v_lshlrev_b32 v1, 3, v250
  v_add_u32 v1, v1, v6
  v_lshlrev_b32 v1, 8, v1
  v_add_u32 v1, s86, v1
  v_and_b32 v7, 1, v250
  v_lshlrev_b32 v7, 2, v7
  v_add_u32 v7, v7, v6
  v_lshlrev_b32 v7, 1, v7
  v_and_b32 v8, 3, v249
  v_add_u32 v5, 0, v8
  v_xor_b32 v5, v5, v7
  v_lshlrev_b32 v5, 4, v5
  v_add_u32 v192, v1, v5
  v_add_u32 v5, 4, v8
  v_xor_b32 v5, v5, v7
  v_lshlrev_b32 v5, 4, v5
  v_add_u32 v193, v1, v5
  v_add_u32 v5, 8, v8
  v_xor_b32 v5, v5, v7
  v_lshlrev_b32 v5, 4, v5
  v_add_u32 v194, v1, v5
  v_add_u32 v5, 12, v8
  v_xor_b32 v5, v5, v7
  v_lshlrev_b32 v5, 4, v5
  v_add_u32 v195, v1, v5
  s_sub_u32 s5, s85, s86
  v_add_u32 v208, s5, v192
  v_add_u32 v209, s5, v193
  v_add_u32 v210, s5, v194
  v_add_u32 v211, s5, v195
  v_lshlrev_b32 v1, 6, v249
  v_lshlrev_b32 v5, 4, v250
  v_add_u32 v1, v1, v5
  s_mul_i32 s5, s60, 3072
  s_add_u32 s5, s5, 49152
  v_add_u32 v206, s5, v1
  s_waitcnt vmcnt(10)
  s_barrier
  ds_read_b128 a[0:3], v206 offset:0
  ds_read_b128 a[4:7], v206 offset:1024
  ds_read_b64_tr_b16 a[24:25], v192 offset:0
  ds_read_b64_tr_b16 a[26:27], v192 offset:1024
  ds_read_b64_tr_b16 a[28:29], v192 offset:8
  ds_read_b64_tr_b16 a[30:31], v192 offset:1032
  ds_read_b64_tr_b16 a[32:33], v193 offset:0
  ds_read_b64_tr_b16 a[34:35], v193 offset:1024
  ds_read_b64_tr_b16 a[36:37], v193 offset:8
  ds_read_b64_tr_b16 a[38:39], v193 offset:1032
  ds_read_b64_tr_b16 a[40:41], v194 offset:0
  ds_read_b64_tr_b16 a[42:43], v194 offset:1024
  ds_read_b64_tr_b16 a[44:45], v194 offset:8
  ds_read_b64_tr_b16 a[46:47], v194 offset:1032
  ds_read_b64_tr_b16 a[48:49], v195 offset:0
  ds_read_b64_tr_b16 a[50:51], v195 offset:1024
  ds_read_b64_tr_b16 a[52:53], v195 offset:8
  ds_read_b64_tr_b16 a[54:55], v195 offset:1032
  s_waitcnt lgkmcnt(8)
  v_mfma_f32_16x16x32_bf16 v[0:3], a[24:27], a[0:3], 0
  s_lshl_b32 s82, s81, 6
  s_add_u32 s82, s82, s83
  v_mfma_f32_16x16x32_bf16 v[64:67], a[24:27], a[4:7], 0
  s_add_u32 s81, s81, 1
  s_add_u32 m0, s84, 59392
  v_mfma_f32_16x16x32_bf16 v[4:7], a[28:31], a[0:3], 0
  s_add_u32 s78, s82, 0
  buffer_load_dwordx4 v205, s[16:19], s78 offen lds
  v_mfma_f32_16x16x32_bf16 v[68:71], a[28:31], a[4:7], 0
  s_add_u32 m0, s84, 60416
  s_add_u32 s78, s82, 14336
  v_mfma_f32_16x16x32_bf16 v[8:11], a[32:35], a[0:3], 0
  buffer_load_dwordx4 v205, s[16:19], s78 offen lds
  s_cmp_eq_u32 s59, 1
  s_cbranch_scc1 L_xskip_1_2
  s_add_u32 m0, s84, 61440
  s_add_u32 s78, s82, 28672
  buffer_load_dwordx4 v205, s[16:19], s78 offen lds
L_xskip_1_2:
  v_mfma_f32_16x16x32_bf16 v[72:75], a[32:35], a[4:7], 0
  s_cmp_eq_u32 s81, 14
  s_cselect_b32 s81, 0, s81
  v_mfma_f32_16x16x32_bf16 v[12:15], a[36:39], a[0:3], 0
  s_lshl_b32 s88, s87, 18
  s_add_u32 m0, s86, 16384
  v_mfma_f32_16x16x32_bf16 v[76:79], a[36:39], a[4:7], 0
  s_add_u32 s89, s88, 0
  buffer_load_dwordx4 v200, s[20:23], s89 offen offset:0 lds
  buffer_load_dwordx4 v201, s[20:23], s89 offen offset:1024 lds
  buffer_load_dwordx4 v202, s[20:23], s89 offen offset:2048 lds
  buffer_load_dwordx4 v203, s[20:23], s89 offen offset:3072 lds
  s_add_u32 m0, s86, 20480
  s_add_u32 s89, s88, 131072
  buffer_load_dwordx4 v200, s[20:23], s89 offen offset:0 lds
  buffer_load_dwordx4 v201, s[20:23], s89 offen offset:1024 lds
  buffer_load_dwordx4 v202, s[20:23], s89 offen offset:2048 lds
  buffer_load_dwordx4 v203, s[20:23], s89 offen offset:3072 lds
  s_lshl_b32 s88, s87, 18
  s_add_u32 s88, s88, 256
  s_add_u32 s87, s87, 1
  s_add_u32 m0, s86, 24576
  s_add_u32 s89, s88, 0
  buffer_load_dwordx4 v200, s[20:23], s89 offen offset:0 lds
  buffer_load_dwordx4 v201, s[20:23], s89 offen offset:1024 lds
  buffer_load_dwordx4 v202, s[20:23], s89 offen offset:2048 lds
  buffer_load_dwordx4 v203, s[20:23], s89 offen offset:3072 lds
  s_add_u32 m0, s86, 28672
  s_add_u32 s89, s88, 131072
  buffer_load_dwordx4 v200, s[20:23], s89 offen offset:0 lds
  buffer_load_dwordx4 v201, s[20:23], s89 offen offset:1024 lds
  buffer_load_dwordx4 v202, s[20:23], s89 offen offset:2048 lds
  buffer_load_dwordx4 v203, s[20:23], s89 offen offset:3072 lds
  s_cmp_eq_u32 s87, 14
  s_cselect_b32 s87, 0, s87
  s_waitcnt lgkmcnt(0)
  s_waitcnt vmcnt(18)
  s_barrier
  v_mfma_f32_16x16x32_bf16 v[16:19], a[40:43], a[0:3], 0
  ds_read_b64_tr_b16 a[24:25], v192 offset:8192
  ds_read_b64_tr_b16 a[26:27], v192 offset:9216
  v_mfma_f32_16x16x32_bf16 v[80:83], a[40:43], a[4:7], 0
  ds_read_b64_tr_b16 a[28:29], v192 offset:8200
  ds_read_b64_tr_b16 a[30:31], v192 offset:9224
  v_mfma_f32_16x16x32_bf16 v[20:23], a[44:47], a[0:3], 0
  ds_read_b64_tr_b16 a[32:33], v193 offset:8192
  ds_read_b64_tr_b16 a[34:35], v193 offset:9216
  v_mfma_f32_16x16x32_bf16 v[84:87], a[44:47], a[4:7], 0
  ds_read_b64_tr_b16 a[36:37], v193 offset:8200
  ds_read_b64_tr_b16 a[38:39], v193 offset:9224
  v_mfma_f32_16x16x32_bf16 v[24:27], a[48:51], a[0:3], 0
  ds_read_b64_tr_b16 a[56:57], v194 offset:8192
  ds_read_b64_tr_b16 a[58:59], v194 offset:9216
  v_mfma_f32_16x16x32_bf16 v[88:91], a[48:51], a[4:7], 0
  ds_read_b64_tr_b16 a[60:61], v194 offset:8200
  ds_read_b64_tr_b16 a[62:63], v194 offset:9224
  v_mfma_f32_16x16x32_bf16 v[28:31], a[52:55], a[0:3], 0
  ds_read_b64_tr_b16 a[64:65], v195 offset:8192
  ds_read_b64_tr_b16 a[66:67], v195 offset:9216
  v_mfma_f32_16x16x32_bf16 v[92:95], a[52:55], a[4:7], 0
  ds_read_b64_tr_b16 a[68:69], v195 offset:8200
  ds_read_b64_tr_b16 a[70:71], v195 offset:9224
  s_waitcnt lgkmcnt(8)
  v_mfma_f32_16x16x32_bf16 v[32:35], a[24:27], a[0:3], 0
  s_lshl_b32 s88, s87, 18
  s_add_u32 m0, s86, 0
  v_mfma_f32_16x16x32_bf16 v[96:99], a[24:27], a[4:7], 0
  s_add_u32 s89, s88, 0
  buffer_load_dwordx4 v200, s[20:23], s89 offen offset:0 lds
  v_mfma_f32_16x16x32_bf16 v[36:39], a[28:31], a[0:3], 0
  buffer_load_dwordx4 v201, s[20:23], s89 offen offset:1024 lds
  buffer_load_dwordx4 v202, s[20:23], s89 offen offset:2048 lds
  v_mfma_f32_16x16x32_bf16 v[100:103], a[28:31], a[4:7], 0
  buffer_load_dwordx4 v203, s[20:23], s89 offen offset:3072 lds
  s_add_u32 m0, s86, 4096
  v_mfma_f32_16x16x32_bf16 v[40:43], a[32:35], a[0:3], 0
  s_add_u32 s89, s88, 131072
  buffer_load_dwordx4 v200, s[20:23], s89 offen offset:0 lds
  v_mfma_f32_16x16x32_bf16 v[104:107], a[32:35], a[4:7], 0
  buffer_load_dwordx4 v201, s[20:23], s89 offen offset:1024 lds
  buffer_load_dwordx4 v202, s[20:23], s89 offen offset:2048 lds
  v_mfma_f32_16x16x32_bf16 v[44:47], a[36:39], a[0:3], 0
  buffer_load_dwordx4 v203, s[20:23], s89 offen offset:3072 lds
  v_mfma_f32_16x16x32_bf16 v[108:111], a[36:39], a[4:7], 0
  s_waitcnt lgkmcnt(0)
  s_waitcnt vmcnt(16)
  s_barrier
  v_mfma_f32_16x16x32_bf16 v[48:51], a[56:59], a[0:3], 0
  ds_read_b128 a[12:15], v206 offset:5120
  ds_read_b128 a[16:19], v206 offset:6144
  v_mfma_f32_16x16x32_bf16 v[112:115], a[56:59], a[4:7], 0
  ds_read_b64_tr_b16 a[24:25], v192 offset:16384
  ds_read_b64_tr_b16 a[26:27], v192 offset:17408
  v_mfma_f32_16x16x32_bf16 v[52:55], a[60:63], a[0:3], 0
  ds_read_b64_tr_b16 a[28:29], v192 offset:16392
  ds_read_b64_tr_b16 a[30:31], v192 offset:17416
  v_mfma_f32_16x16x32_bf16 v[116:119], a[60:63], a[4:7], 0
  ds_read_b64_tr_b16 a[32:33], v193 offset:16384
  ds_read_b64_tr_b16 a[34:35], v193 offset:17408
  v_mfma_f32_16x16x32_bf16 v[56:59], a[64:67], a[0:3], 0
  ds_read_b64_tr_b16 a[36:37], v193 offset:16392
  ds_read_b64_tr_b16 a[38:39], v193 offset:17416
  v_mfma_f32_16x16x32_bf16 v[120:123], a[64:67], a[4:7], 0
  ds_read_b64_tr_b16 a[40:41], v194 offset:16384
  ds_read_b64_tr_b16 a[42:43], v194 offset:17408
  v_mfma_f32_16x16x32_bf16 v[60:63], a[68:71], a[0:3], 0
  ds_read_b64_tr_b16 a[44:45], v194 offset:16392
  ds_read_b64_tr_b16 a[46:47], v194 offset:17416
  v_mfma_f32_16x16x32_bf16 v[124:127], a[68:71], a[4:7], 0
  ds_read_b64_tr_b16 a[48:49], v195 offset:16384
  ds_read_b64_tr_b16 a[50:51], v195 offset:17408
  ds_read_b64_tr_b16 a[52:53], v195 offset:16392
  ds_read_b64_tr_b16 a[54:55], v195 offset:17416
  s_waitcnt lgkmcnt(8)
  v_mfma_f32_16x16x32_bf16 v[0:3], a[24:27], a[12:15], v[0:3]
  s_lshl_b32 s82, s81, 6
  s_add_u32 s82, s82, s83
  v_mfma_f32_16x16x32_bf16 v[64:67], a[24:27], a[16:19], v[64:67]
  s_add_u32 s81, s81, 1
  s_add_u32 m0, s84, 49152
  v_mfma_f32_16x16x32_bf16 v[4:7], a[28:31], a[12:15], v[4:7]
  s_add_u32 s78, s82, 0
  buffer_load_dwordx4 v205, s[16:19], s78 offen lds
  v_mfma_f32_16x16x32_bf16 v[68:71], a[28:31], a[16:19], v[68:71]
  s_add_u32 m0, s84, 50176
  s_add_u32 s78, s82, 14336
  v_mfma_f32_16x16x32_bf16 v[8:11], a[32:35], a[12:15], v[8:11]
  buffer_load_dwordx4 v205, s[16:19], s78 offen lds
  s_cmp_eq_u32 s59, 1
  s_cbranch_scc1 L_xskip_1_3
  s_add_u32 m0, s84, 51200
  s_add_u32 s78, s82, 28672
  buffer_load_dwordx4 v205, s[16:19], s78 offen lds
L_xskip_1_3:
  v_mfma_f32_16x16x32_bf16 v[72:75], a[32:35], a[16:19], v[72:75]
  s_cmp_eq_u32 s81, 14
  s_cselect_b32 s81, 0, s81
  v_mfma_f32_16x16x32_bf16 v[12:15], a[36:39], a[12:15], v[12:15]
  s_lshl_b32 s88, s87, 18
  s_add_u32 s88, s88, 256
  v_mfma_f32_16x16x32_bf16 v[76:79], a[36:39], a[16:19], v[76:79]
  s_add_u32 s87, s87, 1
  s_add_u32 m0, s86, 8192
  s_add_u32 s89, s88, 0
  buffer_load_dwordx4 v200, s[20:23], s89 offen offset:0 lds
  buffer_load_dwordx4 v201, s[20:23], s89 offen offset:1024 lds
  buffer_load_dwordx4 v202, s[20:23], s89 offen offset:2048 lds
  buffer_load_dwordx4 v203, s[20:23], s89 offen offset:3072 lds
  s_add_u32 m0, s86, 12288
  s_add_u32 s89, s88, 131072
  buffer_load_dwordx4 v200, s[20:23], s89 offen offset:0 lds
  buffer_load_dwordx4 v201, s[20:23], s89 offen offset:1024 lds
  buffer_load_dwordx4 v202, s[20:23], s89 offen offset:2048 lds
  buffer_load_dwordx4 v203, s[20:23], s89 offen offset:3072 lds
  s_cmp_eq_u32 s87, 14
  s_cselect_b32 s87, 0, s87
  s_waitcnt lgkmcnt(0)
  s_waitcnt vmcnt(18)
  s_barrier
  v_mfma_f32_16x16x32_bf16 v[16:19], a[40:43], a[12:15], v[16:19]
  ds_read_b64_tr_b16 a[24:25], v192 offset:24576
  ds_read_b64_tr_b16 a[26:27], v192 offset:25600
  v_mfma_f32_16x16x32_bf16 v[80:83], a[40:43], a[16:19], v[80:83]
  ds_read_b64_tr_b16 a[28:29], v192 offset:24584
  ds_read_b64_tr_b16 a[30:31], v192 offset:25608
  v_mfma_f32_16x16x32_bf16 v[20:23], a[44:47], a[12:15], v[20:23]
  ds_read_b64_tr_b16 a[32:33], v193 offset:24576
  ds_read_b64_tr_b16 a[34:35], v193 offset:25600
  v_mfma_f32_16x16x32_bf16 v[84:87], a[44:47], a[16:19], v[84:87]
  ds_read_b64_tr_b16 a[36:37], v193 offset:24584
  ds_read_b64_tr_b16 a[38:39], v193 offset:25608
  v_mfma_f32_16x16x32_bf16 v[24:27], a[48:51], a[12:15], v[24:27]
  ds_read_b64_tr_b16 a[56:57], v194 offset:24576
  ds_read_b64_tr_b16 a[58:59], v194 offset:25600
  v_mfma_f32_16x16x32_bf16 v[88:91], a[48:51], a[16:19], v[88:91]
  ds_read_b64_tr_b16 a[60:61], v194 offset:24584
  ds_read_b64_tr_b16 a[62:63], v194 offset:25608
  v_mfma_f32_16x16x32_bf16 v[28:31], a[52:55], a[12:15], v[28:31]
  ds_read_b64_tr_b16 a[64:65], v195 offset:24576
  ds_read_b64_tr_b16 a[66:67], v195 offset:25600
  v_mfma_f32_16x16x32_bf16 v[92:95], a[52:55], a[16:19], v[92:95]
  ds_read_b64_tr_b16 a[68:69], v195 offset:24584
  ds_read_b64_tr_b16 a[70:71], v195 offset:25608
  s_waitcnt lgkmcnt(8)
  v_mfma_f32_16x16x32_bf16 v[32:35], a[24:27], a[12:15], v[32:35]
  s_lshl_b32 s88, s87, 18
  s_add_u32 m0, s86, 16384
  v_mfma_f32_16x16x32_bf16 v[96:99], a[24:27], a[16:19], v[96:99]
  s_add_u32 s89, s88, 0
  buffer_load_dwordx4 v200, s[20:23], s89 offen offset:0 lds
  v_mfma_f32_16x16x32_bf16 v[36:39], a[28:31], a[12:15], v[36:39]
  buffer_load_dwordx4 v201, s[20:23], s89 offen offset:1024 lds
  buffer_load_dwordx4 v202, s[20:23], s89 offen offset:2048 lds
  v_mfma_f32_16x16x32_bf16 v[100:103], a[28:31], a[16:19], v[100:103]
  buffer_load_dwordx4 v203, s[20:23], s89 offen offset:3072 lds
  s_add_u32 m0, s86, 20480
  v_mfma_f32_16x16x32_bf16 v[40:43], a[32:35], a[12:15], v[40:43]
  s_add_u32 s89, s88, 131072
  buffer_load_dwordx4 v200, s[20:23], s89 offen offset:0 lds
  v_mfma_f32_16x16x32_bf16 v[104:107], a[32:35], a[16:19], v[104:107]
  buffer_load_dwordx4 v201, s[20:23], s89 offen offset:1024 lds
  buffer_load_dwordx4 v202, s[20:23], s89 offen offset:2048 lds
  v_mfma_f32_16x16x32_bf16 v[44:47], a[36:39], a[12:15], v[44:47]
  buffer_load_dwordx4 v203, s[20:23], s89 offen offset:3072 lds
  v_mfma_f32_16x16x32_bf16 v[108:111], a[36:39], a[16:19], v[108:111]
  s_waitcnt lgkmcnt(0)
  s_waitcnt vmcnt(18)
  s_barrier
  v_mfma_f32_16x16x32_bf16 v[48:51], a[56:59], a[12:15], v[48:51]
  ds_read_b128 a[0:3], v206 offset:10240
  ds_read_b128 a[4:7], v206 offset:11264
  v_mfma_f32_16x16x32_bf16 v[112:115], a[56:59], a[16:19], v[112:115]
  ds_read_b64_tr_b16 a[24:25], v192 offset:0
  ds_read_b64_tr_b16 a[26:27], v192 offset:1024
  v_mfma_f32_16x16x32_bf16 v[52:55], a[60:63], a[12:15], v[52:55]
  ds_read_b64_tr_b16 a[28:29], v192 offset:8
  ds_read_b64_tr_b16 a[30:31], v192 offset:1032
  v_mfma_f32_16x16x32_bf16 v[116:119], a[60:63], a[16:19], v[116:119]
  ds_read_b64_tr_b16 a[32:33], v193 offset:0
  ds_read_b64_tr_b16 a[34:35], v193 offset:1024
  v_mfma_f32_16x16x32_bf16 v[56:59], a[64:67], a[12:15], v[56:59]
  ds_read_b64_tr_b16 a[36:37], v193 offset:8
  ds_read_b64_tr_b16 a[38:39], v193 offset:1032
  v_mfma_f32_16x16x32_bf16 v[120:123], a[64:67], a[16:19], v[120:123]
  ds_read_b64_tr_b16 a[40:41], v194 offset:0
  ds_read_b64_tr_b16 a[42:43], v194 offset:1024
  v_mfma_f32_16x16x32_bf16 v[60:63], a[68:71], a[12:15], v[60:63]
  ds_read_b64_tr_b16 a[44:45], v194 offset:8
  ds_read_b64_tr_b16 a[46:47], v194 offset:1032
  v_mfma_f32_16x16x32_bf16 v[124:127], a[68:71], a[16:19], v[124:127]
  ds_read_b64_tr_b16 a[48:49], v195 offset:0
  ds_read_b64_tr_b16 a[50:51], v195 offset:1024
  ds_read_b64_tr_b16 a[52:53], v195 offset:8
  ds_read_b64_tr_b16 a[54:55], v195 offset:1032
  s_waitcnt lgkmcnt(8)
  v_mfma_f32_16x16x32_bf16 v[0:3], a[24:27], a[0:3], v[0:3]
  s_lshl_b32 s82, s81, 6
  s_add_u32 s82, s82, s83
  v_mfma_f32_16x16x32_bf16 v[64:67], a[24:27], a[4:7], v[64:67]
  s_add_u32 s81, s81, 1
  s_add_u32 m0, s84, 54272
  v_mfma_f32_16x16x32_bf16 v[4:7], a[28:31], a[0:3], v[4:7]
  s_add_u32 s78, s82, 0
  buffer_load_dwordx4 v205, s[16:19], s78 offen lds
  v_mfma_f32_16x16x32_bf16 v[68:71], a[28:31], a[4:7], v[68:71]
  s_add_u32 m0, s84, 55296
  s_add_u32 s78, s82, 14336
  v_mfma_f32_16x16x32_bf16 v[8:11], a[32:35], a[0:3], v[8:11]
  buffer_load_dwordx4 v205, s[16:19], s78 offen lds
  s_cmp_eq_u32 s59, 1
  s_cbranch_scc1 L_xskip_1_4
  s_add_u32 m0, s84, 56320
  s_add_u32 s78, s82, 28672
  buffer_load_dwordx4 v205, s[16:19], s78 offen lds
L_xskip_1_4:
  v_mfma_f32_16x16x32_bf16 v[72:75], a[32:35], a[4:7], v[72:75]
  s_cmp_eq_u32 s81, 14
  s_cselect_b32 s81, 0, s81
  v_mfma_f32_16x16x32_bf16 v[12:15], a[36:39], a[0:3], v[12:15]
  s_lshl_b32 s88, s87, 18
  s_add_u32 s88, s88, 256
  v_mfma_f32_16x16x32_bf16 v[76:79], a[36:39], a[4:7], v[76:79]
  s_add_u32 s87, s87, 1
  s_add_u32 m0, s86, 24576
  s_add_u32 s89, s88, 0
  buffer_load_dwordx4 v200, s[20:23], s89 offen offset:0 lds
  buffer_load_dwordx4 v201, s[20:23], s89 offen offset:1024 lds
  buffer_load_dwordx4 v202, s[20:23], s89 offen offset:2048 lds
  buffer_load_dwordx4 v203, s[20:23], s89 offen offset:3072 lds
  s_add_u32 m0, s86, 28672
  s_add_u32 s89, s88, 131072
  buffer_load_dwordx4 v200, s[20:23], s89 offen offset:0 lds
  buffer_load_dwordx4 v201, s[20:23], s89 offen offset:1024 lds
  buffer_load_dwordx4 v202, s[20:23], s89 offen offset:2048 lds
  buffer_load_dwordx4 v203, s[20:23], s89 offen offset:3072 lds
  s_cmp_eq_u32 s87, 14
  s_cselect_b32 s87, 0, s87
  s_waitcnt lgkmcnt(0)
  s_waitcnt vmcnt(18)
  s_barrier
  v_mfma_f32_16x16x32_bf16 v[16:19], a[40:43], a[0:3], v[16:19]
  ds_read_b64_tr_b16 a[24:25], v192 offset:8192
  ds_read_b64_tr_b16 a[26:27], v192 offset:9216
  v_mfma_f32_16x16x32_bf16 v[80:83], a[40:43], a[4:7], v[80:83]
  ds_read_b64_tr_b16 a[28:29], v192 offset:8200
  ds_read_b64_tr_b16 a[30:31], v192 offset:9224
  v_mfma_f32_16x16x32_bf16 v[20:23], a[44:47], a[0:3], v[20:23]
  ds_read_b64_tr_b16 a[32:33], v193 offset:8192
  ds_read_b64_tr_b16 a[34:35], v193 offset:9216
  v_mfma_f32_16x16x32_bf16 v[84:87], a[44:47], a[4:7], v[84:87]
  ds_read_b64_tr_b16 a[36:37], v193 offset:8200
  ds_read_b64_tr_b16 a[38:39], v193 offset:9224
  v_mfma_f32_16x16x32_bf16 v[24:27], a[48:51], a[0:3], v[24:27]
  ds_read_b64_tr_b16 a[56:57], v194 offset:8192
  ds_read_b64_tr_b16 a[58:59], v194 offset:9216
  v_mfma_f32_16x16x32_bf16 v[88:91], a[48:51], a[4:7], v[88:91]
  ds_read_b64_tr_b16 a[60:61], v194 offset:8200
  ds_read_b64_tr_b16 a[62:63], v194 offset:9224
  v_mfma_f32_16x16x32_bf16 v[28:31], a[52:55], a[0:3], v[28:31]
  ds_read_b64_tr_b16 a[64:65], v195 offset:8192
  ds_read_b64_tr_b16 a[66:67], v195 offset:9216
  v_mfma_f32_16x16x32_bf16 v[92:95], a[52:55], a[4:7], v[92:95]
  ds_read_b64_tr_b16 a[68:69], v195 offset:8200
  ds_read_b64_tr_b16 a[70:71], v195 offset:9224
  s_waitcnt lgkmcnt(8)
  v_mfma_f32_16x16x32_bf16 v[32:35], a[24:27], a[0:3], v[32:35]
  s_lshl_b32 s88, s87, 18
  s_add_u32 m0, s86, 0
  v_mfma_f32_16x16x32_bf16 v[96:99], a[24:27], a[4:7], v[96:99]
  s_add_u32 s89, s88, 0
  buffer_load_dwordx4 v200, s[20:23], s89 offen offset:0 lds
  v_mfma_f32_16x16x32_bf16 v[36:39], a[28:31], a[0:3], v[36:39]
  buffer_load_dwordx4 v201, s[20:23], s89 offen offset:1024 lds
  buffer_load_dwordx4 v202, s[20:23], s89 offen offset:2048 lds
  v_mfma_f32_16x16x32_bf16 v[100:103], a[28:31], a[4:7], v[100:103]
  buffer_load_dwordx4 v203, s[20:23], s89 offen offset:3072 lds
  s_add_u32 m0, s86, 4096
  v_mfma_f32_16x16x32_bf16 v[40:43], a[32:35], a[0:3], v[40:43]
  s_add_u32 s89, s88, 131072
  buffer_load_dwordx4 v200, s[20:23], s89 offen offset:0 lds
  v_mfma_f32_16x16x32_bf16 v[104:107], a[32:35], a[4:7], v[104:107]
  buffer_load_dwordx4 v201, s[20:23], s89 offen offset:1024 lds
  buffer_load_dwordx4 v202, s[20:23], s89 offen offset:2048 lds
  v_mfma_f32_16x16x32_bf16 v[44:47], a[36:39], a[0:3], v[44:47]
  buffer_load_dwordx4 v203, s[20:23], s89 offen offset:3072 lds
  v_mfma_f32_16x16x32_bf16 v[108:111], a[36:39], a[4:7], v[108:111]
  s_waitcnt lgkmcnt(0)
  s_waitcnt vmcnt(18)
  s_barrier
  v_mfma_f32_16x16x32_bf16 v[48:51], a[56:59], a[0:3], v[48:51]
  ds_read_b128 a[12:15], v206 offset:0
  ds_read_b128 a[16:19], v206 offset:1024
  v_mfma_f32_16x16x32_bf16 v[112:115], a[56:59], a[4:7], v[112:115]
  ds_read_b64_tr_b16 a[24:25], v192 offset:16384
  ds_read_b64_tr_b16 a[26:27], v192 offset:17408
  v_mfma_f32_16x16x32_bf16 v[52:55], a[60:63], a[0:3], v[52:55]
  ds_read_b64_tr_b16 a[28:29], v192 offset:16392
  ds_read_b64_tr_b16 a[30:31], v192 offset:17416
  v_mfma_f32_16x16x32_bf16 v[116:119], a[60:63], a[4:7], v[116:119]
  ds_read_b64_tr_b16 a[32:33], v193 offset:16384
  ds_read_b64_tr_b16 a[34:35], v193 offset:17408
  v_mfma_f32_16x16x32_bf16 v[56:59], a[64:67], a[0:3], v[56:59]
  ds_read_b64_tr_b16 a[36:37], v193 offset:16392
  ds_read_b64_tr_b16 a[38:39], v193 offset:17416
  v_mfma_f32_16x16x32_bf16 v[120:123], a[64:67], a[4:7], v[120:123]
  ds_read_b64_tr_b16 a[40:41], v194 offset:16384
  ds_read_b64_tr_b16 a[42:43], v194 offset:17408
  v_mfma_f32_16x16x32_bf16 v[60:63], a[68:71], a[0:3], v[60:63]
  ds_read_b64_tr_b16 a[44:45], v194 offset:16392
  ds_read_b64_tr_b16 a[46:47], v194 offset:17416
  v_mfma_f32_16x16x32_bf16 v[124:127], a[68:71], a[4:7], v[124:127]
  ds_read_b64_tr_b16 a[48:49], v195 offset:16384
  ds_read_b64_tr_b16 a[50:51], v195 offset:17408
  ds_read_b64_tr_b16 a[52:53], v195 offset:16392
  ds_read_b64_tr_b16 a[54:55], v195 offset:17416
  s_waitcnt lgkmcnt(8)
  v_mfma_f32_16x16x32_bf16 v[0:3], a[24:27], a[12:15], v[0:3]
  s_lshl_b32 s82, s81, 6
  s_add_u32 s82, s82, s83
  v_mfma_f32_16x16x32_bf16 v[64:67], a[24:27], a[16:19], v[64:67]
  s_add_u32 s81, s81, 1
  s_add_u32 m0, s84, 59392
  v_mfma_f32_16x16x32_bf16 v[4:7], a[28:31], a[12:15], v[4:7]
  s_add_u32 s78, s82, 0
  buffer_load_dwordx4 v205, s[16:19], s78 offen lds
  v_mfma_f32_16x16x32_bf16 v[68:71], a[28:31], a[16:19], v[68:71]
  s_add_u32 m0, s84, 60416
  s_add_u32 s78, s82, 14336
  v_mfma_f32_16x16x32_bf16 v[8:11], a[32:35], a[12:15], v[8:11]
  buffer_load_dwordx4 v205, s[16:19], s78 offen lds
  s_cmp_eq_u32 s59, 1
  s_cbranch_scc1 L_xskip_1_5
  s_add_u32 m0, s84, 61440
  s_add_u32 s78, s82, 28672
  buffer_load_dwordx4 v205, s[16:19], s78 offen lds
L_xskip_1_5:
  v_mfma_f32_16x16x32_bf16 v[72:75], a[32:35], a[16:19], v[72:75]
  s_cmp_eq_u32 s81, 14
  s_cselect_b32 s81, 0, s81
  v_mfma_f32_16x16x32_bf16 v[12:15], a[36:39], a[12:15], v[12:15]
  s_lshl_b32 s88, s87, 18
  s_add_u32 s88, s88, 256
  v_mfma_f32_16x16x32_bf16 v[76:79], a[36:39], a[16:19], v[76:79]
  s_add_u32 s87, s87, 1
  s_add_u32 m0, s86, 8192
  s_add_u32 s89, s88, 0
  buffer_load_dwordx4 v200, s[20:23], s89 offen offset:0 lds
  buffer_load_dwordx4 v201, s[20:23], s89 offen offset:1024 lds
  buffer_load_dwordx4 v202, s[20:23], s89 offen offset:2048 lds
  buffer_load_dwordx4 v203, s[20:23], s89 offen offset:3072 lds
  s_add_u32 m0, s86, 12288
  s_add_u32 s89, s88, 131072
  buffer_load_dwordx4 v200, s[20:23], s89 offen offset:0 lds
  buffer_load_dwordx4 v201, s[20:23], s89 offen offset:1024 lds
  buffer_load_dwordx4 v202, s[20:23], s89 offen offset:2048 lds
  buffer_load_dwordx4 v203, s[20:23], s89 offen offset:3072 lds
  s_cmp_eq_u32 s87, 14
  s_cselect_b32 s87, 0, s87
  s_waitcnt lgkmcnt(0)
  s_waitcnt vmcnt(18)
  s_barrier
  v_mfma_f32_16x16x32_bf16 v[16:19], a[40:43], a[12:15], v[16:19]
  ds_read_b64_tr_b16 a[24:25], v192 offset:24576
  ds_read_b64_tr_b16 a[26:27], v192 offset:25600
  v_mfma_f32_16x16x32_bf16 v[80:83], a[40:43], a[16:19], v[80:83]
  ds_read_b64_tr_b16 a[28:29], v192 offset:24584
  ds_read_b64_tr_b16 a[30:31], v192 offset:25608
  v_mfma_f32_16x16x32_bf16 v[20:23], a[44:47], a[12:15], v[20:23]
  ds_read_b64_tr_b16 a[32:33], v193 offset:24576
  ds_read_b64_tr_b16 a[34:35], v193 offset:25600
  v_mfma_f32_16x16x32_bf16 v[84:87], a[44:47], a[16:19], v[84:87]
  ds_read_b64_tr_b16 a[36:37], v193 offset:24584
  ds_read_b64_tr_b16 a[38:39], v193 offset:25608
  v_mfma_f32_16x16x32_bf16 v[24:27], a[48:51], a[12:15], v[24:27]
  ds_read_b64_tr_b16 a[56:57], v194 offset:24576
  ds_read_b64_tr_b16 a[58:59], v194 offset:25600
  v_mfma_f32_16x16x32_bf16 v[88:91], a[48:51], a[16:19], v[88:91]
  ds_read_b64_tr_b16 a[60:61], v194 offset:24584
  ds_read_b64_tr_b16 a[62:63], v194 offset:25608
  v_mfma_f32_16x16x32_bf16 v[28:31], a[52:55], a[12:15], v[28:31]
  ds_read_b64_tr_b16 a[64:65], v195 offset:24576
  ds_read_b64_tr_b16 a[66:67], v195 offset:25600
  v_mfma_f32_16x16x32_bf16 v[92:95], a[52:55], a[16:19], v[92:95]
  ds_read_b64_tr_b16 a[68:69], v195 offset:24584
  ds_read_b64_tr_b16 a[70:71], v195 offset:25608
  s_waitcnt lgkmcnt(8)
  v_mfma_f32_16x16x32_bf16 v[32:35], a[24:27], a[12:15], v[32:35]
  s_lshl_b32 s88, s87, 18
  s_add_u32 m0, s86, 16384
  v_mfma_f32_16x16x32_bf16 v[96:99], a[24:27], a[16:19], v[96:99]
  s_add_u32 s89, s88, 0
  buffer_load_dwordx4 v200, s[20:23], s89 offen offset:0 lds
  v_mfma_f32_16x16x32_bf16 v[36:39], a[28:31], a[12:15], v[36:39]
  buffer_load_dwordx4 v201, s[20:23], s89 offen offset:1024 lds
  buffer_load_dwordx4 v202, s[20:23], s89 offen offset:2048 lds
  v_mfma_f32_16x16x32_bf16 v[100:103], a[28:31], a[16:19], v[100:103]
  buffer_load_dwordx4 v203, s[20:23], s89 offen offset:3072 lds
  s_add_u32 m0, s86, 20480
  v_mfma_f32_16x16x32_bf16 v[40:43], a[32:35], a[12:15], v[40:43]
  s_add_u32 s89, s88, 131072
  buffer_load_dwordx4 v200, s[20:23], s89 offen offset:0 lds
  v_mfma_f32_16x16x32_bf16 v[104:107], a[32:35], a[16:19], v[104:107]
  buffer_load_dwordx4 v201, s[20:23], s89 offen offset:1024 lds
  buffer_load_dwordx4 v202, s[20:23], s89 offen offset:2048 lds
  v_mfma_f32_16x16x32_bf16 v[44:47], a[36:39], a[12:15], v[44:47]
  buffer_load_dwordx4 v203, s[20:23], s89 offen offset:3072 lds
  v_mfma_f32_16x16x32_bf16 v[108:111], a[36:39], a[16:19], v[108:111]
  s_waitcnt lgkmcnt(0)
  s_waitcnt vmcnt(18)
  s_barrier
  v_mfma_f32_16x16x32_bf16 v[48:51], a[56:59], a[12:15], v[48:51]
  ds_read_b128 a[0:3], v206 offset:5120
  ds_read_b128 a[4:7], v206 offset:6144
  v_mfma_f32_16x16x32_bf16 v[112:115], a[56:59], a[16:19], v[112:115]
  ds_read_b64_tr_b16 a[24:25], v192 offset:0
  ds_read_b64_tr_b16 a[26:27], v192 offset:1024
  v_mfma_f32_16x16x32_bf16 v[52:55], a[60:63], a[12:15], v[52:55]
  ds_read_b64_tr_b16 a[28:29], v192 offset:8
  ds_read_b64_tr_b16 a[30:31], v192 offset:1032
  v_mfma_f32_16x16x32_bf16 v[116:119], a[60:63], a[16:19], v[116:119]
  ds_read_b64_tr_b16 a[32:33], v193 offset:0
  ds_read_b64_tr_b16 a[34:35], v193 offset:1024
  v_mfma_f32_16x16x32_bf16 v[56:59], a[64:67], a[12:15], v[56:59]
  ds_read_b64_tr_b16 a[36:37], v193 offset:8
  ds_read_b64_tr_b16 a[38:39], v193 offset:1032
  v_mfma_f32_16x16x32_bf16 v[120:123], a[64:67], a[16:19], v[120:123]
  ds_read_b64_tr_b16 a[40:41], v194 offset:0
  ds_read_b64_tr_b16 a[42:43], v194 offset:1024
  v_mfma_f32_16x16x32_bf16 v[60:63], a[68:71], a[12:15], v[60:63]
  ds_read_b64_tr_b16 a[44:45], v194 offset:8
  ds_read_b64_tr_b16 a[46:47], v194 offset:1032
  v_mfma_f32_16x16x32_bf16 v[124:127], a[68:71], a[16:19], v[124:127]
  ds_read_b64_tr_b16 a[48:49], v195 offset:0
  ds_read_b64_tr_b16 a[50:51], v195 offset:1024
  ds_read_b64_tr_b16 a[52:53], v195 offset:8
  ds_read_b64_tr_b16 a[54:55], v195 offset:1032
  s_waitcnt lgkmcnt(8)
  v_mfma_f32_16x16x32_bf16 v[0:3], a[24:27], a[0:3], v[0:3]
  s_lshl_b32 s82, s81, 6
  s_add_u32 s82, s82, s83
  v_mfma_f32_16x16x32_bf16 v[64:67], a[24:27], a[4:7], v[64:67]
  s_add_u32 s81, s81, 1
  s_add_u32 m0, s84, 49152
  v_mfma_f32_16x16x32_bf16 v[4:7], a[28:31], a[0:3], v[4:7]
  s_add_u32 s78, s82, 0
  buffer_load_dwordx4 v205, s[16:19], s78 offen lds
  v_mfma_f32_16x16x32_bf16 v[68:71], a[28:31], a[4:7], v[68:71]
  s_add_u32 m0, s84, 50176
  s_add_u32 s78, s82, 14336
  v_mfma_f32_16x16x32_bf16 v[8:11], a[32:35], a[0:3], v[8:11]
  buffer_load_dwordx4 v205, s[16:19], s78 offen lds
  s_cmp_eq_u32 s59, 1
  s_cbranch_scc1 L_xskip_1_6
  s_add_u32 m0, s84, 51200
  s_add_u32 s78, s82, 28672
  buffer_load_dwordx4 v205, s[16:19], s78 offen lds
L_xskip_1_6:
  v_mfma_f32_16x16x32_bf16 v[72:75], a[32:35], a[4:7], v[72:75]
  s_cmp_eq_u32 s81, 14
  s_cselect_b32 s81, 0, s81
  v_mfma_f32_16x16x32_bf16 v[12:15], a[36:39], a[0:3], v[12:15]
  s_lshl_b32 s88, s87, 18
  s_add_u32 s88, s88, 256
  v_mfma_f32_16x16x32_bf16 v[76:79], a[36:39], a[4:7], v[76:79]
  s_add_u32 s87, s87, 1
  s_add_u32 m0, s86, 24576
  s_add_u32 s89, s88, 0
  buffer_load_dwordx4 v200, s[20:23], s89 offen offset:0 lds
  buffer_load_dwordx4 v201, s[20:23], s89 offen offset:1024 lds
  buffer_load_dwordx4 v202, s[20:23], s89 offen offset:2048 lds
  buffer_load_dwordx4 v203, s[20:23], s89 offen offset:3072 lds
  s_add_u32 m0, s86, 28672
  s_add_u32 s89, s88, 131072
  buffer_load_dwordx4 v200, s[20:23], s89 offen offset:0 lds
  buffer_load_dwordx4 v201, s[20:23], s89 offen offset:1024 lds
  buffer_load_dwordx4 v202, s[20:23], s89 offen offset:2048 lds
  buffer_load_dwordx4 v203, s[20:23], s89 offen offset:3072 lds
  s_cmp_eq_u32 s87, 14
  s_cselect_b32 s87, 0, s87
  s_waitcnt lgkmcnt(0)
  s_waitcnt vmcnt(18)
  s_barrier
  v_mfma_f32_16x16x32_bf16 v[16:19], a[40:43], a[0:3], v[16:19]
  ds_read_b64_tr_b16 a[24:25], v192 offset:8192
  ds_read_b64_tr_b16 a[26:27], v192 offset:9216
  v_mfma_f32_16x16x32_bf16 v[80:83], a[40:43], a[4:7], v[80:83]
  ds_read_b64_tr_b16 a[28:29], v192 offset:8200
  ds_read_b64_tr_b16 a[30:31], v192 offset:9224
  v_mfma_f32_16x16x32_bf16 v[20:23], a[44:47], a[0:3], v[20:23]
  ds_read_b64_tr_b16 a[32:33], v193 offset:8192
  ds_read_b64_tr_b16 a[34:35], v193 offset:9216
  v_mfma_f32_16x16x32_bf16 v[84:87], a[44:47], a[4:7], v[84:87]
  ds_read_b64_tr_b16 a[36:37], v193 offset:8200
  ds_read_b64_tr_b16 a[38:39], v193 offset:9224
  v_mfma_f32_16x16x32_bf16 v[24:27], a[48:51], a[0:3], v[24:27]
  ds_read_b64_tr_b16 a[56:57], v194 offset:8192
  ds_read_b64_tr_b16 a[58:59], v194 offset:9216
  v_mfma_f32_16x16x32_bf16 v[88:91], a[48:51], a[4:7], v[88:91]
  ds_read_b64_tr_b16 a[60:61], v194 offset:8200
  ds_read_b64_tr_b16 a[62:63], v194 offset:9224
  v_mfma_f32_16x16x32_bf16 v[28:31], a[52:55], a[0:3], v[28:31]
  ds_read_b64_tr_b16 a[64:65], v195 offset:8192
  ds_read_b64_tr_b16 a[66:67], v195 offset:9216
  v_mfma_f32_16x16x32_bf16 v[92:95], a[52:55], a[4:7], v[92:95]
  ds_read_b64_tr_b16 a[68:69], v195 offset:8200
  ds_read_b64_tr_b16 a[70:71], v195 offset:9224
  s_waitcnt lgkmcnt(8)
  v_mfma_f32_16x16x32_bf16 v[32:35], a[24:27], a[0:3], v[32:35]
  s_lshl_b32 s88, s87, 18
  s_add_u32 m0, s86, 0
  v_mfma_f32_16x16x32_bf16 v[96:99], a[24:27], a[4:7], v[96:99]
  s_add_u32 s89, s88, 0
  buffer_load_dwordx4 v200, s[20:23], s89 offen offset:0 lds
  v_mfma_f32_16x16x32_bf16 v[36:39], a[28:31], a[0:3], v[36:39]
  buffer_load_dwordx4 v201, s[20:23], s89 offen offset:1024 lds
  buffer_load_dwordx4 v202, s[20:23], s89 offen offset:2048 lds
  v_mfma_f32_16x16x32_bf16 v[100:103], a[28:31], a[4:7], v[100:103]
  buffer_load_dwordx4 v203, s[20:23], s89 offen offset:3072 lds
  s_add_u32 m0, s86, 4096
  v_mfma_f32_16x16x32_bf16 v[40:43], a[32:35], a[0:3], v[40:43]
  s_add_u32 s89, s88, 131072
  buffer_load_dwordx4 v200, s[20:23], s89 offen offset:0 lds
  v_mfma_f32_16x16x32_bf16 v[104:107], a[32:35], a[4:7], v[104:107]
  buffer_load_dwordx4 v201, s[20:23], s89 offen offset:1024 lds
  buffer_load_dwordx4 v202, s[20:23], s89 offen offset:2048 lds
  v_mfma_f32_16x16x32_bf16 v[44:47], a[36:39], a[0:3], v[44:47]
  buffer_load_dwordx4 v203, s[20:23], s89 offen offset:3072 lds
  v_mfma_f32_16x16x32_bf16 v[108:111], a[36:39], a[4:7], v[108:111]
  s_waitcnt lgkmcnt(0)
  s_waitcnt vmcnt(18)
  s_barrier
  v_mfma_f32_16x16x32_bf16 v[48:51], a[56:59], a[0:3], v[48:51]
  ds_read_b128 a[12:15], v206 offset:10240
  ds_read_b128 a[16:19], v206 offset:11264
  v_mfma_f32_16x16x32_bf16 v[112:115], a[56:59], a[4:7], v[112:115]
  ds_read_b64_tr_b16 a[24:25], v192 offset:16384
  ds_read_b64_tr_b16 a[26:27], v192 offset:17408
  v_mfma_f32_16x16x32_bf16 v[52:55], a[60:63], a[0:3], v[52:55]
  ds_read_b64_tr_b16 a[28:29], v192 offset:16392
  ds_read_b64_tr_b16 a[30:31], v192 offset:17416
  v_mfma_f32_16x16x32_bf16 v[116:119], a[60:63], a[4:7], v[116:119]
  ds_read_b64_tr_b16 a[32:33], v193 offset:16384
  ds_read_b64_tr_b16 a[34:35], v193 offset:17408
  v_mfma_f32_16x16x32_bf16 v[56:59], a[64:67], a[0:3], v[56:59]
  ds_read_b64_tr_b16 a[36:37], v193 offset:16392
  ds_read_b64_tr_b16 a[38:39], v193 offset:17416
  v_mfma_f32_16x16x32_bf16 v[120:123], a[64:67], a[4:7], v[120:123]
  ds_read_b64_tr_b16 a[40:41], v194 offset:16384
  ds_read_b64_tr_b16 a[42:43], v194 offset:17408
  v_mfma_f32_16x16x32_bf16 v[60:63], a[68:71], a[0:3], v[60:63]
  ds_read_b64_tr_b16 a[44:45], v194 offset:16392
  ds_read_b64_tr_b16 a[46:47], v194 offset:17416
  v_mfma_f32_16x16x32_bf16 v[124:127], a[68:71], a[4:7], v[124:127]
  ds_read_b64_tr_b16 a[48:49], v195 offset:16384
  ds_read_b64_tr_b16 a[50:51], v195 offset:17408
  ds_read_b64_tr_b16 a[52:53], v195 offset:16392
  ds_read_b64_tr_b16 a[54:55], v195 offset:17416
  s_waitcnt lgkmcnt(8)
  v_mfma_f32_16x16x32_bf16 v[0:3], a[24:27], a[12:15], v[0:3]
  s_lshl_b32 s82, s81, 6
  s_add_u32 s82, s82, s83
  v_mfma_f32_16x16x32_bf16 v[64:67], a[24:27], a[16:19], v[64:67]
  s_add_u32 s81, s81, 1
  s_add_u32 m0, s84, 54272
  v_mfma_f32_16x16x32_bf16 v[4:7], a[28:31], a[12:15], v[4:7]
  s_add_u32 s78, s82, 0
  buffer_load_dwordx4 v205, s[16:19], s78 offen lds
  v_mfma_f32_16x16x32_bf16 v[68:71], a[28:31], a[16:19], v[68:71]
  s_add_u32 m0, s84, 55296
  s_add_u32 s78, s82, 14336
  v_mfma_f32_16x16x32_bf16 v[8:11], a[32:35], a[12:15], v[8:11]
  buffer_load_dwordx4 v205, s[16:19], s78 offen lds
  s_cmp_eq_u32 s59, 1
  s_cbranch_scc1 L_xskip_1_7
  s_add_u32 m0, s84, 56320
  s_add_u32 s78, s82, 28672
  buffer_load_dwordx4 v205, s[16:19], s78 offen lds
L_xskip_1_7:
  v_mfma_f32_16x16x32_bf16 v[72:75], a[32:35], a[16:19], v[72:75]
  s_cmp_eq_u32 s81, 14
  s_cselect_b32 s81, 0, s81
  v_mfma_f32_16x16x32_bf16 v[12:15], a[36:39], a[12:15], v[12:15]
  s_lshl_b32 s88, s87, 18
  s_add_u32 s88, s88, 256
  v_mfma_f32_16x16x32_bf16 v[76:79], a[36:39], a[16:19], v[76:79]
  s_add_u32 s87, s87, 1
  s_add_u32 m0, s86, 8192
  s_add_u32 s89, s88, 0
  buffer_load_dwordx4 v200, s[20:23], s89 offen offset:0 lds
  buffer_load_dwordx4 v201, s[20:23], s89 offen offset:1024 lds
  buffer_load_dwordx4 v202, s[20:23], s89 offen offset:2048 lds
  buffer_load_dwordx4 v203, s[20:23], s89 offen offset:3072 lds
  s_add_u32 m0, s86, 12288
  s_add_u32 s89, s88, 131072
  buffer_load_dwordx4 v200, s[20:23], s89 offen offset:0 lds
  buffer_load_dwordx4 v201, s[20:23], s89 offen offset:1024 lds
  buffer_load_dwordx4 v202, s[20:23], s89 offen offset:2048 lds
  buffer_load_dwordx4 v203, s[20:23], s89 offen offset:3072 lds
  s_cmp_eq_u32 s87, 14
  s_cselect_b32 s87, 0, s87
  s_waitcnt lgkmcnt(0)
  s_waitcnt vmcnt(18)
  s_barrier
  v_mfma_f32_16x16x32_bf16 v[16:19], a[40:43], a[12:15], v[16:19]
  ds_read_b64_tr_b16 a[24:25], v192 offset:24576
  ds_read_b64_tr_b16 a[26:27], v192 offset:25600
  v_mfma_f32_16x16x32_bf16 v[80:83], a[40:43], a[16:19], v[80:83]
  ds_read_b64_tr_b16 a[28:29], v192 offset:24584
  ds_read_b64_tr_b16 a[30:31], v192 offset:25608
  v_mfma_f32_16x16x32_bf16 v[20:23], a[44:47], a[12:15], v[20:23]
  ds_read_b64_tr_b16 a[32:33], v193 offset:24576
  ds_read_b64_tr_b16 a[34:35], v193 offset:25600
  v_mfma_f32_16x16x32_bf16 v[84:87], a[44:47], a[16:19], v[84:87]
  ds_read_b64_tr_b16 a[36:37], v193 offset:24584
  ds_read_b64_tr_b16 a[38:39], v193 offset:25608
  v_mfma_f32_16x16x32_bf16 v[24:27], a[48:51], a[12:15], v[24:27]
  ds_read_b64_tr_b16 a[56:57], v194 offset:24576
  ds_read_b64_tr_b16 a[58:59], v194 offset:25600
  v_mfma_f32_16x16x32_bf16 v[88:91], a[48:51], a[16:19], v[88:91]
  ds_read_b64_tr_b16 a[60:61], v194 offset:24584
  ds_read_b64_tr_b16 a[62:63], v194 offset:25608
  v_mfma_f32_16x16x32_bf16 v[28:31], a[52:55], a[12:15], v[28:31]
  ds_read_b64_tr_b16 a[64:65], v195 offset:24576
  ds_read_b64_tr_b16 a[66:67], v195 offset:25600
  v_mfma_f32_16x16x32_bf16 v[92:95], a[52:55], a[16:19], v[92:95]
  ds_read_b64_tr_b16 a[68:69], v195 offset:24584
  ds_read_b64_tr_b16 a[70:71], v195 offset:25608
  s_waitcnt lgkmcnt(8)
  v_mfma_f32_16x16x32_bf16 v[32:35], a[24:27], a[12:15], v[32:35]
  s_lshl_b32 s88, s87, 18
  s_add_u32 m0, s86, 16384
  v_mfma_f32_16x16x32_bf16 v[96:99], a[24:27], a[16:19], v[96:99]
  s_add_u32 s89, s88, 0
  buffer_load_dwordx4 v200, s[20:23], s89 offen offset:0 lds
  v_mfma_f32_16x16x32_bf16 v[36:39], a[28:31], a[12:15], v[36:39]
  buffer_load_dwordx4 v201, s[20:23], s89 offen offset:1024 lds
  buffer_load_dwordx4 v202, s[20:23], s89 offen offset:2048 lds
  v_mfma_f32_16x16x32_bf16 v[100:103], a[28:31], a[16:19], v[100:103]
  buffer_load_dwordx4 v203, s[20:23], s89 offen offset:3072 lds
  s_add_u32 m0, s86, 20480
  v_mfma_f32_16x16x32_bf16 v[40:43], a[32:35], a[12:15], v[40:43]
  s_add_u32 s89, s88, 131072
  buffer_load_dwordx4 v200, s[20:23], s89 offen offset:0 lds
  v_mfma_f32_16x16x32_bf16 v[104:107], a[32:35], a[16:19], v[104:107]
  buffer_load_dwordx4 v201, s[20:23], s89 offen offset:1024 lds
  buffer_load_dwordx4 v202, s[20:23], s89 offen offset:2048 lds
  v_mfma_f32_16x16x32_bf16 v[44:47], a[36:39], a[12:15], v[44:47]
  buffer_load_dwordx4 v203, s[20:23], s89 offen offset:3072 lds
  v_mfma_f32_16x16x32_bf16 v[108:111], a[36:39], a[16:19], v[108:111]
  s_waitcnt lgkmcnt(0)
  s_waitcnt vmcnt(18)
  s_barrier
  v_mfma_f32_16x16x32_bf16 v[48:51], a[56:59], a[12:15], v[48:51]
  ds_read_b128 a[0:3], v206 offset:0
  ds_read_b128 a[4:7], v206 offset:1024
  v_mfma_f32_16x16x32_bf16 v[112:115], a[56:59], a[16:19], v[112:115]
  ds_read_b64_tr_b16 a[24:25], v192 offset:0
  ds_read_b64_tr_b16 a[26:27], v192 offset:1024
  v_mfma_f32_16x16x32_bf16 v[52:55], a[60:63], a[12:15], v[52:55]
  ds_read_b64_tr_b16 a[28:29], v192 offset:8
  ds_read_b64_tr_b16 a[30:31], v192 offset:1032
  v_mfma_f32_16x16x32_bf16 v[116:119], a[60:63], a[16:19], v[116:119]
  ds_read_b64_tr_b16 a[32:33], v193 offset:0
  ds_read_b64_tr_b16 a[34:35], v193 offset:1024
  v_mfma_f32_16x16x32_bf16 v[56:59], a[64:67], a[12:15], v[56:59]
  ds_read_b64_tr_b16 a[36:37], v193 offset:8
  ds_read_b64_tr_b16 a[38:39], v193 offset:1032
  v_mfma_f32_16x16x32_bf16 v[120:123], a[64:67], a[16:19], v[120:123]
  ds_read_b64_tr_b16 a[40:41], v194 offset:0
  ds_read_b64_tr_b16 a[42:43], v194 offset:1024
  v_mfma_f32_16x16x32_bf16 v[60:63], a[68:71], a[12:15], v[60:63]
  ds_read_b64_tr_b16 a[44:45], v194 offset:8
  ds_read_b64_tr_b16 a[46:47], v194 offset:1032
  v_mfma_f32_16x16x32_bf16 v[124:127], a[68:71], a[16:19], v[124:127]
  ds_read_b64_tr_b16 a[48:49], v195 offset:0
  ds_read_b64_tr_b16 a[50:51], v195 offset:1024
  ds_read_b64_tr_b16 a[52:53], v195 offset:8
  ds_read_b64_tr_b16 a[54:55], v195 offset:1032
  s_waitcnt lgkmcnt(8)
  v_mfma_f32_16x16x32_bf16 v[0:3], a[24:27], a[0:3], v[0:3]
  s_lshl_b32 s82, s81, 6
  s_add_u32 s82, s82, s83
  v_mfma_f32_16x16x32_bf16 v[64:67], a[24:27], a[4:7], v[64:67]
  s_add_u32 s81, s81, 1
  s_add_u32 m0, s84, 59392
  v_mfma_f32_16x16x32_bf16 v[4:7], a[28:31], a[0:3], v[4:7]
  s_add_u32 s78, s82, 0
  buffer_load_dwordx4 v205, s[16:19], s78 offen lds
  v_mfma_f32_16x16x32_bf16 v[68:71], a[28:31], a[4:7], v[68:71]
  s_add_u32 m0, s84, 60416
  s_add_u32 s78, s82, 14336
  v_mfma_f32_16x16x32_bf16 v[8:11], a[32:35], a[0:3], v[8:11]
  buffer_load_dwordx4 v205, s[16:19], s78 offen lds
  s_cmp_eq_u32 s59, 1
  s_cbranch_scc1 L_xskip_1_8
  s_add_u32 m0, s84, 61440
  s_add_u32 s78, s82, 28672
  buffer_load_dwordx4 v205, s[16:19], s78 offen lds
L_xskip_1_8:
  v_mfma_f32_16x16x32_bf16 v[72:75], a[32:35], a[4:7], v[72:75]
  s_cmp_eq_u32 s81, 14
  s_cselect_b32 s81, 0, s81
  v_mfma_f32_16x16x32_bf16 v[12:15], a[36:39], a[0:3], v[12:15]
  s_lshl_b32 s88, s87, 18
  s_add_u32 s88, s88, 256
  v_mfma_f32_16x16x32_bf16 v[76:79], a[36:39], a[4:7], v[76:79]
  s_add_u32 s87, s87, 1
  s_add_u32 m0, s86, 24576
  s_add_u32 s89, s88, 0
  buffer_load_dwordx4 v200, s[20:23], s89 offen offset:0 lds
  buffer_load_dwordx4 v201, s[20:23], s89 offen offset:1024 lds
  buffer_load_dwordx4 v202, s[20:23], s89 offen offset:2048 lds
  buffer_load_dwordx4 v203, s[20:23], s89 offen offset:3072 lds
  s_add_u32 m0, s86, 28672
  s_add_u32 s89, s88, 131072
  buffer_load_dwordx4 v200, s[20:23], s89 offen offset:0 lds
  buffer_load_dwordx4 v201, s[20:23], s89 offen offset:1024 lds
  buffer_load_dwordx4 v202, s[20:23], s89 offen offset:2048 lds
  buffer_load_dwordx4 v203, s[20:23], s89 offen offset:3072 lds
  s_cmp_eq_u32 s87, 14
  s_cselect_b32 s87, 0, s87
  s_waitcnt lgkmcnt(0)
  s_waitcnt vmcnt(18)
  s_barrier
  v_mfma_f32_16x16x32_bf16 v[16:19], a[40:43], a[0:3], v[16:19]
  ds_read_b64_tr_b16 a[24:25], v192 offset:8192
  ds_read_b64_tr_b16 a[26:27], v192 offset:9216
  v_mfma_f32_16x16x32_bf16 v[80:83], a[40:43], a[4:7], v[80:83]
  ds_read_b64_tr_b16 a[28:29], v192 offset:8200
  ds_read_b64_tr_b16 a[30:31], v192 offset:9224
  v_mfma_f32_16x16x32_bf16 v[20:23], a[44:47], a[0:3], v[20:23]
  ds_read_b64_tr_b16 a[32:33], v193 offset:8192
  ds_read_b64_tr_b16 a[34:35], v193 offset:9216
  v_mfma_f32_16x16x32_bf16 v[84:87], a[44:47], a[4:7], v[84:87]
  ds_read_b64_tr_b16 a[36:37], v193 offset:8200
  ds_read_b64_tr_b16 a[38:39], v193 offset:9224
  v_mfma_f32_16x16x32_bf16 v[24:27], a[48:51], a[0:3], v[24:27]
  ds_read_b64_tr_b16 a[56:57], v194 offset:8192
  ds_read_b64_tr_b16 a[58:59], v194 offset:9216
  v_mfma_f32_16x16x32_bf16 v[88:91], a[48:51], a[4:7], v[88:91]
  ds_read_b64_tr_b16 a[60:61], v194 offset:8200
  ds_read_b64_tr_b16 a[62:63], v194 offset:9224
  v_mfma_f32_16x16x32_bf16 v[28:31], a[52:55], a[0:3], v[28:31]
  ds_read_b64_tr_b16 a[64:65], v195 offset:8192
  ds_read_b64_tr_b16 a[66:67], v195 offset:9216
  v_mfma_f32_16x16x32_bf16 v[92:95], a[52:55], a[4:7], v[92:95]
  ds_read_b64_tr_b16 a[68:69], v195 offset:8200
  ds_read_b64_tr_b16 a[70:71], v195 offset:9224
  s_waitcnt lgkmcnt(8)
  v_mfma_f32_16x16x32_bf16 v[32:35], a[24:27], a[0:3], v[32:35]
  s_lshl_b32 s88, s87, 18
  s_add_u32 m0, s86, 0
  v_mfma_f32_16x16x32_bf16 v[96:99], a[24:27], a[4:7], v[96:99]
  s_add_u32 s89, s88, 0
  buffer_load_dwordx4 v200, s[20:23], s89 offen offset:0 lds
  v_mfma_f32_16x16x32_bf16 v[36:39], a[28:31], a[0:3], v[36:39]
  buffer_load_dwordx4 v201, s[20:23], s89 offen offset:1024 lds
  buffer_load_dwordx4 v202, s[20:23], s89 offen offset:2048 lds
  v_mfma_f32_16x16x32_bf16 v[100:103], a[28:31], a[4:7], v[100:103]
  buffer_load_dwordx4 v203, s[20:23], s89 offen offset:3072 lds
  s_add_u32 m0, s86, 4096
  v_mfma_f32_16x16x32_bf16 v[40:43], a[32:35], a[0:3], v[40:43]
  s_add_u32 s89, s88, 131072
  buffer_load_dwordx4 v200, s[20:23], s89 offen offset:0 lds
  v_mfma_f32_16x16x32_bf16 v[104:107], a[32:35], a[4:7], v[104:107]
  buffer_load_dwordx4 v201, s[20:23], s89 offen offset:1024 lds
  buffer_load_dwordx4 v202, s[20:23], s89 offen offset:2048 lds
  v_mfma_f32_16x16x32_bf16 v[44:47], a[36:39], a[0:3], v[44:47]
  buffer_load_dwordx4 v203, s[20:23], s89 offen offset:3072 lds
  v_mfma_f32_16x16x32_bf16 v[108:111], a[36:39], a[4:7], v[108:111]
  s_waitcnt lgkmcnt(0)
  s_waitcnt vmcnt(18)
  s_barrier
  v_mfma_f32_16x16x32_bf16 v[48:51], a[56:59], a[0:3], v[48:51]
  ds_read_b128 a[12:15], v206 offset:5120
  ds_read_b128 a[16:19], v206 offset:6144
  v_mfma_f32_16x16x32_bf16 v[112:115], a[56:59], a[4:7], v[112:115]
  ds_read_b64_tr_b16 a[24:25], v192 offset:16384
  ds_read_b64_tr_b16 a[26:27], v192 offset:17408
  v_mfma_f32_16x16x32_bf16 v[52:55], a[60:63], a[0:3], v[52:55]
  ds_read_b64_tr_b16 a[28:29], v192 offset:16392
  ds_read_b64_tr_b16 a[30:31], v192 offset:17416
  v_mfma_f32_16x16x32_bf16 v[116:119], a[60:63], a[4:7], v[116:119]
  ds_read_b64_tr_b16 a[32:33], v193 offset:16384
  ds_read_b64_tr_b16 a[34:35], v193 offset:17408
  v_mfma_f32_16x16x32_bf16 v[56:59], a[64:67], a[0:3], v[56:59]
  ds_read_b64_tr_b16 a[36:37], v193 offset:16392
  ds_read_b64_tr_b16 a[38:39], v193 offset:17416
  v_mfma_f32_16x16x32_bf16 v[120:123], a[64:67], a[4:7], v[120:123]
  ds_read_b64_tr_b16 a[40:41], v194 offset:16384
  ds_read_b64_tr_b16 a[42:43], v194 offset:17408
  v_mfma_f32_16x16x32_bf16 v[60:63], a[68:71], a[0:3], v[60:63]
  ds_read_b64_tr_b16 a[44:45], v194 offset:16392
  ds_read_b64_tr_b16 a[46:47], v194 offset:17416
  v_mfma_f32_16x16x32_bf16 v[124:127], a[68:71], a[4:7], v[124:127]
  ds_read_b64_tr_b16 a[48:49], v195 offset:16384
  ds_read_b64_tr_b16 a[50:51], v195 offset:17408
  ds_read_b64_tr_b16 a[52:53], v195 offset:16392
  ds_read_b64_tr_b16 a[54:55], v195 offset:17416
  s_waitcnt lgkmcnt(8)
  v_mfma_f32_16x16x32_bf16 v[0:3], a[24:27], a[12:15], v[0:3]
  s_lshl_b32 s82, s81, 6
  s_add_u32 s82, s82, s83
  v_mfma_f32_16x16x32_bf16 v[64:67], a[24:27], a[16:19], v[64:67]
  s_add_u32 s81, s81, 1
  s_add_u32 m0, s84, 49152
  v_mfma_f32_16x16x32_bf16 v[4:7], a[28:31], a[12:15], v[4:7]
  s_add_u32 s78, s82, 0
  buffer_load_dwordx4 v205, s[16:19], s78 offen lds
  v_mfma_f32_16x16x32_bf16 v[68:71], a[28:31], a[16:19], v[68:71]
  s_add_u32 m0, s84, 50176
  s_add_u32 s78, s82, 14336
  v_mfma_f32_16x16x32_bf16 v[8:11], a[32:35], a[12:15], v[8:11]
  buffer_load_dwordx4 v205, s[16:19], s78 offen lds
  s_cmp_eq_u32 s59, 1
  s_cbranch_scc1 L_xskip_1_9
  s_add_u32 m0, s84, 51200
  s_add_u32 s78, s82, 28672
  buffer_load_dwordx4 v205, s[16:19], s78 offen lds
L_xskip_1_9:
  v_mfma_f32_16x16x32_bf16 v[72:75], a[32:35], a[16:19], v[72:75]
  s_cmp_eq_u32 s81, 14
  s_cselect_b32 s81, 0, s81
  v_mfma_f32_16x16x32_bf16 v[12:15], a[36:39], a[12:15], v[12:15]
  s_lshl_b32 s88, s87, 18
  s_add_u32 s88, s88, 256
  v_mfma_f32_16x16x32_bf16 v[76:79], a[36:39], a[16:19], v[76:79]
  s_add_u32 s87, s87, 1
  s_add_u32 m0, s86, 8192
  s_add_u32 s89, s88, 0
  buffer_load_dwordx4 v200, s[20:23], s89 offen offset:0 lds
  buffer_load_dwordx4 v201, s[20:23], s89 offen offset:1024 lds
  buffer_load_dwordx4 v202, s[20:23], s89 offen offset:2048 lds
  buffer_load_dwordx4 v203, s[20:23], s89 offen offset:3072 lds
  s_add_u32 m0, s86, 12288
  s_add_u32 s89, s88, 131072
  buffer_load_dwordx4 v200, s[20:23], s89 offen offset:0 lds
  buffer_load_dwordx4 v201, s[20:23], s89 offen offset:1024 lds
  buffer_load_dwordx4 v202, s[20:23], s89 offen offset:2048 lds
  buffer_load_dwordx4 v203, s[20:23], s89 offen offset:3072 lds
  s_cmp_eq_u32 s87, 14
  s_cselect_b32 s87, 0, s87
  s_waitcnt lgkmcnt(0)
  s_waitcnt vmcnt(18)
  s_barrier
  v_mfma_f32_16x16x32_bf16 v[16:19], a[40:43], a[12:15], v[16:19]
  ds_read_b64_tr_b16 a[24:25], v192 offset:24576
  ds_read_b64_tr_b16 a[26:27], v192 offset:25600
  v_mfma_f32_16x16x32_bf16 v[80:83], a[40:43], a[16:19], v[80:83]
  ds_read_b64_tr_b16 a[28:29], v192 offset:24584
  ds_read_b64_tr_b16 a[30:31], v192 offset:25608
  v_mfma_f32_16x16x32_bf16 v[20:23], a[44:47], a[12:15], v[20:23]
  ds_read_b64_tr_b16 a[32:33], v193 offset:24576
  ds_read_b64_tr_b16 a[34:35], v193 offset:25600
  v_mfma_f32_16x16x32_bf16 v[84:87], a[44:47], a[16:19], v[84:87]
  ds_read_b64_tr_b16 a[36:37], v193 offset:24584
  ds_read_b64_tr_b16 a[38:39], v193 offset:25608
  v_mfma_f32_16x16x32_bf16 v[24:27], a[48:51], a[12:15], v[24:27]
  ds_read_b64_tr_b16 a[56:57], v194 offset:24576
  ds_read_b64_tr_b16 a[58:59], v194 offset:25600
  v_mfma_f32_16x16x32_bf16 v[88:91], a[48:51], a[16:19], v[88:91]
  ds_read_b64_tr_b16 a[60:61], v194 offset:24584
  ds_read_b64_tr_b16 a[62:63], v194 offset:25608
  v_mfma_f32_16x16x32_bf16 v[28:31], a[52:55], a[12:15], v[28:31]
  ds_read_b64_tr_b16 a[64:65], v195 offset:24576
  ds_read_b64_tr_b16 a[66:67], v195 offset:25600
  v_mfma_f32_16x16x32_bf16 v[92:95], a[52:55], a[16:19], v[92:95]
  ds_read_b64_tr_b16 a[68:69], v195 offset:24584
  ds_read_b64_tr_b16 a[70:71], v195 offset:25608
  s_waitcnt lgkmcnt(8)
  v_mfma_f32_16x16x32_bf16 v[32:35], a[24:27], a[12:15], v[32:35]
  s_lshl_b32 s88, s87, 18
  s_add_u32 m0, s86, 16384
  v_mfma_f32_16x16x32_bf16 v[96:99], a[24:27], a[16:19], v[96:99]
  s_add_u32 s89, s88, 0
  buffer_load_dwordx4 v200, s[20:23], s89 offen offset:0 lds
  v_mfma_f32_16x16x32_bf16 v[36:39], a[28:31], a[12:15], v[36:39]
  buffer_load_dwordx4 v201, s[20:23], s89 offen offset:1024 lds
  buffer_load_dwordx4 v202, s[20:23], s89 offen offset:2048 lds
  v_mfma_f32_16x16x32_bf16 v[100:103], a[28:31], a[16:19], v[100:103]
  buffer_load_dwordx4 v203, s[20:23], s89 offen offset:3072 lds
  s_add_u32 m0, s86, 20480
  v_mfma_f32_16x16x32_bf16 v[40:43], a[32:35], a[12:15], v[40:43]
  s_add_u32 s89, s88, 131072
  buffer_load_dwordx4 v200, s[20:23], s89 offen offset:0 lds
  v_mfma_f32_16x16x32_bf16 v[104:107], a[32:35], a[16:19], v[104:107]
  buffer_load_dwordx4 v201, s[20:23], s89 offen offset:1024 lds
  buffer_load_dwordx4 v202, s[20:23], s89 offen offset:2048 lds
  v_mfma_f32_16x16x32_bf16 v[44:47], a[36:39], a[12:15], v[44:47]
  buffer_load_dwordx4 v203, s[20:23], s89 offen offset:3072 lds
  v_mfma_f32_16x16x32_bf16 v[108:111], a[36:39], a[16:19], v[108:111]
  s_waitcnt lgkmcnt(0)
  s_waitcnt vmcnt(18)
  s_barrier
  v_mfma_f32_16x16x32_bf16 v[48:51], a[56:59], a[12:15], v[48:51]
  ds_read_b128 a[0:3], v206 offset:10240
  ds_read_b128 a[4:7], v206 offset:11264
  v_mfma_f32_16x16x32_bf16 v[112:115], a[56:59], a[16:19], v[112:115]
  ds_read_b64_tr_b16 a[24:25], v192 offset:0
  ds_read_b64_tr_b16 a[26:27], v192 offset:1024
  v_mfma_f32_16x16x32_bf16 v[52:55], a[60:63], a[12:15], v[52:55]
  ds_read_b64_tr_b16 a[28:29], v192 offset:8
  ds_read_b64_tr_b16 a[30:31], v192 offset:1032
  v_mfma_f32_16x16x32_bf16 v[116:119], a[60:63], a[16:19], v[116:119]
  ds_read_b64_tr_b16 a[32:33], v193 offset:0
  ds_read_b64_tr_b16 a[34:35], v193 offset:1024
  v_mfma_f32_16x16x32_bf16 v[56:59], a[64:67], a[12:15], v[56:59]
  ds_read_b64_tr_b16 a[36:37], v193 offset:8
  ds_read_b64_tr_b16 a[38:39], v193 offset:1032
  v_mfma_f32_16x16x32_bf16 v[120:123], a[64:67], a[16:19], v[120:123]
  ds_read_b64_tr_b16 a[40:41], v194 offset:0
  ds_read_b64_tr_b16 a[42:43], v194 offset:1024
  v_mfma_f32_16x16x32_bf16 v[60:63], a[68:71], a[12:15], v[60:63]
  ds_read_b64_tr_b16 a[44:45], v194 offset:8
  ds_read_b64_tr_b16 a[46:47], v194 offset:1032
  v_mfma_f32_16x16x32_bf16 v[124:127], a[68:71], a[16:19], v[124:127]
  ds_read_b64_tr_b16 a[48:49], v195 offset:0
  ds_read_b64_tr_b16 a[50:51], v195 offset:1024
  ds_read_b64_tr_b16 a[52:53], v195 offset:8
  ds_read_b64_tr_b16 a[54:55], v195 offset:1032
  s_waitcnt lgkmcnt(8)
  v_mfma_f32_16x16x32_bf16 v[0:3], a[24:27], a[0:3], v[0:3]
  s_lshl_b32 s82, s81, 6
  s_add_u32 s82, s82, s83
  v_mfma_f32_16x16x32_bf16 v[64:67], a[24:27], a[4:7], v[64:67]
  s_add_u32 s81, s81, 1
  s_add_u32 m0, s84, 54272
  v_mfma_f32_16x16x32_bf16 v[4:7], a[28:31], a[0:3], v[4:7]
  s_add_u32 s78, s82, 0
  buffer_load_dwordx4 v205, s[16:19], s78 offen lds
  v_mfma_f32_16x16x32_bf16 v[68:71], a[28:31], a[4:7], v[68:71]
  s_add_u32 m0, s84, 55296
  s_add_u32 s78, s82, 14336
  v_mfma_f32_16x16x32_bf16 v[8:11], a[32:35], a[0:3], v[8:11]
  buffer_load_dwordx4 v205, s[16:19], s78 offen lds
  s_cmp_eq_u32 s59, 1
  s_cbranch_scc1 L_xskip_1_10
  s_add_u32 m0, s84, 56320
  s_add_u32 s78, s82, 28672
  buffer_load_dwordx4 v205, s[16:19], s78 offen lds
L_xskip_1_10:
  v_mfma_f32_16x16x32_bf16 v[72:75], a[32:35], a[4:7], v[72:75]
  s_cmp_eq_u32 s81, 14
  s_cselect_b32 s81, 0, s81
  v_mfma_f32_16x16x32_bf16 v[12:15], a[36:39], a[0:3], v[12:15]
  s_lshl_b32 s88, s87, 18
  s_add_u32 s88, s88, 256
  v_mfma_f32_16x16x32_bf16 v[76:79], a[36:39], a[4:7], v[76:79]
  s_add_u32 s87, s87, 1
  s_add_u32 m0, s86, 24576
  s_add_u32 s89, s88, 0
  buffer_load_dwordx4 v200, s[20:23], s89 offen offset:0 lds
  buffer_load_dwordx4 v201, s[20:23], s89 offen offset:1024 lds
  buffer_load_dwordx4 v202, s[20:23], s89 offen offset:2048 lds
  buffer_load_dwordx4 v203, s[20:23], s89 offen offset:3072 lds
  s_add_u32 m0, s86, 28672
  s_add_u32 s89, s88, 131072
  buffer_load_dwordx4 v200, s[20:23], s89 offen offset:0 lds
  buffer_load_dwordx4 v201, s[20:23], s89 offen offset:1024 lds
  buffer_load_dwordx4 v202, s[20:23], s89 offen offset:2048 lds
  buffer_load_dwordx4 v203, s[20:23], s89 offen offset:3072 lds
  s_cmp_eq_u32 s87, 14
  s_cselect_b32 s87, 0, s87
  s_waitcnt lgkmcnt(0)
  s_waitcnt vmcnt(18)
  s_barrier
  v_mfma_f32_16x16x32_bf16 v[16:19], a[40:43], a[0:3], v[16:19]
  ds_read_b64_tr_b16 a[24:25], v192 offset:8192
  ds_read_b64_tr_b16 a[26:27], v192 offset:9216
  v_mfma_f32_16x16x32_bf16 v[80:83], a[40:43], a[4:7], v[80:83]
  ds_read_b64_tr_b16 a[28:29], v192 offset:8200
  ds_read_b64_tr_b16 a[30:31], v192 offset:9224
  v_mfma_f32_16x16x32_bf16 v[20:23], a[44:47], a[0:3], v[20:23]
  ds_read_b64_tr_b16 a[32:33], v193 offset:8192
  ds_read_b64_tr_b16 a[34:35], v193 offset:9216
  v_mfma_f32_16x16x32_bf16 v[84:87], a[44:47], a[4:7], v[84:87]
  ds_read_b64_tr_b16 a[36:37], v193 offset:8200
  ds_read_b64_tr_b16 a[38:39], v193 offset:9224
  v_mfma_f32_16x16x32_bf16 v[24:27], a[48:51], a[0:3], v[24:27]
  ds_read_b64_tr_b16 a[56:57], v194 offset:8192
  ds_read_b64_tr_b16 a[58:59], v194 offset:9216
  v_mfma_f32_16x16x32_bf16 v[88:91], a[48:51], a[4:7], v[88:91]
  ds_read_b64_tr_b16 a[60:61], v194 offset:8200
  ds_read_b64_tr_b16 a[62:63], v194 offset:9224
  v_mfma_f32_16x16x32_bf16 v[28:31], a[52:55], a[0:3], v[28:31]
  ds_read_b64_tr_b16 a[64:65], v195 offset:8192
  ds_read_b64_tr_b16 a[66:67], v195 offset:9216
  v_mfma_f32_16x16x32_bf16 v[92:95], a[52:55], a[4:7], v[92:95]
  ds_read_b64_tr_b16 a[68:69], v195 offset:8200
  ds_read_b64_tr_b16 a[70:71], v195 offset:9224
  s_waitcnt lgkmcnt(8)
  v_mfma_f32_16x16x32_bf16 v[32:35], a[24:27], a[0:3], v[32:35]
  s_lshl_b32 s88, s87, 18
  s_add_u32 m0, s86, 0
  v_mfma_f32_16x16x32_bf16 v[96:99], a[24:27], a[4:7], v[96:99]
  s_add_u32 s89, s88, 0
  buffer_load_dwordx4 v200, s[20:23], s89 offen offset:0 lds
  v_mfma_f32_16x16x32_bf16 v[36:39], a[28:31], a[0:3], v[36:39]
  buffer_load_dwordx4 v201, s[20:23], s89 offen offset:1024 lds
  buffer_load_dwordx4 v202, s[20:23], s89 offen offset:2048 lds
  v_mfma_f32_16x16x32_bf16 v[100:103], a[28:31], a[4:7], v[100:103]
  buffer_load_dwordx4 v203, s[20:23], s89 offen offset:3072 lds
  s_add_u32 m0, s86, 4096
  v_mfma_f32_16x16x32_bf16 v[40:43], a[32:35], a[0:3], v[40:43]
  s_add_u32 s89, s88, 131072
  buffer_load_dwordx4 v200, s[20:23], s89 offen offset:0 lds
  v_mfma_f32_16x16x32_bf16 v[104:107], a[32:35], a[4:7], v[104:107]
  buffer_load_dwordx4 v201, s[20:23], s89 offen offset:1024 lds
  buffer_load_dwordx4 v202, s[20:23], s89 offen offset:2048 lds
  v_mfma_f32_16x16x32_bf16 v[44:47], a[36:39], a[0:3], v[44:47]
  buffer_load_dwordx4 v203, s[20:23], s89 offen offset:3072 lds
  v_mfma_f32_16x16x32_bf16 v[108:111], a[36:39], a[4:7], v[108:111]
  s_waitcnt lgkmcnt(0)
  s_waitcnt vmcnt(18)
  s_barrier
  v_mfma_f32_16x16x32_bf16 v[48:51], a[56:59], a[0:3], v[48:51]
  ds_read_b128 a[12:15], v206 offset:0
  ds_read_b128 a[16:19], v206 offset:1024
  v_mfma_f32_16x16x32_bf16 v[112:115], a[56:59], a[4:7], v[112:115]
  ds_read_b64_tr_b16 a[24:25], v192 offset:16384
  ds_read_b64_tr_b16 a[26:27], v192 offset:17408
  v_mfma_f32_16x16x32_bf16 v[52:55], a[60:63], a[0:3], v[52:55]
  ds_read_b64_tr_b16 a[28:29], v192 offset:16392
  ds_read_b64_tr_b16 a[30:31], v192 offset:17416
  v_mfma_f32_16x16x32_bf16 v[116:119], a[60:63], a[4:7], v[116:119]
  ds_read_b64_tr_b16 a[32:33], v193 offset:16384
  ds_read_b64_tr_b16 a[34:35], v193 offset:17408
  v_mfma_f32_16x16x32_bf16 v[56:59], a[64:67], a[0:3], v[56:59]
  ds_read_b64_tr_b16 a[36:37], v193 offset:16392
  ds_read_b64_tr_b16 a[38:39], v193 offset:17416
  v_mfma_f32_16x16x32_bf16 v[120:123], a[64:67], a[4:7], v[120:123]
  ds_read_b64_tr_b16 a[40:41], v194 offset:16384
  ds_read_b64_tr_b16 a[42:43], v194 offset:17408
  v_mfma_f32_16x16x32_bf16 v[60:63], a[68:71], a[0:3], v[60:63]
  ds_read_b64_tr_b16 a[44:45], v194 offset:16392
  ds_read_b64_tr_b16 a[46:47], v194 offset:17416
  v_mfma_f32_16x16x32_bf16 v[124:127], a[68:71], a[4:7], v[124:127]
  ds_read_b64_tr_b16 a[48:49], v195 offset:16384
  ds_read_b64_tr_b16 a[50:51], v195 offset:17408
  ds_read_b64_tr_b16 a[52:53], v195 offset:16392
  ds_read_b64_tr_b16 a[54:55], v195 offset:17416
  s_waitcnt lgkmcnt(8)
  v_mfma_f32_16x16x32_bf16 v[0:3], a[24:27], a[12:15], v[0:3]
  s_lshl_b32 s82, s81, 6
  s_add_u32 s82, s82, s83
  v_mfma_f32_16x16x32_bf16 v[64:67], a[24:27], a[16:19], v[64:67]
  s_add_u32 s81, s81, 1
  s_add_u32 m0, s84, 59392
  v_mfma_f32_16x16x32_bf16 v[4:7], a[28:31], a[12:15], v[4:7]
  s_add_u32 s78, s82, 0
  buffer_load_dwordx4 v205, s[16:19], s78 offen lds
  v_mfma_f32_16x16x32_bf16 v[68:71], a[28:31], a[16:19], v[68:71]
  s_add_u32 m0, s84, 60416
  s_add_u32 s78, s82, 14336
  v_mfma_f32_16x16x32_bf16 v[8:11], a[32:35], a[12:15], v[8:11]
  buffer_load_dwordx4 v205, s[16:19], s78 offen lds
  s_cmp_eq_u32 s59, 1
  s_cbranch_scc1 L_xskip_1_11
  s_add_u32 m0, s84, 61440
  s_add_u32 s78, s82, 28672
  buffer_load_dwordx4 v205, s[16:19], s78 offen lds
L_xskip_1_11:
  v_mfma_f32_16x16x32_bf16 v[72:75], a[32:35], a[16:19], v[72:75]
  s_cmp_eq_u32 s81, 14
  s_cselect_b32 s81, 0, s81
  v_mfma_f32_16x16x32_bf16 v[12:15], a[36:39], a[12:15], v[12:15]
  s_lshl_b32 s88, s87, 18
  s_add_u32 s88, s88, 256
  v_mfma_f32_16x16x32_bf16 v[76:79], a[36:39], a[16:19], v[76:79]
  s_add_u32 s87, s87, 1
  s_add_u32 m0, s86, 8192
  s_add_u32 s89, s88, 0
  buffer_load_dwordx4 v200, s[20:23], s89 offen offset:0 lds
  buffer_load_dwordx4 v201, s[20:23], s89 offen offset:1024 lds
  buffer_load_dwordx4 v202, s[20:23], s89 offen offset:2048 lds
  buffer_load_dwordx4 v203, s[20:23], s89 offen offset:3072 lds
  s_add_u32 m0, s86, 12288
  s_add_u32 s89, s88, 131072
  buffer_load_dwordx4 v200, s[20:23], s89 offen offset:0 lds
  buffer_load_dwordx4 v201, s[20:23], s89 offen offset:1024 lds
  buffer_load_dwordx4 v202, s[20:23], s89 offen offset:2048 lds
  buffer_load_dwordx4 v203, s[20:23], s89 offen offset:3072 lds
  s_cmp_eq_u32 s87, 14
  s_cselect_b32 s87, 0, s87
  s_waitcnt lgkmcnt(0)
  s_waitcnt vmcnt(18)
  s_barrier
  v_mfma_f32_16x16x32_bf16 v[16:19], a[40:43], a[12:15], v[16:19]
  ds_read_b64_tr_b16 a[24:25], v192 offset:24576
  ds_read_b64_tr_b16 a[26:27], v192 offset:25600
  v_mfma_f32_16x16x32_bf16 v[80:83], a[40:43], a[16:19], v[80:83]
  ds_read_b64_tr_b16 a[28:29], v192 offset:24584
  ds_read_b64_tr_b16 a[30:31], v192 offset:25608
  v_mfma_f32_16x16x32_bf16 v[20:23], a[44:47], a[12:15], v[20:23]
  ds_read_b64_tr_b16 a[32:33], v193 offset:24576
  ds_read_b64_tr_b16 a[34:35], v193 offset:25600
  v_mfma_f32_16x16x32_bf16 v[84:87], a[44:47], a[16:19], v[84:87]
  ds_read_b64_tr_b16 a[36:37], v193 offset:24584
  ds_read_b64_tr_b16 a[38:39], v193 offset:25608
  v_mfma_f32_16x16x32_bf16 v[24:27], a[48:51], a[12:15], v[24:27]
  ds_read_b64_tr_b16 a[56:57], v194 offset:24576
  ds_read_b64_tr_b16 a[58:59], v194 offset:25600
  v_mfma_f32_16x16x32_bf16 v[88:91], a[48:51], a[16:19], v[88:91]
  ds_read_b64_tr_b16 a[60:61], v194 offset:24584
  ds_read_b64_tr_b16 a[62:63], v194 offset:25608
  v_mfma_f32_16x16x32_bf16 v[28:31], a[52:55], a[12:15], v[28:31]
  ds_read_b64_tr_b16 a[64:65], v195 offset:24576
  ds_read_b64_tr_b16 a[66:67], v195 offset:25600
  v_mfma_f32_16x16x32_bf16 v[92:95], a[52:55], a[16:19], v[92:95]
  ds_read_b64_tr_b16 a[68:69], v195 offset:24584
  ds_read_b64_tr_b16 a[70:71], v195 offset:25608
  s_waitcnt lgkmcnt(8)
  v_mfma_f32_16x16x32_bf16 v[32:35], a[24:27], a[12:15], v[32:35]
  s_lshl_b32 s88, s87, 18
  s_add_u32 m0, s86, 16384
  v_mfma_f32_16x16x32_bf16 v[96:99], a[24:27], a[16:19], v[96:99]
  s_add_u32 s89, s88, 0
  buffer_load_dwordx4 v200, s[20:23], s89 offen offset:0 lds
  v_mfma_f32_16x16x32_bf16 v[36:39], a[28:31], a[12:15], v[36:39]
  buffer_load_dwordx4 v201, s[20:23], s89 offen offset:1024 lds
  buffer_load_dwordx4 v202, s[20:23], s89 offen offset:2048 lds
  v_mfma_f32_16x16x32_bf16 v[100:103], a[28:31], a[16:19], v[100:103]
  buffer_load_dwordx4 v203, s[20:23], s89 offen offset:3072 lds
  s_add_u32 m0, s86, 20480
  v_mfma_f32_16x16x32_bf16 v[40:43], a[32:35], a[12:15], v[40:43]
  s_add_u32 s89, s88, 131072
  buffer_load_dwordx4 v200, s[20:23], s89 offen offset:0 lds
  v_mfma_f32_16x16x32_bf16 v[104:107], a[32:35], a[16:19], v[104:107]
  buffer_load_dwordx4 v201, s[20:23], s89 offen offset:1024 lds
  buffer_load_dwordx4 v202, s[20:23], s89 offen offset:2048 lds
  v_mfma_f32_16x16x32_bf16 v[44:47], a[36:39], a[12:15], v[44:47]
  buffer_load_dwordx4 v203, s[20:23], s89 offen offset:3072 lds
  v_mfma_f32_16x16x32_bf16 v[108:111], a[36:39], a[16:19], v[108:111]
  s_waitcnt lgkmcnt(0)
  s_waitcnt vmcnt(18)
  s_barrier
  v_mfma_f32_16x16x32_bf16 v[48:51], a[56:59], a[12:15], v[48:51]
  ds_read_b128 a[0:3], v206 offset:5120
  ds_read_b128 a[4:7], v206 offset:6144
  v_mfma_f32_16x16x32_bf16 v[112:115], a[56:59], a[16:19], v[112:115]
  ds_read_b64_tr_b16 a[24:25], v192 offset:0
  ds_read_b64_tr_b16 a[26:27], v192 offset:1024
  v_mfma_f32_16x16x32_bf16 v[52:55], a[60:63], a[12:15], v[52:55]
  ds_read_b64_tr_b16 a[28:29], v192 offset:8
  ds_read_b64_tr_b16 a[30:31], v192 offset:1032
  v_mfma_f32_16x16x32_bf16 v[116:119], a[60:63], a[16:19], v[116:119]
  ds_read_b64_tr_b16 a[32:33], v193 offset:0
  ds_read_b64_tr_b16 a[34:35], v193 offset:1024
  v_mfma_f32_16x16x32_bf16 v[56:59], a[64:67], a[12:15], v[56:59]
  ds_read_b64_tr_b16 a[36:37], v193 offset:8
  ds_read_b64_tr_b16 a[38:39], v193 offset:1032
  v_mfma_f32_16x16x32_bf16 v[120:123], a[64:67], a[16:19], v[120:123]
  ds_read_b64_tr_b16 a[40:41], v194 offset:0
  ds_read_b64_tr_b16 a[42:43], v194 offset:1024
  v_mfma_f32_16x16x32_bf16 v[60:63], a[68:71], a[12:15], v[60:63]
  ds_read_b64_tr_b16 a[44:45], v194 offset:8
  ds_read_b64_tr_b16 a[46:47], v194 offset:1032
  v_mfma_f32_16x16x32_bf16 v[124:127], a[68:71], a[16:19], v[124:127]
  ds_read_b64_tr_b16 a[48:49], v195 offset:0
  ds_read_b64_tr_b16 a[50:51], v195 offset:1024
  ds_read_b64_tr_b16 a[52:53], v195 offset:8
  ds_read_b64_tr_b16 a[54:55], v195 offset:1032
  s_waitcnt lgkmcnt(8)
  v_mfma_f32_16x16x32_bf16 v[0:3], a[24:27], a[0:3], v[0:3]
  s_lshl_b32 s82, s81, 6
  s_add_u32 s82, s82, s83
  v_mfma_f32_16x16x32_bf16 v[64:67], a[24:27], a[4:7], v[64:67]
  s_add_u32 s81, s81, 1
  s_add_u32 m0, s84, 49152
  v_mfma_f32_16x16x32_bf16 v[4:7], a[28:31], a[0:3], v[4:7]
  s_add_u32 s78, s82, 0
  buffer_load_dwordx4 v205, s[16:19], s78 offen lds
  v_mfma_f32_16x16x32_bf16 v[68:71], a[28:31], a[4:7], v[68:71]
  s_add_u32 m0, s84, 50176
  s_add_u32 s78, s82, 14336
  v_mfma_f32_16x16x32_bf16 v[8:11], a[32:35], a[0:3], v[8:11]
  buffer_load_dwordx4 v205, s[16:19], s78 offen lds
  s_cmp_eq_u32 s59, 1
  s_cbranch_scc1 L_xskip_1_12
  s_add_u32 m0, s84, 51200
  s_add_u32 s78, s82, 28672
  buffer_load_dwordx4 v205, s[16:19], s78 offen lds
L_xskip_1_12:
  v_mfma_f32_16x16x32_bf16 v[72:75], a[32:35], a[4:7], v[72:75]
  s_cmp_eq_u32 s81, 14
  s_cselect_b32 s81, 0, s81
  v_mfma_f32_16x16x32_bf16 v[12:15], a[36:39], a[0:3], v[12:15]
  s_lshl_b32 s88, s87, 18
  s_add_u32 s88, s88, 256
  v_mfma_f32_16x16x32_bf16 v[76:79], a[36:39], a[4:7], v[76:79]
  s_add_u32 s87, s87, 1
  s_add_u32 m0, s86, 24576
  s_add_u32 s89, s88, 0
  buffer_load_dwordx4 v200, s[20:23], s89 offen offset:0 lds
  buffer_load_dwordx4 v201, s[20:23], s89 offen offset:1024 lds
  buffer_load_dwordx4 v202, s[20:23], s89 offen offset:2048 lds
  buffer_load_dwordx4 v203, s[20:23], s89 offen offset:3072 lds
  s_add_u32 m0, s86, 28672
  s_add_u32 s89, s88, 131072
  buffer_load_dwordx4 v200, s[20:23], s89 offen offset:0 lds
  buffer_load_dwordx4 v201, s[20:23], s89 offen offset:1024 lds
  buffer_load_dwordx4 v202, s[20:23], s89 offen offset:2048 lds
  buffer_load_dwordx4 v203, s[20:23], s89 offen offset:3072 lds
  s_cmp_eq_u32 s87, 14
  s_cselect_b32 s87, 0, s87
  s_waitcnt lgkmcnt(0)
  s_waitcnt vmcnt(18)
  s_barrier
  v_mfma_f32_16x16x32_bf16 v[16:19], a[40:43], a[0:3], v[16:19]
  ds_read_b64_tr_b16 a[24:25], v192 offset:8192
  ds_read_b64_tr_b16 a[26:27], v192 offset:9216
  v_mfma_f32_16x16x32_bf16 v[80:83], a[40:43], a[4:7], v[80:83]
  ds_read_b64_tr_b16 a[28:29], v192 offset:8200
  ds_read_b64_tr_b16 a[30:31], v192 offset:9224
  v_mfma_f32_16x16x32_bf16 v[20:23], a[44:47], a[0:3], v[20:23]
  ds_read_b64_tr_b16 a[32:33], v193 offset:8192
  ds_read_b64_tr_b16 a[34:35], v193 offset:9216
  v_mfma_f32_16x16x32_bf16 v[84:87], a[44:47], a[4:7], v[84:87]
  ds_read_b64_tr_b16 a[36:37], v193 offset:8200
  ds_read_b64_tr_b16 a[38:39], v193 offset:9224
  v_mfma_f32_16x16x32_bf16 v[24:27], a[48:51], a[0:3], v[24:27]
  ds_read_b64_tr_b16 a[56:57], v194 offset:8192
  ds_read_b64_tr_b16 a[58:59], v194 offset:9216
  v_mfma_f32_16x16x32_bf16 v[88:91], a[48:51], a[4:7], v[88:91]
  ds_read_b64_tr_b16 a[60:61], v194 offset:8200
  ds_read_b64_tr_b16 a[62:63], v194 offset:9224
  v_mfma_f32_16x16x32_bf16 v[28:31], a[52:55], a[0:3], v[28:31]
  ds_read_b64_tr_b16 a[64:65], v195 offset:8192
  ds_read_b64_tr_b16 a[66:67], v195 offset:9216
  v_mfma_f32_16x16x32_bf16 v[92:95], a[52:55], a[4:7], v[92:95]
  ds_read_b64_tr_b16 a[68:69], v195 offset:8200
  ds_read_b64_tr_b16 a[70:71], v195 offset:9224
  s_waitcnt lgkmcnt(8)
  v_mfma_f32_16x16x32_bf16 v[32:35], a[24:27], a[0:3], v[32:35]
  s_lshl_b32 s88, s87, 18
  s_add_u32 m0, s86, 0
  v_mfma_f32_16x16x32_bf16 v[96:99], a[24:27], a[4:7], v[96:99]
  s_add_u32 s89, s88, 0
  buffer_load_dwordx4 v200, s[20:23], s89 offen offset:0 lds
  v_mfma_f32_16x16x32_bf16 v[36:39], a[28:31], a[0:3], v[36:39]
  buffer_load_dwordx4 v201, s[20:23], s89 offen offset:1024 lds
  buffer_load_dwordx4 v202, s[20:23], s89 offen offset:2048 lds
  v_mfma_f32_16x16x32_bf16 v[100:103], a[28:31], a[4:7], v[100:103]
  buffer_load_dwordx4 v203, s[20:23], s89 offen offset:3072 lds
  s_add_u32 m0, s86, 4096
  v_mfma_f32_16x16x32_bf16 v[40:43], a[32:35], a[0:3], v[40:43]
  s_add_u32 s89, s88, 131072
  buffer_load_dwordx4 v200, s[20:23], s89 offen offset:0 lds
  v_mfma_f32_16x16x32_bf16 v[104:107], a[32:35], a[4:7], v[104:107]
  buffer_load_dwordx4 v201, s[20:23], s89 offen offset:1024 lds
  buffer_load_dwordx4 v202, s[20:23], s89 offen offset:2048 lds
  v_mfma_f32_16x16x32_bf16 v[44:47], a[36:39], a[0:3], v[44:47]
  buffer_load_dwordx4 v203, s[20:23], s89 offen offset:3072 lds
  v_mfma_f32_16x16x32_bf16 v[108:111], a[36:39], a[4:7], v[108:111]
  s_waitcnt lgkmcnt(0)
  s_waitcnt vmcnt(18)
  s_barrier
  v_mfma_f32_16x16x32_bf16 v[48:51], a[56:59], a[0:3], v[48:51]
  ds_read_b128 a[12:15], v206 offset:10240
  ds_read_b128 a[16:19], v206 offset:11264
  v_mfma_f32_16x16x32_bf16 v[112:115], a[56:59], a[4:7], v[112:115]
  ds_read_b64_tr_b16 a[24:25], v192 offset:16384
  ds_read_b64_tr_b16 a[26:27], v192 offset:17408
  v_mfma_f32_16x16x32_bf16 v[52:55], a[60:63], a[0:3], v[52:55]
  ds_read_b64_tr_b16 a[28:29], v192 offset:16392
  ds_read_b64_tr_b16 a[30:31], v192 offset:17416
  v_mfma_f32_16x16x32_bf16 v[116:119], a[60:63], a[4:7], v[116:119]
  ds_read_b64_tr_b16 a[32:33], v193 offset:16384
  ds_read_b64_tr_b16 a[34:35], v193 offset:17408
  v_mfma_f32_16x16x32_bf16 v[56:59], a[64:67], a[0:3], v[56:59]
  ds_read_b64_tr_b16 a[36:37], v193 offset:16392
  ds_read_b64_tr_b16 a[38:39], v193 offset:17416
  v_mfma_f32_16x16x32_bf16 v[120:123], a[64:67], a[4:7], v[120:123]
  ds_read_b64_tr_b16 a[40:41], v194 offset:16384
  ds_read_b64_tr_b16 a[42:43], v194 offset:17408
  v_mfma_f32_16x16x32_bf16 v[60:63], a[68:71], a[0:3], v[60:63]
  ds_read_b64_tr_b16 a[44:45], v194 offset:16392
  ds_read_b64_tr_b16 a[46:47], v194 offset:17416
  v_mfma_f32_16x16x32_bf16 v[124:127], a[68:71], a[4:7], v[124:127]
  ds_read_b64_tr_b16 a[48:49], v195 offset:16384
  ds_read_b64_tr_b16 a[50:51], v195 offset:17408
  ds_read_b64_tr_b16 a[52:53], v195 offset:16392
  ds_read_b64_tr_b16 a[54:55], v195 offset:17416
  s_waitcnt lgkmcnt(8)
  v_mfma_f32_16x16x32_bf16 v[0:3], a[24:27], a[12:15], v[0:3]
  s_lshl_b32 s82, s81, 6
  s_add_u32 s82, s82, s83
  v_mfma_f32_16x16x32_bf16 v[64:67], a[24:27], a[16:19], v[64:67]
  s_add_u32 s81, s81, 1
  s_add_u32 m0, s84, 54272
  v_mfma_f32_16x16x32_bf16 v[4:7], a[28:31], a[12:15], v[4:7]
  s_add_u32 s78, s82, 0
  buffer_load_dwordx4 v205, s[16:19], s78 offen lds
  v_mfma_f32_16x16x32_bf16 v[68:71], a[28:31], a[16:19], v[68:71]
  s_add_u32 m0, s84, 55296
  s_add_u32 s78, s82, 14336
  v_mfma_f32_16x16x32_bf16 v[8:11], a[32:35], a[12:15], v[8:11]
  buffer_load_dwordx4 v205, s[16:19], s78 offen lds
  s_cmp_eq_u32 s59, 1
  s_cbranch_scc1 L_xskip_1_13
  s_add_u32 m0, s84, 56320
  s_add_u32 s78, s82, 28672
  buffer_load_dwordx4 v205, s[16:19], s78 offen lds
L_xskip_1_13:
  v_mfma_f32_16x16x32_bf16 v[72:75], a[32:35], a[16:19], v[72:75]
  s_cmp_eq_u32 s81, 14
  s_cselect_b32 s81, 0, s81
  v_mfma_f32_16x16x32_bf16 v[12:15], a[36:39], a[12:15], v[12:15]
  s_lshl_b32 s88, s87, 18
  s_add_u32 s88, s88, 256
  v_mfma_f32_16x16x32_bf16 v[76:79], a[36:39], a[16:19], v[76:79]
  s_add_u32 s87, s87, 1
  s_add_u32 m0, s86, 8192
  s_add_u32 s89, s88, 0
  buffer_load_dwordx4 v200, s[20:23], s89 offen offset:0 lds
  buffer_load_dwordx4 v201, s[20:23], s89 offen offset:1024 lds
  buffer_load_dwordx4 v202, s[20:23], s89 offen offset:2048 lds
  buffer_load_dwordx4 v203, s[20:23], s89 offen offset:3072 lds
  s_add_u32 m0, s86, 12288
  s_add_u32 s89, s88, 131072
  buffer_load_dwordx4 v200, s[20:23], s89 offen offset:0 lds
  buffer_load_dwordx4 v201, s[20:23], s89 offen offset:1024 lds
  buffer_load_dwordx4 v202, s[20:23], s89 offen offset:2048 lds
  buffer_load_dwordx4 v203, s[20:23], s89 offen offset:3072 lds
  s_cmp_eq_u32 s87, 14
  s_cselect_b32 s87, 0, s87
  s_waitcnt lgkmcnt(0)
  s_waitcnt vmcnt(18)
  s_barrier
  v_mfma_f32_16x16x32_bf16 v[16:19], a[40:43], a[12:15], v[16:19]
  ds_read_b64_tr_b16 a[24:25], v192 offset:24576
  ds_read_b64_tr_b16 a[26:27], v192 offset:25600
  v_mfma_f32_16x16x32_bf16 v[80:83], a[40:43], a[16:19], v[80:83]
  ds_read_b64_tr_b16 a[28:29], v192 offset:24584
  ds_read_b64_tr_b16 a[30:31], v192 offset:25608
  v_mfma_f32_16x16x32_bf16 v[20:23], a[44:47], a[12:15], v[20:23]
  ds_read_b64_tr_b16 a[32:33], v193 offset:24576
  ds_read_b64_tr_b16 a[34:35], v193 offset:25600
  v_mfma_f32_16x16x32_bf16 v[84:87], a[44:47], a[16:19], v[84:87]
  ds_read_b64_tr_b16 a[36:37], v193 offset:24584
  ds_read_b64_tr_b16 a[38:39], v193 offset:25608
  v_mfma_f32_16x16x32_bf16 v[24:27], a[48:51], a[12:15], v[24:27]
  ds_read_b64_tr_b16 a[56:57], v194 offset:24576
  ds_read_b64_tr_b16 a[58:59], v194 offset:25600
  v_mfma_f32_16x16x32_bf16 v[88:91], a[48:51], a[16:19], v[88:91]
  ds_read_b64_tr_b16 a[60:61], v194 offset:24584
  ds_read_b64_tr_b16 a[62:63], v194 offset:25608
  v_mfma_f32_16x16x32_bf16 v[28:31], a[52:55], a[12:15], v[28:31]
  ds_read_b64_tr_b16 a[64:65], v195 offset:24576
  ds_read_b64_tr_b16 a[66:67], v195 offset:25600
  v_mfma_f32_16x16x32_bf16 v[92:95], a[52:55], a[16:19], v[92:95]
  ds_read_b64_tr_b16 a[68:69], v195 offset:24584
  ds_read_b64_tr_b16 a[70:71], v195 offset:25608
  s_waitcnt lgkmcnt(8)
  v_mfma_f32_16x16x32_bf16 v[32:35], a[24:27], a[12:15], v[32:35]
  s_lshl_b32 s88, s87, 18
  s_add_u32 m0, s86, 16384
  v_mfma_f32_16x16x32_bf16 v[96:99], a[24:27], a[16:19], v[96:99]
  s_add_u32 s89, s88, 0
  buffer_load_dwordx4 v200, s[20:23], s89 offen offset:0 lds
  v_mfma_f32_16x16x32_bf16 v[36:39], a[28:31], a[12:15], v[36:39]
  buffer_load_dwordx4 v201, s[20:23], s89 offen offset:1024 lds
  buffer_load_dwordx4 v202, s[20:23], s89 offen offset:2048 lds
  v_mfma_f32_16x16x32_bf16 v[100:103], a[28:31], a[16:19], v[100:103]
  buffer_load_dwordx4 v203, s[20:23], s89 offen offset:3072 lds
  s_add_u32 m0, s86, 20480
  v_mfma_f32_16x16x32_bf16 v[40:43], a[32:35], a[12:15], v[40:43]
  s_add_u32 s89, s88, 131072
  buffer_load_dwordx4 v200, s[20:23], s89 offen offset:0 lds
  v_mfma_f32_16x16x32_bf16 v[104:107], a[32:35], a[16:19], v[104:107]
  buffer_load_dwordx4 v201, s[20:23], s89 offen offset:1024 lds
  buffer_load_dwordx4 v202, s[20:23], s89 offen offset:2048 lds
  v_mfma_f32_16x16x32_bf16 v[44:47], a[36:39], a[12:15], v[44:47]
  buffer_load_dwordx4 v203, s[20:23], s89 offen offset:3072 lds
  v_mfma_f32_16x16x32_bf16 v[108:111], a[36:39], a[16:19], v[108:111]
  s_waitcnt lgkmcnt(0)
  s_waitcnt vmcnt(18)
  s_barrier
  v_mfma_f32_16x16x32_bf16 v[48:51], a[56:59], a[12:15], v[48:51]
  ds_read_b128 a[0:3], v206 offset:0
  ds_read_b128 a[4:7], v206 offset:1024
  v_mfma_f32_16x16x32_bf16 v[112:115], a[56:59], a[16:19], v[112:115]
  ds_read_b64_tr_b16 a[24:25], v192 offset:0
  ds_read_b64_tr_b16 a[26:27], v192 offset:1024
  v_mfma_f32_16x16x32_bf16 v[52:55], a[60:63], a[12:15], v[52:55]
  ds_read_b64_tr_b16 a[28:29], v192 offset:8
  ds_read_b64_tr_b16 a[30:31], v192 offset:1032
  v_mfma_f32_16x16x32_bf16 v[116:119], a[60:63], a[16:19], v[116:119]
  ds_read_b64_tr_b16 a[32:33], v193 offset:0
  ds_read_b64_tr_b16 a[34:35], v193 offset:1024
  v_mfma_f32_16x16x32_bf16 v[56:59], a[64:67], a[12:15], v[56:59]
  ds_read_b64_tr_b16 a[36:37], v193 offset:8
  ds_read_b64_tr_b16 a[38:39], v193 offset:1032
  v_mfma_f32_16x16x32_bf16 v[120:123], a[64:67], a[16:19], v[120:123]
  ds_read_b64_tr_b16 a[40:41], v194 offset:0
  ds_read_b64_tr_b16 a[42:43], v194 offset:1024
  v_mfma_f32_16x16x32_bf16 v[60:63], a[68:71], a[12:15], v[60:63]
  ds_read_b64_tr_b16 a[44:45], v194 offset:8
  ds_read_b64_tr_b16 a[46:47], v194 offset:1032
  v_mfma_f32_16x16x32_bf16 v[124:127], a[68:71], a[16:19], v[124:127]
  ds_read_b64_tr_b16 a[48:49], v195 offset:0
  ds_read_b64_tr_b16 a[50:51], v195 offset:1024
  ds_read_b64_tr_b16 a[52:53], v195 offset:8
  ds_read_b64_tr_b16 a[54:55], v195 offset:1032
  s_waitcnt lgkmcnt(8)
  v_mfma_f32_16x16x32_bf16 v[0:3], a[24:27], a[0:3], v[0:3]
  s_lshl_b32 s88, s87, 18
  s_add_u32 s88, s88, 256
  v_mfma_f32_16x16x32_bf16 v[64:67], a[24:27], a[4:7], v[64:67]
  s_add_u32 s87, s87, 1
  s_add_u32 m0, s86, 24576
  v_mfma_f32_16x16x32_bf16 v[4:7], a[28:31], a[0:3], v[4:7]
  s_add_u32 s89, s88, 0
  buffer_load_dwordx4 v200, s[20:23], s89 offen offset:0 lds
  v_mfma_f32_16x16x32_bf16 v[68:71], a[28:31], a[4:7], v[68:71]
  buffer_load_dwordx4 v201, s[20:23], s89 offen offset:1024 lds
  buffer_load_dwordx4 v202, s[20:23], s89 offen offset:2048 lds
  v_mfma_f32_16x16x32_bf16 v[8:11], a[32:35], a[0:3], v[8:11]
  buffer_load_dwordx4 v203, s[20:23], s89 offen offset:3072 lds
  s_add_u32 m0, s86, 28672
  v_mfma_f32_16x16x32_bf16 v[72:75], a[32:35], a[4:7], v[72:75]
  s_add_u32 s89, s88, 131072
  buffer_load_dwordx4 v200, s[20:23], s89 offen offset:0 lds
  v_mfma_f32_16x16x32_bf16 v[12:15], a[36:39], a[0:3], v[12:15]
  buffer_load_dwordx4 v201, s[20:23], s89 offen offset:1024 lds
  buffer_load_dwordx4 v202, s[20:23], s89 offen offset:2048 lds
  v_mfma_f32_16x16x32_bf16 v[76:79], a[36:39], a[4:7], v[76:79]
  buffer_load_dwordx4 v203, s[20:23], s89 offen offset:3072 lds
  s_cmp_eq_u32 s87, 14
  s_cselect_b32 s87, 0, s87
  s_waitcnt lgkmcnt(0)
  s_waitcnt vmcnt(16)
  s_barrier
  v_mfma_f32_16x16x32_bf16 v[16:19], a[40:43], a[0:3], v[16:19]
  ds_read_b64_tr_b16 a[24:25], v192 offset:8192
  ds_read_b64_tr_b16 a[26:27], v192 offset:9216
  v_mfma_f32_16x16x32_bf16 v[80:83], a[40:43], a[4:7], v[80:83]
  ds_read_b64_tr_b16 a[28:29], v192 offset:8200
  ds_read_b64_tr_b16 a[30:31], v192 offset:9224
  v_mfma_f32_16x16x32_bf16 v[20:23], a[44:47], a[0:3], v[20:23]
  ds_read_b64_tr_b16 a[32:33], v193 offset:8192
  ds_read_b64_tr_b16 a[34:35], v193 offset:9216
  v_mfma_f32_16x16x32_bf16 v[84:87], a[44:47], a[4:7], v[84:87]
  ds_read_b64_tr_b16 a[36:37], v193 offset:8200
  ds_read_b64_tr_b16 a[38:39], v193 offset:9224
  v_mfma_f32_16x16x32_bf16 v[24:27], a[48:51], a[0:3], v[24:27]
  ds_read_b64_tr_b16 a[56:57], v194 offset:8192
  ds_read_b64_tr_b16 a[58:59], v194 offset:9216
  v_mfma_f32_16x16x32_bf16 v[88:91], a[48:51], a[4:7], v[88:91]
  ds_read_b64_tr_b16 a[60:61], v194 offset:8200
  ds_read_b64_tr_b16 a[62:63], v194 offset:9224
  v_mfma_f32_16x16x32_bf16 v[28:31], a[52:55], a[0:3], v[28:31]
  ds_read_b64_tr_b16 a[64:65], v195 offset:8192
  ds_read_b64_tr_b16 a[66:67], v195 offset:9216
  v_mfma_f32_16x16x32_bf16 v[92:95], a[52:55], a[4:7], v[92:95]
  ds_read_b64_tr_b16 a[68:69], v195 offset:8200
  ds_read_b64_tr_b16 a[70:71], v195 offset:9224
  s_waitcnt lgkmcnt(8)
  v_mfma_f32_16x16x32_bf16 v[32:35], a[24:27], a[0:3], v[32:35]
  v_mfma_f32_16x16x32_bf16 v[96:99], a[24:27], a[4:7], v[96:99]
  v_mfma_f32_16x16x32_bf16 v[36:39], a[28:31], a[0:3], v[36:39]
  v_mfma_f32_16x16x32_bf16 v[100:103], a[28:31], a[4:7], v[100:103]
  v_mfma_f32_16x16x32_bf16 v[40:43], a[32:35], a[0:3], v[40:43]
  v_mfma_f32_16x16x32_bf16 v[104:107], a[32:35], a[4:7], v[104:107]
  v_mfma_f32_16x16x32_bf16 v[44:47], a[36:39], a[0:3], v[44:47]
  v_mfma_f32_16x16x32_bf16 v[108:111], a[36:39], a[4:7], v[108:111]
  s_waitcnt lgkmcnt(0)
  s_waitcnt vmcnt(8)
  s_barrier
  v_mfma_f32_16x16x32_bf16 v[48:51], a[56:59], a[0:3], v[48:51]
  ds_read_b128 a[12:15], v206 offset:5120
  ds_read_b128 a[16:19], v206 offset:6144
  v_mfma_f32_16x16x32_bf16 v[112:115], a[56:59], a[4:7], v[112:115]
  ds_read_b64_tr_b16 a[24:25], v192 offset:16384
  ds_read_b64_tr_b16 a[26:27], v192 offset:17408
  v_mfma_f32_16x16x32_bf16 v[52:55], a[60:63], a[0:3], v[52:55]
  ds_read_b64_tr_b16 a[28:29], v192 offset:16392
  ds_read_b64_tr_b16 a[30:31], v192 offset:17416
  v_mfma_f32_16x16x32_bf16 v[116:119], a[60:63], a[4:7], v[116:119]
  ds_read_b64_tr_b16 a[32:33], v193 offset:16384
  ds_read_b64_tr_b16 a[34:35], v193 offset:17408
  v_mfma_f32_16x16x32_bf16 v[56:59], a[64:67], a[0:3], v[56:59]
  ds_read_b64_tr_b16 a[36:37], v193 offset:16392
  ds_read_b64_tr_b16 a[38:39], v193 offset:17416
  v_mfma_f32_16x16x32_bf16 v[120:123], a[64:67], a[4:7], v[120:123]
  ds_read_b64_tr_b16 a[40:41], v194 offset:16384
  ds_read_b64_tr_b16 a[42:43], v194 offset:17408
  v_mfma_f32_16x16x32_bf16 v[60:63], a[68:71], a[0:3], v[60:63]
  ds_read_b64_tr_b16 a[44:45], v194 offset:16392
  ds_read_b64_tr_b16 a[46:47], v194 offset:17416
  v_mfma_f32_16x16x32_bf16 v[124:127], a[68:71], a[4:7], v[124:127]
  ds_read_b64_tr_b16 a[48:49], v195 offset:16384
  ds_read_b64_tr_b16 a[50:51], v195 offset:17408
  ds_read_b64_tr_b16 a[52:53], v195 offset:16392
  ds_read_b64_tr_b16 a[54:55], v195 offset:17416
  s_waitcnt lgkmcnt(8)
  v_mfma_f32_16x16x32_bf16 v[0:3], a[24:27], a[12:15], v[0:3]
  v_mfma_f32_16x16x32_bf16 v[64:67], a[24:27], a[16:19], v[64:67]
  v_mfma_f32_16x16x32_bf16 v[4:7], a[28:31], a[12:15], v[4:7]
  v_mfma_f32_16x16x32_bf16 v[68:71], a[28:31], a[16:19], v[68:71]
  v_mfma_f32_16x16x32_bf16 v[8:11], a[32:35], a[12:15], v[8:11]
  v_mfma_f32_16x16x32_bf16 v[72:75], a[32:35], a[16:19], v[72:75]
  v_mfma_f32_16x16x32_bf16 v[12:15], a[36:39], a[12:15], v[12:15]
  v_mfma_f32_16x16x32_bf16 v[76:79], a[36:39], a[16:19], v[76:79]
  s_waitcnt lgkmcnt(0)
  s_waitcnt vmcnt(0)
  s_barrier
  v_mfma_f32_16x16x32_bf16 v[16:19], a[40:43], a[12:15], v[16:19]
  ds_read_b64_tr_b16 a[24:25], v192 offset:24576
  ds_read_b64_tr_b16 a[26:27], v192 offset:25600
  v_mfma_f32_16x16x32_bf16 v[80:83], a[40:43], a[16:19], v[80:83]
  ds_read_b64_tr_b16 a[28:29], v192 offset:24584
  ds_read_b64_tr_b16 a[30:31], v192 offset:25608
  v_mfma_f32_16x16x32_bf16 v[20:23], a[44:47], a[12:15], v[20:23]
  ds_read_b64_tr_b16 a[32:33], v193 offset:24576
  ds_read_b64_tr_b16 a[34:35], v193 offset:25600
  v_mfma_f32_16x16x32_bf16 v[84:87], a[44:47], a[16:19], v[84:87]
  ds_read_b64_tr_b16 a[36:37], v193 offset:24584
  ds_read_b64_tr_b16 a[38:39], v193 offset:25608
  v_mfma_f32_16x16x32_bf16 v[24:27], a[48:51], a[12:15], v[24:27]
  ds_read_b64_tr_b16 a[56:57], v194 offset:24576
  ds_read_b64_tr_b16 a[58:59], v194 offset:25600
  v_mfma_f32_16x16x32_bf16 v[88:91], a[48:51], a[16:19], v[88:91]
  ds_read_b64_tr_b16 a[60:61], v194 offset:24584
  ds_read_b64_tr_b16 a[62:63], v194 offset:25608
  v_mfma_f32_16x16x32_bf16 v[28:31], a[52:55], a[12:15], v[28:31]
  ds_read_b64_tr_b16 a[64:65], v195 offset:24576
  ds_read_b64_tr_b16 a[66:67], v195 offset:25600
  v_mfma_f32_16x16x32_bf16 v[92:95], a[52:55], a[16:19], v[92:95]
  ds_read_b64_tr_b16 a[68:69], v195 offset:24584
  ds_read_b64_tr_b16 a[70:71], v195 offset:25608
  s_waitcnt lgkmcnt(8)
  v_mfma_f32_16x16x32_bf16 v[32:35], a[24:27], a[12:15], v[32:35]
  v_mfma_f32_16x16x32_bf16 v[96:99], a[24:27], a[16:19], v[96:99]
  v_mfma_f32_16x16x32_bf16 v[36:39], a[28:31], a[12:15], v[36:39]
  v_mfma_f32_16x16x32_bf16 v[100:103], a[28:31], a[16:19], v[100:103]
  v_mfma_f32_16x16x32_bf16 v[40:43], a[32:35], a[12:15], v[40:43]
  v_mfma_f32_16x16x32_bf16 v[104:107], a[32:35], a[16:19], v[104:107]
  v_mfma_f32_16x16x32_bf16 v[44:47], a[36:39], a[12:15], v[44:47]
  v_mfma_f32_16x16x32_bf16 v[108:111], a[36:39], a[16:19], v[108:111]
  s_waitcnt lgkmcnt(0)
  v_mfma_f32_16x16x32_bf16 v[48:51], a[56:59], a[12:15], v[48:51]
  v_mfma_f32_16x16x32_bf16 v[112:115], a[56:59], a[16:19], v[112:115]
  v_mfma_f32_16x16x32_bf16 v[52:55], a[60:63], a[12:15], v[52:55]
  v_mfma_f32_16x16x32_bf16 v[116:119], a[60:63], a[16:19], v[116:119]
  v_mfma_f32_16x16x32_bf16 v[56:59], a[64:67], a[12:15], v[56:59]
  v_mfma_f32_16x16x32_bf16 v[120:123], a[64:67], a[16:19], v[120:123]
  v_mfma_f32_16x16x32_bf16 v[60:63], a[68:71], a[12:15], v[60:63]
  v_mfma_f32_16x16x32_bf16 v[124:127], a[68:71], a[16:19], v[124:127]
  s_lshl_b32 s66, s59, 15
  s_mov_b32 s68, 32768
  s_mul_i32 s67, s59, 49152
  s_add_u32 s67, s67, 65536
  s_mov_b32 s70, 16384
  s_barrier
  ds_read_b128 a[192:195], v224 offset:0
  ds_read_b128 a[196:199], v224 offset:8192
  ds_read_b128 a[200:203], v225 offset:0
  ds_read_b128 a[204:207], v225 offset:8192
  ds_read_b128 a[208:211], v226 offset:0
  ds_read_b128 a[212:215], v226 offset:8192
  ds_read_b128 a[216:219], v227 offset:0
  ds_read_b128 a[220:223], v227 offset:8192
  ds_read_b128 a[224:227], v224 offset:256
  ds_read_b128 a[228:231], v224 offset:8448
  ds_read_b128 a[232:235], v225 offset:256
  ds_read_b128 a[236:239], v225 offset:8448
  ds_read_b128 a[240:243], v226 offset:256
  ds_read_b128 a[244:247], v226 offset:8448
  ds_read_b128 a[248:251], v227 offset:256
  ds_read_b128 a[252:255], v227 offset:8448
  s_add_u32 m0, s67, 24576
  s_add_u32 s71, s70, 8192
  buffer_load_dwordx4 v244, s[12:15], s71 offen offset:0 nt lds
  buffer_load_dwordx4 v245, s[12:15], s71 offen offset:1024 nt lds
  buffer_load_dwordx4 v246, s[12:15], s71 offen offset:2048 nt lds
  buffer_load_dwordx4 v247, s[12:15], s71 offen offset:3072 nt lds
  s_add_u32 m0, s67, 28672
  s_add_u32 s71, s70, 12288
  buffer_load_dwordx4 v244, s[12:15], s71 offen offset:0 nt lds
  buffer_load_dwordx4 v245, s[12:15], s71 offen offset:1024 nt lds
  buffer_load_dwordx4 v246, s[12:15], s71 offen offset:2048 nt lds
  buffer_load_dwordx4 v247, s[12:15], s71 offen offset:3072 nt lds
  s_add_u32 s70, s70, 16384
  v_cvt_pk_bf16_f32 v0, v0, v1
  v_cvt_pk_bf16_f32 v1, v2, v3
  v_cvt_pk_bf16_f32 v2, v4, v5
  v_cvt_pk_bf16_f32 v3, v6, v7
  v_cvt_pk_bf16_f32 v4, v8, v9
  v_cvt_pk_bf16_f32 v5, v10, v11
  v_cvt_pk_bf16_f32 v6, v12, v13
  v_cvt_pk_bf16_f32 v7, v14, v15
  v_cvt_pk_bf16_f32 v8, v16, v17
  v_cvt_pk_bf16_f32 v9, v18, v19
  v_cvt_pk_bf16_f32 v10, v20, v21
  v_cvt_pk_bf16_f32 v11, v22, v23
  v_cvt_pk_bf16_f32 v12, v24, v25
  v_cvt_pk_bf16_f32 v13, v26, v27
  v_cvt_pk_bf16_f32 v14, v28, v29
  v_cvt_pk_bf16_f32 v15, v30, v31
  v_cvt_pk_bf16_f32 v16, v32, v33
  v_cvt_pk_bf16_f32 v17, v34, v35
  v_cvt_pk_bf16_f32 v18, v36, v37
  v_cvt_pk_bf16_f32 v19, v38, v39
  v_cvt_pk_bf16_f32 v20, v40, v41
  v_cvt_pk_bf16_f32 v21, v42, v43
  v_cvt_pk_bf16_f32 v22, v44, v45
  v_cvt_pk_bf16_f32 v23, v46, v47
  v_cvt_pk_bf16_f32 v24, v48, v49
  v_cvt_pk_bf16_f32 v25, v50, v51
  v_cvt_pk_bf16_f32 v26, v52, v53
  v_cvt_pk_bf16_f32 v27, v54, v55
  v_cvt_pk_bf16_f32 v28, v56, v57
  v_cvt_pk_bf16_f32 v29, v58, v59
  v_cvt_pk_bf16_f32 v30, v60, v61
  v_cvt_pk_bf16_f32 v31, v62, v63
  v_cvt_pk_bf16_f32 v32, v64, v65
  v_cvt_pk_bf16_f32 v33, v66, v67
  v_cvt_pk_bf16_f32 v34, v68, v69
  v_cvt_pk_bf16_f32 v35, v70, v71
  v_cvt_pk_bf16_f32 v36, v72, v73
  v_cvt_pk_bf16_f32 v37, v74, v75
  v_cvt_pk_bf16_f32 v38, v76, v77
  v_cvt_pk_bf16_f32 v39, v78, v79
  v_cvt_pk_bf16_f32 v40, v80, v81
  v_cvt_pk_bf16_f32 v41, v82, v83
  v_cvt_pk_bf16_f32 v42, v84, v85
  v_cvt_pk_bf16_f32 v43, v86, v87
  v_cvt_pk_bf16_f32 v44, v88, v89
  v_cvt_pk_bf16_f32 v45, v90, v91
  v_cvt_pk_bf16_f32 v46, v92, v93
  v_cvt_pk_bf16_f32 v47, v94, v95
  v_cvt_pk_bf16_f32 v48, v96, v97
  v_cvt_pk_bf16_f32 v49, v98, v99
  v_cvt_pk_bf16_f32 v50, v100, v101
  v_cvt_pk_bf16_f32 v51, v102, v103
  v_cvt_pk_bf16_f32 v52, v104, v105
  v_cvt_pk_bf16_f32 v53, v106, v107
  v_cvt_pk_bf16_f32 v54, v108, v109
  v_cvt_pk_bf16_f32 v55, v110, v111
  v_cvt_pk_bf16_f32 v56, v112, v113
  v_cvt_pk_bf16_f32 v57, v114, v115
  v_cvt_pk_bf16_f32 v58, v116, v117
  v_cvt_pk_bf16_f32 v59, v118, v119
  v_cvt_pk_bf16_f32 v60, v120, v121
  v_cvt_pk_bf16_f32 v61, v122, v123
  v_cvt_pk_bf16_f32 v62, v124, v125
  v_cvt_pk_bf16_f32 v63, v126, v127
  s_branch L_att1
L_att0:
  s_waitcnt lgkmcnt(0) vmcnt(24)
  s_barrier
  v_mfma_f32_16x16x32_bf16 v[96:99], a[192:195], v[0:3], 0
  s_add_u32 m0, s66, 0
  s_add_u32 s69, s68, 0
  v_mfma_f32_16x16x32_bf16 v[100:103], a[196:199], v[0:3], 0
  buffer_load_dwordx4 v236, s[8:11], s69 offen offset:0 nt lds
  buffer_load_dwordx4 v237, s[8:11], s69 offen offset:1024 nt lds
  v_mfma_f32_16x16x32_bf16 v[96:99], a[200:203], v[4:7], v[96:99]
  buffer_load_dwordx4 v238, s[8:11], s69 offen offset:2048 nt lds
  buffer_load_dwordx4 v239, s[8:11], s69 offen offset:3072 nt lds
  v_mfma_f32_16x16x32_bf16 v[100:103], a[204:207], v[4:7], v[100:103]
  s_add_u32 m0, s66, 4096
  s_add_u32 s69, s68, 4096
  v_mfma_f32_16x16x32_bf16 v[96:99], a[208:211], v[8:11], v[96:99]
  buffer_load_dwordx4 v240, s[8:11], s69 offen offset:0 nt lds
  buffer_load_dwordx4 v241, s[8:11], s69 offen offset:1024 nt lds
  v_mfma_f32_16x16x32_bf16 v[100:103], a[212:215], v[8:11], v[100:103]
  buffer_load_dwordx4 v242, s[8:11], s69 offen offset:2048 nt lds
  v_mfma_f32_16x16x32_bf16 v[96:99], a[216:219], v[12:15], v[96:99]
  buffer_load_dwordx4 v243, s[8:11], s69 offen offset:3072 nt lds
  s_add_u32 s68, s68, 16384
  v_mfma_f32_16x16x32_bf16 v[100:103], a[220:223], v[12:15], v[100:103]
  ds_read_b64_tr_b16 v[160:161], v228 offset:0
  ds_read_b64_tr_b16 v[162:163], v228 offset:8192
  v_mfma_f32_16x16x32_bf16 v[96:99], a[224:227], v[16:19], v[96:99]
  ds_read_b64_tr_b16 v[164:165], v229 offset:0
  ds_read_b64_tr_b16 v[166:167], v229 offset:8192
  v_mfma_f32_16x16x32_bf16 v[100:103], a[228:231], v[16:19], v[100:103]
  ds_read_b64_tr_b16 v[168:169], v230 offset:0
  ds_read_b64_tr_b16 v[170:171], v230 offset:8192
  v_mfma_f32_16x16x32_bf16 v[96:99], a[232:235], v[20:23], v[96:99]
  ds_read_b64_tr_b16 v[172:173], v231 offset:0
  v_mfma_f32_16x16x32_bf16 v[100:103], a[236:239], v[20:23], v[100:103]
  ds_read_b64_tr_b16 v[174:175], v231 offset:8192
  ds_read_b64_tr_b16 v[176:177], v232 offset:0
  v_mfma_f32_16x16x32_bf16 v[96:99], a[240:243], v[24:27], v[96:99]
  ds_read_b64_tr_b16 v[178:179], v232 offset:8192
  ds_read_b64_tr_b16 v[180:181], v233 offset:0
  v_mfma_f32_16x16x32_bf16 v[100:103], a[244:247], v[24:27], v[100:103]
  ds_read_b64_tr_b16 v[182:183], v233 offset:8192
  ds_read_b64_tr_b16 v[184:185], v234 offset:0
  v_mfma_f32_16x16x32_bf16 v[96:99], a[248:251], v[28:31], v[96:99]
  ds_read_b64_tr_b16 v[186:187], v234 offset:8192
  ds_read_b64_tr_b16 v[188:189], v235 offset:0
  v_mfma_f32_16x16x32_bf16 v[100:103], a[252:255], v[28:31], v[100:103]
  ds_read_b64_tr_b16 v[190:191], v235 offset:8192
  v_mfma_f32_16x16x32_bf16 v[104:107], a[192:195], v[32:35], 0
  ds_read_b64_tr_b16 v[192:193], v228 offset:256
  ds_read_b64_tr_b16 v[194:195], v228 offset:8448
  v_mfma_f32_16x16x32_bf16 v[108:111], a[196:199], v[32:35], 0
  ds_read_b64_tr_b16 v[196:197], v229 offset:256
  ds_read_b64_tr_b16 v[198:199], v229 offset:8448
  v_mfma_f32_16x16x32_bf16 v[104:107], a[200:203], v[36:39], v[104:107]
  ds_read_b64_tr_b16 v[200:201], v230 offset:256
  v_mfma_f32_16x16x32_bf16 v[108:111], a[204:207], v[36:39], v[108:111]
  ds_read_b64_tr_b16 v[202:203], v230 offset:8448
  ds_read_b64_tr_b16 v[204:205], v231 offset:256
  ds_read_b64_tr_b16 v[206:207], v231 offset:8448
  v_mfma_f32_16x16x32_bf16 v[104:107], a[208:211], v[40:43], v[104:107]
  ds_read_b64_tr_b16 v[208:209], v232 offset:256
  ds_read_b64_tr_b16 v[210:211], v232 offset:8448
  ds_read_b64_tr_b16 v[212:213], v233 offset:256
  v_mfma_f32_16x16x32_bf16 v[108:111], a[212:215], v[40:43], v[108:111]
  ds_read_b64_tr_b16 v[214:215], v233 offset:8448
  ds_read_b64_tr_b16 v[216:217], v234 offset:256
  ds_read_b64_tr_b16 v[218:219], v234 offset:8448
  v_mfma_f32_16x16x32_bf16 v[104:107], a[216:219], v[44:47], v[104:107]
  ds_read_b64_tr_b16 v[220:221], v235 offset:256
  ds_read_b64_tr_b16 v[222:223], v235 offset:8448
  v_max3_f32 v147, v96, v97, v98
  v_mfma_f32_16x16x32_bf16 v[108:111], a[220:223], v[44:47], v[108:111]
  v_max3_f32 v147, v147, v99, v100
  v_max3_f32 v147, v147, v101, v102
  v_max_f32 v147, v147, v103
  v_mfma_f32_16x16x32_bf16 v[104:107], a[224:227], v[48:51], v[104:107]
  v_mov_b32 v150, v147
  s_nop 1
  v_permlane32_swap_b32 v147, v150
  v_mfma_f32_16x16x32_bf16 v[108:111], a[228:231], v[48:51], v[108:111]
  v_max_f32 v147, v147, v150
  v_mov_b32 v150, v147
  s_nop 1
  v_mfma_f32_16x16x32_bf16 v[104:107], a[232:235], v[52:55], v[104:107]
  v_permlane16_swap_b32 v147, v150
  v_max_f32 v147, v147, v150
  v_mov_b32 v132, v147
  v_mfma_f32_16x16x32_bf16 v[108:111], a[236:239], v[52:55], v[108:111]
  v_add_f32 v135, s73, v147
  v_mul_f32 v138, s72, v147
  v_sub_f32 v138, 0, v138
  v_mfma_f32_16x16x32_bf16 v[104:107], a[240:243], v[56:59], v[104:107]
  v_mov_b32 v141, 0
  v_mov_b32 v144, 0
  v_fma_f32 v96, v96, s72, v138
  v_mfma_f32_16x16x32_bf16 v[108:111], a[244:247], v[56:59], v[108:111]
  v_fma_f32 v97, v97, s72, v138
  v_fma_f32 v98, v98, s72, v138
  v_fma_f32 v99, v99, s72, v138
  v_mfma_f32_16x16x32_bf16 v[104:107], a[248:251], v[60:63], v[104:107]
  v_fma_f32 v100, v100, s72, v138
  v_fma_f32 v101, v101, s72, v138
  v_fma_f32 v102, v102, s72, v138
  v_mfma_f32_16x16x32_bf16 v[108:111], a[252:255], v[60:63], v[108:111]
  v_fma_f32 v103, v103, s72, v138
  v_exp_f32 v96, v96
  v_exp_f32 v97, v97
  v_exp_f32 v98, v98
  v_exp_f32 v99, v99
  v_exp_f32 v100, v100
  v_exp_f32 v101, v101
  v_exp_f32 v102, v102
  v_exp_f32 v103, v103
  v_cvt_pk_bf16_f32 v120, v96, v97
  v_add_f32 v141, v141, v96
  v_add_f32 v144, v144, v97
  v_cvt_pk_bf16_f32 v121, v98, v99
  v_add_f32 v141, v141, v98
  v_add_f32 v144, v144, v99
  v_cvt_pk_bf16_f32 v122, v100, v101
  v_add_f32 v141, v141, v100
  v_add_f32 v144, v144, v101
  v_cvt_pk_bf16_f32 v123, v102, v103
  v_add_f32 v141, v141, v102
  v_add_f32 v144, v144, v103
  v_mfma_f32_16x16x32_bf16 v[112:115], a[192:195], v[64:67], 0
  v_mfma_f32_16x16x32_bf16 v[116:119], a[196:199], v[64:67], 0
  v_mfma_f32_16x16x32_bf16 v[112:115], a[200:203], v[68:71], v[112:115]
  v_mfma_f32_16x16x32_bf16 v[116:119], a[204:207], v[68:71], v[116:119]
  v_mfma_f32_16x16x32_bf16 v[112:115], a[208:211], v[72:75], v[112:115]
  s_nop 2
  v_mfma_f32_16x16x32_bf16 v[116:119], a[212:215], v[72:75], v[116:119]
  v_max3_f32 v148, v104, v105, v106
  v_max3_f32 v148, v148, v107, v108
  v_max3_f32 v148, v148, v109, v110
  v_mfma_f32_16x16x32_bf16 v[112:115], a[216:219], v[76:79], v[112:115]
  v_max_f32 v148, v148, v111
  v_mov_b32 v150, v148
  s_nop 1
  v_mfma_f32_16x16x32_bf16 v[116:119], a[220:223], v[76:79], v[116:119]
  v_permlane32_swap_b32 v148, v150
  v_max_f32 v148, v148, v150
  v_mov_b32 v150, v148
  v_mfma_f32_16x16x32_bf16 v[112:115], a[224:227], v[80:83], v[112:115]
  s_nop 1
  v_permlane16_swap_b32 v148, v150
  v_max_f32 v148, v148, v150
  v_mfma_f32_16x16x32_bf16 v[116:119], a[228:231], v[80:83], v[116:119]
  v_mov_b32 v133, v148
  v_add_f32 v136, s73, v148
  v_mul_f32 v139, s72, v148
  v_mfma_f32_16x16x32_bf16 v[112:115], a[232:235], v[84:87], v[112:115]
  v_sub_f32 v139, 0, v139
  v_mov_b32 v142, 0
  v_mov_b32 v145, 0
  v_mfma_f32_16x16x32_bf16 v[116:119], a[236:239], v[84:87], v[116:119]
  v_fma_f32 v104, v104, s72, v139
  v_fma_f32 v105, v105, s72, v139
  v_fma_f32 v106, v106, s72, v139
  v_mfma_f32_16x16x32_bf16 v[112:115], a[240:243], v[88:91], v[112:115]
  v_fma_f32 v107, v107, s72, v139
  v_fma_f32 v108, v108, s72, v139
  v_fma_f32 v109, v109, s72, v139
  v_mfma_f32_16x16x32_bf16 v[116:119], a[244:247], v[88:91], v[116:119]
  v_fma_f32 v110, v110, s72, v139
  v_fma_f32 v111, v111, s72, v139
  v_exp_f32 v104, v104
  v_mfma_f32_16x16x32_bf16 v[112:115], a[248:251], v[92:95], v[112:115]
  v_exp_f32 v105, v105
  v_exp_f32 v106, v106
  v_exp_f32 v107, v107
  v_mfma_f32_16x16x32_bf16 v[116:119], a[252:255], v[92:95], v[116:119]
  v_exp_f32 v108, v108
  v_exp_f32 v109, v109
  v_exp_f32 v110, v110
  v_exp_f32 v111, v111
  v_cvt_pk_bf16_f32 v124, v104, v105
  v_add_f32 v142, v142, v104
  v_add_f32 v145, v145, v105
  v_cvt_pk_bf16_f32 v125, v106, v107
  v_add_f32 v142, v142, v106
  v_add_f32 v145, v145, v107
  v_cvt_pk_bf16_f32 v126, v108, v109
  v_add_f32 v142, v142, v108
  v_add_f32 v145, v145, v109
  v_cvt_pk_bf16_f32 v127, v110, v111
  v_add_f32 v142, v142, v110
  v_add_f32 v145, v145, v111
  s_waitcnt lgkmcnt(0)
  v_mfma_f32_16x16x32_bf16 a[0:3], v[160:163], v[120:123], 0
  v_mfma_f32_16x16x32_bf16 a[4:7], v[164:167], v[120:123], 0
  v_mfma_f32_16x16x32_bf16 a[8:11], v[168:171], v[120:123], 0
  v_mfma_f32_16x16x32_bf16 a[12:15], v[172:175], v[120:123], 0
  v_mfma_f32_16x16x32_bf16 a[16:19], v[176:179], v[120:123], 0
  s_nop 2
  v_mfma_f32_16x16x32_bf16 a[20:23], v[180:183], v[120:123], 0
  v_max3_f32 v149, v112, v113, v114
  v_max3_f32 v149, v149, v115, v116
  v_max3_f32 v149, v149, v117, v118
  v_mfma_f32_16x16x32_bf16 a[24:27], v[184:187], v[120:123], 0
  v_max_f32 v149, v149, v119
  v_mov_b32 v150, v149
  s_nop 1
  v_mfma_f32_16x16x32_bf16 a[28:31], v[188:191], v[120:123], 0
  v_permlane32_swap_b32 v149, v150
  v_max_f32 v149, v149, v150
  v_mov_b32 v150, v149
  v_mfma_f32_16x16x32_bf16 a[32:35], v[192:195], v[120:123], 0
  s_nop 1
  v_permlane16_swap_b32 v149, v150
  v_max_f32 v149, v149, v150
  v_mfma_f32_16x16x32_bf16 a[36:39], v[196:199], v[120:123], 0
  v_mov_b32 v134, v149
  v_add_f32 v137, s73, v149
  v_mul_f32 v140, s72, v149
  v_mfma_f32_16x16x32_bf16 a[40:43], v[200:203], v[120:123], 0
  v_sub_f32 v140, 0, v140
  v_mov_b32 v143, 0
  v_mov_b32 v146, 0
  v_mfma_f32_16x16x32_bf16 a[44:47], v[204:207], v[120:123], 0
  v_fma_f32 v112, v112, s72, v140
  v_fma_f32 v113, v113, s72, v140
  v_fma_f32 v114, v114, s72, v140
  v_mfma_f32_16x16x32_bf16 a[48:51], v[208:211], v[120:123], 0
  v_fma_f32 v115, v115, s72, v140
  v_fma_f32 v116, v116, s72, v140
  v_fma_f32 v117, v117, s72, v140
  v_mfma_f32_16x16x32_bf16 a[52:55], v[212:215], v[120:123], 0
  v_fma_f32 v118, v118, s72, v140
  v_fma_f32 v119, v119, s72, v140
  v_exp_f32 v112, v112
  v_mfma_f32_16x16x32_bf16 a[56:59], v[216:219], v[120:123], 0
  v_exp_f32 v113, v113
  v_exp_f32 v114, v114
  v_exp_f32 v115, v115
  v_mfma_f32_16x16x32_bf16 a[60:63], v[220:223], v[120:123], 0
  v_exp_f32 v116, v116
  v_exp_f32 v117, v117
  v_exp_f32 v118, v118
  v_exp_f32 v119, v119
  v_cvt_pk_bf16_f32 v128, v112, v113
  v_add_f32 v143, v143, v112
  v_add_f32 v146, v146, v113
  v_cvt_pk_bf16_f32 v129, v114, v115
  v_add_f32 v143, v143, v114
  v_add_f32 v146, v146, v115
  v_cvt_pk_bf16_f32 v130, v116, v117
  v_add_f32 v143, v143, v116
  v_add_f32 v146, v146, v117
  v_cvt_pk_bf16_f32 v131, v118, v119
  v_add_f32 v143, v143, v118
  v_add_f32 v146, v146, v119
  s_waitcnt vmcnt(16)
  s_barrier
  v_mfma_f32_16x16x32_bf16 a[64:67], v[160:163], v[124:127], 0
  s_add_u32 m0, s67, 0
  s_add_u32 s71, s70, 0
  v_mfma_f32_16x16x32_bf16 a[68:71], v[164:167], v[124:127], 0
  buffer_load_dwordx4 v244, s[12:15], s71 offen offset:0 nt lds
  v_mfma_f32_16x16x32_bf16 a[72:75], v[168:171], v[124:127], 0
  buffer_load_dwordx4 v245, s[12:15], s71 offen offset:1024 nt lds
  v_mfma_f32_16x16x32_bf16 a[76:79], v[172:175], v[124:127], 0
  buffer_load_dwordx4 v246, s[12:15], s71 offen offset:2048 nt lds
  v_mfma_f32_16x16x32_bf16 a[80:83], v[176:179], v[124:127], 0
  buffer_load_dwordx4 v247, s[12:15], s71 offen offset:3072 nt lds
  v_mfma_f32_16x16x32_bf16 a[84:87], v[180:183], v[124:127], 0
  s_add_u32 m0, s67, 4096
  v_mfma_f32_16x16x32_bf16 a[88:91], v[184:187], v[124:127], 0
  s_add_u32 s71, s70, 4096
  v_mfma_f32_16x16x32_bf16 a[92:95], v[188:191], v[124:127], 0
  buffer_load_dwordx4 v244, s[12:15], s71 offen offset:0 nt lds
  v_mfma_f32_16x16x32_bf16 a[96:99], v[192:195], v[124:127], 0
  buffer_load_dwordx4 v245, s[12:15], s71 offen offset:1024 nt lds
  v_mfma_f32_16x16x32_bf16 a[100:103], v[196:199], v[124:127], 0
  buffer_load_dwordx4 v246, s[12:15], s71 offen offset:2048 nt lds
  v_mfma_f32_16x16x32_bf16 a[104:107], v[200:203], v[124:127], 0
  buffer_load_dwordx4 v247, s[12:15], s71 offen offset:3072 nt lds
  v_mfma_f32_16x16x32_bf16 a[108:111], v[204:207], v[124:127], 0
  s_add_u32 s70, s70, 16384
  v_mfma_f32_16x16x32_bf16 a[112:115], v[208:211], v[124:127], 0
  ds_read_b128 a[192:195], v224 offset:16384
  v_mfma_f32_16x16x32_bf16 a[116:119], v[212:215], v[124:127], 0
  ds_read_b128 a[196:199], v224 offset:24576
  v_mfma_f32_16x16x32_bf16 a[120:123], v[216:219], v[124:127], 0
  ds_read_b128 a[200:203], v225 offset:16384
  v_mfma_f32_16x16x32_bf16 a[124:127], v[220:223], v[124:127], 0
  ds_read_b128 a[204:207], v225 offset:24576
  v_mfma_f32_16x16x32_bf16 a[128:131], v[160:163], v[128:131], 0
  ds_read_b128 a[208:211], v226 offset:16384
  v_mfma_f32_16x16x32_bf16 a[132:135], v[164:167], v[128:131], 0
  ds_read_b128 a[212:215], v226 offset:24576
  v_mfma_f32_16x16x32_bf16 a[136:139], v[168:171], v[128:131], 0
  ds_read_b128 a[216:219], v227 offset:16384
  v_mfma_f32_16x16x32_bf16 a[140:143], v[172:175], v[128:131], 0
  v_mfma_f32_16x16x32_bf16 a[144:147], v[176:179], v[128:131], 0
  ds_read_b128 a[220:223], v227 offset:24576
  v_mfma_f32_16x16x32_bf16 a[148:151], v[180:183], v[128:131], 0
  ds_read_b128 a[224:227], v224 offset:16640
  v_mfma_f32_16x16x32_bf16 a[152:155], v[184:187], v[128:131], 0
  ds_read_b128 a[228:231], v224 offset:24832
  v_mfma_f32_16x16x32_bf16 a[156:159], v[188:191], v[128:131], 0
  v_mfma_f32_16x16x32_bf16 a[160:163], v[192:195], v[128:131], 0
  ds_read_b128 a[232:235], v225 offset:16640
  v_mfma_f32_16x16x32_bf16 a[164:167], v[196:199], v[128:131], 0
  ds_read_b128 a[236:239], v225 offset:24832
  v_mfma_f32_16x16x32_bf16 a[168:171], v[200:203], v[128:131], 0
  ds_read_b128 a[240:243], v226 offset:16640
  v_mfma_f32_16x16x32_bf16 a[172:175], v[204:207], v[128:131], 0
  v_mfma_f32_16x16x32_bf16 a[176:179], v[208:211], v[128:131], 0
  ds_read_b128 a[244:247], v226 offset:24832
  v_mfma_f32_16x16x32_bf16 a[180:183], v[212:215], v[128:131], 0
  ds_read_b128 a[248:251], v227 offset:16640
  v_mfma_f32_16x16x32_bf16 a[184:187], v[216:219], v[128:131], 0
  ds_read_b128 a[252:255], v227 offset:24832
  v_mfma_f32_16x16x32_bf16 a[188:191], v[220:223], v[128:131], 0
  s_mov_b32 s74, 15
L_loop_b0:
  s_waitcnt lgkmcnt(0) vmcnt(16)
  s_barrier
  v_mfma_f32_16x16x32_bf16 v[96:99], a[192:195], v[0:3], 0
  s_add_u32 m0, s66, 16384
  s_add_u32 s69, s68, 0
  v_mfma_f32_16x16x32_bf16 v[100:103], a[196:199], v[0:3], 0
  buffer_load_dwordx4 v236, s[8:11], s69 offen offset:0 nt lds
  buffer_load_dwordx4 v237, s[8:11], s69 offen offset:1024 nt lds
  v_mfma_f32_16x16x32_bf16 v[96:99], a[200:203], v[4:7], v[96:99]
  buffer_load_dwordx4 v238, s[8:11], s69 offen offset:2048 nt lds
  buffer_load_dwordx4 v239, s[8:11], s69 offen offset:3072 nt lds
  v_mfma_f32_16x16x32_bf16 v[100:103], a[204:207], v[4:7], v[100:103]
  s_add_u32 m0, s66, 20480
  s_add_u32 s69, s68, 4096
  v_mfma_f32_16x16x32_bf16 v[96:99], a[208:211], v[8:11], v[96:99]
  buffer_load_dwordx4 v240, s[8:11], s69 offen offset:0 nt lds
  buffer_load_dwordx4 v241, s[8:11], s69 offen offset:1024 nt lds
  v_mfma_f32_16x16x32_bf16 v[100:103], a[212:215], v[8:11], v[100:103]
  buffer_load_dwordx4 v242, s[8:11], s69 offen offset:2048 nt lds
  v_mfma_f32_16x16x32_bf16 v[96:99], a[216:219], v[12:15], v[96:99]
  buffer_load_dwordx4 v243, s[8:11], s69 offen offset:3072 nt lds
  s_add_u32 s68, s68, 16384
  v_mfma_f32_16x16x32_bf16 v[100:103], a[220:223], v[12:15], v[100:103]
  ds_read_b64_tr_b16 v[160:161], v228 offset:16384
  ds_read_b64_tr_b16 v[162:163], v228 offset:24576
  v_mfma_f32_16x16x32_bf16 v[96:99], a[224:227], v[16:19], v[96:99]
  ds_read_b64_tr_b16 v[164:165], v229 offset:16384
  ds_read_b64_tr_b16 v[166:167], v229 offset:24576
  v_mfma_f32_16x16x32_bf16 v[100:103], a[228:231], v[16:19], v[100:103]
  ds_read_b64_tr_b16 v[168:169], v230 offset:16384
  ds_read_b64_tr_b16 v[170:171], v230 offset:24576
  v_mfma_f32_16x16x32_bf16 v[96:99], a[232:235], v[20:23], v[96:99]
  ds_read_b64_tr_b16 v[172:173], v231 offset:16384
  v_mfma_f32_16x16x32_bf16 v[100:103], a[236:239], v[20:23], v[100:103]
  ds_read_b64_tr_b16 v[174:175], v231 offset:24576
  ds_read_b64_tr_b16 v[176:177], v232 offset:16384
  v_mfma_f32_16x16x32_bf16 v[96:99], a[240:243], v[24:27], v[96:99]
  ds_read_b64_tr_b16 v[178:179], v232 offset:24576
  ds_read_b64_tr_b16 v[180:181], v233 offset:16384
  v_mfma_f32_16x16x32_bf16 v[100:103], a[244:247], v[24:27], v[100:103]
  ds_read_b64_tr_b16 v[182:183], v233 offset:24576
  ds_read_b64_tr_b16 v[184:185], v234 offset:16384
  v_mfma_f32_16x16x32_bf16 v[96:99], a[248:251], v[28:31], v[96:99]
  ds_read_b64_tr_b16 v[186:187], v234 offset:24576
  ds_read_b64_tr_b16 v[188:189], v235 offset:16384
  v_mfma_f32_16x16x32_bf16 v[100:103], a[252:255], v[28:31], v[100:103]
  ds_read_b64_tr_b16 v[190:191], v235 offset:24576
  v_mfma_f32_16x16x32_bf16 v[104:107], a[192:195], v[32:35], 0
  ds_read_b64_tr_b16 v[192:193], v228 offset:16640
  ds_read_b64_tr_b16 v[194:195], v228 offset:24832
  v_mfma_f32_16x16x32_bf16 v[108:111], a[196:199], v[32:35], 0
  ds_read_b64_tr_b16 v[196:197], v229 offset:16640
  ds_read_b64_tr_b16 v[198:199], v229 offset:24832
  v_mfma_f32_16x16x32_bf16 v[104:107], a[200:203], v[36:39], v[104:107]
  ds_read_b64_tr_b16 v[200:201], v230 offset:16640
  v_mfma_f32_16x16x32_bf16 v[108:111], a[204:207], v[36:39], v[108:111]
  ds_read_b64_tr_b16 v[202:203], v230 offset:24832
  ds_read_b64_tr_b16 v[204:205], v231 offset:16640
  ds_read_b64_tr_b16 v[206:207], v231 offset:24832
  v_mfma_f32_16x16x32_bf16 v[104:107], a[208:211], v[40:43], v[104:107]
  ds_read_b64_tr_b16 v[208:209], v232 offset:16640
  ds_read_b64_tr_b16 v[210:211], v232 offset:24832
  ds_read_b64_tr_b16 v[212:213], v233 offset:16640
  v_mfma_f32_16x16x32_bf16 v[108:111], a[212:215], v[40:43], v[108:111]
  ds_read_b64_tr_b16 v[214:215], v233 offset:24832
  ds_read_b64_tr_b16 v[216:217], v234 offset:16640
  ds_read_b64_tr_b16 v[218:219], v234 offset:24832
  v_mfma_f32_16x16x32_bf16 v[104:107], a[216:219], v[44:47], v[104:107]
  ds_read_b64_tr_b16 v[220:221], v235 offset:16640
  ds_read_b64_tr_b16 v[222:223], v235 offset:24832
  v_max3_f32 v147, v96, v97, v98
  v_mfma_f32_16x16x32_bf16 v[108:111], a[220:223], v[44:47], v[108:111]
  v_max3_f32 v147, v147, v99, v100
  v_max3_f32 v147, v147, v101, v102
  v_max_f32 v147, v147, v103
  v_mfma_f32_16x16x32_bf16 v[104:107], a[224:227], v[48:51], v[104:107]
  v_cmp_gt_f32 vcc, v147, v135
  s_cbranch_vccnz L_rare_b0b_0
L_back_b0b_0:
  v_fma_f32 v96, v96, s72, v138
  v_mfma_f32_16x16x32_bf16 v[108:111], a[228:231], v[48:51], v[108:111]
  v_fma_f32 v97, v97, s72, v138
  v_fma_f32 v98, v98, s72, v138
  v_fma_f32 v99, v99, s72, v138
  v_mfma_f32_16x16x32_bf16 v[104:107], a[232:235], v[52:55], v[104:107]
  v_fma_f32 v100, v100, s72, v138
  v_fma_f32 v101, v101, s72, v138
  v_fma_f32 v102, v102, s72, v138
  v_mfma_f32_16x16x32_bf16 v[108:111], a[236:239], v[52:55], v[108:111]
  v_fma_f32 v103, v103, s72, v138
  v_exp_f32 v96, v96
  v_exp_f32 v97, v97
  v_mfma_f32_16x16x32_bf16 v[104:107], a[240:243], v[56:59], v[104:107]
  v_exp_f32 v98, v98
  v_exp_f32 v99, v99
  v_exp_f32 v100, v100
  v_mfma_f32_16x16x32_bf16 v[108:111], a[244:247], v[56:59], v[108:111]
  v_exp_f32 v101, v101
  v_exp_f32 v102, v102
  v_exp_f32 v103, v103
  v_mfma_f32_16x16x32_bf16 v[104:107], a[248:251], v[60:63], v[104:107]
  v_cvt_pk_bf16_f32 v120, v96, v97
  v_add_f32 v141, v141, v96
  v_add_f32 v144, v144, v97
  v_mfma_f32_16x16x32_bf16 v[108:111], a[252:255], v[60:63], v[108:111]
  v_cvt_pk_bf16_f32 v121, v98, v99
  v_add_f32 v141, v141, v98
  v_add_f32 v144, v144, v99
  v_cvt_pk_bf16_f32 v122, v100, v101
  v_add_f32 v141, v141, v100
  v_add_f32 v144, v144, v101
  v_cvt_pk_bf16_f32 v123, v102, v103
  v_add_f32 v141, v141, v102
  v_add_f32 v144, v144, v103
  v_mfma_f32_16x16x32_bf16 v[112:115], a[192:195], v[64:67], 0
  v_mfma_f32_16x16x32_bf16 v[116:119], a[196:199], v[64:67], 0
  v_mfma_f32_16x16x32_bf16 v[112:115], a[200:203], v[68:71], v[112:115]
  v_mfma_f32_16x16x32_bf16 v[116:119], a[204:207], v[68:71], v[116:119]
  v_mfma_f32_16x16x32_bf16 v[112:115], a[208:211], v[72:75], v[112:115]
  s_nop 2
  v_mfma_f32_16x16x32_bf16 v[116:119], a[212:215], v[72:75], v[116:119]
  v_max3_f32 v148, v104, v105, v106
  v_max3_f32 v148, v148, v107, v108
  v_max3_f32 v148, v148, v109, v110
  v_mfma_f32_16x16x32_bf16 v[112:115], a[216:219], v[76:79], v[112:115]
  v_max_f32 v148, v148, v111
  v_cmp_gt_f32 vcc, v148, v136
  s_cbranch_vccnz L_rare_b0b_1
L_back_b0b_1:
  v_mfma_f32_16x16x32_bf16 v[116:119], a[220:223], v[76:79], v[116:119]
  v_fma_f32 v104, v104, s72, v139
  v_fma_f32 v105, v105, s72, v139
  v_fma_f32 v106, v106, s72, v139
  v_mfma_f32_16x16x32_bf16 v[112:115], a[224:227], v[80:83], v[112:115]
  v_fma_f32 v107, v107, s72, v139
  v_fma_f32 v108, v108, s72, v139
  v_fma_f32 v109, v109, s72, v139
  v_mfma_f32_16x16x32_bf16 v[116:119], a[228:231], v[80:83], v[116:119]
  v_fma_f32 v110, v110, s72, v139
  v_fma_f32 v111, v111, s72, v139
  v_exp_f32 v104, v104
  v_mfma_f32_16x16x32_bf16 v[112:115], a[232:235], v[84:87], v[112:115]
  v_exp_f32 v105, v105
  v_exp_f32 v106, v106
  v_exp_f32 v107, v107
  v_mfma_f32_16x16x32_bf16 v[116:119], a[236:239], v[84:87], v[116:119]
  v_exp_f32 v108, v108
  v_exp_f32 v109, v109
  v_exp_f32 v110, v110
  v_mfma_f32_16x16x32_bf16 v[112:115], a[240:243], v[88:91], v[112:115]
  v_exp_f32 v111, v111
  v_cvt_pk_bf16_f32 v124, v104, v105
  v_add_f32 v142, v142, v104
  v_mfma_f32_16x16x32_bf16 v[116:119], a[244:247], v[88:91], v[116:119]
  v_add_f32 v145, v145, v105
  v_cvt_pk_bf16_f32 v125, v106, v107
  v_add_f32 v142, v142, v106
  v_mfma_f32_16x16x32_bf16 v[112:115], a[248:251], v[92:95], v[112:115]
  v_add_f32 v145, v145, v107
  v_cvt_pk_bf16_f32 v126, v108, v109
  v_add_f32 v142, v142, v108
  v_mfma_f32_16x16x32_bf16 v[116:119], a[252:255], v[92:95], v[116:119]
  v_add_f32 v145, v145, v109
  v_cvt_pk_bf16_f32 v127, v110, v111
  v_add_f32 v142, v142, v110
  v_add_f32 v145, v145, v111
  s_waitcnt lgkmcnt(0)
  v_mfma_f32_16x16x32_bf16 a[0:3], v[160:163], v[120:123], a[0:3]
  v_mfma_f32_16x16x32_bf16 a[4:7], v[164:167], v[120:123], a[4:7]
  v_mfma_f32_16x16x32_bf16 a[8:11], v[168:171], v[120:123], a[8:11]
  v_mfma_f32_16x16x32_bf16 a[12:15], v[172:175], v[120:123], a[12:15]
  v_mfma_f32_16x16x32_bf16 a[16:19], v[176:179], v[120:123], a[16:19]
  s_nop 2
  v_mfma_f32_16x16x32_bf16 a[20:23], v[180:183], v[120:123], a[20:23]
  v_max3_f32 v149, v112, v113, v114
  v_max3_f32 v149, v149, v115, v116
  v_max3_f32 v149, v149, v117, v118
  v_mfma_f32_16x16x32_bf16 a[24:27], v[184:187], v[120:123], a[24:27]
  v_max_f32 v149, v149, v119
  v_cmp_gt_f32 vcc, v149, v137
  s_cbranch_vccnz L_rare_b0b_2
L_back_b0b_2:
  v_mfma_f32_16x16x32_bf16 a[28:31], v[188:191], v[120:123], a[28:31]
  v_fma_f32 v112, v112, s72, v140
  v_fma_f32 v113, v113, s72, v140
  v_fma_f32 v114, v114, s72, v140
  v_mfma_f32_16x16x32_bf16 a[32:35], v[192:195], v[120:123], a[32:35]
  v_fma_f32 v115, v115, s72, v140
  v_fma_f32 v116, v116, s72, v140
  v_fma_f32 v117, v117, s72, v140
  v_mfma_f32_16x16x32_bf16 a[36:39], v[196:199], v[120:123], a[36:39]
  v_fma_f32 v118, v118, s72, v140
  v_fma_f32 v119, v119, s72, v140
  v_exp_f32 v112, v112
  v_mfma_f32_16x16x32_bf16 a[40:43], v[200:203], v[120:123], a[40:43]
  v_exp_f32 v113, v113
  v_exp_f32 v114, v114
  v_exp_f32 v115, v115
  v_mfma_f32_16x16x32_bf16 a[44:47], v[204:207], v[120:123], a[44:47]
  v_exp_f32 v116, v116
  v_exp_f32 v117, v117
  v_exp_f32 v118, v118
  v_mfma_f32_16x16x32_bf16 a[48:51], v[208:211], v[120:123], a[48:51]
  v_exp_f32 v119, v119
  v_cvt_pk_bf16_f32 v128, v112, v113
  v_add_f32 v143, v143, v112
  v_mfma_f32_16x16x32_bf16 a[52:55], v[212:215], v[120:123], a[52:55]
  v_add_f32 v146, v146, v113
  v_cvt_pk_bf16_f32 v129, v114, v115
  v_add_f32 v143, v143, v114
  v_mfma_f32_16x16x32_bf16 a[56:59], v[216:219], v[120:123], a[56:59]
  v_add_f32 v146, v146, v115
  v_cvt_pk_bf16_f32 v130, v116, v117
  v_add_f32 v143, v143, v116
  v_mfma_f32_16x16x32_bf16 a[60:63], v[220:223], v[120:123], a[60:63]
  v_add_f32 v146, v146, v117
  v_cvt_pk_bf16_f32 v131, v118, v119
  v_add_f32 v143, v143, v118
  v_add_f32 v146, v146, v119
  s_waitcnt vmcnt(16)
  s_barrier
  v_mfma_f32_16x16x32_bf16 a[64:67], v[160:163], v[124:127], a[64:67]
  s_add_u32 m0, s67, 16384
  s_add_u32 s71, s70, 0
  v_mfma_f32_16x16x32_bf16 a[68:71], v[164:167], v[124:127], a[68:71]
  buffer_load_dwordx4 v244, s[12:15], s71 offen offset:0 nt lds
  v_mfma_f32_16x16x32_bf16 a[72:75], v[168:171], v[124:127], a[72:75]
  buffer_load_dwordx4 v245, s[12:15], s71 offen offset:1024 nt lds
  v_mfma_f32_16x16x32_bf16 a[76:79], v[172:175], v[124:127], a[76:79]
  buffer_load_dwordx4 v246, s[12:15], s71 offen offset:2048 nt lds
  v_mfma_f32_16x16x32_bf16 a[80:83], v[176:179], v[124:127], a[80:83]
  buffer_load_dwordx4 v247, s[12:15], s71 offen offset:3072 nt lds
  v_mfma_f32_16x16x32_bf16 a[84:87], v[180:183], v[124:127], a[84:87]
  s_add_u32 m0, s67, 20480
  v_mfma_f32_16x16x32_bf16 a[88:91], v[184:187], v[124:127], a[88:91]
  s_add_u32 s71, s70, 4096
  v_mfma_f32_16x16x32_bf16 a[92:95], v[188:191], v[124:127], a[92:95]
  buffer_load_dwordx4 v244, s[12:15], s71 offen offset:0 nt lds
  v_mfma_f32_16x16x32_bf16 a[96:99], v[192:195], v[124:127], a[96:99]
  buffer_load_dwordx4 v245, s[12:15], s71 offen offset:1024 nt lds
  v_mfma_f32_16x16x32_bf16 a[100:103], v[196:199], v[124:127], a[100:103]
  buffer_load_dwordx4 v246, s[12:15], s71 offen offset:2048 nt lds
  v_mfma_f32_16x16x32_bf16 a[104:107], v[200:203], v[124:127], a[104:107]
  buffer_load_dwordx4 v247, s[12:15], s71 offen offset:3072 nt lds
  v_mfma_f32_16x16x32_bf16 a[108:111], v[204:207], v[124:127], a[108:111]
  s_add_u32 s70, s70, 16384
  v_mfma_f32_16x16x32_bf16 a[112:115], v[208:211], v[124:127], a[112:115]
  ds_read_b128 a[192:195], v224 offset:0
  v_mfma_f32_16x16x32_bf16 a[116:119], v[212:215], v[124:127], a[116:119]
  ds_read_b128 a[196:199], v224 offset:8192
  v_mfma_f32_16x16x32_bf16 a[120:123], v[216:219], v[124:127], a[120:123]
  ds_read_b128 a[200:203], v225 offset:0
  v_mfma_f32_16x16x32_bf16 a[124:127], v[220:223], v[124:127], a[124:127]
  ds_read_b128 a[204:207], v225 offset:8192
  v_mfma_f32_16x16x32_bf16 a[128:131], v[160:163], v[128:131], a[128:131]
  ds_read_b128 a[208:211], v226 offset:0
  v_mfma_f32_16x16x32_bf16 a[132:135], v[164:167], v[128:131], a[132:135]
  ds_read_b128 a[212:215], v226 offset:8192
  v_mfma_f32_16x16x32_bf16 a[136:139], v[168:171], v[128:131], a[136:139]
  ds_read_b128 a[216:219], v227 offset:0
  v_mfma_f32_16x16x32_bf16 a[140:143], v[172:175], v[128:131], a[140:143]
  v_mfma_f32_16x16x32_bf16 a[144:147], v[176:179], v[128:131], a[144:147]
  ds_read_b128 a[220:223], v227 offset:8192
  v_mfma_f32_16x16x32_bf16 a[148:151], v[180:183], v[128:131], a[148:151]
  ds_read_b128 a[224:227], v224 offset:256
  v_mfma_f32_16x16x32_bf16 a[152:155], v[184:187], v[128:131], a[152:155]
  ds_read_b128 a[228:231], v224 offset:8448
  v_mfma_f32_16x16x32_bf16 a[156:159], v[188:191], v[128:131], a[156:159]
  v_mfma_f32_16x16x32_bf16 a[160:163], v[192:195], v[128:131], a[160:163]
  ds_read_b128 a[232:235], v225 offset:256
  v_mfma_f32_16x16x32_bf16 a[164:167], v[196:199], v[128:131], a[164:167]
  ds_read_b128 a[236:239], v225 offset:8448
  v_mfma_f32_16x16x32_bf16 a[168:171], v[200:203], v[128:131], a[168:171]
  ds_read_b128 a[240:243], v226 offset:256
  v_mfma_f32_16x16x32_bf16 a[172:175], v[204:207], v[128:131], a[172:175]
  v_mfma_f32_16x16x32_bf16 a[176:179], v[208:211], v[128:131], a[176:179]
  ds_read_b128 a[244:247], v226 offset:8448
  v_mfma_f32_16x16x32_bf16 a[180:183], v[212:215], v[128:131], a[180:183]
  ds_read_b128 a[248:251], v227 offset:256
  v_mfma_f32_16x16x32_bf16 a[184:187], v[216:219], v[128:131], a[184:187]
  ds_read_b128 a[252:255], v227 offset:8448
  v_mfma_f32_16x16x32_bf16 a[188:191], v[220:223], v[128:131], a[188:191]
  s_sub_u32 s74, s74, 1
  s_cmp_eq_u32 s74, 0
  s_cbranch_scc1 L_loopend_b0
  s_waitcnt lgkmcnt(0) vmcnt(16)
  s_barrier
  v_mfma_f32_16x16x32_bf16 v[96:99], a[192:195], v[0:3], 0
  s_add_u32 m0, s66, 0
  s_add_u32 s69, s68, 0
  v_mfma_f32_16x16x32_bf16 v[100:103], a[196:199], v[0:3], 0
  buffer_load_dwordx4 v236, s[8:11], s69 offen offset:0 nt lds
  buffer_load_dwordx4 v237, s[8:11], s69 offen offset:1024 nt lds
  v_mfma_f32_16x16x32_bf16 v[96:99], a[200:203], v[4:7], v[96:99]
  buffer_load_dwordx4 v238, s[8:11], s69 offen offset:2048 nt lds
  buffer_load_dwordx4 v239, s[8:11], s69 offen offset:3072 nt lds
  v_mfma_f32_16x16x32_bf16 v[100:103], a[204:207], v[4:7], v[100:103]
  s_add_u32 m0, s66, 4096
  s_add_u32 s69, s68, 4096
  v_mfma_f32_16x16x32_bf16 v[96:99], a[208:211], v[8:11], v[96:99]
  buffer_load_dwordx4 v240, s[8:11], s69 offen offset:0 nt lds
  buffer_load_dwordx4 v241, s[8:11], s69 offen offset:1024 nt lds
  v_mfma_f32_16x16x32_bf16 v[100:103], a[212:215], v[8:11], v[100:103]
  buffer_load_dwordx4 v242, s[8:11], s69 offen offset:2048 nt lds
  v_mfma_f32_16x16x32_bf16 v[96:99], a[216:219], v[12:15], v[96:99]
  buffer_load_dwordx4 v243, s[8:11], s69 offen offset:3072 nt lds
  s_add_u32 s68, s68, 16384
  v_mfma_f32_16x16x32_bf16 v[100:103], a[220:223], v[12:15], v[100:103]
  ds_read_b64_tr_b16 v[160:161], v228 offset:0
  ds_read_b64_tr_b16 v[162:163], v228 offset:8192
  v_mfma_f32_16x16x32_bf16 v[96:99], a[224:227], v[16:19], v[96:99]
  ds_read_b64_tr_b16 v[164:165], v229 offset:0
  ds_read_b64_tr_b16 v[166:167], v229 offset:8192
  v_mfma_f32_16x16x32_bf16 v[100:103], a[228:231], v[16:19], v[100:103]
  ds_read_b64_tr_b16 v[168:169], v230 offset:0
  ds_read_b64_tr_b16 v[170:171], v230 offset:8192
  v_mfma_f32_16x16x32_bf16 v[96:99], a[232:235], v[20:23], v[96:99]
  ds_read_b64_tr_b16 v[172:173], v231 offset:0
  v_mfma_f32_16x16x32_bf16 v[100:103], a[236:239], v[20:23], v[100:103]
  ds_read_b64_tr_b16 v[174:175], v231 offset:8192
  ds_read_b64_tr_b16 v[176:177], v232 offset:0
  v_mfma_f32_16x16x32_bf16 v[96:99], a[240:243], v[24:27], v[96:99]
  ds_read_b64_tr_b16 v[178:179], v232 offset:8192
  ds_read_b64_tr_b16 v[180:181], v233 offset:0
  v_mfma_f32_16x16x32_bf16 v[100:103], a[244:247], v[24:27], v[100:103]
  ds_read_b64_tr_b16 v[182:183], v233 offset:8192
  ds_read_b64_tr_b16 v[184:185], v234 offset:0
  v_mfma_f32_16x16x32_bf16 v[96:99], a[248:251], v[28:31], v[96:99]
  ds_read_b64_tr_b16 v[186:187], v234 offset:8192
  ds_read_b64_tr_b16 v[188:189], v235 offset:0
  v_mfma_f32_16x16x32_bf16 v[100:103], a[252:255], v[28:31], v[100:103]
  ds_read_b64_tr_b16 v[190:191], v235 offset:8192
  v_mfma_f32_16x16x32_bf16 v[104:107], a[192:195], v[32:35], 0
  ds_read_b64_tr_b16 v[192:193], v228 offset:256
  ds_read_b64_tr_b16 v[194:195], v228 offset:8448
  v_mfma_f32_16x16x32_bf16 v[108:111], a[196:199], v[32:35], 0
  ds_read_b64_tr_b16 v[196:197], v229 offset:256
  ds_read_b64_tr_b16 v[198:199], v229 offset:8448
  v_mfma_f32_16x16x32_bf16 v[104:107], a[200:203], v[36:39], v[104:107]
  ds_read_b64_tr_b16 v[200:201], v230 offset:256
  v_mfma_f32_16x16x32_bf16 v[108:111], a[204:207], v[36:39], v[108:111]
  ds_read_b64_tr_b16 v[202:203], v230 offset:8448
  ds_read_b64_tr_b16 v[204:205], v231 offset:256
  ds_read_b64_tr_b16 v[206:207], v231 offset:8448
  v_mfma_f32_16x16x32_bf16 v[104:107], a[208:211], v[40:43], v[104:107]
  ds_read_b64_tr_b16 v[208:209], v232 offset:256
  ds_read_b64_tr_b16 v[210:211], v232 offset:8448
  ds_read_b64_tr_b16 v[212:213], v233 offset:256
  v_mfma_f32_16x16x32_bf16 v[108:111], a[212:215], v[40:43], v[108:111]
  ds_read_b64_tr_b16 v[214:215], v233 offset:8448
  ds_read_b64_tr_b16 v[216:217], v234 offset:256
  ds_read_b64_tr_b16 v[218:219], v234 offset:8448
  v_mfma_f32_16x16x32_bf16 v[104:107], a[216:219], v[44:47], v[104:107]
  ds_read_b64_tr_b16 v[220:221], v235 offset:256
  ds_read_b64_tr_b16 v[222:223], v235 offset:8448
  v_max3_f32 v147, v96, v97, v98
  v_mfma_f32_16x16x32_bf16 v[108:111], a[220:223], v[44:47], v[108:111]
  v_max3_f32 v147, v147, v99, v100
  v_max3_f32 v147, v147, v101, v102
  v_max_f32 v147, v147, v103
  v_mfma_f32_16x16x32_bf16 v[104:107], a[224:227], v[48:51], v[104:107]
  v_cmp_gt_f32 vcc, v147, v135
  s_cbranch_vccnz L_rare_b0c_0
L_back_b0c_0:
  v_fma_f32 v96, v96, s72, v138
  v_mfma_f32_16x16x32_bf16 v[108:111], a[228:231], v[48:51], v[108:111]
  v_fma_f32 v97, v97, s72, v138
  v_fma_f32 v98, v98, s72, v138
  v_fma_f32 v99, v99, s72, v138
  v_mfma_f32_16x16x32_bf16 v[104:107], a[232:235], v[52:55], v[104:107]
  v_fma_f32 v100, v100, s72, v138
  v_fma_f32 v101, v101, s72, v138
  v_fma_f32 v102, v102, s72, v138
  v_mfma_f32_16x16x32_bf16 v[108:111], a[236:239], v[52:55], v[108:111]
  v_fma_f32 v103, v103, s72, v138
  v_exp_f32 v96, v96
  v_exp_f32 v97, v97
  v_mfma_f32_16x16x32_bf16 v[104:107], a[240:243], v[56:59], v[104:107]
  v_exp_f32 v98, v98
  v_exp_f32 v99, v99
  v_exp_f32 v100, v100
  v_mfma_f32_16x16x32_bf16 v[108:111], a[244:247], v[56:59], v[108:111]
  v_exp_f32 v101, v101
  v_exp_f32 v102, v102
  v_exp_f32 v103, v103
  v_mfma_f32_16x16x32_bf16 v[104:107], a[248:251], v[60:63], v[104:107]
  v_cvt_pk_bf16_f32 v120, v96, v97
  v_add_f32 v141, v141, v96
  v_add_f32 v144, v144, v97
  v_mfma_f32_16x16x32_bf16 v[108:111], a[252:255], v[60:63], v[108:111]
  v_cvt_pk_bf16_f32 v121, v98, v99
  v_add_f32 v141, v141, v98
  v_add_f32 v144, v144, v99
  v_cvt_pk_bf16_f32 v122, v100, v101
  v_add_f32 v141, v141, v100
  v_add_f32 v144, v144, v101
  v_cvt_pk_bf16_f32 v123, v102, v103
  v_add_f32 v141, v141, v102
  v_add_f32 v144, v144, v103
  v_mfma_f32_16x16x32_bf16 v[112:115], a[192:195], v[64:67], 0
  v_mfma_f32_16x16x32_bf16 v[116:119], a[196:199], v[64:67], 0
  v_mfma_f32_16x16x32_bf16 v[112:115], a[200:203], v[68:71], v[112:115]
  v_mfma_f32_16x16x32_bf16 v[116:119], a[204:207], v[68:71], v[116:119]
  v_mfma_f32_16x16x32_bf16 v[112:115], a[208:211], v[72:75], v[112:115]
  s_nop 2
  v_mfma_f32_16x16x32_bf16 v[116:119], a[212:215], v[72:75], v[116:119]
  v_max3_f32 v148, v104, v105, v106
  v_max3_f32 v148, v148, v107, v108
  v_max3_f32 v148, v148, v109, v110
  v_mfma_f32_16x16x32_bf16 v[112:115], a[216:219], v[76:79], v[112:115]
  v_max_f32 v148, v148, v111
  v_cmp_gt_f32 vcc, v148, v136
  s_cbranch_vccnz L_rare_b0c_1
L_back_b0c_1:
  v_mfma_f32_16x16x32_bf16 v[116:119], a[220:223], v[76:79], v[116:119]
  v_fma_f32 v104, v104, s72, v139
  v_fma_f32 v105, v105, s72, v139
  v_fma_f32 v106, v106, s72, v139
  v_mfma_f32_16x16x32_bf16 v[112:115], a[224:227], v[80:83], v[112:115]
  v_fma_f32 v107, v107, s72, v139
  v_fma_f32 v108, v108, s72, v139
  v_fma_f32 v109, v109, s72, v139
  v_mfma_f32_16x16x32_bf16 v[116:119], a[228:231], v[80:83], v[116:119]
  v_fma_f32 v110, v110, s72, v139
  v_fma_f32 v111, v111, s72, v139
  v_exp_f32 v104, v104
  v_mfma_f32_16x16x32_bf16 v[112:115], a[232:235], v[84:87], v[112:115]
  v_exp_f32 v105, v105
  v_exp_f32 v106, v106
  v_exp_f32 v107, v107
  v_mfma_f32_16x16x32_bf16 v[116:119], a[236:239], v[84:87], v[116:119]
  v_exp_f32 v108, v108
  v_exp_f32 v109, v109
  v_exp_f32 v110, v110
  v_mfma_f32_16x16x32_bf16 v[112:115], a[240:243], v[88:91], v[112:115]
  v_exp_f32 v111, v111
  v_cvt_pk_bf16_f32 v124, v104, v105
  v_add_f32 v142, v142, v104
  v_mfma_f32_16x16x32_bf16 v[116:119], a[244:247], v[88:91], v[116:119]
  v_add_f32 v145, v145, v105
  v_cvt_pk_bf16_f32 v125, v106, v107
  v_add_f32 v142, v142, v106
  v_mfma_f32_16x16x32_bf16 v[112:115], a[248:251], v[92:95], v[112:115]
  v_add_f32 v145, v145, v107
  v_cvt_pk_bf16_f32 v126, v108, v109
  v_add_f32 v142, v142, v108
  v_mfma_f32_16x16x32_bf16 v[116:119], a[252:255], v[92:95], v[116:119]
  v_add_f32 v145, v145, v109
  v_cvt_pk_bf16_f32 v127, v110, v111
  v_add_f32 v142, v142, v110
  v_add_f32 v145, v145, v111
  s_waitcnt lgkmcnt(0)
  v_mfma_f32_16x16x32_bf16 a[0:3], v[160:163], v[120:123], a[0:3]
  v_mfma_f32_16x16x32_bf16 a[4:7], v[164:167], v[120:123], a[4:7]
  v_mfma_f32_16x16x32_bf16 a[8:11], v[168:171], v[120:123], a[8:11]
  v_mfma_f32_16x16x32_bf16 a[12:15], v[172:175], v[120:123], a[12:15]
  v_mfma_f32_16x16x32_bf16 a[16:19], v[176:179], v[120:123], a[16:19]
  s_nop 2
  v_mfma_f32_16x16x32_bf16 a[20:23], v[180:183], v[120:123], a[20:23]
  v_max3_f32 v149, v112, v113, v114
  v_max3_f32 v149, v149, v115, v116
  v_max3_f32 v149, v149, v117, v118
  v_mfma_f32_16x16x32_bf16 a[24:27], v[184:187], v[120:123], a[24:27]
  v_max_f32 v149, v149, v119
  v_cmp_gt_f32 vcc, v149, v137
  s_cbranch_vccnz L_rare_b0c_2
L_back_b0c_2:
  v_mfma_f32_16x16x32_bf16 a[28:31], v[188:191], v[120:123], a[28:31]
  v_fma_f32 v112, v112, s72, v140
  v_fma_f32 v113, v113, s72, v140
  v_fma_f32 v114, v114, s72, v140
  v_mfma_f32_16x16x32_bf16 a[32:35], v[192:195], v[120:123], a[32:35]
  v_fma_f32 v115, v115, s72, v140
  v_fma_f32 v116, v116, s72, v140
  v_fma_f32 v117, v117, s72, v140
  v_mfma_f32_16x16x32_bf16 a[36:39], v[196:199], v[120:123], a[36:39]
  v_fma_f32 v118, v118, s72, v140
  v_fma_f32 v119, v119, s72, v140
  v_exp_f32 v112, v112
  v_mfma_f32_16x16x32_bf16 a[40:43], v[200:203], v[120:123], a[40:43]
  v_exp_f32 v113, v113
  v_exp_f32 v114, v114
  v_exp_f32 v115, v115
  v_mfma_f32_16x16x32_bf16 a[44:47], v[204:207], v[120:123], a[44:47]
  v_exp_f32 v116, v116
  v_exp_f32 v117, v117
  v_exp_f32 v118, v118
  v_mfma_f32_16x16x32_bf16 a[48:51], v[208:211], v[120:123], a[48:51]
  v_exp_f32 v119, v119
  v_cvt_pk_bf16_f32 v128, v112, v113
  v_add_f32 v143, v143, v112
  v_mfma_f32_16x16x32_bf16 a[52:55], v[212:215], v[120:123], a[52:55]
  v_add_f32 v146, v146, v113
  v_cvt_pk_bf16_f32 v129, v114, v115
  v_add_f32 v143, v143, v114
  v_mfma_f32_16x16x32_bf16 a[56:59], v[216:219], v[120:123], a[56:59]
  v_add_f32 v146, v146, v115
  v_cvt_pk_bf16_f32 v130, v116, v117
  v_add_f32 v143, v143, v116
  v_mfma_f32_16x16x32_bf16 a[60:63], v[220:223], v[120:123], a[60:63]
  v_add_f32 v146, v146, v117
  v_cvt_pk_bf16_f32 v131, v118, v119
  v_add_f32 v143, v143, v118
  v_add_f32 v146, v146, v119
  s_waitcnt vmcnt(16)
  s_barrier
  v_mfma_f32_16x16x32_bf16 a[64:67], v[160:163], v[124:127], a[64:67]
  s_add_u32 m0, s67, 0
  s_add_u32 s71, s70, 0
  v_mfma_f32_16x16x32_bf16 a[68:71], v[164:167], v[124:127], a[68:71]
  buffer_load_dwordx4 v244, s[12:15], s71 offen offset:0 nt lds
  v_mfma_f32_16x16x32_bf16 a[72:75], v[168:171], v[124:127], a[72:75]
  buffer_load_dwordx4 v245, s[12:15], s71 offen offset:1024 nt lds
  v_mfma_f32_16x16x32_bf16 a[76:79], v[172:175], v[124:127], a[76:79]
  buffer_load_dwordx4 v246, s[12:15], s71 offen offset:2048 nt lds
  v_mfma_f32_16x16x32_bf16 a[80:83], v[176:179], v[124:127], a[80:83]
  buffer_load_dwordx4 v247, s[12:15], s71 offen offset:3072 nt lds
  v_mfma_f32_16x16x32_bf16 a[84:87], v[180:183], v[124:127], a[84:87]
  s_add_u32 m0, s67, 4096
  v_mfma_f32_16x16x32_bf16 a[88:91], v[184:187], v[124:127], a[88:91]
  s_add_u32 s71, s70, 4096
  v_mfma_f32_16x16x32_bf16 a[92:95], v[188:191], v[124:127], a[92:95]
  buffer_load_dwordx4 v244, s[12:15], s71 offen offset:0 nt lds
  v_mfma_f32_16x16x32_bf16 a[96:99], v[192:195], v[124:127], a[96:99]
  buffer_load_dwordx4 v245, s[12:15], s71 offen offset:1024 nt lds
  v_mfma_f32_16x16x32_bf16 a[100:103], v[196:199], v[124:127], a[100:103]
  buffer_load_dwordx4 v246, s[12:15], s71 offen offset:2048 nt lds
  v_mfma_f32_16x16x32_bf16 a[104:107], v[200:203], v[124:127], a[104:107]
  buffer_load_dwordx4 v247, s[12:15], s71 offen offset:3072 nt lds
  v_mfma_f32_16x16x32_bf16 a[108:111], v[204:207], v[124:127], a[108:111]
  s_add_u32 s70, s70, 16384
  v_mfma_f32_16x16x32_bf16 a[112:115], v[208:211], v[124:127], a[112:115]
  ds_read_b128 a[192:195], v224 offset:16384
  v_mfma_f32_16x16x32_bf16 a[116:119], v[212:215], v[124:127], a[116:119]
  ds_read_b128 a[196:199], v224 offset:24576
  v_mfma_f32_16x16x32_bf16 a[120:123], v[216:219], v[124:127], a[120:123]
  ds_read_b128 a[200:203], v225 offset:16384
  v_mfma_f32_16x16x32_bf16 a[124:127], v[220:223], v[124:127], a[124:127]
  ds_read_b128 a[204:207], v225 offset:24576
  v_mfma_f32_16x16x32_bf16 a[128:131], v[160:163], v[128:131], a[128:131]
  ds_read_b128 a[208:211], v226 offset:16384
  v_mfma_f32_16x16x32_bf16 a[132:135], v[164:167], v[128:131], a[132:135]
  ds_read_b128 a[212:215], v226 offset:24576
  v_mfma_f32_16x16x32_bf16 a[136:139], v[168:171], v[128:131], a[136:139]
  ds_read_b128 a[216:219], v227 offset:16384
  v_mfma_f32_16x16x32_bf16 a[140:143], v[172:175], v[128:131], a[140:143]
  v_mfma_f32_16x16x32_bf16 a[144:147], v[176:179], v[128:131], a[144:147]
  ds_read_b128 a[220:223], v227 offset:24576
  v_mfma_f32_16x16x32_bf16 a[148:151], v[180:183], v[128:131], a[148:151]
  ds_read_b128 a[224:227], v224 offset:16640
  v_mfma_f32_16x16x32_bf16 a[152:155], v[184:187], v[128:131], a[152:155]
  ds_read_b128 a[228:231], v224 offset:24832
  v_mfma_f32_16x16x32_bf16 a[156:159], v[188:191], v[128:131], a[156:159]
  v_mfma_f32_16x16x32_bf16 a[160:163], v[192:195], v[128:131], a[160:163]
  ds_read_b128 a[232:235], v225 offset:16640
  v_mfma_f32_16x16x32_bf16 a[164:167], v[196:199], v[128:131], a[164:167]
  ds_read_b128 a[236:239], v225 offset:24832
  v_mfma_f32_16x16x32_bf16 a[168:171], v[200:203], v[128:131], a[168:171]
  ds_read_b128 a[240:243], v226 offset:16640
  v_mfma_f32_16x16x32_bf16 a[172:175], v[204:207], v[128:131], a[172:175]
  v_mfma_f32_16x16x32_bf16 a[176:179], v[208:211], v[128:131], a[176:179]
  ds_read_b128 a[244:247], v226 offset:24832
  v_mfma_f32_16x16x32_bf16 a[180:183], v[212:215], v[128:131], a[180:183]
  ds_read_b128 a[248:251], v227 offset:16640
  v_mfma_f32_16x16x32_bf16 a[184:187], v[216:219], v[128:131], a[184:187]
  ds_read_b128 a[252:255], v227 offset:24832
  v_mfma_f32_16x16x32_bf16 a[188:191], v[220:223], v[128:131], a[188:191]
  s_branch L_loop_b0
L_loopend_b0:
  s_waitcnt lgkmcnt(0) vmcnt(16)
  s_barrier
  v_mfma_f32_16x16x32_bf16 v[96:99], a[192:195], v[0:3], 0
  ds_read_b64_tr_b16 v[160:161], v228 offset:0
  v_mfma_f32_16x16x32_bf16 v[100:103], a[196:199], v[0:3], 0
  ds_read_b64_tr_b16 v[162:163], v228 offset:8192
  v_mfma_f32_16x16x32_bf16 v[96:99], a[200:203], v[4:7], v[96:99]
  ds_read_b64_tr_b16 v[164:165], v229 offset:0
  v_mfma_f32_16x16x32_bf16 v[100:103], a[204:207], v[4:7], v[100:103]
  ds_read_b64_tr_b16 v[166:167], v229 offset:8192
  v_mfma_f32_16x16x32_bf16 v[96:99], a[208:211], v[8:11], v[96:99]
  ds_read_b64_tr_b16 v[168:169], v230 offset:0
  v_mfma_f32_16x16x32_bf16 v[100:103], a[212:215], v[8:11], v[100:103]
  ds_read_b64_tr_b16 v[170:171], v230 offset:8192
  v_mfma_f32_16x16x32_bf16 v[96:99], a[216:219], v[12:15], v[96:99]
  ds_read_b64_tr_b16 v[172:173], v231 offset:0
  v_mfma_f32_16x16x32_bf16 v[100:103], a[220:223], v[12:15], v[100:103]
  ds_read_b64_tr_b16 v[174:175], v231 offset:8192
  v_mfma_f32_16x16x32_bf16 v[96:99], a[224:227], v[16:19], v[96:99]
  ds_read_b64_tr_b16 v[176:177], v232 offset:0
  v_mfma_f32_16x16x32_bf16 v[100:103], a[228:231], v[16:19], v[100:103]
  ds_read_b64_tr_b16 v[178:179], v232 offset:8192
  v_mfma_f32_16x16x32_bf16 v[96:99], a[232:235], v[20:23], v[96:99]
  ds_read_b64_tr_b16 v[180:181], v233 offset:0
  v_mfma_f32_16x16x32_bf16 v[100:103], a[236:239], v[20:23], v[100:103]
  ds_read_b64_tr_b16 v[182:183], v233 offset:8192
  v_mfma_f32_16x16x32_bf16 v[96:99], a[240:243], v[24:27], v[96:99]
  ds_read_b64_tr_b16 v[184:185], v234 offset:0
  v_mfma_f32_16x16x32_bf16 v[100:103], a[244:247], v[24:27], v[100:103]
  ds_read_b64_tr_b16 v[186:187], v234 offset:8192
  v_mfma_f32_16x16x32_bf16 v[96:99], a[248:251], v[28:31], v[96:99]
  ds_read_b64_tr_b16 v[188:189], v235 offset:0
  v_mfma_f32_16x16x32_bf16 v[100:103], a[252:255], v[28:31], v[100:103]
  ds_read_b64_tr_b16 v[190:191], v235 offset:8192
  v_mfma_f32_16x16x32_bf16 v[104:107], a[192:195], v[32:35], 0
  ds_read_b64_tr_b16 v[192:193], v228 offset:256
  ds_read_b64_tr_b16 v[194:195], v228 offset:8448
  v_mfma_f32_16x16x32_bf16 v[108:111], a[196:199], v[32:35], 0
  ds_read_b64_tr_b16 v[196:197], v229 offset:256
  ds_read_b64_tr_b16 v[198:199], v229 offset:8448
  v_mfma_f32_16x16x32_bf16 v[104:107], a[200:203], v[36:39], v[104:107]
  ds_read_b64_tr_b16 v[200:201], v230 offset:256
  v_mfma_f32_16x16x32_bf16 v[108:111], a[204:207], v[36:39], v[108:111]
  ds_read_b64_tr_b16 v[202:203], v230 offset:8448
  ds_read_b64_tr_b16 v[204:205], v231 offset:256
  ds_read_b64_tr_b16 v[206:207], v231 offset:8448
  v_mfma_f32_16x16x32_bf16 v[104:107], a[208:211], v[40:43], v[104:107]
  ds_read_b64_tr_b16 v[208:209], v232 offset:256
  ds_read_b64_tr_b16 v[210:211], v232 offset:8448
  ds_read_b64_tr_b16 v[212:213], v233 offset:256
  v_mfma_f32_16x16x32_bf16 v[108:111], a[212:215], v[40:43], v[108:111]
  ds_read_b64_tr_b16 v[214:215], v233 offset:8448
  ds_read_b64_tr_b16 v[216:217], v234 offset:256
  ds_read_b64_tr_b16 v[218:219], v234 offset:8448
  v_mfma_f32_16x16x32_bf16 v[104:107], a[216:219], v[44:47], v[104:107]
  ds_read_b64_tr_b16 v[220:221], v235 offset:256
  ds_read_b64_tr_b16 v[222:223], v235 offset:8448
  v_max3_f32 v147, v96, v97, v98
  v_mfma_f32_16x16x32_bf16 v[108:111], a[220:223], v[44:47], v[108:111]
  v_max3_f32 v147, v147, v99, v100
  v_max3_f32 v147, v147, v101, v102
  v_max_f32 v147, v147, v103
  v_mfma_f32_16x16x32_bf16 v[104:107], a[224:227], v[48:51], v[104:107]
  v_cmp_gt_f32 vcc, v147, v135
  s_cbranch_vccnz L_rare_b0d_0
L_back_b0d_0:
  v_fma_f32 v96, v96, s72, v138
  v_mfma_f32_16x16x32_bf16 v[108:111], a[228:231], v[48:51], v[108:111]
  v_fma_f32 v97, v97, s72, v138
  v_fma_f32 v98, v98, s72, v138
  v_fma_f32 v99, v99, s72, v138
  v_mfma_f32_16x16x32_bf16 v[104:107], a[232:235], v[52:55], v[104:107]
  v_fma_f32 v100, v100, s72, v138
  v_fma_f32 v101, v101, s72, v138
  v_fma_f32 v102, v102, s72, v138
  v_mfma_f32_16x16x32_bf16 v[108:111], a[236:239], v[52:55], v[108:111]
  v_fma_f32 v103, v103, s72, v138
  v_exp_f32 v96, v96
  v_exp_f32 v97, v97
  v_mfma_f32_16x16x32_bf16 v[104:107], a[240:243], v[56:59], v[104:107]
  v_exp_f32 v98, v98
  v_exp_f32 v99, v99
  v_exp_f32 v100, v100
  v_mfma_f32_16x16x32_bf16 v[108:111], a[244:247], v[56:59], v[108:111]
  v_exp_f32 v101, v101
  v_exp_f32 v102, v102
  v_exp_f32 v103, v103
  v_mfma_f32_16x16x32_bf16 v[104:107], a[248:251], v[60:63], v[104:107]
  v_cvt_pk_bf16_f32 v120, v96, v97
  v_add_f32 v141, v141, v96
  v_add_f32 v144, v144, v97
  v_mfma_f32_16x16x32_bf16 v[108:111], a[252:255], v[60:63], v[108:111]
  v_cvt_pk_bf16_f32 v121, v98, v99
  v_add_f32 v141, v141, v98
  v_add_f32 v144, v144, v99
  v_cvt_pk_bf16_f32 v122, v100, v101
  v_add_f32 v141, v141, v100
  v_add_f32 v144, v144, v101
  v_cvt_pk_bf16_f32 v123, v102, v103
  v_add_f32 v141, v141, v102
  v_add_f32 v144, v144, v103
  v_mfma_f32_16x16x32_bf16 v[112:115], a[192:195], v[64:67], 0
  v_mfma_f32_16x16x32_bf16 v[116:119], a[196:199], v[64:67], 0
  v_mfma_f32_16x16x32_bf16 v[112:115], a[200:203], v[68:71], v[112:115]
  v_mfma_f32_16x16x32_bf16 v[116:119], a[204:207], v[68:71], v[116:119]
  v_mfma_f32_16x16x32_bf16 v[112:115], a[208:211], v[72:75], v[112:115]
  s_nop 2
  v_mfma_f32_16x16x32_bf16 v[116:119], a[212:215], v[72:75], v[116:119]
  v_max3_f32 v148, v104, v105, v106
  v_max3_f32 v148, v148, v107, v108
  v_max3_f32 v148, v148, v109, v110
  v_mfma_f32_16x16x32_bf16 v[112:115], a[216:219], v[76:79], v[112:115]
  v_max_f32 v148, v148, v111
  v_cmp_gt_f32 vcc, v148, v136
  s_cbranch_vccnz L_rare_b0d_1
L_back_b0d_1:
  v_mfma_f32_16x16x32_bf16 v[116:119], a[220:223], v[76:79], v[116:119]
  v_fma_f32 v104, v104, s72, v139
  v_fma_f32 v105, v105, s72, v139
  v_fma_f32 v106, v106, s72, v139
  v_mfma_f32_16x16x32_bf16 v[112:115], a[224:227], v[80:83], v[112:115]
  v_fma_f32 v107, v107, s72, v139
  v_fma_f32 v108, v108, s72, v139
  v_fma_f32 v109, v109, s72, v139
  v_mfma_f32_16x16x32_bf16 v[116:119], a[228:231], v[80:83], v[116:119]
  v_fma_f32 v110, v110, s72, v139
  v_fma_f32 v111, v111, s72, v139
  v_exp_f32 v104, v104
  v_mfma_f32_16x16x32_bf16 v[112:115], a[232:235], v[84:87], v[112:115]
  v_exp_f32 v105, v105
  v_exp_f32 v106, v106
  v_exp_f32 v107, v107
  v_mfma_f32_16x16x32_bf16 v[116:119], a[236:239], v[84:87], v[116:119]
  v_exp_f32 v108, v108
  v_exp_f32 v109, v109
  v_exp_f32 v110, v110
  v_mfma_f32_16x16x32_bf16 v[112:115], a[240:243], v[88:91], v[112:115]
  v_exp_f32 v111, v111
  v_cvt_pk_bf16_f32 v124, v104, v105
  v_add_f32 v142, v142, v104
  v_mfma_f32_16x16x32_bf16 v[116:119], a[244:247], v[88:91], v[116:119]
  v_add_f32 v145, v145, v105
  v_cvt_pk_bf16_f32 v125, v106, v107
  v_add_f32 v142, v142, v106
  v_mfma_f32_16x16x32_bf16 v[112:115], a[248:251], v[92:95], v[112:115]
  v_add_f32 v145, v145, v107
  v_cvt_pk_bf16_f32 v126, v108, v109
  v_add_f32 v142, v142, v108
  v_mfma_f32_16x16x32_bf16 v[116:119], a[252:255], v[92:95], v[116:119]
  v_add_f32 v145, v145, v109
  v_cvt_pk_bf16_f32 v127, v110, v111
  v_add_f32 v142, v142, v110
  v_add_f32 v145, v145, v111
  s_waitcnt lgkmcnt(0)
  v_mfma_f32_16x16x32_bf16 a[0:3], v[160:163], v[120:123], a[0:3]
  v_mfma_f32_16x16x32_bf16 a[4:7], v[164:167], v[120:123], a[4:7]
  v_mfma_f32_16x16x32_bf16 a[8:11], v[168:171], v[120:123], a[8:11]
  v_mfma_f32_16x16x32_bf16 a[12:15], v[172:175], v[120:123], a[12:15]
  v_mfma_f32_16x16x32_bf16 a[16:19], v[176:179], v[120:123], a[16:19]
  s_nop 2
  v_mfma_f32_16x16x32_bf16 a[20:23], v[180:183], v[120:123], a[20:23]
  v_max3_f32 v149, v112, v113, v114
  v_max3_f32 v149, v149, v115, v116
  v_max3_f32 v149, v149, v117, v118
  v_mfma_f32_16x16x32_bf16 a[24:27], v[184:187], v[120:123], a[24:27]
  v_max_f32 v149, v149, v119
  v_cmp_gt_f32 vcc, v149, v137
  s_cbranch_vccnz L_rare_b0d_2
L_back_b0d_2:
  v_mfma_f32_16x16x32_bf16 a[28:31], v[188:191], v[120:123], a[28:31]
  v_fma_f32 v112, v112, s72, v140
  v_fma_f32 v113, v113, s72, v140
  v_fma_f32 v114, v114, s72, v140
  v_mfma_f32_16x16x32_bf16 a[32:35], v[192:195], v[120:123], a[32:35]
  v_fma_f32 v115, v115, s72, v140
  v_fma_f32 v116, v116, s72, v140
  v_fma_f32 v117, v117, s72, v140
  v_mfma_f32_16x16x32_bf16 a[36:39], v[196:199], v[120:123], a[36:39]
  v_fma_f32 v118, v118, s72, v140
  v_fma_f32 v119, v119, s72, v140
  v_exp_f32 v112, v112
  v_mfma_f32_16x16x32_bf16 a[40:43], v[200:203], v[120:123], a[40:43]
  v_exp_f32 v113, v113
  v_exp_f32 v114, v114
  v_exp_f32 v115, v115
  v_mfma_f32_16x16x32_bf16 a[44:47], v[204:207], v[120:123], a[44:47]
  v_exp_f32 v116, v116
  v_exp_f32 v117, v117
  v_exp_f32 v118, v118
  v_mfma_f32_16x16x32_bf16 a[48:51], v[208:211], v[120:123], a[48:51]
  v_exp_f32 v119, v119
  v_cvt_pk_bf16_f32 v128, v112, v113
  v_add_f32 v143, v143, v112
  v_mfma_f32_16x16x32_bf16 a[52:55], v[212:215], v[120:123], a[52:55]
  v_add_f32 v146, v146, v113
  v_cvt_pk_bf16_f32 v129, v114, v115
  v_add_f32 v143, v143, v114
  v_mfma_f32_16x16x32_bf16 a[56:59], v[216:219], v[120:123], a[56:59]
  v_add_f32 v146, v146, v115
  v_cvt_pk_bf16_f32 v130, v116, v117
  v_add_f32 v143, v143, v116
  v_mfma_f32_16x16x32_bf16 a[60:63], v[220:223], v[120:123], a[60:63]
  v_add_f32 v146, v146, v117
  v_cvt_pk_bf16_f32 v131, v118, v119
  v_add_f32 v143, v143, v118
  v_add_f32 v146, v146, v119
  s_waitcnt vmcnt(8)
  s_barrier
  v_mfma_f32_16x16x32_bf16 a[64:67], v[160:163], v[124:127], a[64:67]
  ds_read_b128 a[192:195], v224 offset:16384
  v_mfma_f32_16x16x32_bf16 a[68:71], v[164:167], v[124:127], a[68:71]
  v_mfma_f32_16x16x32_bf16 a[72:75], v[168:171], v[124:127], a[72:75]
  v_mfma_f32_16x16x32_bf16 a[76:79], v[172:175], v[124:127], a[76:79]
  v_mfma_f32_16x16x32_bf16 a[80:83], v[176:179], v[124:127], a[80:83]
  ds_read_b128 a[196:199], v224 offset:24576
  v_mfma_f32_16x16x32_bf16 a[84:87], v[180:183], v[124:127], a[84:87]
  v_mfma_f32_16x16x32_bf16 a[88:91], v[184:187], v[124:127], a[88:91]
  v_mfma_f32_16x16x32_bf16 a[92:95], v[188:191], v[124:127], a[92:95]
  v_mfma_f32_16x16x32_bf16 a[96:99], v[192:195], v[124:127], a[96:99]
  ds_read_b128 a[200:203], v225 offset:16384
  v_mfma_f32_16x16x32_bf16 a[100:103], v[196:199], v[124:127], a[100:103]
  v_mfma_f32_16x16x32_bf16 a[104:107], v[200:203], v[124:127], a[104:107]
  v_mfma_f32_16x16x32_bf16 a[108:111], v[204:207], v[124:127], a[108:111]
  v_mfma_f32_16x16x32_bf16 a[112:115], v[208:211], v[124:127], a[112:115]
  ds_read_b128 a[204:207], v225 offset:24576
  v_mfma_f32_16x16x32_bf16 a[116:119], v[212:215], v[124:127], a[116:119]
  v_mfma_f32_16x16x32_bf16 a[120:123], v[216:219], v[124:127], a[120:123]
  v_mfma_f32_16x16x32_bf16 a[124:127], v[220:223], v[124:127], a[124:127]
  v_mfma_f32_16x16x32_bf16 a[128:131], v[160:163], v[128:131], a[128:131]
  ds_read_b128 a[208:211], v226 offset:16384
  v_mfma_f32_16x16x32_bf16 a[132:135], v[164:167], v[128:131], a[132:135]
  ds_read_b128 a[212:215], v226 offset:24576
  v_mfma_f32_16x16x32_bf16 a[136:139], v[168:171], v[128:131], a[136:139]
  ds_read_b128 a[216:219], v227 offset:16384
  v_mfma_f32_16x16x32_bf16 a[140:143], v[172:175], v[128:131], a[140:143]
  v_mfma_f32_16x16x32_bf16 a[144:147], v[176:179], v[128:131], a[144:147]
  ds_read_b128 a[220:223], v227 offset:24576
  v_mfma_f32_16x16x32_bf16 a[148:151], v[180:183], v[128:131], a[148:151]
  ds_read_b128 a[224:227], v224 offset:16640
  v_mfma_f32_16x16x32_bf16 a[152:155], v[184:187], v[128:131], a[152:155]
  ds_read_b128 a[228:231], v224 offset:24832
  v_mfma_f32_16x16x32_bf16 a[156:159], v[188:191], v[128:131], a[156:159]
  v_mfma_f32_16x16x32_bf16 a[160:163], v[192:195], v[128:131], a[160:163]
  ds_read_b128 a[232:235], v225 offset:16640
  v_mfma_f32_16x16x32_bf16 a[164:167], v[196:199], v[128:131], a[164:167]
  ds_read_b128 a[236:239], v225 offset:24832
  v_mfma_f32_16x16x32_bf16 a[168:171], v[200:203], v[128:131], a[168:171]
  ds_read_b128 a[240:243], v226 offset:16640
  v_mfma_f32_16x16x32_bf16 a[172:175], v[204:207], v[128:131], a[172:175]
  v_mfma_f32_16x16x32_bf16 a[176:179], v[208:211], v[128:131], a[176:179]
  ds_read_b128 a[244:247], v226 offset:24832
  v_mfma_f32_16x16x32_bf16 a[180:183], v[212:215], v[128:131], a[180:183]
  ds_read_b128 a[248:251], v227 offset:16640
  v_mfma_f32_16x16x32_bf16 a[184:187], v[216:219], v[128:131], a[184:187]
  ds_read_b128 a[252:255], v227 offset:24832
  v_mfma_f32_16x16x32_bf16 a[188:191], v[220:223], v[128:131], a[188:191]
  v_lshrrev_b32 v150, 7, v248
  v_add_u32 v150, 0, v150
  v_mul_u32_u24 v150, 37, v150
  v_lshrrev_b32 v150, 8, v150
  v_mul_u32_u24 v151, 896, v150
  v_add_u32 v152, 0, v248
  v_sub_u32 v152, v152, v151
  v_lshrrev_b32 v150, 1, v150
  v_and_b32 v150, 3, v150
  v_lshlrev_b32 v150, 5, v150
  v_xor_b32 v152, v152, v150
  v_add_u32 v155, v151, v152
  v_lshrrev_b32 v150, 7, v248
  v_add_u32 v150, 8, v150
  v_mul_u32_u24 v150, 37, v150
  v_lshrrev_b32 v150, 8, v150
  v_mul_u32_u24 v151, 896, v150
  v_add_u32 v152, 1024, v248
  v_sub_u32 v152, v152, v151
  v_lshrrev_b32 v150, 1, v150
  v_and_b32 v150, 3, v150
  v_lshlrev_b32 v150, 5, v150
  v_xor_b32 v152, v152, v150
  v_add_u32 v156, v151, v152
  v_lshrrev_b32 v150, 7, v248
  v_add_u32 v150, 16, v150
  v_mul_u32_u24 v150, 37, v150
  v_lshrrev_b32 v150, 8, v150
  v_mul_u32_u24 v151, 896, v150
  v_add_u32 v152, 2048, v248
  v_sub_u32 v152, v152, v151
  v_lshrrev_b32 v150, 1, v150
  v_and_b32 v150, 3, v150
  v_lshlrev_b32 v150, 5, v150
  v_xor_b32 v152, v152, v150
  v_add_u32 v157, v151, v152
  v_lshrrev_b32 v150, 7, v248
  v_add_u32 v150, 24, v150
  v_mul_u32_u24 v150, 37, v150
  v_lshrrev_b32 v150, 8, v150
  v_mul_u32_u24 v151, 896, v150
  v_add_u32 v152, 3072, v248
  v_sub_u32 v152, v152, v151
  v_lshrrev_b32 v150, 1, v150
  v_and_b32 v150, 3, v150
  v_lshlrev_b32 v150, 5, v150
  v_xor_b32 v152, v152, v150
  v_add_u32 v158, v151, v152
  v_lshrrev_b32 v150, 7, v248
  v_add_u32 v150, 32, v150
  v_mul_u32_u24 v150, 37, v150
  v_lshrrev_b32 v150, 8, v150
  v_mul_u32_u24 v151, 896, v150
  v_add_u32 v152, 4096, v248
  v_sub_u32 v152, v152, v151
  v_lshrrev_b32 v150, 1, v150
  v_and_b32 v150, 3, v150
  v_lshlrev_b32 v150, 5, v150
  v_xor_b32 v152, v152, v150
  v_add_u32 v159, v151, v152
  v_lshrrev_b32 v150, 7, v248
  v_add_u32 v150, 40, v150
  v_mul_u32_u24 v150, 37, v150
  v_lshrrev_b32 v150, 8, v150
  v_mul_u32_u24 v151, 896, v150
  v_add_u32 v152, 5120, v248
  v_sub_u32 v152, v152, v151
  v_lshrrev_b32 v150, 1, v150
  v_and_b32 v150, 3, v150
  v_lshlrev_b32 v150, 5, v150
  v_xor_b32 v152, v152, v150
  v_add_u32 v251, v151, v152
  v_lshrrev_b32 v150, 7, v248
  v_add_u32 v150, 48, v150
  v_mul_u32_u24 v150, 37, v150
  v_lshrrev_b32 v150, 8, v150
  v_mul_u32_u24 v151, 896, v150
  v_add_u32 v152, 6144, v248
  v_sub_u32 v152, v152, v151
  v_lshrrev_b32 v150, 1, v150
  v_and_b32 v150, 3, v150
  v_lshlrev_b32 v150, 5, v150
  v_xor_b32 v152, v152, v150
  v_add_u32 v252, v151, v152
  s_waitcnt lgkmcnt(0) vmcnt(0)
  s_barrier
  v_mfma_f32_16x16x32_bf16 v[96:99], a[192:195], v[0:3], 0
  ds_read_b64_tr_b16 v[160:161], v228 offset:16384
  v_mfma_f32_16x16x32_bf16 v[100:103], a[196:199], v[0:3], 0
  ds_read_b64_tr_b16 v[162:163], v228 offset:24576
  v_mfma_f32_16x16x32_bf16 v[96:99], a[200:203], v[4:7], v[96:99]
  ds_read_b64_tr_b16 v[164:165], v229 offset:16384
  v_mfma_f32_16x16x32_bf16 v[100:103], a[204:207], v[4:7], v[100:103]
  ds_read_b64_tr_b16 v[166:167], v229 offset:24576
  v_mfma_f32_16x16x32_bf16 v[96:99], a[208:211], v[8:11], v[96:99]
  ds_read_b64_tr_b16 v[168:169], v230 offset:16384
  v_mfma_f32_16x16x32_bf16 v[100:103], a[212:215], v[8:11], v[100:103]
  ds_read_b64_tr_b16 v[170:171], v230 offset:24576
  v_mfma_f32_16x16x32_bf16 v[96:99], a[216:219], v[12:15], v[96:99]
  ds_read_b64_tr_b16 v[172:173], v231 offset:16384
  v_mfma_f32_16x16x32_bf16 v[100:103], a[220:223], v[12:15], v[100:103]
  ds_read_b64_tr_b16 v[174:175], v231 offset:24576
  v_mfma_f32_16x16x32_bf16 v[96:99], a[224:227], v[16:19], v[96:99]
  ds_read_b64_tr_b16 v[176:177], v232 offset:16384
  v_mfma_f32_16x16x32_bf16 v[100:103], a[228:231], v[16:19], v[100:103]
  ds_read_b64_tr_b16 v[178:179], v232 offset:24576
  v_mfma_f32_16x16x32_bf16 v[96:99], a[232:235], v[20:23], v[96:99]
  ds_read_b64_tr_b16 v[180:181], v233 offset:16384
  v_mfma_f32_16x16x32_bf16 v[100:103], a[236:239], v[20:23], v[100:103]
  ds_read_b64_tr_b16 v[182:183], v233 offset:24576
  v_mfma_f32_16x16x32_bf16 v[96:99], a[240:243], v[24:27], v[96:99]
  ds_read_b64_tr_b16 v[184:185], v234 offset:16384
  v_mfma_f32_16x16x32_bf16 v[100:103], a[244:247], v[24:27], v[100:103]
  ds_read_b64_tr_b16 v[186:187], v234 offset:24576
  v_mfma_f32_16x16x32_bf16 v[96:99], a[248:251], v[28:31], v[96:99]
  ds_read_b64_tr_b16 v[188:189], v235 offset:16384
  v_mfma_f32_16x16x32_bf16 v[100:103], a[252:255], v[28:31], v[100:103]
  ds_read_b64_tr_b16 v[190:191], v235 offset:24576
  v_mfma_f32_16x16x32_bf16 v[104:107], a[192:195], v[32:35], 0
  ds_read_b64_tr_b16 v[192:193], v228 offset:16640
  ds_read_b64_tr_b16 v[194:195], v228 offset:24832
  v_mfma_f32_16x16x32_bf16 v[108:111], a[196:199], v[32:35], 0
  ds_read_b64_tr_b16 v[196:197], v229 offset:16640
  ds_read_b64_tr_b16 v[198:199], v229 offset:24832
  v_mfma_f32_16x16x32_bf16 v[104:107], a[200:203], v[36:39], v[104:107]
  ds_read_b64_tr_b16 v[200:201], v230 offset:16640
  v_mfma_f32_16x16x32_bf16 v[108:111], a[204:207], v[36:39], v[108:111]
  ds_read_b64_tr_b16 v[202:203], v230 offset:24832
  ds_read_b64_tr_b16 v[204:205], v231 offset:16640
  ds_read_b64_tr_b16 v[206:207], v231 offset:24832
  v_mfma_f32_16x16x32_bf16 v[104:107], a[208:211], v[40:43], v[104:107]
  ds_read_b64_tr_b16 v[208:209], v232 offset:16640
  ds_read_b64_tr_b16 v[210:211], v232 offset:24832
  ds_read_b64_tr_b16 v[212:213], v233 offset:16640
  v_mfma_f32_16x16x32_bf16 v[108:111], a[212:215], v[40:43], v[108:111]
  ds_read_b64_tr_b16 v[214:215], v233 offset:24832
  ds_read_b64_tr_b16 v[216:217], v234 offset:16640
  ds_read_b64_tr_b16 v[218:219], v234 offset:24832
  v_mfma_f32_16x16x32_bf16 v[104:107], a[216:219], v[44:47], v[104:107]
  ds_read_b64_tr_b16 v[220:221], v235 offset:16640
  ds_read_b64_tr_b16 v[222:223], v235 offset:24832
  v_max3_f32 v147, v96, v97, v98
  v_mfma_f32_16x16x32_bf16 v[108:111], a[220:223], v[44:47], v[108:111]
  v_max3_f32 v147, v147, v99, v100
  v_max3_f32 v147, v147, v101, v102
  v_max_f32 v147, v147, v103
  v_mfma_f32_16x16x32_bf16 v[104:107], a[224:227], v[48:51], v[104:107]
  v_cmp_gt_f32 vcc, v147, v135
  s_cbranch_vccnz L_rare_b0e_0
L_back_b0e_0:
  v_fma_f32 v96, v96, s72, v138
  v_mfma_f32_16x16x32_bf16 v[108:111], a[228:231], v[48:51], v[108:111]
  v_fma_f32 v97, v97, s72, v138
  v_fma_f32 v98, v98, s72, v138
  v_fma_f32 v99, v99, s72, v138
  v_mfma_f32_16x16x32_bf16 v[104:107], a[232:235], v[52:55], v[104:107]
  v_fma_f32 v100, v100, s72, v138
  v_fma_f32 v101, v101, s72, v138
  v_fma_f32 v102, v102, s72, v138
  v_mfma_f32_16x16x32_bf16 v[108:111], a[236:239], v[52:55], v[108:111]
  v_fma_f32 v103, v103, s72, v138
  v_exp_f32 v96, v96
  v_exp_f32 v97, v97
  v_mfma_f32_16x16x32_bf16 v[104:107], a[240:243], v[56:59], v[104:107]
  v_exp_f32 v98, v98
  v_exp_f32 v99, v99
  v_exp_f32 v100, v100
  v_mfma_f32_16x16x32_bf16 v[108:111], a[244:247], v[56:59], v[108:111]
  v_exp_f32 v101, v101
  v_exp_f32 v102, v102
  v_exp_f32 v103, v103
  v_mfma_f32_16x16x32_bf16 v[104:107], a[248:251], v[60:63], v[104:107]
  v_cvt_pk_bf16_f32 v120, v96, v97
  v_add_f32 v141, v141, v96
  v_add_f32 v144, v144, v97
  v_mfma_f32_16x16x32_bf16 v[108:111], a[252:255], v[60:63], v[108:111]
  v_cvt_pk_bf16_f32 v121, v98, v99
  v_add_f32 v141, v141, v98
  v_add_f32 v144, v144, v99
  v_cvt_pk_bf16_f32 v122, v100, v101
  v_add_f32 v141, v141, v100
  v_add_f32 v144, v144, v101
  v_cvt_pk_bf16_f32 v123, v102, v103
  v_add_f32 v141, v141, v102
  v_add_f32 v144, v144, v103
  v_mfma_f32_16x16x32_bf16 v[112:115], a[192:195], v[64:67], 0
  v_mfma_f32_16x16x32_bf16 v[116:119], a[196:199], v[64:67], 0
  v_mfma_f32_16x16x32_bf16 v[112:115], a[200:203], v[68:71], v[112:115]
  v_mfma_f32_16x16x32_bf16 v[116:119], a[204:207], v[68:71], v[116:119]
  v_mfma_f32_16x16x32_bf16 v[112:115], a[208:211], v[72:75], v[112:115]
  s_nop 2
  v_mfma_f32_16x16x32_bf16 v[116:119], a[212:215], v[72:75], v[116:119]
  v_max3_f32 v148, v104, v105, v106
  v_max3_f32 v148, v148, v107, v108
  v_max3_f32 v148, v148, v109, v110
  v_mfma_f32_16x16x32_bf16 v[112:115], a[216:219], v[76:79], v[112:115]
  v_max_f32 v148, v148, v111
  v_cmp_gt_f32 vcc, v148, v136
  s_cbranch_vccnz L_rare_b0e_1
L_back_b0e_1:
  v_mfma_f32_16x16x32_bf16 v[116:119], a[220:223], v[76:79], v[116:119]
  v_fma_f32 v104, v104, s72, v139
  v_fma_f32 v105, v105, s72, v139
  v_fma_f32 v106, v106, s72, v139
  v_mfma_f32_16x16x32_bf16 v[112:115], a[224:227], v[80:83], v[112:115]
  v_fma_f32 v107, v107, s72, v139
  v_fma_f32 v108, v108, s72, v139
  v_fma_f32 v109, v109, s72, v139
  v_mfma_f32_16x16x32_bf16 v[116:119], a[228:231], v[80:83], v[116:119]
  v_fma_f32 v110, v110, s72, v139
  v_fma_f32 v111, v111, s72, v139
  v_exp_f32 v104, v104
  v_mfma_f32_16x16x32_bf16 v[112:115], a[232:235], v[84:87], v[112:115]
  v_exp_f32 v105, v105
  v_exp_f32 v106, v106
  v_exp_f32 v107, v107
  v_mfma_f32_16x16x32_bf16 v[116:119], a[236:239], v[84:87], v[116:119]
  v_exp_f32 v108, v108
  v_exp_f32 v109, v109
  v_exp_f32 v110, v110
  v_mfma_f32_16x16x32_bf16 v[112:115], a[240:243], v[88:91], v[112:115]
  v_exp_f32 v111, v111
  v_cvt_pk_bf16_f32 v124, v104, v105
  v_add_f32 v142, v142, v104
  v_mfma_f32_16x16x32_bf16 v[116:119], a[244:247], v[88:91], v[116:119]
  v_add_f32 v145, v145, v105
  v_cvt_pk_bf16_f32 v125, v106, v107
  v_add_f32 v142, v142, v106
  v_mfma_f32_16x16x32_bf16 v[112:115], a[248:251], v[92:95], v[112:115]
  v_add_f32 v145, v145, v107
  v_cvt_pk_bf16_f32 v126, v108, v109
  v_add_f32 v142, v142, v108
  v_mfma_f32_16x16x32_bf16 v[116:119], a[252:255], v[92:95], v[116:119]
  v_add_f32 v145, v145, v109
  v_cvt_pk_bf16_f32 v127, v110, v111
  v_add_f32 v142, v142, v110
  v_add_f32 v145, v145, v111
  s_waitcnt lgkmcnt(0)
  v_mfma_f32_16x16x32_bf16 a[0:3], v[160:163], v[120:123], a[0:3]
  v_mfma_f32_16x16x32_bf16 a[4:7], v[164:167], v[120:123], a[4:7]
  v_mfma_f32_16x16x32_bf16 a[8:11], v[168:171], v[120:123], a[8:11]
  v_mfma_f32_16x16x32_bf16 a[12:15], v[172:175], v[120:123], a[12:15]
  v_mfma_f32_16x16x32_bf16 a[16:19], v[176:179], v[120:123], a[16:19]
  s_nop 2
  v_mfma_f32_16x16x32_bf16 a[20:23], v[180:183], v[120:123], a[20:23]
  v_max3_f32 v149, v112, v113, v114
  v_max3_f32 v149, v149, v115, v116
  v_max3_f32 v149, v149, v117, v118
  v_mfma_f32_16x16x32_bf16 a[24:27], v[184:187], v[120:123], a[24:27]
  v_max_f32 v149, v149, v119
  v_cmp_gt_f32 vcc, v149, v137
  s_cbranch_vccnz L_rare_b0e_2
L_back_b0e_2:
  v_mfma_f32_16x16x32_bf16 a[28:31], v[188:191], v[120:123], a[28:31]
  v_fma_f32 v112, v112, s72, v140
  v_fma_f32 v113, v113, s72, v140
  v_fma_f32 v114, v114, s72, v140
  v_mfma_f32_16x16x32_bf16 a[32:35], v[192:195], v[120:123], a[32:35]
  v_fma_f32 v115, v115, s72, v140
  v_fma_f32 v116, v116, s72, v140
  v_fma_f32 v117, v117, s72, v140
  v_mfma_f32_16x16x32_bf16 a[36:39], v[196:199], v[120:123], a[36:39]
  v_fma_f32 v118, v118, s72, v140
  v_fma_f32 v119, v119, s72, v140
  v_exp_f32 v112, v112
  v_mfma_f32_16x16x32_bf16 a[40:43], v[200:203], v[120:123], a[40:43]
  v_exp_f32 v113, v113
  v_exp_f32 v114, v114
  v_exp_f32 v115, v115
  v_mfma_f32_16x16x32_bf16 a[44:47], v[204:207], v[120:123], a[44:47]
  v_exp_f32 v116, v116
  v_exp_f32 v117, v117
  v_exp_f32 v118, v118
  v_mfma_f32_16x16x32_bf16 a[48:51], v[208:211], v[120:123], a[48:51]
  v_exp_f32 v119, v119
  v_cvt_pk_bf16_f32 v128, v112, v113
  v_add_f32 v143, v143, v112
  v_mfma_f32_16x16x32_bf16 a[52:55], v[212:215], v[120:123], a[52:55]
  v_add_f32 v146, v146, v113
  v_cvt_pk_bf16_f32 v129, v114, v115
  v_add_f32 v143, v143, v114
  v_mfma_f32_16x16x32_bf16 a[56:59], v[216:219], v[120:123], a[56:59]
  v_add_f32 v146, v146, v115
  v_cvt_pk_bf16_f32 v130, v116, v117
  v_add_f32 v143, v143, v116
  v_mfma_f32_16x16x32_bf16 a[60:63], v[220:223], v[120:123], a[60:63]
  v_add_f32 v146, v146, v117
  v_cvt_pk_bf16_f32 v131, v118, v119
  v_add_f32 v143, v143, v118
  v_add_f32 v146, v146, v119
  s_barrier
  v_mfma_f32_16x16x32_bf16 a[64:67], v[160:163], v[124:127], a[64:67]
  v_add_f32 v141, v141, v144
  v_mov_b32 v153, v141
  v_mfma_f32_16x16x32_bf16 a[68:71], v[164:167], v[124:127], a[68:71]
  s_nop 1
  v_permlane32_swap_b32 v141, v153
  v_mfma_f32_16x16x32_bf16 a[72:75], v[168:171], v[124:127], a[72:75]
  v_add_f32 v141, v141, v153
  v_mov_b32 v153, v141
  v_mfma_f32_16x16x32_bf16 a[76:79], v[172:175], v[124:127], a[76:79]
  s_nop 1
  v_permlane16_swap_b32 v141, v153
  v_mfma_f32_16x16x32_bf16 a[80:83], v[176:179], v[124:127], a[80:83]
  v_add_f32 v141, v141, v153
  v_rcp_f32 v150, v141
  v_mfma_f32_16x16x32_bf16 a[84:87], v[180:183], v[124:127], a[84:87]
  v_add_f32 v142, v142, v145
  v_mov_b32 v153, v142
  v_mfma_f32_16x16x32_bf16 a[88:91], v[184:187], v[124:127], a[88:91]
  s_nop 1
  v_permlane32_swap_b32 v142, v153
  v_mfma_f32_16x16x32_bf16 a[92:95], v[188:191], v[124:127], a[92:95]
  v_add_f32 v142, v142, v153
  v_mov_b32 v153, v142
  v_mfma_f32_16x16x32_bf16 a[96:99], v[192:195], v[124:127], a[96:99]
  s_nop 1
  v_permlane16_swap_b32 v142, v153
  v_mfma_f32_16x16x32_bf16 a[100:103], v[196:199], v[124:127], a[100:103]
  v_add_f32 v142, v142, v153
  v_rcp_f32 v152, v142
  v_mfma_f32_16x16x32_bf16 a[104:107], v[200:203], v[124:127], a[104:107]
  v_add_f32 v143, v143, v146
  v_mov_b32 v153, v143
  v_mfma_f32_16x16x32_bf16 a[108:111], v[204:207], v[124:127], a[108:111]
  s_nop 1
  v_permlane32_swap_b32 v143, v153
  v_mfma_f32_16x16x32_bf16 a[112:115], v[208:211], v[124:127], a[112:115]
  v_add_f32 v143, v143, v153
  v_mov_b32 v153, v143
  v_mfma_f32_16x16x32_bf16 a[116:119], v[212:215], v[124:127], a[116:119]
  s_nop 1
  v_permlane16_swap_b32 v143, v153
  v_mfma_f32_16x16x32_bf16 a[120:123], v[216:219], v[124:127], a[120:123]
  v_add_f32 v143, v143, v153
  v_rcp_f32 v154, v143
  v_mfma_f32_16x16x32_bf16 a[124:127], v[220:223], v[124:127], a[124:127]
  s_mul_i32 s75, s59, 40960
  s_sub_u32 s75, 106496, s75
  s_mul_i32 s76, s60, 24576
  s_add_u32 s75, s75, s76
  v_add_u32 v151, s75, v248
  v_mfma_f32_16x16x32_bf16 a[128:131], v[160:163], v[128:131], a[128:131]
  v_mfma_f32_16x16x32_bf16 a[132:135], v[164:167], v[128:131], a[132:135]
  v_accvgpr_read_b32 v96, a0
  v_accvgpr_read_b32 v97, a1
  v_mfma_f32_16x16x32_bf16 a[136:139], v[168:171], v[128:131], a[136:139]
  v_accvgpr_read_b32 v98, a2
  v_accvgpr_read_b32 v99, a3
  v_mfma_f32_16x16x32_bf16 a[140:143], v[172:175], v[128:131], a[140:143]
  v_accvgpr_read_b32 v100, a4
  v_accvgpr_read_b32 v101, a5
  v_mfma_f32_16x16x32_bf16 a[144:147], v[176:179], v[128:131], a[144:147]
  v_accvgpr_read_b32 v102, a6
  v_accvgpr_read_b32 v103, a7
  v_mfma_f32_16x16x32_bf16 a[148:151], v[180:183], v[128:131], a[148:151]
  v_pk_mul_f32 v[96:97], v[96:97], v[150:151] op_sel_hi:[1,0]
  v_pk_mul_f32 v[98:99], v[98:99], v[150:151] op_sel_hi:[1,0]
  v_mfma_f32_16x16x32_bf16 a[152:155], v[184:187], v[128:131], a[152:155]
  v_pk_mul_f32 v[100:101], v[100:101], v[150:151] op_sel_hi:[1,0]
  v_pk_mul_f32 v[102:103], v[102:103], v[150:151] op_sel_hi:[1,0]
  v_mfma_f32_16x16x32_bf16 a[156:159], v[188:191], v[128:131], a[156:159]
  v_cvt_pk_bf16_f32 v104, v96, v97
  v_cvt_pk_bf16_f32 v105, v98, v99
  v_mfma_f32_16x16x32_bf16 a[160:163], v[192:195], v[128:131], a[160:163]
  v_cvt_pk_bf16_f32 v106, v100, v101
  v_cvt_pk_bf16_f32 v107, v102, v103
  v_mfma_f32_16x16x32_bf16 a[164:167], v[196:199], v[128:131], a[164:167]
  ds_write_b128 v151, v[104:107] offset:0
  v_accvgpr_read_b32 v108, a8
  v_mfma_f32_16x16x32_bf16 a[168:171], v[200:203], v[128:131], a[168:171]
  v_accvgpr_read_b32 v109, a9
  v_accvgpr_read_b32 v110, a10
  v_mfma_f32_16x16x32_bf16 a[172:175], v[204:207], v[128:131], a[172:175]
  v_accvgpr_read_b32 v111, a11
  v_accvgpr_read_b32 v112, a12
  v_mfma_f32_16x16x32_bf16 a[176:179], v[208:211], v[128:131], a[176:179]
  v_accvgpr_read_b32 v113, a13
  v_accvgpr_read_b32 v114, a14
  v_mfma_f32_16x16x32_bf16 a[180:183], v[212:215], v[128:131], a[180:183]
  v_accvgpr_read_b32 v115, a15
  v_pk_mul_f32 v[108:109], v[108:109], v[150:151] op_sel_hi:[1,0]
  v_mfma_f32_16x16x32_bf16 a[184:187], v[216:219], v[128:131], a[184:187]
  v_pk_mul_f32 v[110:111], v[110:111], v[150:151] op_sel_hi:[1,0]
  v_pk_mul_f32 v[112:113], v[112:113], v[150:151] op_sel_hi:[1,0]
  v_mfma_f32_16x16x32_bf16 a[188:191], v[220:223], v[128:131], a[188:191]
  v_pk_mul_f32 v[114:115], v[114:115], v[150:151] op_sel_hi:[1,0]
  v_cvt_pk_bf16_f32 v116, v108, v109
  v_cvt_pk_bf16_f32 v117, v110, v111
  v_cvt_pk_bf16_f32 v118, v112, v113
  v_cvt_pk_bf16_f32 v119, v114, v115
  ds_write_b128 v151, v[116:119] offset:1024
  v_accvgpr_read_b32 v96, a16
  v_accvgpr_read_b32 v97, a17
  v_accvgpr_read_b32 v98, a18
  v_accvgpr_read_b32 v99, a19
  v_accvgpr_read_b32 v100, a20
  v_accvgpr_read_b32 v101, a21
  v_accvgpr_read_b32 v102, a22
  v_accvgpr_read_b32 v103, a23
  v_pk_mul_f32 v[96:97], v[96:97], v[150:151] op_sel_hi:[1,0]
  v_pk_mul_f32 v[98:99], v[98:99], v[150:151] op_sel_hi:[1,0]
  v_pk_mul_f32 v[100:101], v[100:101], v[150:151] op_sel_hi:[1,0]
  v_pk_mul_f32 v[102:103], v[102:103], v[150:151] op_sel_hi:[1,0]
  v_cvt_pk_bf16_f32 v104, v96, v97
  v_cvt_pk_bf16_f32 v105, v98, v99
  v_cvt_pk_bf16_f32 v106, v100, v101
  v_cvt_pk_bf16_f32 v107, v102, v103
  ds_write_b128 v151, v[104:107] offset:2048
  v_accvgpr_read_b32 v108, a24
  v_accvgpr_read_b32 v109, a25
  v_accvgpr_read_b32 v110, a26
  v_accvgpr_read_b32 v111, a27
  v_accvgpr_read_b32 v112, a28
  v_accvgpr_read_b32 v113, a29
  v_accvgpr_read_b32 v114, a30
  v_accvgpr_read_b32 v115, a31
  v_pk_mul_f32 v[108:109], v[108:109], v[150:151] op_sel_hi:[1,0]
  v_pk_mul_f32 v[110:111], v[110:111], v[150:151] op_sel_hi:[1,0]
  v_pk_mul_f32 v[112:113], v[112:113], v[150:151] op_sel_hi:[1,0]
  v_pk_mul_f32 v[114:115], v[114:115], v[150:151] op_sel_hi:[1,0]
  v_cvt_pk_bf16_f32 v116, v108, v109
  v_cvt_pk_bf16_f32 v117, v110, v111
  v_cvt_pk_bf16_f32 v118, v112, v113
  v_cvt_pk_bf16_f32 v119, v114, v115
  ds_write_b128 v151, v[116:119] offset:3072
  v_accvgpr_read_b32 v96, a32
  v_accvgpr_read_b32 v97, a33
  v_accvgpr_read_b32 v98, a34
  v_accvgpr_read_b32 v99, a35
  v_accvgpr_read_b32 v100, a36
  v_accvgpr_read_b32 v101, a37
  v_accvgpr_read_b32 v102, a38
  v_accvgpr_read_b32 v103, a39
  v_pk_mul_f32 v[96:97], v[96:97], v[150:151] op_sel_hi:[1,0]
  v_pk_mul_f32 v[98:99], v[98:99], v[150:151] op_sel_hi:[1,0]
  v_pk_mul_f32 v[100:101], v[100:101], v[150:151] op_sel_hi:[1,0]
  v_pk_mul_f32 v[102:103], v[102:103], v[150:151] op_sel_hi:[1,0]
  v_cvt_pk_bf16_f32 v104, v96, v97
  v_cvt_pk_bf16_f32 v105, v98, v99
  v_cvt_pk_bf16_f32 v106, v100, v101
  v_cvt_pk_bf16_f32 v107, v102, v103
  ds_write_b128 v151, v[104:107] offset:4096
  v_accvgpr_read_b32 v108, a40
  v_accvgpr_read_b32 v109, a41
  v_accvgpr_read_b32 v110, a42
  v_accvgpr_read_b32 v111, a43
  v_accvgpr_read_b32 v112, a44
  v_accvgpr_read_b32 v113, a45
  v_accvgpr_read_b32 v114, a46
  v_accvgpr_read_b32 v115, a47
  v_pk_mul_f32 v[108:109], v[108:109], v[150:151] op_sel_hi:[1,0]
  v_pk_mul_f32 v[110:111], v[110:111], v[150:151] op_sel_hi:[1,0]
  v_pk_mul_f32 v[112:113], v[112:113], v[150:151] op_sel_hi:[1,0]
  v_pk_mul_f32 v[114:115], v[114:115], v[150:151] op_sel_hi:[1,0]
  v_cvt_pk_bf16_f32 v116, v108, v109
  v_cvt_pk_bf16_f32 v117, v110, v111
  v_cvt_pk_bf16_f32 v118, v112, v113
  v_cvt_pk_bf16_f32 v119, v114, v115
  ds_write_b128 v151, v[116:119] offset:5120
  v_accvgpr_read_b32 v96, a48
  v_accvgpr_read_b32 v97, a49
  v_accvgpr_read_b32 v98, a50
  v_accvgpr_read_b32 v99, a51
  v_accvgpr_read_b32 v100, a52
  v_accvgpr_read_b32 v101, a53
  v_accvgpr_read_b32 v102, a54
  v_accvgpr_read_b32 v103, a55
  v_pk_mul_f32 v[96:97], v[96:97], v[150:151] op_sel_hi:[1,0]
  v_pk_mul_f32 v[98:99], v[98:99], v[150:151] op_sel_hi:[1,0]
  v_pk_mul_f32 v[100:101], v[100:101], v[150:151] op_sel_hi:[1,0]
  v_pk_mul_f32 v[102:103], v[102:103], v[150:151] op_sel_hi:[1,0]
  v_cvt_pk_bf16_f32 v104, v96, v97
  v_cvt_pk_bf16_f32 v105, v98, v99
  v_cvt_pk_bf16_f32 v106, v100, v101
  v_cvt_pk_bf16_f32 v107, v102, v103
  ds_write_b128 v151, v[104:107] offset:6144
  v_accvgpr_read_b32 v108, a56
  v_accvgpr_read_b32 v109, a57
  v_accvgpr_read_b32 v110, a58
  v_accvgpr_read_b32 v111, a59
  v_accvgpr_read_b32 v112, a60
  v_accvgpr_read_b32 v113, a61
  v_accvgpr_read_b32 v114, a62
  v_accvgpr_read_b32 v115, a63
  v_pk_mul_f32 v[108:109], v[108:109], v[150:151] op_sel_hi:[1,0]
  v_pk_mul_f32 v[110:111], v[110:111], v[150:151] op_sel_hi:[1,0]
  v_pk_mul_f32 v[112:113], v[112:113], v[150:151] op_sel_hi:[1,0]
  v_pk_mul_f32 v[114:115], v[114:115], v[150:151] op_sel_hi:[1,0]
  v_cvt_pk_bf16_f32 v116, v108, v109
  v_cvt_pk_bf16_f32 v117, v110, v111
  v_cvt_pk_bf16_f32 v118, v112, v113
  v_cvt_pk_bf16_f32 v119, v114, v115
  ds_write_b128 v151, v[116:119] offset:7168
  v_accvgpr_read_b32 v96, a64
  v_accvgpr_read_b32 v97, a65
  v_accvgpr_read_b32 v98, a66
  v_accvgpr_read_b32 v99, a67
  v_accvgpr_read_b32 v100, a68
  v_accvgpr_read_b32 v101, a69
  v_accvgpr_read_b32 v102, a70
  v_accvgpr_read_b32 v103, a71
  v_pk_mul_f32 v[96:97], v[96:97], v[152:153] op_sel_hi:[1,0]
  v_pk_mul_f32 v[98:99], v[98:99], v[152:153] op_sel_hi:[1,0]
  v_pk_mul_f32 v[100:101], v[100:101], v[152:153] op_sel_hi:[1,0]
  v_pk_mul_f32 v[102:103], v[102:103], v[152:153] op_sel_hi:[1,0]
  v_cvt_pk_bf16_f32 v104, v96, v97
  v_cvt_pk_bf16_f32 v105, v98, v99
  v_cvt_pk_bf16_f32 v106, v100, v101
  v_cvt_pk_bf16_f32 v107, v102, v103
  ds_write_b128 v151, v[104:107] offset:8192
  v_accvgpr_read_b32 v108, a72
  v_accvgpr_read_b32 v109, a73
  v_accvgpr_read_b32 v110, a74
  v_accvgpr_read_b32 v111, a75
  v_accvgpr_read_b32 v112, a76
  v_accvgpr_read_b32 v113, a77
  v_accvgpr_read_b32 v114, a78
  v_accvgpr_read_b32 v115, a79
  v_pk_mul_f32 v[108:109], v[108:109], v[152:153] op_sel_hi:[1,0]
  v_pk_mul_f32 v[110:111], v[110:111], v[152:153] op_sel_hi:[1,0]
  v_pk_mul_f32 v[112:113], v[112:113], v[152:153] op_sel_hi:[1,0]
  v_pk_mul_f32 v[114:115], v[114:115], v[152:153] op_sel_hi:[1,0]
  v_cvt_pk_bf16_f32 v116, v108, v109
  v_cvt_pk_bf16_f32 v117, v110, v111
  v_cvt_pk_bf16_f32 v118, v112, v113
  v_cvt_pk_bf16_f32 v119, v114, v115
  ds_write_b128 v151, v[116:119] offset:9216
  v_accvgpr_read_b32 v96, a80
  v_accvgpr_read_b32 v97, a81
  v_accvgpr_read_b32 v98, a82
  v_accvgpr_read_b32 v99, a83
  v_accvgpr_read_b32 v100, a84
  v_accvgpr_read_b32 v101, a85
  v_accvgpr_read_b32 v102, a86
  v_accvgpr_read_b32 v103, a87
  v_pk_mul_f32 v[96:97], v[96:97], v[152:153] op_sel_hi:[1,0]
  v_pk_mul_f32 v[98:99], v[98:99], v[152:153] op_sel_hi:[1,0]
  v_pk_mul_f32 v[100:101], v[100:101], v[152:153] op_sel_hi:[1,0]
  v_pk_mul_f32 v[102:103], v[102:103], v[152:153] op_sel_hi:[1,0]
  v_cvt_pk_bf16_f32 v104, v96, v97
  v_cvt_pk_bf16_f32 v105, v98, v99
  v_cvt_pk_bf16_f32 v106, v100, v101
  v_cvt_pk_bf16_f32 v107, v102, v103
  ds_write_b128 v151, v[104:107] offset:10240
  v_accvgpr_read_b32 v108, a88
  v_accvgpr_read_b32 v109, a89
  v_accvgpr_read_b32 v110, a90
  v_accvgpr_read_b32 v111, a91
  v_accvgpr_read_b32 v112, a92
  v_accvgpr_read_b32 v113, a93
  v_accvgpr_read_b32 v114, a94
  v_accvgpr_read_b32 v115, a95
  v_pk_mul_f32 v[108:109], v[108:109], v[152:153] op_sel_hi:[1,0]
  v_pk_mul_f32 v[110:111], v[110:111], v[152:153] op_sel_hi:[1,0]
  v_pk_mul_f32 v[112:113], v[112:113], v[152:153] op_sel_hi:[1,0]
  v_pk_mul_f32 v[114:115], v[114:115], v[152:153] op_sel_hi:[1,0]
  v_cvt_pk_bf16_f32 v116, v108, v109
  v_cvt_pk_bf16_f32 v117, v110, v111
  v_cvt_pk_bf16_f32 v118, v112, v113
  v_cvt_pk_bf16_f32 v119, v114, v115
  ds_write_b128 v151, v[116:119] offset:11264
  v_accvgpr_read_b32 v96, a96
  v_accvgpr_read_b32 v97, a97
  v_accvgpr_read_b32 v98, a98
  v_accvgpr_read_b32 v99, a99
  v_accvgpr_read_b32 v100, a100
  v_accvgpr_read_b32 v101, a101
  v_accvgpr_read_b32 v102, a102
  v_accvgpr_read_b32 v103, a103
  v_pk_mul_f32 v[96:97], v[96:97], v[152:153] op_sel_hi:[1,0]
  v_pk_mul_f32 v[98:99], v[98:99], v[152:153] op_sel_hi:[1,0]
  v_pk_mul_f32 v[100:101], v[100:101], v[152:153] op_sel_hi:[1,0]
  v_pk_mul_f32 v[102:103], v[102:103], v[152:153] op_sel_hi:[1,0]
  v_cvt_pk_bf16_f32 v104, v96, v97
  v_cvt_pk_bf16_f32 v105, v98, v99
  v_cvt_pk_bf16_f32 v106, v100, v101
  v_cvt_pk_bf16_f32 v107, v102, v103
  ds_write_b128 v151, v[104:107] offset:12288
  v_accvgpr_read_b32 v108, a104
  v_accvgpr_read_b32 v109, a105
  v_accvgpr_read_b32 v110, a106
  v_accvgpr_read_b32 v111, a107
  v_accvgpr_read_b32 v112, a108
  v_accvgpr_read_b32 v113, a109
  v_accvgpr_read_b32 v114, a110
  v_accvgpr_read_b32 v115, a111
  v_pk_mul_f32 v[108:109], v[108:109], v[152:153] op_sel_hi:[1,0]
  v_pk_mul_f32 v[110:111], v[110:111], v[152:153] op_sel_hi:[1,0]
  v_pk_mul_f32 v[112:113], v[112:113], v[152:153] op_sel_hi:[1,0]
  v_pk_mul_f32 v[114:115], v[114:115], v[152:153] op_sel_hi:[1,0]
  v_cvt_pk_bf16_f32 v116, v108, v109
  v_cvt_pk_bf16_f32 v117, v110, v111
  v_cvt_pk_bf16_f32 v118, v112, v113
  v_cvt_pk_bf16_f32 v119, v114, v115
  ds_write_b128 v151, v[116:119] offset:13312
  v_accvgpr_read_b32 v96, a112
  v_accvgpr_read_b32 v97, a113
  v_accvgpr_read_b32 v98, a114
  v_accvgpr_read_b32 v99, a115
  v_accvgpr_read_b32 v100, a116
  v_accvgpr_read_b32 v101, a117
  v_accvgpr_read_b32 v102, a118
  v_accvgpr_read_b32 v103, a119
  v_pk_mul_f32 v[96:97], v[96:97], v[152:153] op_sel_hi:[1,0]
  v_pk_mul_f32 v[98:99], v[98:99], v[152:153] op_sel_hi:[1,0]
  v_pk_mul_f32 v[100:101], v[100:101], v[152:153] op_sel_hi:[1,0]
  v_pk_mul_f32 v[102:103], v[102:103], v[152:153] op_sel_hi:[1,0]
  v_cvt_pk_bf16_f32 v104, v96, v97
  v_cvt_pk_bf16_f32 v105, v98, v99
  v_cvt_pk_bf16_f32 v106, v100, v101
  v_cvt_pk_bf16_f32 v107, v102, v103
  ds_write_b128 v151, v[104:107] offset:14336
  v_accvgpr_read_b32 v108, a120
  v_accvgpr_read_b32 v109, a121
  v_accvgpr_read_b32 v110, a122
  v_accvgpr_read_b32 v111, a123
  v_accvgpr_read_b32 v112, a124
  v_accvgpr_read_b32 v113, a125
  v_accvgpr_read_b32 v114, a126
  v_accvgpr_read_b32 v115, a127
  v_pk_mul_f32 v[108:109], v[108:109], v[152:153] op_sel_hi:[1,0]
  v_pk_mul_f32 v[110:111], v[110:111], v[152:153] op_sel_hi:[1,0]
  v_pk_mul_f32 v[112:113], v[112:113], v[152:153] op_sel_hi:[1,0]
  v_pk_mul_f32 v[114:115], v[114:115], v[152:153] op_sel_hi:[1,0]
  v_cvt_pk_bf16_f32 v116, v108, v109
  v_cvt_pk_bf16_f32 v117, v110, v111
  v_cvt_pk_bf16_f32 v118, v112, v113
  v_cvt_pk_bf16_f32 v119, v114, v115
  ds_write_b128 v151, v[116:119] offset:15360
  v_accvgpr_read_b32 v96, a128
  v_accvgpr_read_b32 v97, a129
  v_accvgpr_read_b32 v98, a130
  v_accvgpr_read_b32 v99, a131
  v_accvgpr_read_b32 v100, a132
  v_accvgpr_read_b32 v101, a133
  v_accvgpr_read_b32 v102, a134
  v_accvgpr_read_b32 v103, a135
  v_pk_mul_f32 v[96:97], v[96:97], v[154:155] op_sel_hi:[1,0]
  v_pk_mul_f32 v[98:99], v[98:99], v[154:155] op_sel_hi:[1,0]
  v_pk_mul_f32 v[100:101], v[100:101], v[154:155] op_sel_hi:[1,0]
  v_pk_mul_f32 v[102:103], v[102:103], v[154:155] op_sel_hi:[1,0]
  v_cvt_pk_bf16_f32 v104, v96, v97
  v_cvt_pk_bf16_f32 v105, v98, v99
  v_cvt_pk_bf16_f32 v106, v100, v101
  v_cvt_pk_bf16_f32 v107, v102, v103
  ds_write_b128 v151, v[104:107] offset:16384
  v_accvgpr_read_b32 v108, a136
  v_accvgpr_read_b32 v109, a137
  v_accvgpr_read_b32 v110, a138
  v_accvgpr_read_b32 v111, a139
  v_accvgpr_read_b32 v112, a140
  v_accvgpr_read_b32 v113, a141
  v_accvgpr_read_b32 v114, a142
  v_accvgpr_read_b32 v115, a143
  v_pk_mul_f32 v[108:109], v[108:109], v[154:155] op_sel_hi:[1,0]
  v_pk_mul_f32 v[110:111], v[110:111], v[154:155] op_sel_hi:[1,0]
  v_pk_mul_f32 v[112:113], v[112:113], v[154:155] op_sel_hi:[1,0]
  v_pk_mul_f32 v[114:115], v[114:115], v[154:155] op_sel_hi:[1,0]
  v_cvt_pk_bf16_f32 v116, v108, v109
  v_cvt_pk_bf16_f32 v117, v110, v111
  v_cvt_pk_bf16_f32 v118, v112, v113
  v_cvt_pk_bf16_f32 v119, v114, v115
  ds_write_b128 v151, v[116:119] offset:17408
  v_accvgpr_read_b32 v96, a144
  v_accvgpr_read_b32 v97, a145
  v_accvgpr_read_b32 v98, a146
  v_accvgpr_read_b32 v99, a147
  v_accvgpr_read_b32 v100, a148
  v_accvgpr_read_b32 v101, a149
  v_accvgpr_read_b32 v102, a150
  v_accvgpr_read_b32 v103, a151
  v_pk_mul_f32 v[96:97], v[96:97], v[154:155] op_sel_hi:[1,0]
  v_pk_mul_f32 v[98:99], v[98:99], v[154:155] op_sel_hi:[1,0]
  v_pk_mul_f32 v[100:101], v[100:101], v[154:155] op_sel_hi:[1,0]
  v_pk_mul_f32 v[102:103], v[102:103], v[154:155] op_sel_hi:[1,0]
  v_cvt_pk_bf16_f32 v104, v96, v97
  v_cvt_pk_bf16_f32 v105, v98, v99
  v_cvt_pk_bf16_f32 v106, v100, v101
  v_cvt_pk_bf16_f32 v107, v102, v103
  ds_write_b128 v151, v[104:107] offset:18432
  v_accvgpr_read_b32 v108, a152
  v_accvgpr_read_b32 v109, a153
  v_accvgpr_read_b32 v110, a154
  v_accvgpr_read_b32 v111, a155
  v_accvgpr_read_b32 v112, a156
  v_accvgpr_read_b32 v113, a157
  v_accvgpr_read_b32 v114, a158
  v_accvgpr_read_b32 v115, a159
  v_pk_mul_f32 v[108:109], v[108:109], v[154:155] op_sel_hi:[1,0]
  v_pk_mul_f32 v[110:111], v[110:111], v[154:155] op_sel_hi:[1,0]
  v_pk_mul_f32 v[112:113], v[112:113], v[154:155] op_sel_hi:[1,0]
  v_pk_mul_f32 v[114:115], v[114:115], v[154:155] op_sel_hi:[1,0]
  v_cvt_pk_bf16_f32 v116, v108, v109
  v_cvt_pk_bf16_f32 v117, v110, v111
  v_cvt_pk_bf16_f32 v118, v112, v113
  v_cvt_pk_bf16_f32 v119, v114, v115
  ds_write_b128 v151, v[116:119] offset:19456
  v_accvgpr_read_b32 v96, a160
  v_accvgpr_read_b32 v97, a161
  v_accvgpr_read_b32 v98, a162
  v_accvgpr_read_b32 v99, a163
  v_accvgpr_read_b32 v100, a164
  v_accvgpr_read_b32 v101, a165
  v_accvgpr_read_b32 v102, a166
  v_accvgpr_read_b32 v103, a167
  v_pk_mul_f32 v[96:97], v[96:97], v[154:155] op_sel_hi:[1,0]
  v_pk_mul_f32 v[98:99], v[98:99], v[154:155] op_sel_hi:[1,0]
  v_pk_mul_f32 v[100:101], v[100:101], v[154:155] op_sel_hi:[1,0]
  v_pk_mul_f32 v[102:103], v[102:103], v[154:155] op_sel_hi:[1,0]
  v_cvt_pk_bf16_f32 v104, v96, v97
  v_cvt_pk_bf16_f32 v105, v98, v99
  v_cvt_pk_bf16_f32 v106, v100, v101
  v_cvt_pk_bf16_f32 v107, v102, v103
  ds_write_b128 v151, v[104:107] offset:20480
  v_accvgpr_read_b32 v108, a168
  v_accvgpr_read_b32 v109, a169
  v_accvgpr_read_b32 v110, a170
  v_accvgpr_read_b32 v111, a171
  v_accvgpr_read_b32 v112, a172
  v_accvgpr_read_b32 v113, a173
  v_accvgpr_read_b32 v114, a174
  v_accvgpr_read_b32 v115, a175
  v_pk_mul_f32 v[108:109], v[108:109], v[154:155] op_sel_hi:[1,0]
  v_pk_mul_f32 v[110:111], v[110:111], v[154:155] op_sel_hi:[1,0]
  v_pk_mul_f32 v[112:113], v[112:113], v[154:155] op_sel_hi:[1,0]
  v_pk_mul_f32 v[114:115], v[114:115], v[154:155] op_sel_hi:[1,0]
  v_cvt_pk_bf16_f32 v116, v108, v109
  v_cvt_pk_bf16_f32 v117, v110, v111
  v_cvt_pk_bf16_f32 v118, v112, v113
  v_cvt_pk_bf16_f32 v119, v114, v115
  ds_write_b128 v151, v[116:119] offset:21504
  v_accvgpr_read_b32 v96, a176
  v_accvgpr_read_b32 v97, a177
  v_accvgpr_read_b32 v98, a178
  v_accvgpr_read_b32 v99, a179
  v_accvgpr_read_b32 v100, a180
  v_accvgpr_read_b32 v101, a181
  v_accvgpr_read_b32 v102, a182
  v_accvgpr_read_b32 v103, a183
  v_pk_mul_f32 v[96:97], v[96:97], v[154:155] op_sel_hi:[1,0]
  v_pk_mul_f32 v[98:99], v[98:99], v[154:155] op_sel_hi:[1,0]
  v_pk_mul_f32 v[100:101], v[100:101], v[154:155] op_sel_hi:[1,0]
  v_pk_mul_f32 v[102:103], v[102:103], v[154:155] op_sel_hi:[1,0]
  v_cvt_pk_bf16_f32 v104, v96, v97
  v_cvt_pk_bf16_f32 v105, v98, v99
  v_cvt_pk_bf16_f32 v106, v100, v101
  v_cvt_pk_bf16_f32 v107, v102, v103
  ds_write_b128 v151, v[104:107] offset:22528
  v_accvgpr_read_b32 v108, a184
  v_accvgpr_read_b32 v109, a185
  v_accvgpr_read_b32 v110, a186
  v_accvgpr_read_b32 v111, a187
  v_accvgpr_read_b32 v112, a188
  v_accvgpr_read_b32 v113, a189
  v_accvgpr_read_b32 v114, a190
  v_accvgpr_read_b32 v115, a191
  v_pk_mul_f32 v[108:109], v[108:109], v[154:155] op_sel_hi:[1,0]
  v_pk_mul_f32 v[110:111], v[110:111], v[154:155] op_sel_hi:[1,0]
  v_pk_mul_f32 v[112:113], v[112:113], v[154:155] op_sel_hi:[1,0]
  v_pk_mul_f32 v[114:115], v[114:115], v[154:155] op_sel_hi:[1,0]
  v_cvt_pk_bf16_f32 v116, v108, v109
  v_cvt_pk_bf16_f32 v117, v110, v111
  v_cvt_pk_bf16_f32 v118, v112, v113
  v_cvt_pk_bf16_f32 v119, v114, v115
  ds_write_b128 v151, v[116:119] offset:23552
  s_branch L_fin0
L_att1:
  s_waitcnt lgkmcnt(0)
  s_barrier
  v_mfma_f32_16x16x32_bf16 v[96:99], a[192:195], v[0:3], 0
  s_add_u32 m0, s66, 8192
  v_mfma_f32_16x16x32_bf16 v[100:103], a[196:199], v[0:3], 0
  s_add_u32 s69, s68, 8192
  v_mfma_f32_16x16x32_bf16 v[96:99], a[200:203], v[4:7], v[96:99]
  buffer_load_dwordx4 v236, s[8:11], s69 offen offset:0 nt lds
  v_mfma_f32_16x16x32_bf16 v[100:103], a[204:207], v[4:7], v[100:103]
  buffer_load_dwordx4 v237, s[8:11], s69 offen offset:1024 nt lds
  v_mfma_f32_16x16x32_bf16 v[96:99], a[208:211], v[8:11], v[96:99]
  buffer_load_dwordx4 v238, s[8:11], s69 offen offset:2048 nt lds
  v_mfma_f32_16x16x32_bf16 v[100:103], a[212:215], v[8:11], v[100:103]
  v_mfma_f32_16x16x32_bf16 v[96:99], a[216:219], v[12:15], v[96:99]
  buffer_load_dwordx4 v239, s[8:11], s69 offen offset:3072 nt lds
  v_mfma_f32_16x16x32_bf16 v[100:103], a[220:223], v[12:15], v[100:103]
  s_add_u32 m0, s66, 12288
  v_mfma_f32_16x16x32_bf16 v[96:99], a[224:227], v[16:19], v[96:99]
  s_add_u32 s69, s68, 12288
  v_mfma_f32_16x16x32_bf16 v[100:103], a[228:231], v[16:19], v[100:103]
  buffer_load_dwordx4 v240, s[8:11], s69 offen offset:0 nt lds
  v_mfma_f32_16x16x32_bf16 v[96:99], a[232:235], v[20:23], v[96:99]
  v_mfma_f32_16x16x32_bf16 v[100:103], a[236:239], v[20:23], v[100:103]
  buffer_load_dwordx4 v241, s[8:11], s69 offen offset:1024 nt lds
  v_mfma_f32_16x16x32_bf16 v[96:99], a[240:243], v[24:27], v[96:99]
  buffer_load_dwordx4 v242, s[8:11], s69 offen offset:2048 nt lds
  v_mfma_f32_16x16x32_bf16 v[100:103], a[244:247], v[24:27], v[100:103]
  buffer_load_dwordx4 v243, s[8:11], s69 offen offset:3072 nt lds
  v_mfma_f32_16x16x32_bf16 v[96:99], a[248:251], v[28:31], v[96:99]
  s_add_u32 s68, s68, 16384
  v_mfma_f32_16x16x32_bf16 v[100:103], a[252:255], v[28:31], v[100:103]
  v_mfma_f32_16x16x32_bf16 v[104:107], a[192:195], v[32:35], 0
  ds_read_b64_tr_b16 v[160:161], v228 offset:0
  ds_read_b64_tr_b16 v[162:163], v228 offset:8192
  v_mfma_f32_16x16x32_bf16 v[108:111], a[196:199], v[32:35], 0
  ds_read_b64_tr_b16 v[164:165], v229 offset:0
  ds_read_b64_tr_b16 v[166:167], v229 offset:8192
  v_mfma_f32_16x16x32_bf16 v[104:107], a[200:203], v[36:39], v[104:107]
  ds_read_b64_tr_b16 v[168:169], v230 offset:0
  v_mfma_f32_16x16x32_bf16 v[108:111], a[204:207], v[36:39], v[108:111]
  ds_read_b64_tr_b16 v[170:171], v230 offset:8192
  ds_read_b64_tr_b16 v[172:173], v231 offset:0
  ds_read_b64_tr_b16 v[174:175], v231 offset:8192
  ds_read_b64_tr_b16 v[176:177], v232 offset:0
  v_mfma_f32_16x16x32_bf16 v[104:107], a[208:211], v[40:43], v[104:107]
  ds_read_b64_tr_b16 v[178:179], v232 offset:8192
  ds_read_b64_tr_b16 v[180:181], v233 offset:0
  ds_read_b64_tr_b16 v[182:183], v233 offset:8192
  ds_read_b64_tr_b16 v[184:185], v234 offset:0
  v_mfma_f32_16x16x32_bf16 v[108:111], a[212:215], v[40:43], v[108:111]
  ds_read_b64_tr_b16 v[186:187], v234 offset:8192
  ds_read_b64_tr_b16 v[188:189], v235 offset:0
  ds_read_b64_tr_b16 v[190:191], v235 offset:8192
  ds_read_b64_tr_b16 v[192:193], v228 offset:256
  v_mfma_f32_16x16x32_bf16 v[104:107], a[216:219], v[44:47], v[104:107]
  ds_read_b64_tr_b16 v[194:195], v228 offset:8448
  ds_read_b64_tr_b16 v[196:197], v229 offset:256
  ds_read_b64_tr_b16 v[198:199], v229 offset:8448
  ds_read_b64_tr_b16 v[200:201], v230 offset:256
  v_mfma_f32_16x16x32_bf16 v[108:111], a[220:223], v[44:47], v[108:111]
  ds_read_b64_tr_b16 v[202:203], v230 offset:8448
  ds_read_b64_tr_b16 v[204:205], v231 offset:256
  ds_read_b64_tr_b16 v[206:207], v231 offset:8448
  ds_read_b64_tr_b16 v[208:209], v232 offset:256
  v_mfma_f32_16x16x32_bf16 v[104:107], a[224:227], v[48:51], v[104:107]
  ds_read_b64_tr_b16 v[210:211], v232 offset:8448
  ds_read_b64_tr_b16 v[212:213], v233 offset:256
  ds_read_b64_tr_b16 v[214:215], v233 offset:8448
  ds_read_b64_tr_b16 v[216:217], v234 offset:256
  v_mfma_f32_16x16x32_bf16 v[108:111], a[228:231], v[48:51], v[108:111]
  ds_read_b64_tr_b16 v[218:219], v234 offset:8448
  ds_read_b64_tr_b16 v[220:221], v235 offset:256
  ds_read_b64_tr_b16 v[222:223], v235 offset:8448
  v_max3_f32 v147, v96, v97, v98
  v_mfma_f32_16x16x32_bf16 v[104:107], a[232:235], v[52:55], v[104:107]
  v_max3_f32 v147, v147, v99, v100
  v_max3_f32 v147, v147, v101, v102
  v_max_f32 v147, v147, v103
  v_mov_b32 v150, v147
  v_mfma_f32_16x16x32_bf16 v[108:111], a[236:239], v[52:55], v[108:111]
  s_nop 1
  v_permlane32_swap_b32 v147, v150
  v_max_f32 v147, v147, v150
  v_mov_b32 v150, v147
  v_mfma_f32_16x16x32_bf16 v[104:107], a[240:243], v[56:59], v[104:107]
  s_nop 1
  v_permlane16_swap_b32 v147, v150
  v_max_f32 v147, v147, v150
  v_mov_b32 v132, v147
  v_mfma_f32_16x16x32_bf16 v[108:111], a[244:247], v[56:59], v[108:111]
  v_add_f32 v135, s73, v147
  v_mul_f32 v138, s72, v147
  v_sub_f32 v138, 0, v138
  v_mov_b32 v141, 0
  v_mfma_f32_16x16x32_bf16 v[104:107], a[248:251], v[60:63], v[104:107]
  v_mov_b32 v144, 0
  v_fma_f32 v96, v96, s72, v138
  v_fma_f32 v97, v97, s72, v138
  v_fma_f32 v98, v98, s72, v138
  v_mfma_f32_16x16x32_bf16 v[108:111], a[252:255], v[60:63], v[108:111]
  v_fma_f32 v99, v99, s72, v138
  v_fma_f32 v100, v100, s72, v138
  v_fma_f32 v101, v101, s72, v138
  v_fma_f32 v102, v102, s72, v138
  v_fma_f32 v103, v103, s72, v138
  v_exp_f32 v96, v96
  v_exp_f32 v97, v97
  v_exp_f32 v98, v98
  v_exp_f32 v99, v99
  v_exp_f32 v100, v100
  v_exp_f32 v101, v101
  v_exp_f32 v102, v102
  v_exp_f32 v103, v103
  v_cvt_pk_bf16_f32 v120, v96, v97
  v_add_f32 v141, v141, v96
  v_add_f32 v144, v144, v97
  v_cvt_pk_bf16_f32 v121, v98, v99
  v_add_f32 v141, v141, v98
  v_add_f32 v144, v144, v99
  v_cvt_pk_bf16_f32 v122, v100, v101
  v_add_f32 v141, v141, v100
  v_add_f32 v144, v144, v101
  v_cvt_pk_bf16_f32 v123, v102, v103
  v_add_f32 v141, v141, v102
  v_add_f32 v144, v144, v103
  s_waitcnt lgkmcnt(0)
  v_mfma_f32_16x16x32_bf16 a[0:3], v[160:163], v[120:123], 0
  v_mfma_f32_16x16x32_bf16 a[4:7], v[164:167], v[120:123], 0
  v_mfma_f32_16x16x32_bf16 a[8:11], v[168:171], v[120:123], 0
  v_mfma_f32_16x16x32_bf16 a[12:15], v[172:175], v[120:123], 0
  v_mfma_f32_16x16x32_bf16 a[16:19], v[176:179], v[120:123], 0
  s_nop 2
  v_mfma_f32_16x16x32_bf16 a[20:23], v[180:183], v[120:123], 0
  v_max3_f32 v148, v104, v105, v106
  v_max3_f32 v148, v148, v107, v108
  v_max3_f32 v148, v148, v109, v110
  v_mfma_f32_16x16x32_bf16 a[24:27], v[184:187], v[120:123], 0
  v_max_f32 v148, v148, v111
  v_mov_b32 v150, v148
  s_nop 1
  v_mfma_f32_16x16x32_bf16 a[28:31], v[188:191], v[120:123], 0
  v_permlane32_swap_b32 v148, v150
  v_max_f32 v148, v148, v150
  v_mov_b32 v150, v148
  v_mfma_f32_16x16x32_bf16 a[32:35], v[192:195], v[120:123], 0
  s_nop 1
  v_permlane16_swap_b32 v148, v150
  v_max_f32 v148, v148, v150
  v_mfma_f32_16x16x32_bf16 a[36:39], v[196:199], v[120:123], 0
  v_mov_b32 v133, v148
  v_add_f32 v136, s73, v148
  v_mul_f32 v139, s72, v148
  v_mfma_f32_16x16x32_bf16 a[40:43], v[200:203], v[120:123], 0
  v_sub_f32 v139, 0, v139
  v_mov_b32 v142, 0
  v_mov_b32 v145, 0
  v_mfma_f32_16x16x32_bf16 a[44:47], v[204:207], v[120:123], 0
  v_fma_f32 v104, v104, s72, v139
  v_fma_f32 v105, v105, s72, v139
  v_fma_f32 v106, v106, s72, v139
  v_mfma_f32_16x16x32_bf16 a[48:51], v[208:211], v[120:123], 0
  v_fma_f32 v107, v107, s72, v139
  v_fma_f32 v108, v108, s72, v139
  v_fma_f32 v109, v109, s72, v139
  v_mfma_f32_16x16x32_bf16 a[52:55], v[212:215], v[120:123], 0
  v_fma_f32 v110, v110, s72, v139
  v_fma_f32 v111, v111, s72, v139
  v_exp_f32 v104, v104
  v_mfma_f32_16x16x32_bf16 a[56:59], v[216:219], v[120:123], 0
  v_exp_f32 v105, v105
  v_exp_f32 v106, v106
  v_exp_f32 v107, v107
  v_mfma_f32_16x16x32_bf16 a[60:63], v[220:223], v[120:123], 0
  v_exp_f32 v108, v108
  v_exp_f32 v109, v109
  v_exp_f32 v110, v110
  v_exp_f32 v111, v111
  v_cvt_pk_bf16_f32 v124, v104, v105
  v_add_f32 v142, v142, v104
  v_add_f32 v145, v145, v105
  v_cvt_pk_bf16_f32 v125, v106, v107
  v_add_f32 v142, v142, v106
  v_add_f32 v145, v145, v107
  v_cvt_pk_bf16_f32 v126, v108, v109
  v_add_f32 v142, v142, v108
  v_add_f32 v145, v145, v109
  v_cvt_pk_bf16_f32 v127, v110, v111
  v_add_f32 v142, v142, v110
  v_add_f32 v145, v145, v111
  s_waitcnt vmcnt(16)
  s_barrier
  v_mfma_f32_16x16x32_bf16 a[64:67], v[160:163], v[124:127], 0
  s_add_u32 m0, s67, 8192
  s_add_u32 s71, s70, 8192
  v_mfma_f32_16x16x32_bf16 a[68:71], v[164:167], v[124:127], 0
  buffer_load_dwordx4 v244, s[12:15], s71 offen offset:0 nt lds
  buffer_load_dwordx4 v245, s[12:15], s71 offen offset:1024 nt lds
  v_mfma_f32_16x16x32_bf16 a[72:75], v[168:171], v[124:127], 0
  buffer_load_dwordx4 v246, s[12:15], s71 offen offset:2048 nt lds
  buffer_load_dwordx4 v247, s[12:15], s71 offen offset:3072 nt lds
  v_mfma_f32_16x16x32_bf16 a[76:79], v[172:175], v[124:127], 0
  s_add_u32 m0, s67, 12288
  s_add_u32 s71, s70, 12288
  v_mfma_f32_16x16x32_bf16 a[80:83], v[176:179], v[124:127], 0
  buffer_load_dwordx4 v244, s[12:15], s71 offen offset:0 nt lds
  buffer_load_dwordx4 v245, s[12:15], s71 offen offset:1024 nt lds
  v_mfma_f32_16x16x32_bf16 a[84:87], v[180:183], v[124:127], 0
  buffer_load_dwordx4 v246, s[12:15], s71 offen offset:2048 nt lds
  v_mfma_f32_16x16x32_bf16 a[88:91], v[184:187], v[124:127], 0
  buffer_load_dwordx4 v247, s[12:15], s71 offen offset:3072 nt lds
  s_add_u32 s70, s70, 16384
  v_mfma_f32_16x16x32_bf16 a[92:95], v[188:191], v[124:127], 0
  ds_read_b128 a[192:195], v224 offset:16384
  ds_read_b128 a[196:199], v224 offset:24576
  v_mfma_f32_16x16x32_bf16 a[96:99], v[192:195], v[124:127], 0
  ds_read_b128 a[200:203], v225 offset:16384
  ds_read_b128 a[204:207], v225 offset:24576
  v_mfma_f32_16x16x32_bf16 a[100:103], v[196:199], v[124:127], 0
  ds_read_b128 a[208:211], v226 offset:16384
  ds_read_b128 a[212:215], v226 offset:24576
  v_mfma_f32_16x16x32_bf16 a[104:107], v[200:203], v[124:127], 0
  ds_read_b128 a[216:219], v227 offset:16384
  v_mfma_f32_16x16x32_bf16 a[108:111], v[204:207], v[124:127], 0
  ds_read_b128 a[220:223], v227 offset:24576
  ds_read_b128 a[224:227], v224 offset:16640
  v_mfma_f32_16x16x32_bf16 a[112:115], v[208:211], v[124:127], 0
  ds_read_b128 a[228:231], v224 offset:24832
  ds_read_b128 a[232:235], v225 offset:16640
  v_mfma_f32_16x16x32_bf16 a[116:119], v[212:215], v[124:127], 0
  ds_read_b128 a[236:239], v225 offset:24832
  ds_read_b128 a[240:243], v226 offset:16640
  v_mfma_f32_16x16x32_bf16 a[120:123], v[216:219], v[124:127], 0
  ds_read_b128 a[244:247], v226 offset:24832
  ds_read_b128 a[248:251], v227 offset:16640
  v_mfma_f32_16x16x32_bf16 a[124:127], v[220:223], v[124:127], 0
  ds_read_b128 a[252:255], v227 offset:24832
  s_mov_b32 s74, 15
L_loop_b1:
  s_waitcnt lgkmcnt(0) vmcnt(16)
  s_barrier
  v_mfma_f32_16x16x32_bf16 v[96:99], a[192:195], v[0:3], 0
  s_add_u32 m0, s66, 24576
  v_mfma_f32_16x16x32_bf16 v[100:103], a[196:199], v[0:3], 0
  s_add_u32 s69, s68, 8192
  v_mfma_f32_16x16x32_bf16 v[96:99], a[200:203], v[4:7], v[96:99]
  buffer_load_dwordx4 v236, s[8:11], s69 offen offset:0 nt lds
  v_mfma_f32_16x16x32_bf16 v[100:103], a[204:207], v[4:7], v[100:103]
  buffer_load_dwordx4 v237, s[8:11], s69 offen offset:1024 nt lds
  v_mfma_f32_16x16x32_bf16 v[96:99], a[208:211], v[8:11], v[96:99]
  buffer_load_dwordx4 v238, s[8:11], s69 offen offset:2048 nt lds
  v_mfma_f32_16x16x32_bf16 v[100:103], a[212:215], v[8:11], v[100:103]
  v_mfma_f32_16x16x32_bf16 v[96:99], a[216:219], v[12:15], v[96:99]
  buffer_load_dwordx4 v239, s[8:11], s69 offen offset:3072 nt lds
  v_mfma_f32_16x16x32_bf16 v[100:103], a[220:223], v[12:15], v[100:103]
  s_add_u32 m0, s66, 28672
  v_mfma_f32_16x16x32_bf16 v[96:99], a[224:227], v[16:19], v[96:99]
  s_add_u32 s69, s68, 12288
  v_mfma_f32_16x16x32_bf16 v[100:103], a[228:231], v[16:19], v[100:103]
  buffer_load_dwordx4 v240, s[8:11], s69 offen offset:0 nt lds
  v_mfma_f32_16x16x32_bf16 v[96:99], a[232:235], v[20:23], v[96:99]
  v_mfma_f32_16x16x32_bf16 v[100:103], a[236:239], v[20:23], v[100:103]
  buffer_load_dwordx4 v241, s[8:11], s69 offen offset:1024 nt lds
  v_mfma_f32_16x16x32_bf16 v[96:99], a[240:243], v[24:27], v[96:99]
  buffer_load_dwordx4 v242, s[8:11], s69 offen offset:2048 nt lds
  v_mfma_f32_16x16x32_bf16 v[100:103], a[244:247], v[24:27], v[100:103]
  buffer_load_dwordx4 v243, s[8:11], s69 offen offset:3072 nt lds
  v_mfma_f32_16x16x32_bf16 v[96:99], a[248:251], v[28:31], v[96:99]
  s_add_u32 s68, s68, 16384
  v_mfma_f32_16x16x32_bf16 v[100:103], a[252:255], v[28:31], v[100:103]
  v_mfma_f32_16x16x32_bf16 v[104:107], a[192:195], v[32:35], 0
  ds_read_b64_tr_b16 v[160:161], v228 offset:16384
  ds_read_b64_tr_b16 v[162:163], v228 offset:24576
  v_mfma_f32_16x16x32_bf16 v[108:111], a[196:199], v[32:35], 0
  ds_read_b64_tr_b16 v[164:165], v229 offset:16384
  ds_read_b64_tr_b16 v[166:167], v229 offset:24576
  v_mfma_f32_16x16x32_bf16 v[104:107], a[200:203], v[36:39], v[104:107]
  ds_read_b64_tr_b16 v[168:169], v230 offset:16384
  v_mfma_f32_16x16x32_bf16 v[108:111], a[204:207], v[36:39], v[108:111]
  ds_read_b64_tr_b16 v[170:171], v230 offset:24576
  ds_read_b64_tr_b16 v[172:173], v231 offset:16384
  ds_read_b64_tr_b16 v[174:175], v231 offset:24576
  ds_read_b64_tr_b16 v[176:177], v232 offset:16384
  v_mfma_f32_16x16x32_bf16 v[104:107], a[208:211], v[40:43], v[104:107]
  ds_read_b64_tr_b16 v[178:179], v232 offset:24576
  ds_read_b64_tr_b16 v[180:181], v233 offset:16384
  ds_read_b64_tr_b16 v[182:183], v233 offset:24576
  ds_read_b64_tr_b16 v[184:185], v234 offset:16384
  v_mfma_f32_16x16x32_bf16 v[108:111], a[212:215], v[40:43], v[108:111]
  ds_read_b64_tr_b16 v[186:187], v234 offset:24576
  ds_read_b64_tr_b16 v[188:189], v235 offset:16384
  ds_read_b64_tr_b16 v[190:191], v235 offset:24576
  ds_read_b64_tr_b16 v[192:193], v228 offset:16640
  v_mfma_f32_16x16x32_bf16 v[104:107], a[216:219], v[44:47], v[104:107]
  ds_read_b64_tr_b16 v[194:195], v228 offset:24832
  ds_read_b64_tr_b16 v[196:197], v229 offset:16640
  ds_read_b64_tr_b16 v[198:199], v229 offset:24832
  ds_read_b64_tr_b16 v[200:201], v230 offset:16640
  v_mfma_f32_16x16x32_bf16 v[108:111], a[220:223], v[44:47], v[108:111]
  ds_read_b64_tr_b16 v[202:203], v230 offset:24832
  ds_read_b64_tr_b16 v[204:205], v231 offset:16640
  ds_read_b64_tr_b16 v[206:207], v231 offset:24832
  ds_read_b64_tr_b16 v[208:209], v232 offset:16640
  v_mfma_f32_16x16x32_bf16 v[104:107], a[224:227], v[48:51], v[104:107]
  ds_read_b64_tr_b16 v[210:211], v232 offset:24832
  ds_read_b64_tr_b16 v[212:213], v233 offset:16640
  ds_read_b64_tr_b16 v[214:215], v233 offset:24832
  ds_read_b64_tr_b16 v[216:217], v234 offset:16640
  v_mfma_f32_16x16x32_bf16 v[108:111], a[228:231], v[48:51], v[108:111]
  ds_read_b64_tr_b16 v[218:219], v234 offset:24832
  ds_read_b64_tr_b16 v[220:221], v235 offset:16640
  ds_read_b64_tr_b16 v[222:223], v235 offset:24832
  v_max3_f32 v147, v96, v97, v98
  v_mfma_f32_16x16x32_bf16 v[104:107], a[232:235], v[52:55], v[104:107]
  v_max3_f32 v147, v147, v99, v100
  v_max3_f32 v147, v147, v101, v102
  v_max_f32 v147, v147, v103
  v_cmp_gt_f32 vcc, v147, v135
  v_mfma_f32_16x16x32_bf16 v[108:111], a[236:239], v[52:55], v[108:111]
  s_cbranch_vccnz L_rare_b1b_0
L_back_b1b_0:
  v_fma_f32 v96, v96, s72, v138
  v_fma_f32 v97, v97, s72, v138
  v_fma_f32 v98, v98, s72, v138
  v_mfma_f32_16x16x32_bf16 v[104:107], a[240:243], v[56:59], v[104:107]
  v_fma_f32 v99, v99, s72, v138
  v_fma_f32 v100, v100, s72, v138
  v_fma_f32 v101, v101, s72, v138
  v_fma_f32 v102, v102, s72, v138
  v_mfma_f32_16x16x32_bf16 v[108:111], a[244:247], v[56:59], v[108:111]
  v_fma_f32 v103, v103, s72, v138
  v_exp_f32 v96, v96
  v_exp_f32 v97, v97
  v_exp_f32 v98, v98
  v_mfma_f32_16x16x32_bf16 v[104:107], a[248:251], v[60:63], v[104:107]
  v_exp_f32 v99, v99
  v_exp_f32 v100, v100
  v_exp_f32 v101, v101
  v_exp_f32 v102, v102
  v_mfma_f32_16x16x32_bf16 v[108:111], a[252:255], v[60:63], v[108:111]
  v_exp_f32 v103, v103
  v_cvt_pk_bf16_f32 v120, v96, v97
  v_add_f32 v141, v141, v96
  v_add_f32 v144, v144, v97
  v_cvt_pk_bf16_f32 v121, v98, v99
  v_add_f32 v141, v141, v98
  v_add_f32 v144, v144, v99
  v_cvt_pk_bf16_f32 v122, v100, v101
  v_add_f32 v141, v141, v100
  v_add_f32 v144, v144, v101
  v_cvt_pk_bf16_f32 v123, v102, v103
  v_add_f32 v141, v141, v102
  v_add_f32 v144, v144, v103
  s_waitcnt lgkmcnt(0)
  v_mfma_f32_16x16x32_bf16 a[0:3], v[160:163], v[120:123], a[0:3]
  v_mfma_f32_16x16x32_bf16 a[4:7], v[164:167], v[120:123], a[4:7]
  v_mfma_f32_16x16x32_bf16 a[8:11], v[168:171], v[120:123], a[8:11]
  v_mfma_f32_16x16x32_bf16 a[12:15], v[172:175], v[120:123], a[12:15]
  v_mfma_f32_16x16x32_bf16 a[16:19], v[176:179], v[120:123], a[16:19]
  s_nop 2
  v_mfma_f32_16x16x32_bf16 a[20:23], v[180:183], v[120:123], a[20:23]
  v_max3_f32 v148, v104, v105, v106
  v_max3_f32 v148, v148, v107, v108
  v_max3_f32 v148, v148, v109, v110
  v_mfma_f32_16x16x32_bf16 a[24:27], v[184:187], v[120:123], a[24:27]
  v_max_f32 v148, v148, v111
  v_cmp_gt_f32 vcc, v148, v136
  s_cbranch_vccnz L_rare_b1b_1
L_back_b1b_1:
  v_mfma_f32_16x16x32_bf16 a[28:31], v[188:191], v[120:123], a[28:31]
  v_fma_f32 v104, v104, s72, v139
  v_fma_f32 v105, v105, s72, v139
  v_fma_f32 v106, v106, s72, v139
  v_mfma_f32_16x16x32_bf16 a[32:35], v[192:195], v[120:123], a[32:35]
  v_fma_f32 v107, v107, s72, v139
  v_fma_f32 v108, v108, s72, v139
  v_fma_f32 v109, v109, s72, v139
  v_mfma_f32_16x16x32_bf16 a[36:39], v[196:199], v[120:123], a[36:39]
  v_fma_f32 v110, v110, s72, v139
  v_fma_f32 v111, v111, s72, v139
  v_exp_f32 v104, v104
  v_mfma_f32_16x16x32_bf16 a[40:43], v[200:203], v[120:123], a[40:43]
  v_exp_f32 v105, v105
  v_exp_f32 v106, v106
  v_exp_f32 v107, v107
  v_mfma_f32_16x16x32_bf16 a[44:47], v[204:207], v[120:123], a[44:47]
  v_exp_f32 v108, v108
  v_exp_f32 v109, v109
  v_exp_f32 v110, v110
  v_mfma_f32_16x16x32_bf16 a[48:51], v[208:211], v[120:123], a[48:51]
  v_exp_f32 v111, v111
  v_cvt_pk_bf16_f32 v124, v104, v105
  v_add_f32 v142, v142, v104
  v_mfma_f32_16x16x32_bf16 a[52:55], v[212:215], v[120:123], a[52:55]
  v_add_f32 v145, v145, v105
  v_cvt_pk_bf16_f32 v125, v106, v107
  v_add_f32 v142, v142, v106
  v_mfma_f32_16x16x32_bf16 a[56:59], v[216:219], v[120:123], a[56:59]
  v_add_f32 v145, v145, v107
  v_cvt_pk_bf16_f32 v126, v108, v109
  v_add_f32 v142, v142, v108
  v_mfma_f32_16x16x32_bf16 a[60:63], v[220:223], v[120:123], a[60:63]
  v_add_f32 v145, v145, v109
  v_cvt_pk_bf16_f32 v127, v110, v111
  v_add_f32 v142, v142, v110
  v_add_f32 v145, v145, v111
  s_waitcnt vmcnt(16)
  s_barrier
  v_mfma_f32_16x16x32_bf16 a[64:67], v[160:163], v[124:127], a[64:67]
  s_add_u32 m0, s67, 24576
  s_add_u32 s71, s70, 8192
  v_mfma_f32_16x16x32_bf16 a[68:71], v[164:167], v[124:127], a[68:71]
  buffer_load_dwordx4 v244, s[12:15], s71 offen offset:0 nt lds
  buffer_load_dwordx4 v245, s[12:15], s71 offen offset:1024 nt lds
  v_mfma_f32_16x16x32_bf16 a[72:75], v[168:171], v[124:127], a[72:75]
  buffer_load_dwordx4 v246, s[12:15], s71 offen offset:2048 nt lds
  buffer_load_dwordx4 v247, s[12:15], s71 offen offset:3072 nt lds
  v_mfma_f32_16x16x32_bf16 a[76:79], v[172:175], v[124:127], a[76:79]
  s_add_u32 m0, s67, 28672
  s_add_u32 s71, s70, 12288
  v_mfma_f32_16x16x32_bf16 a[80:83], v[176:179], v[124:127], a[80:83]
  buffer_load_dwordx4 v244, s[12:15], s71 offen offset:0 nt lds
  buffer_load_dwordx4 v245, s[12:15], s71 offen offset:1024 nt lds
  v_mfma_f32_16x16x32_bf16 a[84:87], v[180:183], v[124:127], a[84:87]
  buffer_load_dwordx4 v246, s[12:15], s71 offen offset:2048 nt lds
  v_mfma_f32_16x16x32_bf16 a[88:91], v[184:187], v[124:127], a[88:91]
  buffer_load_dwordx4 v247, s[12:15], s71 offen offset:3072 nt lds
  s_add_u32 s70, s70, 16384
  v_mfma_f32_16x16x32_bf16 a[92:95], v[188:191], v[124:127], a[92:95]
  ds_read_b128 a[192:195], v224 offset:0
  ds_read_b128 a[196:199], v224 offset:8192
  v_mfma_f32_16x16x32_bf16 a[96:99], v[192:195], v[124:127], a[96:99]
  ds_read_b128 a[200:203], v225 offset:0
  ds_read_b128 a[204:207], v225 offset:8192
  v_mfma_f32_16x16x32_bf16 a[100:103], v[196:199], v[124:127], a[100:103]
  ds_read_b128 a[208:211], v226 offset:0
  ds_read_b128 a[212:215], v226 offset:8192
  v_mfma_f32_16x16x32_bf16 a[104:107], v[200:203], v[124:127], a[104:107]
  ds_read_b128 a[216:219], v227 offset:0
  v_mfma_f32_16x16x32_bf16 a[108:111], v[204:207], v[124:127], a[108:111]
  ds_read_b128 a[220:223], v227 offset:8192
  ds_read_b128 a[224:227], v224 offset:256
  v_mfma_f32_16x16x32_bf16 a[112:115], v[208:211], v[124:127], a[112:115]
  ds_read_b128 a[228:231], v224 offset:8448
  ds_read_b128 a[232:235], v225 offset:256
  v_mfma_f32_16x16x32_bf16 a[116:119], v[212:215], v[124:127], a[116:119]
  ds_read_b128 a[236:239], v225 offset:8448
  ds_read_b128 a[240:243], v226 offset:256
  v_mfma_f32_16x16x32_bf16 a[120:123], v[216:219], v[124:127], a[120:123]
  ds_read_b128 a[244:247], v226 offset:8448
  ds_read_b128 a[248:251], v227 offset:256
  v_mfma_f32_16x16x32_bf16 a[124:127], v[220:223], v[124:127], a[124:127]
  ds_read_b128 a[252:255], v227 offset:8448
  s_sub_u32 s74, s74, 1
  s_cmp_eq_u32 s74, 0
  s_cbranch_scc1 L_loopend_b1
  s_waitcnt lgkmcnt(0) vmcnt(16)
  s_barrier
  v_mfma_f32_16x16x32_bf16 v[96:99], a[192:195], v[0:3], 0
  s_add_u32 m0, s66, 8192
  v_mfma_f32_16x16x32_bf16 v[100:103], a[196:199], v[0:3], 0
  s_add_u32 s69, s68, 8192
  v_mfma_f32_16x16x32_bf16 v[96:99], a[200:203], v[4:7], v[96:99]
  buffer_load_dwordx4 v236, s[8:11], s69 offen offset:0 nt lds
  v_mfma_f32_16x16x32_bf16 v[100:103], a[204:207], v[4:7], v[100:103]
  buffer_load_dwordx4 v237, s[8:11], s69 offen offset:1024 nt lds
  v_mfma_f32_16x16x32_bf16 v[96:99], a[208:211], v[8:11], v[96:99]
  buffer_load_dwordx4 v238, s[8:11], s69 offen offset:2048 nt lds
  v_mfma_f32_16x16x32_bf16 v[100:103], a[212:215], v[8:11], v[100:103]
  v_mfma_f32_16x16x32_bf16 v[96:99], a[216:219], v[12:15], v[96:99]
  buffer_load_dwordx4 v239, s[8:11], s69 offen offset:3072 nt lds
  v_mfma_f32_16x16x32_bf16 v[100:103], a[220:223], v[12:15], v[100:103]
  s_add_u32 m0, s66, 12288
  v_mfma_f32_16x16x32_bf16 v[96:99], a[224:227], v[16:19], v[96:99]
  s_add_u32 s69, s68, 12288
  v_mfma_f32_16x16x32_bf16 v[100:103], a[228:231], v[16:19], v[100:103]
  buffer_load_dwordx4 v240, s[8:11], s69 offen offset:0 nt lds
  v_mfma_f32_16x16x32_bf16 v[96:99], a[232:235], v[20:23], v[96:99]
  v_mfma_f32_16x16x32_bf16 v[100:103], a[236:239], v[20:23], v[100:103]
  buffer_load_dwordx4 v241, s[8:11], s69 offen offset:1024 nt lds
  v_mfma_f32_16x16x32_bf16 v[96:99], a[240:243], v[24:27], v[96:99]
  buffer_load_dwordx4 v242, s[8:11], s69 offen offset:2048 nt lds
  v_mfma_f32_16x16x32_bf16 v[100:103], a[244:247], v[24:27], v[100:103]
  buffer_load_dwordx4 v243, s[8:11], s69 offen offset:3072 nt lds
  v_mfma_f32_16x16x32_bf16 v[96:99], a[248:251], v[28:31], v[96:99]
  s_add_u32 s68, s68, 16384
  v_mfma_f32_16x16x32_bf16 v[100:103], a[252:255], v[28:31], v[100:103]
  v_mfma_f32_16x16x32_bf16 v[104:107], a[192:195], v[32:35], 0
  ds_read_b64_tr_b16 v[160:161], v228 offset:0
  ds_read_b64_tr_b16 v[162:163], v228 offset:8192
  v_mfma_f32_16x16x32_bf16 v[108:111], a[196:199], v[32:35], 0
  ds_read_b64_tr_b16 v[164:165], v229 offset:0
  ds_read_b64_tr_b16 v[166:167], v229 offset:8192
  v_mfma_f32_16x16x32_bf16 v[104:107], a[200:203], v[36:39], v[104:107]
  ds_read_b64_tr_b16 v[168:169], v230 offset:0
  v_mfma_f32_16x16x32_bf16 v[108:111], a[204:207], v[36:39], v[108:111]
  ds_read_b64_tr_b16 v[170:171], v230 offset:8192
  ds_read_b64_tr_b16 v[172:173], v231 offset:0
  ds_read_b64_tr_b16 v[174:175], v231 offset:8192
  ds_read_b64_tr_b16 v[176:177], v232 offset:0
  v_mfma_f32_16x16x32_bf16 v[104:107], a[208:211], v[40:43], v[104:107]
  ds_read_b64_tr_b16 v[178:179], v232 offset:8192
  ds_read_b64_tr_b16 v[180:181], v233 offset:0
  ds_read_b64_tr_b16 v[182:183], v233 offset:8192
  ds_read_b64_tr_b16 v[184:185], v234 offset:0
  v_mfma_f32_16x16x32_bf16 v[108:111], a[212:215], v[40:43], v[108:111]
  ds_read_b64_tr_b16 v[186:187], v234 offset:8192
  ds_read_b64_tr_b16 v[188:189], v235 offset:0
  ds_read_b64_tr_b16 v[190:191], v235 offset:8192
  ds_read_b64_tr_b16 v[192:193], v228 offset:256
  v_mfma_f32_16x16x32_bf16 v[104:107], a[216:219], v[44:47], v[104:107]
  ds_read_b64_tr_b16 v[194:195], v228 offset:8448
  ds_read_b64_tr_b16 v[196:197], v229 offset:256
  ds_read_b64_tr_b16 v[198:199], v229 offset:8448
  ds_read_b64_tr_b16 v[200:201], v230 offset:256
  v_mfma_f32_16x16x32_bf16 v[108:111], a[220:223], v[44:47], v[108:111]
  ds_read_b64_tr_b16 v[202:203], v230 offset:8448
  ds_read_b64_tr_b16 v[204:205], v231 offset:256
  ds_read_b64_tr_b16 v[206:207], v231 offset:8448
  ds_read_b64_tr_b16 v[208:209], v232 offset:256
  v_mfma_f32_16x16x32_bf16 v[104:107], a[224:227], v[48:51], v[104:107]
  ds_read_b64_tr_b16 v[210:211], v232 offset:8448
  ds_read_b64_tr_b16 v[212:213], v233 offset:256
  ds_read_b64_tr_b16 v[214:215], v233 offset:8448
  ds_read_b64_tr_b16 v[216:217], v234 offset:256
  v_mfma_f32_16x16x32_bf16 v[108:111], a[228:231], v[48:51], v[108:111]
  ds_read_b64_tr_b16 v[218:219], v234 offset:8448
  ds_read_b64_tr_b16 v[220:221], v235 offset:256
  ds_read_b64_tr_b16 v[222:223], v235 offset:8448
  v_max3_f32 v147, v96, v97, v98
  v_mfma_f32_16x16x32_bf16 v[104:107], a[232:235], v[52:55], v[104:107]
  v_max3_f32 v147, v147, v99, v100
  v_max3_f32 v147, v147, v101, v102
  v_max_f32 v147, v147, v103
  v_cmp_gt_f32 vcc, v147, v135
  v_mfma_f32_16x16x32_bf16 v[108:111], a[236:239], v[52:55], v[108:111]
  s_cbranch_vccnz L_rare_b1c_0
L_back_b1c_0:
  v_fma_f32 v96, v96, s72, v138
  v_fma_f32 v97, v97, s72, v138
  v_fma_f32 v98, v98, s72, v138
  v_mfma_f32_16x16x32_bf16 v[104:107], a[240:243], v[56:59], v[104:107]
  v_fma_f32 v99, v99, s72, v138
  v_fma_f32 v100, v100, s72, v138
  v_fma_f32 v101, v101, s72, v138
  v_fma_f32 v102, v102, s72, v138
  v_mfma_f32_16x16x32_bf16 v[108:111], a[244:247], v[56:59], v[108:111]
  v_fma_f32 v103, v103, s72, v138
  v_exp_f32 v96, v96
  v_exp_f32 v97, v97
  v_exp_f32 v98, v98
  v_mfma_f32_16x16x32_bf16 v[104:107], a[248:251], v[60:63], v[104:107]
  v_exp_f32 v99, v99
  v_exp_f32 v100, v100
  v_exp_f32 v101, v101
  v_exp_f32 v102, v102
  v_mfma_f32_16x16x32_bf16 v[108:111], a[252:255], v[60:63], v[108:111]
  v_exp_f32 v103, v103
  v_cvt_pk_bf16_f32 v120, v96, v97
  v_add_f32 v141, v141, v96
  v_add_f32 v144, v144, v97
  v_cvt_pk_bf16_f32 v121, v98, v99
  v_add_f32 v141, v141, v98
  v_add_f32 v144, v144, v99
  v_cvt_pk_bf16_f32 v122, v100, v101
  v_add_f32 v141, v141, v100
  v_add_f32 v144, v144, v101
  v_cvt_pk_bf16_f32 v123, v102, v103
  v_add_f32 v141, v141, v102
  v_add_f32 v144, v144, v103
  s_waitcnt lgkmcnt(0)
  v_mfma_f32_16x16x32_bf16 a[0:3], v[160:163], v[120:123], a[0:3]
  v_mfma_f32_16x16x32_bf16 a[4:7], v[164:167], v[120:123], a[4:7]
  v_mfma_f32_16x16x32_bf16 a[8:11], v[168:171], v[120:123], a[8:11]
  v_mfma_f32_16x16x32_bf16 a[12:15], v[172:175], v[120:123], a[12:15]
  v_mfma_f32_16x16x32_bf16 a[16:19], v[176:179], v[120:123], a[16:19]
  s_nop 2
  v_mfma_f32_16x16x32_bf16 a[20:23], v[180:183], v[120:123], a[20:23]
  v_max3_f32 v148, v104, v105, v106
  v_max3_f32 v148, v148, v107, v108
  v_max3_f32 v148, v148, v109, v110
  v_mfma_f32_16x16x32_bf16 a[24:27], v[184:187], v[120:123], a[24:27]
  v_max_f32 v148, v148, v111
  v_cmp_gt_f32 vcc, v148, v136
  s_cbranch_vccnz L_rare_b1c_1
L_back_b1c_1:
  v_mfma_f32_16x16x32_bf16 a[28:31], v[188:191], v[120:123], a[28:31]
  v_fma_f32 v104, v104, s72, v139
  v_fma_f32 v105, v105, s72, v139
  v_fma_f32 v106, v106, s72, v139
  v_mfma_f32_16x16x32_bf16 a[32:35], v[192:195], v[120:123], a[32:35]
  v_fma_f32 v107, v107, s72, v139
  v_fma_f32 v108, v108, s72, v139
  v_fma_f32 v109, v109, s72, v139
  v_mfma_f32_16x16x32_bf16 a[36:39], v[196:199], v[120:123], a[36:39]
  v_fma_f32 v110, v110, s72, v139
  v_fma_f32 v111, v111, s72, v139
  v_exp_f32 v104, v104
  v_mfma_f32_16x16x32_bf16 a[40:43], v[200:203], v[120:123], a[40:43]
  v_exp_f32 v105, v105
  v_exp_f32 v106, v106
  v_exp_f32 v107, v107
  v_mfma_f32_16x16x32_bf16 a[44:47], v[204:207], v[120:123], a[44:47]
  v_exp_f32 v108, v108
  v_exp_f32 v109, v109
  v_exp_f32 v110, v110
  v_mfma_f32_16x16x32_bf16 a[48:51], v[208:211], v[120:123], a[48:51]
  v_exp_f32 v111, v111
  v_cvt_pk_bf16_f32 v124, v104, v105
  v_add_f32 v142, v142, v104
  v_mfma_f32_16x16x32_bf16 a[52:55], v[212:215], v[120:123], a[52:55]
  v_add_f32 v145, v145, v105
  v_cvt_pk_bf16_f32 v125, v106, v107
  v_add_f32 v142, v142, v106
  v_mfma_f32_16x16x32_bf16 a[56:59], v[216:219], v[120:123], a[56:59]
  v_add_f32 v145, v145, v107
  v_cvt_pk_bf16_f32 v126, v108, v109
  v_add_f32 v142, v142, v108
  v_mfma_f32_16x16x32_bf16 a[60:63], v[220:223], v[120:123], a[60:63]
  v_add_f32 v145, v145, v109
  v_cvt_pk_bf16_f32 v127, v110, v111
  v_add_f32 v142, v142, v110
  v_add_f32 v145, v145, v111
  s_waitcnt vmcnt(16)
  s_barrier
  v_mfma_f32_16x16x32_bf16 a[64:67], v[160:163], v[124:127], a[64:67]
  s_add_u32 m0, s67, 8192
  s_add_u32 s71, s70, 8192
  v_mfma_f32_16x16x32_bf16 a[68:71], v[164:167], v[124:127], a[68:71]
  buffer_load_dwordx4 v244, s[12:15], s71 offen offset:0 nt lds
  buffer_load_dwordx4 v245, s[12:15], s71 offen offset:1024 nt lds
  v_mfma_f32_16x16x32_bf16 a[72:75], v[168:171], v[124:127], a[72:75]
  buffer_load_dwordx4 v246, s[12:15], s71 offen offset:2048 nt lds
  buffer_load_dwordx4 v247, s[12:15], s71 offen offset:3072 nt lds
  v_mfma_f32_16x16x32_bf16 a[76:79], v[172:175], v[124:127], a[76:79]
  s_add_u32 m0, s67, 12288
  s_add_u32 s71, s70, 12288
  v_mfma_f32_16x16x32_bf16 a[80:83], v[176:179], v[124:127], a[80:83]
  buffer_load_dwordx4 v244, s[12:15], s71 offen offset:0 nt lds
  buffer_load_dwordx4 v245, s[12:15], s71 offen offset:1024 nt lds
  v_mfma_f32_16x16x32_bf16 a[84:87], v[180:183], v[124:127], a[84:87]
  buffer_load_dwordx4 v246, s[12:15], s71 offen offset:2048 nt lds
  v_mfma_f32_16x16x32_bf16 a[88:91], v[184:187], v[124:127], a[88:91]
  buffer_load_dwordx4 v247, s[12:15], s71 offen offset:3072 nt lds
  s_add_u32 s70, s70, 16384
  v_mfma_f32_16x16x32_bf16 a[92:95], v[188:191], v[124:127], a[92:95]
  ds_read_b128 a[192:195], v224 offset:16384
  ds_read_b128 a[196:199], v224 offset:24576
  v_mfma_f32_16x16x32_bf16 a[96:99], v[192:195], v[124:127], a[96:99]
  ds_read_b128 a[200:203], v225 offset:16384
  ds_read_b128 a[204:207], v225 offset:24576
  v_mfma_f32_16x16x32_bf16 a[100:103], v[196:199], v[124:127], a[100:103]
  ds_read_b128 a[208:211], v226 offset:16384
  ds_read_b128 a[212:215], v226 offset:24576
  v_mfma_f32_16x16x32_bf16 a[104:107], v[200:203], v[124:127], a[104:107]
  ds_read_b128 a[216:219], v227 offset:16384
  v_mfma_f32_16x16x32_bf16 a[108:111], v[204:207], v[124:127], a[108:111]
  ds_read_b128 a[220:223], v227 offset:24576
  ds_read_b128 a[224:227], v224 offset:16640
  v_mfma_f32_16x16x32_bf16 a[112:115], v[208:211], v[124:127], a[112:115]
  ds_read_b128 a[228:231], v224 offset:24832
  ds_read_b128 a[232:235], v225 offset:16640
  v_mfma_f32_16x16x32_bf16 a[116:119], v[212:215], v[124:127], a[116:119]
  ds_read_b128 a[236:239], v225 offset:24832
  ds_read_b128 a[240:243], v226 offset:16640
  v_mfma_f32_16x16x32_bf16 a[120:123], v[216:219], v[124:127], a[120:123]
  ds_read_b128 a[244:247], v226 offset:24832
  ds_read_b128 a[248:251], v227 offset:16640
  v_mfma_f32_16x16x32_bf16 a[124:127], v[220:223], v[124:127], a[124:127]
  ds_read_b128 a[252:255], v227 offset:24832
  s_branch L_loop_b1
L_loopend_b1:
  s_waitcnt lgkmcnt(0) vmcnt(16)
  s_barrier
  v_mfma_f32_16x16x32_bf16 v[96:99], a[192:195], v[0:3], 0
  v_mfma_f32_16x16x32_bf16 v[100:103], a[196:199], v[0:3], 0
  v_mfma_f32_16x16x32_bf16 v[96:99], a[200:203], v[4:7], v[96:99]
  v_mfma_f32_16x16x32_bf16 v[100:103], a[204:207], v[4:7], v[100:103]
  v_mfma_f32_16x16x32_bf16 v[96:99], a[208:211], v[8:11], v[96:99]
  v_mfma_f32_16x16x32_bf16 v[100:103], a[212:215], v[8:11], v[100:103]
  v_mfma_f32_16x16x32_bf16 v[96:99], a[216:219], v[12:15], v[96:99]
  v_mfma_f32_16x16x32_bf16 v[100:103], a[220:223], v[12:15], v[100:103]
  v_mfma_f32_16x16x32_bf16 v[96:99], a[224:227], v[16:19], v[96:99]
  v_mfma_f32_16x16x32_bf16 v[100:103], a[228:231], v[16:19], v[100:103]
  v_mfma_f32_16x16x32_bf16 v[96:99], a[232:235], v[20:23], v[96:99]
  v_mfma_f32_16x16x32_bf16 v[100:103], a[236:239], v[20:23], v[100:103]
  v_mfma_f32_16x16x32_bf16 v[96:99], a[240:243], v[24:27], v[96:99]
  v_mfma_f32_16x16x32_bf16 v[100:103], a[244:247], v[24:27], v[100:103]
  v_mfma_f32_16x16x32_bf16 v[96:99], a[248:251], v[28:31], v[96:99]
  v_mfma_f32_16x16x32_bf16 v[100:103], a[252:255], v[28:31], v[100:103]
  v_mfma_f32_16x16x32_bf16 v[104:107], a[192:195], v[32:35], 0
  ds_read_b64_tr_b16 v[160:161], v228 offset:0
  ds_read_b64_tr_b16 v[162:163], v228 offset:8192
  v_mfma_f32_16x16x32_bf16 v[108:111], a[196:199], v[32:35], 0
  ds_read_b64_tr_b16 v[164:165], v229 offset:0
  ds_read_b64_tr_b16 v[166:167], v229 offset:8192
  v_mfma_f32_16x16x32_bf16 v[104:107], a[200:203], v[36:39], v[104:107]
  ds_read_b64_tr_b16 v[168:169], v230 offset:0
  v_mfma_f32_16x16x32_bf16 v[108:111], a[204:207], v[36:39], v[108:111]
  ds_read_b64_tr_b16 v[170:171], v230 offset:8192
  ds_read_b64_tr_b16 v[172:173], v231 offset:0
  ds_read_b64_tr_b16 v[174:175], v231 offset:8192
  ds_read_b64_tr_b16 v[176:177], v232 offset:0
  v_mfma_f32_16x16x32_bf16 v[104:107], a[208:211], v[40:43], v[104:107]
  ds_read_b64_tr_b16 v[178:179], v232 offset:8192
  ds_read_b64_tr_b16 v[180:181], v233 offset:0
  ds_read_b64_tr_b16 v[182:183], v233 offset:8192
  ds_read_b64_tr_b16 v[184:185], v234 offset:0
  v_mfma_f32_16x16x32_bf16 v[108:111], a[212:215], v[40:43], v[108:111]
  ds_read_b64_tr_b16 v[186:187], v234 offset:8192
  ds_read_b64_tr_b16 v[188:189], v235 offset:0
  ds_read_b64_tr_b16 v[190:191], v235 offset:8192
  ds_read_b64_tr_b16 v[192:193], v228 offset:256
  v_mfma_f32_16x16x32_bf16 v[104:107], a[216:219], v[44:47], v[104:107]
  ds_read_b64_tr_b16 v[194:195], v228 offset:8448
  ds_read_b64_tr_b16 v[196:197], v229 offset:256
  ds_read_b64_tr_b16 v[198:199], v229 offset:8448
  ds_read_b64_tr_b16 v[200:201], v230 offset:256
  v_mfma_f32_16x16x32_bf16 v[108:111], a[220:223], v[44:47], v[108:111]
  ds_read_b64_tr_b16 v[202:203], v230 offset:8448
  ds_read_b64_tr_b16 v[204:205], v231 offset:256
  ds_read_b64_tr_b16 v[206:207], v231 offset:8448
  ds_read_b64_tr_b16 v[208:209], v232 offset:256
  v_mfma_f32_16x16x32_bf16 v[104:107], a[224:227], v[48:51], v[104:107]
  ds_read_b64_tr_b16 v[210:211], v232 offset:8448
  ds_read_b64_tr_b16 v[212:213], v233 offset:256
  ds_read_b64_tr_b16 v[214:215], v233 offset:8448
  ds_read_b64_tr_b16 v[216:217], v234 offset:256
  v_mfma_f32_16x16x32_bf16 v[108:111], a[228:231], v[48:51], v[108:111]
  ds_read_b64_tr_b16 v[218:219], v234 offset:8448
  ds_read_b64_tr_b16 v[220:221], v235 offset:256
  ds_read_b64_tr_b16 v[222:223], v235 offset:8448
  v_max3_f32 v147, v96, v97, v98
  v_mfma_f32_16x16x32_bf16 v[104:107], a[232:235], v[52:55], v[104:107]
  v_max3_f32 v147, v147, v99, v100
  v_max3_f32 v147, v147, v101, v102
  v_max_f32 v147, v147, v103
  v_cmp_gt_f32 vcc, v147, v135
  v_mfma_f32_16x16x32_bf16 v[108:111], a[236:239], v[52:55], v[108:111]
  s_cbranch_vccnz L_rare_b1d_0
L_back_b1d_0:
  v_fma_f32 v96, v96, s72, v138
  v_fma_f32 v97, v97, s72, v138
  v_fma_f32 v98, v98, s72, v138
  v_mfma_f32_16x16x32_bf16 v[104:107], a[240:243], v[56:59], v[104:107]
  v_fma_f32 v99, v99, s72, v138
  v_fma_f32 v100, v100, s72, v138
  v_fma_f32 v101, v101, s72, v138
  v_fma_f32 v102, v102, s72, v138
  v_mfma_f32_16x16x32_bf16 v[108:111], a[244:247], v[56:59], v[108:111]
  v_fma_f32 v103, v103, s72, v138
  v_exp_f32 v96, v96
  v_exp_f32 v97, v97
  v_exp_f32 v98, v98
  v_mfma_f32_16x16x32_bf16 v[104:107], a[248:251], v[60:63], v[104:107]
  v_exp_f32 v99, v99
  v_exp_f32 v100, v100
  v_exp_f32 v101, v101
  v_exp_f32 v102, v102
  v_mfma_f32_16x16x32_bf16 v[108:111], a[252:255], v[60:63], v[108:111]
  v_exp_f32 v103, v103
  v_cvt_pk_bf16_f32 v120, v96, v97
  v_add_f32 v141, v141, v96
  v_add_f32 v144, v144, v97
  v_cvt_pk_bf16_f32 v121, v98, v99
  v_add_f32 v141, v141, v98
  v_add_f32 v144, v144, v99
  v_cvt_pk_bf16_f32 v122, v100, v101
  v_add_f32 v141, v141, v100
  v_add_f32 v144, v144, v101
  v_cvt_pk_bf16_f32 v123, v102, v103
  v_add_f32 v141, v141, v102
  v_add_f32 v144, v144, v103
  s_waitcnt lgkmcnt(0)
  v_mfma_f32_16x16x32_bf16 a[0:3], v[160:163], v[120:123], a[0:3]
  v_mfma_f32_16x16x32_bf16 a[4:7], v[164:167], v[120:123], a[4:7]
  v_mfma_f32_16x16x32_bf16 a[8:11], v[168:171], v[120:123], a[8:11]
  v_mfma_f32_16x16x32_bf16 a[12:15], v[172:175], v[120:123], a[12:15]
  v_mfma_f32_16x16x32_bf16 a[16:19], v[176:179], v[120:123], a[16:19]
  s_nop 2
  v_mfma_f32_16x16x32_bf16 a[20:23], v[180:183], v[120:123], a[20:23]
  v_max3_f32 v148, v104, v105, v106
  v_max3_f32 v148, v148, v107, v108
  v_max3_f32 v148, v148, v109, v110
  v_mfma_f32_16x16x32_bf16 a[24:27], v[184:187], v[120:123], a[24:27]
  v_max_f32 v148, v148, v111
  v_cmp_gt_f32 vcc, v148, v136
  s_cbranch_vccnz L_rare_b1d_1
L_back_b1d_1:
  v_mfma_f32_16x16x32_bf16 a[28:31], v[188:191], v[120:123], a[28:31]
  v_fma_f32 v104, v104, s72, v139
  v_fma_f32 v105, v105, s72, v139
  v_fma_f32 v106, v106, s72, v139
  v_mfma_f32_16x16x32_bf16 a[32:35], v[192:195], v[120:123], a[32:35]
  v_fma_f32 v107, v107, s72, v139
  v_fma_f32 v108, v108, s72, v139
  v_fma_f32 v109, v109, s72, v139
  v_mfma_f32_16x16x32_bf16 a[36:39], v[196:199], v[120:123], a[36:39]
  v_fma_f32 v110, v110, s72, v139
  v_fma_f32 v111, v111, s72, v139
  v_exp_f32 v104, v104
  v_mfma_f32_16x16x32_bf16 a[40:43], v[200:203], v[120:123], a[40:43]
  v_exp_f32 v105, v105
  v_exp_f32 v106, v106
  v_exp_f32 v107, v107
  v_mfma_f32_16x16x32_bf16 a[44:47], v[204:207], v[120:123], a[44:47]
  v_exp_f32 v108, v108
  v_exp_f32 v109, v109
  v_exp_f32 v110, v110
  v_mfma_f32_16x16x32_bf16 a[48:51], v[208:211], v[120:123], a[48:51]
  v_exp_f32 v111, v111
  v_cvt_pk_bf16_f32 v124, v104, v105
  v_add_f32 v142, v142, v104
  v_mfma_f32_16x16x32_bf16 a[52:55], v[212:215], v[120:123], a[52:55]
  v_add_f32 v145, v145, v105
  v_cvt_pk_bf16_f32 v125, v106, v107
  v_add_f32 v142, v142, v106
  v_mfma_f32_16x16x32_bf16 a[56:59], v[216:219], v[120:123], a[56:59]
  v_add_f32 v145, v145, v107
  v_cvt_pk_bf16_f32 v126, v108, v109
  v_add_f32 v142, v142, v108
  v_mfma_f32_16x16x32_bf16 a[60:63], v[220:223], v[120:123], a[60:63]
  v_add_f32 v145, v145, v109
  v_cvt_pk_bf16_f32 v127, v110, v111
  v_add_f32 v142, v142, v110
  v_add_f32 v145, v145, v111
  s_waitcnt vmcnt(8)
  s_barrier
  v_mfma_f32_16x16x32_bf16 a[64:67], v[160:163], v[124:127], a[64:67]
  ds_read_b128 a[192:195], v224 offset:16384
  v_mfma_f32_16x16x32_bf16 a[68:71], v[164:167], v[124:127], a[68:71]
  ds_read_b128 a[196:199], v224 offset:24576
  v_mfma_f32_16x16x32_bf16 a[72:75], v[168:171], v[124:127], a[72:75]
  ds_read_b128 a[200:203], v225 offset:16384
  v_mfma_f32_16x16x32_bf16 a[76:79], v[172:175], v[124:127], a[76:79]
  ds_read_b128 a[204:207], v225 offset:24576
  v_mfma_f32_16x16x32_bf16 a[80:83], v[176:179], v[124:127], a[80:83]
  ds_read_b128 a[208:211], v226 offset:16384
  v_mfma_f32_16x16x32_bf16 a[84:87], v[180:183], v[124:127], a[84:87]
  ds_read_b128 a[212:215], v226 offset:24576
  v_mfma_f32_16x16x32_bf16 a[88:91], v[184:187], v[124:127], a[88:91]
  ds_read_b128 a[216:219], v227 offset:16384
  v_mfma_f32_16x16x32_bf16 a[92:95], v[188:191], v[124:127], a[92:95]
  ds_read_b128 a[220:223], v227 offset:24576
  v_mfma_f32_16x16x32_bf16 a[96:99], v[192:195], v[124:127], a[96:99]
  ds_read_b128 a[224:227], v224 offset:16640
  v_mfma_f32_16x16x32_bf16 a[100:103], v[196:199], v[124:127], a[100:103]
  ds_read_b128 a[228:231], v224 offset:24832
  v_mfma_f32_16x16x32_bf16 a[104:107], v[200:203], v[124:127], a[104:107]
  ds_read_b128 a[232:235], v225 offset:16640
  v_mfma_f32_16x16x32_bf16 a[108:111], v[204:207], v[124:127], a[108:111]
  ds_read_b128 a[236:239], v225 offset:24832
  v_mfma_f32_16x16x32_bf16 a[112:115], v[208:211], v[124:127], a[112:115]
  ds_read_b128 a[240:243], v226 offset:16640
  v_mfma_f32_16x16x32_bf16 a[116:119], v[212:215], v[124:127], a[116:119]
  ds_read_b128 a[244:247], v226 offset:24832
  v_mfma_f32_16x16x32_bf16 a[120:123], v[216:219], v[124:127], a[120:123]
  ds_read_b128 a[248:251], v227 offset:16640
  v_mfma_f32_16x16x32_bf16 a[124:127], v[220:223], v[124:127], a[124:127]
  ds_read_b128 a[252:255], v227 offset:24832
  v_lshrrev_b32 v150, 7, v248
  v_add_u32 v150, 0, v150
  v_mul_u32_u24 v150, 37, v150
  v_lshrrev_b32 v150, 8, v150
  v_mul_u32_u24 v151, 896, v150
  v_add_u32 v152, 0, v248
  v_sub_u32 v152, v152, v151
  v_lshrrev_b32 v150, 1, v150
  v_and_b32 v150, 3, v150
  v_lshlrev_b32 v150, 5, v150
  v_xor_b32 v152, v152, v150
  v_add_u32 v155, v151, v152
  v_lshrrev_b32 v150, 7, v248
  v_add_u32 v150, 8, v150
  v_mul_u32_u24 v150, 37, v150
  v_lshrrev_b32 v150, 8, v150
  v_mul_u32_u24 v151, 896, v150
  v_add_u32 v152, 1024, v248
  v_sub_u32 v152, v152, v151
  v_lshrrev_b32 v150, 1, v150
  v_and_b32 v150, 3, v150
  v_lshlrev_b32 v150, 5, v150
  v_xor_b32 v152, v152, v150
  v_add_u32 v156, v151, v152
  v_lshrrev_b32 v150, 7, v248
  v_add_u32 v150, 16, v150
  v_mul_u32_u24 v150, 37, v150
  v_lshrrev_b32 v150, 8, v150
  v_mul_u32_u24 v151, 896, v150
  v_add_u32 v152, 2048, v248
  v_sub_u32 v152, v152, v151
  v_lshrrev_b32 v150, 1, v150
  v_and_b32 v150, 3, v150
  v_lshlrev_b32 v150, 5, v150
  v_xor_b32 v152, v152, v150
  v_add_u32 v157, v151, v152
  v_lshrrev_b32 v150, 7, v248
  v_add_u32 v150, 24, v150
  v_mul_u32_u24 v150, 37, v150
  v_lshrrev_b32 v150, 8, v150
  v_mul_u32_u24 v151, 896, v150
  v_add_u32 v152, 3072, v248
  v_sub_u32 v152, v152, v151
  v_lshrrev_b32 v150, 1, v150
  v_and_b32 v150, 3, v150
  v_lshlrev_b32 v150, 5, v150
  v_xor_b32 v152, v152, v150
  v_add_u32 v158, v151, v152
  v_lshrrev_b32 v150, 7, v248
  v_add_u32 v150, 32, v150
  v_mul_u32_u24 v150, 37, v150
  v_lshrrev_b32 v150, 8, v150
  v_mul_u32_u24 v151, 896, v150
  v_add_u32 v152, 4096, v248
  v_sub_u32 v152, v152, v151
  v_lshrrev_b32 v150, 1, v150
  v_and_b32 v150, 3, v150
  v_lshlrev_b32 v150, 5, v150
  v_xor_b32 v152, v152, v150
  v_add_u32 v159, v151, v152
  v_lshrrev_b32 v150, 7, v248
  v_add_u32 v150, 40, v150
  v_mul_u32_u24 v150, 37, v150
  v_lshrrev_b32 v150, 8, v150
  v_mul_u32_u24 v151, 896, v150
  v_add_u32 v152, 5120, v248
  v_sub_u32 v152, v152, v151
  v_lshrrev_b32 v150, 1, v150
  v_and_b32 v150, 3, v150
  v_lshlrev_b32 v150, 5, v150
  v_xor_b32 v152, v152, v150
  v_add_u32 v251, v151, v152
  v_lshrrev_b32 v150, 7, v248
  v_add_u32 v150, 48, v150
  v_mul_u32_u24 v150, 37, v150
  v_lshrrev_b32 v150, 8, v150
  v_mul_u32_u24 v151, 896, v150
  v_add_u32 v152, 6144, v248
  v_sub_u32 v152, v152, v151
  v_lshrrev_b32 v150, 1, v150
  v_and_b32 v150, 3, v150
  v_lshlrev_b32 v150, 5, v150
  v_xor_b32 v152, v152, v150
  v_add_u32 v252, v151, v152
  s_waitcnt lgkmcnt(0) vmcnt(0)
  s_barrier
  v_mfma_f32_16x16x32_bf16 v[96:99], a[192:195], v[0:3], 0
  s_add_u32 s75, s65, 0
  s_and_b32 s75, s75, 7
  s_mul_i32 s75, s75, 28672
  v_mfma_f32_16x16x32_bf16 v[100:103], a[196:199], v[0:3], 0
  s_add_u32 s91, s75, s90
  v_mfma_f32_16x16x32_bf16 v[96:99], a[200:203], v[4:7], v[96:99]
  s_add_u32 m0, s90, 0x0
  v_mfma_f32_16x16x32_bf16 v[100:103], a[204:207], v[4:7], v[100:103]
  buffer_load_dwordx4 v155, s[24:27], s91 offen lds
  v_mfma_f32_16x16x32_bf16 v[96:99], a[208:211], v[8:11], v[96:99]
  s_add_u32 m0, s90, 0x400
  v_mfma_f32_16x16x32_bf16 v[100:103], a[212:215], v[8:11], v[100:103]
  buffer_load_dwordx4 v156, s[24:27], s91 offen lds
  v_mfma_f32_16x16x32_bf16 v[96:99], a[216:219], v[12:15], v[96:99]
  s_add_u32 m0, s90, 0x800
  v_mfma_f32_16x16x32_bf16 v[100:103], a[220:223], v[12:15], v[100:103]
  buffer_load_dwordx4 v157, s[24:27], s91 offen lds
  v_mfma_f32_16x16x32_bf16 v[96:99], a[224:227], v[16:19], v[96:99]
  s_add_u32 m0, s90, 0xc00
  v_mfma_f32_16x16x32_bf16 v[100:103], a[228:231], v[16:19], v[100:103]
  buffer_load_dwordx4 v158, s[24:27], s91 offen lds
  v_mfma_f32_16x16x32_bf16 v[96:99], a[232:235], v[20:23], v[96:99]
  s_add_u32 m0, s90, 0x1000
  v_mfma_f32_16x16x32_bf16 v[100:103], a[236:239], v[20:23], v[100:103]
  buffer_load_dwordx4 v159, s[24:27], s91 offen lds
  v_mfma_f32_16x16x32_bf16 v[96:99], a[240:243], v[24:27], v[96:99]
  s_add_u32 m0, s90, 0x1400
  v_mfma_f32_16x16x32_bf16 v[100:103], a[244:247], v[24:27], v[100:103]
  buffer_load_dwordx4 v251, s[24:27], s91 offen lds
  v_mfma_f32_16x16x32_bf16 v[96:99], a[248:251], v[28:31], v[96:99]
  s_add_u32 m0, s90, 0x1800
  v_mfma_f32_16x16x32_bf16 v[100:103], a[252:255], v[28:31], v[100:103]
  buffer_load_dwordx4 v252, s[24:27], s91 offen lds
  v_mfma_f32_16x16x32_bf16 v[104:107], a[192:195], v[32:35], 0
  ds_read_b64_tr_b16 v[160:161], v228 offset:16384
  ds_read_b64_tr_b16 v[162:163], v228 offset:24576
  v_mfma_f32_16x16x32_bf16 v[108:111], a[196:199], v[32:35], 0
  ds_read_b64_tr_b16 v[164:165], v229 offset:16384
  ds_read_b64_tr_b16 v[166:167], v229 offset:24576
  v_mfma_f32_16x16x32_bf16 v[104:107], a[200:203], v[36:39], v[104:107]
  ds_read_b64_tr_b16 v[168:169], v230 offset:16384
  v_mfma_f32_16x16x32_bf16 v[108:111], a[204:207], v[36:39], v[108:111]
  ds_read_b64_tr_b16 v[170:171], v230 offset:24576
  ds_read_b64_tr_b16 v[172:173], v231 offset:16384
  ds_read_b64_tr_b16 v[174:175], v231 offset:24576
  ds_read_b64_tr_b16 v[176:177], v232 offset:16384
  v_mfma_f32_16x16x32_bf16 v[104:107], a[208:211], v[40:43], v[104:107]
  ds_read_b64_tr_b16 v[178:179], v232 offset:24576
  ds_read_b64_tr_b16 v[180:181], v233 offset:16384
  ds_read_b64_tr_b16 v[182:183], v233 offset:24576
  ds_read_b64_tr_b16 v[184:185], v234 offset:16384
  v_mfma_f32_16x16x32_bf16 v[108:111], a[212:215], v[40:43], v[108:111]
  ds_read_b64_tr_b16 v[186:187], v234 offset:24576
  ds_read_b64_tr_b16 v[188:189], v235 offset:16384
  ds_read_b64_tr_b16 v[190:191], v235 offset:24576
  ds_read_b64_tr_b16 v[192:193], v228 offset:16640
  v_mfma_f32_16x16x32_bf16 v[104:107], a[216:219], v[44:47], v[104:107]
  ds_read_b64_tr_b16 v[194:195], v228 offset:24832
  ds_read_b64_tr_b16 v[196:197], v229 offset:16640
  ds_read_b64_tr_b16 v[198:199], v229 offset:24832
  ds_read_b64_tr_b16 v[200:201], v230 offset:16640
  v_mfma_f32_16x16x32_bf16 v[108:111], a[220:223], v[44:47], v[108:111]
  ds_read_b64_tr_b16 v[202:203], v230 offset:24832
  ds_read_b64_tr_b16 v[204:205], v231 offset:16640
  ds_read_b64_tr_b16 v[206:207], v231 offset:24832
  ds_read_b64_tr_b16 v[208:209], v232 offset:16640
  v_mfma_f32_16x16x32_bf16 v[104:107], a[224:227], v[48:51], v[104:107]
  ds_read_b64_tr_b16 v[210:211], v232 offset:24832
  ds_read_b64_tr_b16 v[212:213], v233 offset:16640
  ds_read_b64_tr_b16 v[214:215], v233 offset:24832
  ds_read_b64_tr_b16 v[216:217], v234 offset:16640
  v_mfma_f32_16x16x32_bf16 v[108:111], a[228:231], v[48:51], v[108:111]
  ds_read_b64_tr_b16 v[218:219], v234 offset:24832
  ds_read_b64_tr_b16 v[220:221], v235 offset:16640
  ds_read_b64_tr_b16 v[222:223], v235 offset:24832
  v_max3_f32 v147, v96, v97, v98
  v_mfma_f32_16x16x32_bf16 v[104:107], a[232:235], v[52:55], v[104:107]
  v_max3_f32 v147, v147, v99, v100
  v_max3_f32 v147, v147, v101, v102
  v_max_f32 v147, v147, v103
  v_cmp_gt_f32 vcc, v147, v135
  v_mfma_f32_16x16x32_bf16 v[108:111], a[236:239], v[52:55], v[108:111]
  s_cbranch_vccnz L_rare_b1e_0
L_back_b1e_0:
  v_fma_f32 v96, v96, s72, v138
  v_fma_f32 v97, v97, s72, v138
  v_fma_f32 v98, v98, s72, v138
  v_mfma_f32_16x16x32_bf16 v[104:107], a[240:243], v[56:59], v[104:107]
  v_fma_f32 v99, v99, s72, v138
  v_fma_f32 v100, v100, s72, v138
  v_fma_f32 v101, v101, s72, v138
  v_fma_f32 v102, v102, s72, v138
  v_mfma_f32_16x16x32_bf16 v[108:111], a[244:247], v[56:59], v[108:111]
  v_fma_f32 v103, v103, s72, v138
  v_exp_f32 v96, v96
  v_exp_f32 v97, v97
  v_exp_f32 v98, v98
  v_mfma_f32_16x16x32_bf16 v[104:107], a[248:251], v[60:63], v[104:107]
  v_exp_f32 v99, v99
  v_exp_f32 v100, v100
  v_exp_f32 v101, v101
  v_exp_f32 v102, v102
  v_mfma_f32_16x16x32_bf16 v[108:111], a[252:255], v[60:63], v[108:111]
  v_exp_f32 v103, v103
  v_cvt_pk_bf16_f32 v120, v96, v97
  v_add_f32 v141, v141, v96
  v_add_f32 v144, v144, v97
  v_cvt_pk_bf16_f32 v121, v98, v99
  v_add_f32 v141, v141, v98
  v_add_f32 v144, v144, v99
  v_cvt_pk_bf16_f32 v122, v100, v101
  v_add_f32 v141, v141, v100
  v_add_f32 v144, v144, v101
  v_cvt_pk_bf16_f32 v123, v102, v103
  v_add_f32 v141, v141, v102
  v_add_f32 v144, v144, v103
  s_nop 0
  s_add_u32 m0, s90, 0xffffe400
  s_sub_u32 s91, s91, 7168
  s_nop 0
  buffer_load_dwordx4 v155, s[24:27], s91 offen lds
  s_nop 0
  s_add_u32 m0, s90, 0xffffe800
  s_nop 0
  buffer_load_dwordx4 v156, s[24:27], s91 offen lds
  s_nop 0
  s_add_u32 m0, s90, 0xffffec00
  s_nop 0
  buffer_load_dwordx4 v157, s[24:27], s91 offen lds
  s_nop 0
  s_add_u32 m0, s90, 0xfffff000
  s_nop 0
  buffer_load_dwordx4 v158, s[24:27], s91 offen lds
  s_nop 0
  s_add_u32 m0, s90, 0xfffff400
  s_nop 0
  buffer_load_dwordx4 v159, s[24:27], s91 offen lds
  s_nop 0
  s_add_u32 m0, s90, 0xfffff800
  s_nop 0
  buffer_load_dwordx4 v251, s[24:27], s91 offen lds
  s_nop 0
  s_add_u32 m0, s90, 0xfffffc00
  s_nop 0
  buffer_load_dwordx4 v252, s[24:27], s91 offen lds
  s_nop 0
  s_add_u32 s75, s65, 1
  s_and_b32 s75, s75, 7
  s_mul_i32 s75, s75, 28672
  s_nop 0
  s_add_u32 s91, s75, s90
  s_nop 0
  s_add_u32 m0, s90, 0x7000
  s_nop 0
  buffer_load_dwordx4 v155, s[24:27], s91 offen lds
  s_nop 0
  s_add_u32 m0, s90, 0x7400
  s_nop 0
  buffer_load_dwordx4 v156, s[24:27], s91 offen lds
  s_nop 0
  s_add_u32 m0, s90, 0x7800
  s_nop 0
  buffer_load_dwordx4 v157, s[24:27], s91 offen lds
  s_nop 0
  s_add_u32 m0, s90, 0x7c00
  s_nop 0
  buffer_load_dwordx4 v158, s[24:27], s91 offen lds
  s_nop 0
  s_add_u32 m0, s90, 0x8000
  s_nop 0
  buffer_load_dwordx4 v159, s[24:27], s91 offen lds
  s_nop 0
  s_add_u32 m0, s90, 0x8400
  s_nop 0
  buffer_load_dwordx4 v251, s[24:27], s91 offen lds
  s_nop 0
  s_add_u32 m0, s90, 0x8800
  s_nop 0
  buffer_load_dwordx4 v252, s[24:27], s91 offen lds
  s_nop 0
  s_add_u32 m0, s90, 0x5400
  s_sub_u32 s91, s91, 7168
  s_nop 0
  buffer_load_dwordx4 v155, s[24:27], s91 offen lds
  s_nop 0
  s_add_u32 m0, s90, 0x5800
  s_nop 0
  buffer_load_dwordx4 v156, s[24:27], s91 offen lds
  s_nop 0
  s_add_u32 m0, s90, 0x5c00
  s_nop 0
  buffer_load_dwordx4 v157, s[24:27], s91 offen lds
  s_nop 0
  s_add_u32 m0, s90, 0x6000
  s_nop 0
  buffer_load_dwordx4 v158, s[24:27], s91 offen lds
  s_nop 0
  s_add_u32 m0, s90, 0x6400
  s_nop 0
  buffer_load_dwordx4 v159, s[24:27], s91 offen lds
  s_nop 0
  s_add_u32 m0, s90, 0x6800
  s_nop 0
  buffer_load_dwordx4 v251, s[24:27], s91 offen lds
  s_nop 0
  s_add_u32 m0, s90, 0x6c00
  s_nop 0
  buffer_load_dwordx4 v252, s[24:27], s91 offen lds
  s_waitcnt lgkmcnt(0)
  v_mfma_f32_16x16x32_bf16 a[0:3], v[160:163], v[120:123], a[0:3]
  v_mfma_f32_16x16x32_bf16 a[4:7], v[164:167], v[120:123], a[4:7]
  v_mfma_f32_16x16x32_bf16 a[8:11], v[168:171], v[120:123], a[8:11]
  v_mfma_f32_16x16x32_bf16 a[12:15], v[172:175], v[120:123], a[12:15]
  v_mfma_f32_16x16x32_bf16 a[16:19], v[176:179], v[120:123], a[16:19]
  s_nop 2
  v_mfma_f32_16x16x32_bf16 a[20:23], v[180:183], v[120:123], a[20:23]
  v_max3_f32 v148, v104, v105, v106
  v_max3_f32 v148, v148, v107, v108
  v_max3_f32 v148, v148, v109, v110
  v_mfma_f32_16x16x32_bf16 a[24:27], v[184:187], v[120:123], a[24:27]
  v_max_f32 v148, v148, v111
  v_cmp_gt_f32 vcc, v148, v136
  s_cbranch_vccnz L_rare_b1e_1
L_back_b1e_1:
  v_mfma_f32_16x16x32_bf16 a[28:31], v[188:191], v[120:123], a[28:31]
  v_fma_f32 v104, v104, s72, v139
  v_fma_f32 v105, v105, s72, v139
  v_fma_f32 v106, v106, s72, v139
  v_mfma_f32_16x16x32_bf16 a[32:35], v[192:195], v[120:123], a[32:35]
  v_fma_f32 v107, v107, s72, v139
  v_fma_f32 v108, v108, s72, v139
  v_fma_f32 v109, v109, s72, v139
  v_mfma_f32_16x16x32_bf16 a[36:39], v[196:199], v[120:123], a[36:39]
  v_fma_f32 v110, v110, s72, v139
  v_fma_f32 v111, v111, s72, v139
  v_exp_f32 v104, v104
  v_mfma_f32_16x16x32_bf16 a[40:43], v[200:203], v[120:123], a[40:43]
  v_exp_f32 v105, v105
  v_exp_f32 v106, v106
  v_exp_f32 v107, v107
  v_mfma_f32_16x16x32_bf16 a[44:47], v[204:207], v[120:123], a[44:47]
  v_exp_f32 v108, v108
  v_exp_f32 v109, v109
  v_exp_f32 v110, v110
  v_mfma_f32_16x16x32_bf16 a[48:51], v[208:211], v[120:123], a[48:51]
  v_exp_f32 v111, v111
  v_cvt_pk_bf16_f32 v124, v104, v105
  v_add_f32 v142, v142, v104
  v_mfma_f32_16x16x32_bf16 a[52:55], v[212:215], v[120:123], a[52:55]
  v_add_f32 v145, v145, v105
  v_cvt_pk_bf16_f32 v125, v106, v107
  v_add_f32 v142, v142, v106
  v_mfma_f32_16x16x32_bf16 a[56:59], v[216:219], v[120:123], a[56:59]
  v_add_f32 v145, v145, v107
  v_cvt_pk_bf16_f32 v126, v108, v109
  v_add_f32 v142, v142, v108
  v_mfma_f32_16x16x32_bf16 a[60:63], v[220:223], v[120:123], a[60:63]
  v_add_f32 v145, v145, v109
  v_cvt_pk_bf16_f32 v127, v110, v111
  v_add_f32 v142, v142, v110
  v_add_f32 v145, v145, v111
  s_barrier
  v_mfma_f32_16x16x32_bf16 a[64:67], v[160:163], v[124:127], a[64:67]
  v_add_f32 v141, v141, v144
  v_mov_b32 v153, v141
  v_mfma_f32_16x16x32_bf16 a[68:71], v[164:167], v[124:127], a[68:71]
  s_nop 1
  v_permlane32_swap_b32 v141, v153
  v_mfma_f32_16x16x32_bf16 a[72:75], v[168:171], v[124:127], a[72:75]
  v_add_f32 v141, v141, v153
  v_mov_b32 v153, v141
  v_mfma_f32_16x16x32_bf16 a[76:79], v[172:175], v[124:127], a[76:79]
  s_nop 1
  v_permlane16_swap_b32 v141, v153
  v_mfma_f32_16x16x32_bf16 a[80:83], v[176:179], v[124:127], a[80:83]
  v_add_f32 v141, v141, v153
  v_rcp_f32 v150, v141
  v_mfma_f32_16x16x32_bf16 a[84:87], v[180:183], v[124:127], a[84:87]
  v_add_f32 v142, v142, v145
  v_mov_b32 v153, v142
  v_mfma_f32_16x16x32_bf16 a[88:91], v[184:187], v[124:127], a[88:91]
  s_nop 1
  v_permlane32_swap_b32 v142, v153
  v_mfma_f32_16x16x32_bf16 a[92:95], v[188:191], v[124:127], a[92:95]
  v_add_f32 v142, v142, v153
  v_mov_b32 v153, v142
  v_mfma_f32_16x16x32_bf16 a[96:99], v[192:195], v[124:127], a[96:99]
  s_nop 1
  v_permlane16_swap_b32 v142, v153
  v_mfma_f32_16x16x32_bf16 a[100:103], v[196:199], v[124:127], a[100:103]
  v_add_f32 v142, v142, v153
  v_rcp_f32 v152, v142
  v_mfma_f32_16x16x32_bf16 a[104:107], v[200:203], v[124:127], a[104:107]
  s_mul_i32 s75, s59, 40960
  s_sub_u32 s75, 106496, s75
  v_mfma_f32_16x16x32_bf16 a[108:111], v[204:207], v[124:127], a[108:111]
  s_mul_i32 s76, s60, 24576
  s_add_u32 s75, s75, s76
  v_mfma_f32_16x16x32_bf16 a[112:115], v[208:211], v[124:127], a[112:115]
  v_add_u32 v151, s75, v248
  v_mfma_f32_16x16x32_bf16 a[116:119], v[212:215], v[124:127], a[116:119]
  v_mfma_f32_16x16x32_bf16 a[120:123], v[216:219], v[124:127], a[120:123]
  v_mfma_f32_16x16x32_bf16 a[124:127], v[220:223], v[124:127], a[124:127]
  s_nop 4
  v_accvgpr_read_b32 v96, a0
  v_accvgpr_read_b32 v97, a1
  v_accvgpr_read_b32 v98, a2
  v_accvgpr_read_b32 v99, a3
  v_accvgpr_read_b32 v100, a4
  v_accvgpr_read_b32 v101, a5
  v_accvgpr_read_b32 v102, a6
  v_accvgpr_read_b32 v103, a7
  v_pk_mul_f32 v[96:97], v[96:97], v[150:151] op_sel_hi:[1,0]
  v_pk_mul_f32 v[98:99], v[98:99], v[150:151] op_sel_hi:[1,0]
  v_pk_mul_f32 v[100:101], v[100:101], v[150:151] op_sel_hi:[1,0]
  v_pk_mul_f32 v[102:103], v[102:103], v[150:151] op_sel_hi:[1,0]
  v_cvt_pk_bf16_f32 v104, v96, v97
  v_cvt_pk_bf16_f32 v105, v98, v99
  v_cvt_pk_bf16_f32 v106, v100, v101
  v_cvt_pk_bf16_f32 v107, v102, v103
  ds_write_b128 v151, v[104:107] offset:0
  v_accvgpr_read_b32 v108, a8
  v_accvgpr_read_b32 v109, a9
  v_accvgpr_read_b32 v110, a10
  v_accvgpr_read_b32 v111, a11
  v_accvgpr_read_b32 v112, a12
  v_accvgpr_read_b32 v113, a13
  v_accvgpr_read_b32 v114, a14
  v_accvgpr_read_b32 v115, a15
  v_pk_mul_f32 v[108:109], v[108:109], v[150:151] op_sel_hi:[1,0]
  v_pk_mul_f32 v[110:111], v[110:111], v[150:151] op_sel_hi:[1,0]
  v_pk_mul_f32 v[112:113], v[112:113], v[150:151] op_sel_hi:[1,0]
  v_pk_mul_f32 v[114:115], v[114:115], v[150:151] op_sel_hi:[1,0]
  v_cvt_pk_bf16_f32 v116, v108, v109
  v_cvt_pk_bf16_f32 v117, v110, v111
  v_cvt_pk_bf16_f32 v118, v112, v113
  v_cvt_pk_bf16_f32 v119, v114, v115
  ds_write_b128 v151, v[116:119] offset:1024
  v_accvgpr_read_b32 v96, a16
  v_accvgpr_read_b32 v97, a17
  v_accvgpr_read_b32 v98, a18
  v_accvgpr_read_b32 v99, a19
  v_accvgpr_read_b32 v100, a20
  v_accvgpr_read_b32 v101, a21
  v_accvgpr_read_b32 v102, a22
  v_accvgpr_read_b32 v103, a23
  v_pk_mul_f32 v[96:97], v[96:97], v[150:151] op_sel_hi:[1,0]
  v_pk_mul_f32 v[98:99], v[98:99], v[150:151] op_sel_hi:[1,0]
  v_pk_mul_f32 v[100:101], v[100:101], v[150:151] op_sel_hi:[1,0]
  v_pk_mul_f32 v[102:103], v[102:103], v[150:151] op_sel_hi:[1,0]
  v_cvt_pk_bf16_f32 v104, v96, v97
  v_cvt_pk_bf16_f32 v105, v98, v99
  v_cvt_pk_bf16_f32 v106, v100, v101
  v_cvt_pk_bf16_f32 v107, v102, v103
  ds_write_b128 v151, v[104:107] offset:2048
  v_accvgpr_read_b32 v108, a24
  v_accvgpr_read_b32 v109, a25
  v_accvgpr_read_b32 v110, a26
  v_accvgpr_read_b32 v111, a27
  v_accvgpr_read_b32 v112, a28
  v_accvgpr_read_b32 v113, a29
  v_accvgpr_read_b32 v114, a30
  v_accvgpr_read_b32 v115, a31
  v_pk_mul_f32 v[108:109], v[108:109], v[150:151] op_sel_hi:[1,0]
  v_pk_mul_f32 v[110:111], v[110:111], v[150:151] op_sel_hi:[1,0]
  v_pk_mul_f32 v[112:113], v[112:113], v[150:151] op_sel_hi:[1,0]
  v_pk_mul_f32 v[114:115], v[114:115], v[150:151] op_sel_hi:[1,0]
  v_cvt_pk_bf16_f32 v116, v108, v109
  v_cvt_pk_bf16_f32 v117, v110, v111
  v_cvt_pk_bf16_f32 v118, v112, v113
  v_cvt_pk_bf16_f32 v119, v114, v115
  ds_write_b128 v151, v[116:119] offset:3072
  v_accvgpr_read_b32 v96, a32
  v_accvgpr_read_b32 v97, a33
  v_accvgpr_read_b32 v98, a34
  v_accvgpr_read_b32 v99, a35
  v_accvgpr_read_b32 v100, a36
  v_accvgpr_read_b32 v101, a37
  v_accvgpr_read_b32 v102, a38
  v_accvgpr_read_b32 v103, a39
  v_pk_mul_f32 v[96:97], v[96:97], v[150:151] op_sel_hi:[1,0]
  v_pk_mul_f32 v[98:99], v[98:99], v[150:151] op_sel_hi:[1,0]
  v_pk_mul_f32 v[100:101], v[100:101], v[150:151] op_sel_hi:[1,0]
  v_pk_mul_f32 v[102:103], v[102:103], v[150:151] op_sel_hi:[1,0]
  v_cvt_pk_bf16_f32 v104, v96, v97
  v_cvt_pk_bf16_f32 v105, v98, v99
  v_cvt_pk_bf16_f32 v106, v100, v101
  v_cvt_pk_bf16_f32 v107, v102, v103
  ds_write_b128 v151, v[104:107] offset:4096
  v_accvgpr_read_b32 v108, a40
  v_accvgpr_read_b32 v109, a41
  v_accvgpr_read_b32 v110, a42
  v_accvgpr_read_b32 v111, a43
  v_accvgpr_read_b32 v112, a44
  v_accvgpr_read_b32 v113, a45
  v_accvgpr_read_b32 v114, a46
  v_accvgpr_read_b32 v115, a47
  v_pk_mul_f32 v[108:109], v[108:109], v[150:151] op_sel_hi:[1,0]
  v_pk_mul_f32 v[110:111], v[110:111], v[150:151] op_sel_hi:[1,0]
  v_pk_mul_f32 v[112:113], v[112:113], v[150:151] op_sel_hi:[1,0]
  v_pk_mul_f32 v[114:115], v[114:115], v[150:151] op_sel_hi:[1,0]
  v_cvt_pk_bf16_f32 v116, v108, v109
  v_cvt_pk_bf16_f32 v117, v110, v111
  v_cvt_pk_bf16_f32 v118, v112, v113
  v_cvt_pk_bf16_f32 v119, v114, v115
  ds_write_b128 v151, v[116:119] offset:5120
  v_accvgpr_read_b32 v96, a48
  v_accvgpr_read_b32 v97, a49
  v_accvgpr_read_b32 v98, a50
  v_accvgpr_read_b32 v99, a51
  v_accvgpr_read_b32 v100, a52
  v_accvgpr_read_b32 v101, a53
  v_accvgpr_read_b32 v102, a54
  v_accvgpr_read_b32 v103, a55
  v_pk_mul_f32 v[96:97], v[96:97], v[150:151] op_sel_hi:[1,0]
  v_pk_mul_f32 v[98:99], v[98:99], v[150:151] op_sel_hi:[1,0]
  v_pk_mul_f32 v[100:101], v[100:101], v[150:151] op_sel_hi:[1,0]
  v_pk_mul_f32 v[102:103], v[102:103], v[150:151] op_sel_hi:[1,0]
  v_cvt_pk_bf16_f32 v104, v96, v97
  v_cvt_pk_bf16_f32 v105, v98, v99
  v_cvt_pk_bf16_f32 v106, v100, v101
  v_cvt_pk_bf16_f32 v107, v102, v103
  ds_write_b128 v151, v[104:107] offset:6144
  v_accvgpr_read_b32 v108, a56
  v_accvgpr_read_b32 v109, a57
  v_accvgpr_read_b32 v110, a58
  v_accvgpr_read_b32 v111, a59
  v_accvgpr_read_b32 v112, a60
  v_accvgpr_read_b32 v113, a61
  v_accvgpr_read_b32 v114, a62
  v_accvgpr_read_b32 v115, a63
  v_pk_mul_f32 v[108:109], v[108:109], v[150:151] op_sel_hi:[1,0]
  v_pk_mul_f32 v[110:111], v[110:111], v[150:151] op_sel_hi:[1,0]
  v_pk_mul_f32 v[112:113], v[112:113], v[150:151] op_sel_hi:[1,0]
  v_pk_mul_f32 v[114:115], v[114:115], v[150:151] op_sel_hi:[1,0]
  v_cvt_pk_bf16_f32 v116, v108, v109
  v_cvt_pk_bf16_f32 v117, v110, v111
  v_cvt_pk_bf16_f32 v118, v112, v113
  v_cvt_pk_bf16_f32 v119, v114, v115
  ds_write_b128 v151, v[116:119] offset:7168
  v_accvgpr_read_b32 v96, a64
  v_accvgpr_read_b32 v97, a65
  v_accvgpr_read_b32 v98, a66
  v_accvgpr_read_b32 v99, a67
  v_accvgpr_read_b32 v100, a68
  v_accvgpr_read_b32 v101, a69
  v_accvgpr_read_b32 v102, a70
  v_accvgpr_read_b32 v103, a71
  v_pk_mul_f32 v[96:97], v[96:97], v[152:153] op_sel_hi:[1,0]
  v_pk_mul_f32 v[98:99], v[98:99], v[152:153] op_sel_hi:[1,0]
  v_pk_mul_f32 v[100:101], v[100:101], v[152:153] op_sel_hi:[1,0]
  v_pk_mul_f32 v[102:103], v[102:103], v[152:153] op_sel_hi:[1,0]
  v_cvt_pk_bf16_f32 v104, v96, v97
  v_cvt_pk_bf16_f32 v105, v98, v99
  v_cvt_pk_bf16_f32 v106, v100, v101
  v_cvt_pk_bf16_f32 v107, v102, v103
  ds_write_b128 v151, v[104:107] offset:8192
  v_accvgpr_read_b32 v108, a72
  v_accvgpr_read_b32 v109, a73
  v_accvgpr_read_b32 v110, a74
  v_accvgpr_read_b32 v111, a75
  v_accvgpr_read_b32 v112, a76
  v_accvgpr_read_b32 v113, a77
  v_accvgpr_read_b32 v114, a78
  v_accvgpr_read_b32 v115, a79
  v_pk_mul_f32 v[108:109], v[108:109], v[152:153] op_sel_hi:[1,0]
  v_pk_mul_f32 v[110:111], v[110:111], v[152:153] op_sel_hi:[1,0]
  v_pk_mul_f32 v[112:113], v[112:113], v[152:153] op_sel_hi:[1,0]
  v_pk_mul_f32 v[114:115], v[114:115], v[152:153] op_sel_hi:[1,0]
  v_cvt_pk_bf16_f32 v116, v108, v109
  v_cvt_pk_bf16_f32 v117, v110, v111
  v_cvt_pk_bf16_f32 v118, v112, v113
  v_cvt_pk_bf16_f32 v119, v114, v115
  ds_write_b128 v151, v[116:119] offset:9216
  v_accvgpr_read_b32 v96, a80
  v_accvgpr_read_b32 v97, a81
  v_accvgpr_read_b32 v98, a82
  v_accvgpr_read_b32 v99, a83
  v_accvgpr_read_b32 v100, a84
  v_accvgpr_read_b32 v101, a85
  v_accvgpr_read_b32 v102, a86
  v_accvgpr_read_b32 v103, a87
  v_pk_mul_f32 v[96:97], v[96:97], v[152:153] op_sel_hi:[1,0]
  v_pk_mul_f32 v[98:99], v[98:99], v[152:153] op_sel_hi:[1,0]
  v_pk_mul_f32 v[100:101], v[100:101], v[152:153] op_sel_hi:[1,0]
  v_pk_mul_f32 v[102:103], v[102:103], v[152:153] op_sel_hi:[1,0]
  v_cvt_pk_bf16_f32 v104, v96, v97
  v_cvt_pk_bf16_f32 v105, v98, v99
  v_cvt_pk_bf16_f32 v106, v100, v101
  v_cvt_pk_bf16_f32 v107, v102, v103
  ds_write_b128 v151, v[104:107] offset:10240
  v_accvgpr_read_b32 v108, a88
  v_accvgpr_read_b32 v109, a89
  v_accvgpr_read_b32 v110, a90
  v_accvgpr_read_b32 v111, a91
  v_accvgpr_read_b32 v112, a92
  v_accvgpr_read_b32 v113, a93
  v_accvgpr_read_b32 v114, a94
  v_accvgpr_read_b32 v115, a95
  v_pk_mul_f32 v[108:109], v[108:109], v[152:153] op_sel_hi:[1,0]
  v_pk_mul_f32 v[110:111], v[110:111], v[152:153] op_sel_hi:[1,0]
  v_pk_mul_f32 v[112:113], v[112:113], v[152:153] op_sel_hi:[1,0]
  v_pk_mul_f32 v[114:115], v[114:115], v[152:153] op_sel_hi:[1,0]
  v_cvt_pk_bf16_f32 v116, v108, v109
  v_cvt_pk_bf16_f32 v117, v110, v111
  v_cvt_pk_bf16_f32 v118, v112, v113
  v_cvt_pk_bf16_f32 v119, v114, v115
  ds_write_b128 v151, v[116:119] offset:11264
  v_accvgpr_read_b32 v96, a96
  v_accvgpr_read_b32 v97, a97
  v_accvgpr_read_b32 v98, a98
  v_accvgpr_read_b32 v99, a99
  v_accvgpr_read_b32 v100, a100
  v_accvgpr_read_b32 v101, a101
  v_accvgpr_read_b32 v102, a102
  v_accvgpr_read_b32 v103, a103
  v_pk_mul_f32 v[96:97], v[96:97], v[152:153] op_sel_hi:[1,0]
  v_pk_mul_f32 v[98:99], v[98:99], v[152:153] op_sel_hi:[1,0]
  v_pk_mul_f32 v[100:101], v[100:101], v[152:153] op_sel_hi:[1,0]
  v_pk_mul_f32 v[102:103], v[102:103], v[152:153] op_sel_hi:[1,0]
  v_cvt_pk_bf16_f32 v104, v96, v97
  v_cvt_pk_bf16_f32 v105, v98, v99
  v_cvt_pk_bf16_f32 v106, v100, v101
  v_cvt_pk_bf16_f32 v107, v102, v103
  ds_write_b128 v151, v[104:107] offset:12288
  v_accvgpr_read_b32 v108, a104
  v_accvgpr_read_b32 v109, a105
  v_accvgpr_read_b32 v110, a106
  v_accvgpr_read_b32 v111, a107
  v_accvgpr_read_b32 v112, a108
  v_accvgpr_read_b32 v113, a109
  v_accvgpr_read_b32 v114, a110
  v_accvgpr_read_b32 v115, a111
  v_pk_mul_f32 v[108:109], v[108:109], v[152:153] op_sel_hi:[1,0]
  v_pk_mul_f32 v[110:111], v[110:111], v[152:153] op_sel_hi:[1,0]
  v_pk_mul_f32 v[112:113], v[112:113], v[152:153] op_sel_hi:[1,0]
  v_pk_mul_f32 v[114:115], v[114:115], v[152:153] op_sel_hi:[1,0]
  v_cvt_pk_bf16_f32 v116, v108, v109
  v_cvt_pk_bf16_f32 v117, v110, v111
  v_cvt_pk_bf16_f32 v118, v112, v113
  v_cvt_pk_bf16_f32 v119, v114, v115
  ds_write_b128 v151, v[116:119] offset:13312
  v_accvgpr_read_b32 v96, a112
  v_accvgpr_read_b32 v97, a113
  v_accvgpr_read_b32 v98, a114
  v_accvgpr_read_b32 v99, a115
  v_accvgpr_read_b32 v100, a116
  v_accvgpr_read_b32 v101, a117
  v_accvgpr_read_b32 v102, a118
  v_accvgpr_read_b32 v103, a119
  v_pk_mul_f32 v[96:97], v[96:97], v[152:153] op_sel_hi:[1,0]
  v_pk_mul_f32 v[98:99], v[98:99], v[152:153] op_sel_hi:[1,0]
  v_pk_mul_f32 v[100:101], v[100:101], v[152:153] op_sel_hi:[1,0]
  v_pk_mul_f32 v[102:103], v[102:103], v[152:153] op_sel_hi:[1,0]
  v_cvt_pk_bf16_f32 v104, v96, v97
  v_cvt_pk_bf16_f32 v105, v98, v99
  v_cvt_pk_bf16_f32 v106, v100, v101
  v_cvt_pk_bf16_f32 v107, v102, v103
  ds_write_b128 v151, v[104:107] offset:14336
  v_accvgpr_read_b32 v108, a120
  v_accvgpr_read_b32 v109, a121
  v_accvgpr_read_b32 v110, a122
  v_accvgpr_read_b32 v111, a123
  v_accvgpr_read_b32 v112, a124
  v_accvgpr_read_b32 v113, a125
  v_accvgpr_read_b32 v114, a126
  v_accvgpr_read_b32 v115, a127
  v_pk_mul_f32 v[108:109], v[108:109], v[152:153] op_sel_hi:[1,0]
  v_pk_mul_f32 v[110:111], v[110:111], v[152:153] op_sel_hi:[1,0]
  v_pk_mul_f32 v[112:113], v[112:113], v[152:153] op_sel_hi:[1,0]
  v_pk_mul_f32 v[114:115], v[114:115], v[152:153] op_sel_hi:[1,0]
  v_cvt_pk_bf16_f32 v116, v108, v109
  v_cvt_pk_bf16_f32 v117, v110, v111
  v_cvt_pk_bf16_f32 v118, v112, v113
  v_cvt_pk_bf16_f32 v119, v114, v115
  ds_write_b128 v151, v[116:119] offset:15360
  s_branch L_fin1
L_fin0:
  s_waitcnt lgkmcnt(0)
  s_branch L_common
L_fin1:
  s_waitcnt lgkmcnt(0)
L_common:
  s_barrier
  s_add_u32 s76, s65, 0
  s_and_b32 s76, s76, 7
  s_lshl_b32 s76, s76, 10
  s_add_u32 s76, s76, 106496
  v_add_u32 v211, s76, v248
  ds_read_b128 a[0:3], v211 offset:0
  ds_read_b128 a[4:7], v211 offset:8192
  ds_read_b128 a[8:11], v211 offset:16384
  ds_read_b128 a[12:15], v211 offset:24576
  ds_read_b128 a[16:19], v211 offset:32768
  s_add_u32 s76, s65, 1
  s_and_b32 s76, s76, 7
  s_lshl_b32 s76, s76, 10
  s_add_u32 s76, s76, 106496
  v_add_u32 v212, s76, v248
  ds_read_b128 a[20:23], v212 offset:0
  ds_read_b128 a[24:27], v212 offset:8192
  ds_read_b128 a[28:31], v212 offset:16384
  ds_read_b128 a[32:35], v212 offset:24576
  ds_read_b128 a[36:39], v212 offset:32768
  s_add_u32 s76, s65, 2
  s_and_b32 s76, s76, 7
  s_lshl_b32 s76, s76, 10
  s_add_u32 s76, s76, 106496
  v_add_u32 v211, s76, v248
  ds_read_b128 a[40:43], v211 offset:0
  ds_read_b128 a[44:47], v211 offset:8192
  ds_read_b128 a[48:51], v211 offset:16384
  ds_read_b128 a[52:55], v211 offset:24576
  ds_read_b128 a[56:59], v211 offset:32768
  s_add_u32 s76, s65, 3
  s_and_b32 s76, s76, 7
  s_lshl_b32 s76, s76, 10
  s_add_u32 s76, s76, 106496
  v_add_u32 v212, s76, v248
  ds_read_b128 a[60:63], v212 offset:0
  ds_read_b128 a[64:67], v212 offset:8192
  ds_read_b128 a[68:71], v212 offset:16384
  ds_read_b128 a[72:75], v212 offset:24576
  ds_read_b128 a[76:79], v212 offset:32768
  s_add_u32 s76, s65, 4
  s_and_b32 s76, s76, 7
  s_lshl_b32 s76, s76, 10
  s_add_u32 s76, s76, 106496
  v_add_u32 v211, s76, v248
  ds_read_b128 a[80:83], v211 offset:0
  ds_read_b128 a[84:87], v211 offset:8192
  ds_read_b128 a[88:91], v211 offset:16384
  ds_read_b128 a[92:95], v211 offset:24576
  ds_read_b128 a[96:99], v211 offset:32768
  s_add_u32 s76, s65, 5
  s_and_b32 s76, s76, 7
  s_lshl_b32 s76, s76, 10
  s_add_u32 s76, s76, 106496
  v_add_u32 v212, s76, v248
  ds_read_b128 a[100:103], v212 offset:0
  ds_read_b128 a[104:107], v212 offset:8192
  ds_read_b128 a[108:111], v212 offset:16384
  ds_read_b128 a[112:115], v212 offset:24576
  ds_read_b128 a[116:119], v212 offset:32768
  s_add_u32 s76, s65, 6
  s_and_b32 s76, s76, 7
  s_lshl_b32 s76, s76, 10
  s_add_u32 s76, s76, 106496
  v_add_u32 v211, s76, v248
  ds_read_b128 a[120:123], v211 offset:0
  ds_read_b128 a[124:127], v211 offset:8192
  ds_read_b128 a[128:131], v211 offset:16384
  ds_read_b128 a[132:135], v211 offset:24576
  ds_read_b128 a[136:139], v211 offset:32768
  s_add_u32 s76, s65, 7
  s_and_b32 s76, s76, 7
  s_lshl_b32 s76, s76, 10
  s_add_u32 s76, s76, 106496
  v_add_u32 v212, s76, v248
  ds_read_b128 a[140:143], v212 offset:0
  ds_read_b128 a[144:147], v212 offset:8192
  ds_read_b128 a[148:151], v212 offset:16384
  ds_read_b128 a[152:155], v212 offset:24576
  ds_read_b128 a[156:159], v212 offset:32768
  s_waitcnt lgkmcnt(0)
  s_barrier
  s_nop 0
  s_add_u32 s75, s65, 2
  s_and_b32 s75, s75, 7
  s_mul_i32 s75, s75, 28672
  s_nop 0
  s_add_u32 s91, s75, s90
  s_nop 0
  s_add_u32 m0, s90, 0x1a000
  s_nop 0
  buffer_load_dwordx4 v155, s[24:27], s91 offen lds
  s_nop 0
  s_add_u32 m0, s90, 0x1a400
  s_nop 0
  buffer_load_dwordx4 v156, s[24:27], s91 offen lds
  s_nop 0
  s_add_u32 m0, s90, 0x1a800
  s_nop 0
  buffer_load_dwordx4 v157, s[24:27], s91 offen lds
  s_nop 0
  s_add_u32 m0, s90, 0x1ac00
  s_nop 0
  buffer_load_dwordx4 v158, s[24:27], s91 offen lds
  s_nop 0
  s_add_u32 m0, s90, 0x1b000
  s_nop 0
  buffer_load_dwordx4 v159, s[24:27], s91 offen lds
  s_nop 0
  s_add_u32 m0, s90, 0x1b400
  s_nop 0
  buffer_load_dwordx4 v251, s[24:27], s91 offen lds
  s_nop 0
  s_add_u32 m0, s90, 0x1b800
  s_nop 0
  buffer_load_dwordx4 v252, s[24:27], s91 offen lds
  s_nop 0
  s_add_u32 s75, s65, 3
  s_and_b32 s75, s75, 7
  s_mul_i32 s75, s75, 28672
  s_nop 0
  s_add_u32 s91, s75, s90
  s_nop 0
  s_add_u32 m0, s90, 0x21000
  s_nop 0
  buffer_load_dwordx4 v155, s[24:27], s91 offen lds
  s_nop 0
  s_add_u32 m0, s90, 0x21400
  s_nop 0
  buffer_load_dwordx4 v156, s[24:27], s91 offen lds
  s_nop 0
  s_add_u32 m0, s90, 0x21800
  s_nop 0
  buffer_load_dwordx4 v157, s[24:27], s91 offen lds
  s_nop 0
  s_add_u32 m0, s90, 0x21c00
  s_nop 0
  buffer_load_dwordx4 v158, s[24:27], s91 offen lds
  s_nop 0
  s_add_u32 m0, s90, 0x22000
  s_nop 0
  buffer_load_dwordx4 v159, s[24:27], s91 offen lds
  s_nop 0
  s_add_u32 m0, s90, 0x22400
  s_nop 0
  buffer_load_dwordx4 v251, s[24:27], s91 offen lds
  s_nop 0
  s_add_u32 m0, s90, 0x22800
  s_nop 0
  buffer_load_dwordx4 v252, s[24:27], s91 offen lds
  v_lshrrev_b32 v213, 2, v249
  v_lshlrev_b32 v214, 2, v250
  v_add_u32 v213, v213, v214
  v_lshrrev_b32 v214, 1, v213
  v_and_b32 v214, 3, v214
  v_mul_u32_u24 v213, 896, v213
  v_and_b32 v215, 3, v249
  v_lshlrev_b32 v215, 3, v215
  v_add_u32 v213, v213, v215
  s_mul_i32 s77, s58, 7
  v_xor_b32 v215, s77, v214
  v_lshlrev_b32 v215, 5, v215
  v_add_u32 v196, v213, v215
  v_add_u32 v203, 106496, v196
  s_add_u32 s77, s77, 1
  v_xor_b32 v215, s77, v214
  v_lshlrev_b32 v215, 5, v215
  v_add_u32 v197, v213, v215
  v_add_u32 v204, 106496, v197
  s_add_u32 s77, s77, 1
  v_xor_b32 v215, s77, v214
  v_lshlrev_b32 v215, 5, v215
  v_add_u32 v198, v213, v215
  v_add_u32 v205, 106496, v198
  s_add_u32 s77, s77, 1
  v_xor_b32 v215, s77, v214
  v_lshlrev_b32 v215, 5, v215
  v_add_u32 v199, v213, v215
  v_add_u32 v206, 106496, v199
  s_add_u32 s77, s77, 1
  v_xor_b32 v215, s77, v214
  v_lshlrev_b32 v215, 5, v215
  v_add_u32 v200, v213, v215
  v_add_u32 v207, 106496, v200
  s_add_u32 s77, s77, 1
  v_xor_b32 v215, s77, v214
  v_lshlrev_b32 v215, 5, v215
  v_add_u32 v201, v213, v215
  v_add_u32 v208, 106496, v201
  s_add_u32 s77, s77, 1
  v_xor_b32 v215, s77, v214
  v_lshlrev_b32 v215, 5, v215
  v_add_u32 v202, v213, v215
  v_add_u32 v209, 106496, v202
  s_add_u32 s77, s77, 1
  s_waitcnt vmcnt(21)
  s_barrier
  ds_read_b64_tr_b16 a[160:161], v196 offset:0
  ds_read_b64_tr_b16 a[162:163], v196 offset:14336
  ds_read_b64_tr_b16 a[164:165], v197 offset:0
  ds_read_b64_tr_b16 a[166:167], v197 offset:14336
  ds_read_b64_tr_b16 a[168:169], v198 offset:0
  ds_read_b64_tr_b16 a[170:171], v198 offset:14336
  ds_read_b64_tr_b16 a[172:173], v199 offset:0
  ds_read_b64_tr_b16 a[174:175], v199 offset:14336
  ds_read_b64_tr_b16 a[176:177], v200 offset:0
  ds_read_b64_tr_b16 a[178:179], v200 offset:14336
  ds_read_b64_tr_b16 a[180:181], v201 offset:0
  ds_read_b64_tr_b16 a[182:183], v201 offset:14336
  ds_read_b64_tr_b16 a[184:185], v202 offset:0
  ds_read_b64_tr_b16 a[186:187], v202 offset:14336
  s_waitcnt lgkmcnt(6)
  v_mfma_f32_16x16x32_bf16 v[0:3], a[160:163], a[0:3], 0
  v_mfma_f32_16x16x32_bf16 v[4:7], a[160:163], a[4:7], 0
  v_mfma_f32_16x16x32_bf16 v[8:11], a[160:163], a[8:11], 0
  v_mfma_f32_16x16x32_bf16 v[12:15], a[160:163], a[12:15], 0
  v_mfma_f32_16x16x32_bf16 v[16:19], a[160:163], a[16:19], 0
  v_mfma_f32_16x16x32_bf16 v[20:23], a[164:167], a[0:3], 0
  v_mfma_f32_16x16x32_bf16 v[24:27], a[164:167], a[4:7], 0
  v_mfma_f32_16x16x32_bf16 v[28:31], a[164:167], a[8:11], 0
  v_mfma_f32_16x16x32_bf16 v[32:35], a[164:167], a[12:15], 0
  v_mfma_f32_16x16x32_bf16 v[36:39], a[164:167], a[16:19], 0
  v_mfma_f32_16x16x32_bf16 v[40:43], a[168:171], a[0:3], 0
  v_mfma_f32_16x16x32_bf16 v[44:47], a[168:171], a[4:7], 0
  v_mfma_f32_16x16x32_bf16 v[48:51], a[168:171], a[8:11], 0
  v_mfma_f32_16x16x32_bf16 v[52:55], a[168:171], a[12:15], 0
  v_mfma_f32_16x16x32_bf16 v[56:59], a[168:171], a[16:19], 0
  v_mfma_f32_16x16x32_bf16 v[60:63], a[172:175], a[0:3], 0
  v_mfma_f32_16x16x32_bf16 v[64:67], a[172:175], a[4:7], 0
  v_mfma_f32_16x16x32_bf16 v[68:71], a[172:175], a[8:11], 0
  v_mfma_f32_16x16x32_bf16 v[72:75], a[172:175], a[12:15], 0
  v_mfma_f32_16x16x32_bf16 v[76:79], a[172:175], a[16:19], 0
  s_waitcnt lgkmcnt(0)
  s_waitcnt vmcnt(14)
  s_barrier
  v_mfma_f32_16x16x32_bf16 v[80:83], a[176:179], a[0:3], 0
  ds_read_b64_tr_b16 a[160:161], v196 offset:28672
  s_add_u32 s75, s65, 4
  s_and_b32 s75, s75, 7
  s_mul_i32 s75, s75, 28672
  v_mfma_f32_16x16x32_bf16 v[84:87], a[176:179], a[4:7], 0
  ds_read_b64_tr_b16 a[162:163], v196 offset:43008
  s_add_u32 s91, s75, s90
  v_mfma_f32_16x16x32_bf16 v[88:91], a[176:179], a[8:11], 0
  ds_read_b64_tr_b16 a[164:165], v197 offset:28672
  s_add_u32 m0, s90, 0x0
  v_mfma_f32_16x16x32_bf16 v[92:95], a[176:179], a[12:15], 0
  ds_read_b64_tr_b16 a[166:167], v197 offset:43008
  buffer_load_dwordx4 v155, s[24:27], s91 offen lds
  v_mfma_f32_16x16x32_bf16 v[96:99], a[176:179], a[16:19], 0
  ds_read_b64_tr_b16 a[168:169], v198 offset:28672
  s_add_u32 m0, s90, 0x400
  v_mfma_f32_16x16x32_bf16 v[100:103], a[180:183], a[0:3], 0
  ds_read_b64_tr_b16 a[170:171], v198 offset:43008
  buffer_load_dwordx4 v156, s[24:27], s91 offen lds
  v_mfma_f32_16x16x32_bf16 v[104:107], a[180:183], a[4:7], 0
  ds_read_b64_tr_b16 a[172:173], v199 offset:28672
  s_add_u32 m0, s90, 0x800
  v_mfma_f32_16x16x32_bf16 v[108:111], a[180:183], a[8:11], 0
  ds_read_b64_tr_b16 a[174:175], v199 offset:43008
  buffer_load_dwordx4 v157, s[24:27], s91 offen lds
  v_mfma_f32_16x16x32_bf16 v[112:115], a[180:183], a[12:15], 0
  ds_read_b64_tr_b16 a[188:189], v200 offset:28672
  s_add_u32 m0, s90, 0xc00
  v_mfma_f32_16x16x32_bf16 v[116:119], a[180:183], a[16:19], 0
  ds_read_b64_tr_b16 a[190:191], v200 offset:43008
  buffer_load_dwordx4 v158, s[24:27], s91 offen lds
  v_mfma_f32_16x16x32_bf16 v[120:123], a[184:187], a[0:3], 0
  ds_read_b64_tr_b16 a[192:193], v201 offset:28672
  s_add_u32 m0, s90, 0x1000
  v_mfma_f32_16x16x32_bf16 v[124:127], a[184:187], a[4:7], 0
  ds_read_b64_tr_b16 a[194:195], v201 offset:43008
  buffer_load_dwordx4 v159, s[24:27], s91 offen lds
  v_mfma_f32_16x16x32_bf16 v[128:131], a[184:187], a[8:11], 0
  ds_read_b64_tr_b16 a[196:197], v202 offset:28672
  s_add_u32 m0, s90, 0x1400
  v_mfma_f32_16x16x32_bf16 v[132:135], a[184:187], a[12:15], 0
  ds_read_b64_tr_b16 a[198:199], v202 offset:43008
  buffer_load_dwordx4 v251, s[24:27], s91 offen lds
  v_mfma_f32_16x16x32_bf16 v[136:139], a[184:187], a[16:19], 0
  s_waitcnt lgkmcnt(6)
  v_mfma_f32_16x16x32_bf16 v[0:3], a[160:163], a[20:23], v[0:3]
  s_add_u32 m0, s90, 0x1800
  v_mfma_f32_16x16x32_bf16 v[4:7], a[160:163], a[24:27], v[4:7]
  buffer_load_dwordx4 v252, s[24:27], s91 offen lds
  v_mfma_f32_16x16x32_bf16 v[8:11], a[160:163], a[28:31], v[8:11]
  s_add_u32 s76, s65, 0
  s_and_b32 s76, s76, 7
  v_mfma_f32_16x16x32_bf16 v[12:15], a[160:163], a[32:35], v[12:15]
  s_lshl_b32 s76, s76, 10
  s_add_u32 s76, s76, 65536
  v_mfma_f32_16x16x32_bf16 v[16:19], a[160:163], a[36:39], v[16:19]
  v_add_u32 v211, s76, v248
  ds_read_b128 a[0:3], v211 offset:0
  v_mfma_f32_16x16x32_bf16 v[20:23], a[164:167], a[20:23], v[20:23]
  ds_read_b128 a[4:7], v211 offset:8192
  ds_read_b128 a[8:11], v211 offset:16384
  v_mfma_f32_16x16x32_bf16 v[24:27], a[164:167], a[24:27], v[24:27]
  ds_read_b128 a[12:15], v211 offset:24576
  ds_read_b128 a[16:19], v211 offset:32768
  v_mfma_f32_16x16x32_bf16 v[28:31], a[164:167], a[28:31], v[28:31]
  v_mfma_f32_16x16x32_bf16 v[32:35], a[164:167], a[32:35], v[32:35]
  v_mfma_f32_16x16x32_bf16 v[36:39], a[164:167], a[36:39], v[36:39]
  v_mfma_f32_16x16x32_bf16 v[40:43], a[168:171], a[20:23], v[40:43]
  v_mfma_f32_16x16x32_bf16 v[44:47], a[168:171], a[24:27], v[44:47]
  v_mfma_f32_16x16x32_bf16 v[48:51], a[168:171], a[28:31], v[48:51]
  v_mfma_f32_16x16x32_bf16 v[52:55], a[168:171], a[32:35], v[52:55]
  v_mfma_f32_16x16x32_bf16 v[56:59], a[168:171], a[36:39], v[56:59]
  v_mfma_f32_16x16x32_bf16 v[60:63], a[172:175], a[20:23], v[60:63]
  v_mfma_f32_16x16x32_bf16 v[64:67], a[172:175], a[24:27], v[64:67]
  v_mfma_f32_16x16x32_bf16 v[68:71], a[172:175], a[28:31], v[68:71]
  v_mfma_f32_16x16x32_bf16 v[72:75], a[172:175], a[32:35], v[72:75]
  v_mfma_f32_16x16x32_bf16 v[76:79], a[172:175], a[36:39], v[76:79]
  s_waitcnt lgkmcnt(0)
  s_waitcnt vmcnt(14)
  s_barrier
  v_mfma_f32_16x16x32_bf16 v[80:83], a[188:191], a[20:23], v[80:83]
  ds_read_b64_tr_b16 a[160:161], v203 offset:0
  s_add_u32 s75, s65, 5
  s_and_b32 s75, s75, 7
  s_mul_i32 s75, s75, 28672
  v_mfma_f32_16x16x32_bf16 v[84:87], a[188:191], a[24:27], v[84:87]
  ds_read_b64_tr_b16 a[162:163], v203 offset:14336
  s_add_u32 s91, s75, s90
  v_mfma_f32_16x16x32_bf16 v[88:91], a[188:191], a[28:31], v[88:91]
  ds_read_b64_tr_b16 a[164:165], v204 offset:0
  s_add_u32 m0, s90, 0x7000
  v_mfma_f32_16x16x32_bf16 v[92:95], a[188:191], a[32:35], v[92:95]
  ds_read_b64_tr_b16 a[166:167], v204 offset:14336
  buffer_load_dwordx4 v155, s[24:27], s91 offen lds
  v_mfma_f32_16x16x32_bf16 v[96:99], a[188:191], a[36:39], v[96:99]
  ds_read_b64_tr_b16 a[168:169], v205 offset:0
  s_add_u32 m0, s90, 0x7400
  v_mfma_f32_16x16x32_bf16 v[100:103], a[192:195], a[20:23], v[100:103]
  ds_read_b64_tr_b16 a[170:171], v205 offset:14336
  buffer_load_dwordx4 v156, s[24:27], s91 offen lds
  v_mfma_f32_16x16x32_bf16 v[104:107], a[192:195], a[24:27], v[104:107]
  ds_read_b64_tr_b16 a[172:173], v206 offset:0
  s_add_u32 m0, s90, 0x7800
  v_mfma_f32_16x16x32_bf16 v[108:111], a[192:195], a[28:31], v[108:111]
  ds_read_b64_tr_b16 a[174:175], v206 offset:14336
  buffer_load_dwordx4 v157, s[24:27], s91 offen lds
  v_mfma_f32_16x16x32_bf16 v[112:115], a[192:195], a[32:35], v[112:115]
  ds_read_b64_tr_b16 a[176:177], v207 offset:0
  s_add_u32 m0, s90, 0x7c00
  v_mfma_f32_16x16x32_bf16 v[116:119], a[192:195], a[36:39], v[116:119]
  ds_read_b64_tr_b16 a[178:179], v207 offset:14336
  buffer_load_dwordx4 v158, s[24:27], s91 offen lds
  v_mfma_f32_16x16x32_bf16 v[120:123], a[196:199], a[20:23], v[120:123]
  ds_read_b64_tr_b16 a[180:181], v208 offset:0
  s_add_u32 m0, s90, 0x8000
  v_mfma_f32_16x16x32_bf16 v[124:127], a[196:199], a[24:27], v[124:127]
  ds_read_b64_tr_b16 a[182:183], v208 offset:14336
  buffer_load_dwordx4 v159, s[24:27], s91 offen lds
  v_mfma_f32_16x16x32_bf16 v[128:131], a[196:199], a[28:31], v[128:131]
  ds_read_b64_tr_b16 a[184:185], v209 offset:0
  s_add_u32 m0, s90, 0x8400
  v_mfma_f32_16x16x32_bf16 v[132:135], a[196:199], a[32:35], v[132:135]
  ds_read_b64_tr_b16 a[186:187], v209 offset:14336
  buffer_load_dwordx4 v251, s[24:27], s91 offen lds
  v_mfma_f32_16x16x32_bf16 v[136:139], a[196:199], a[36:39], v[136:139]
  s_waitcnt lgkmcnt(6)
  v_mfma_f32_16x16x32_bf16 v[0:3], a[160:163], a[40:43], v[0:3]
  s_add_u32 m0, s90, 0x8800
  v_mfma_f32_16x16x32_bf16 v[4:7], a[160:163], a[44:47], v[4:7]
  buffer_load_dwordx4 v252, s[24:27], s91 offen lds
  v_mfma_f32_16x16x32_bf16 v[8:11], a[160:163], a[48:51], v[8:11]
  s_add_u32 s76, s65, 1
  s_and_b32 s76, s76, 7
  v_mfma_f32_16x16x32_bf16 v[12:15], a[160:163], a[52:55], v[12:15]
  s_lshl_b32 s76, s76, 10
  s_add_u32 s76, s76, 65536
  v_mfma_f32_16x16x32_bf16 v[16:19], a[160:163], a[56:59], v[16:19]
  v_add_u32 v212, s76, v248
  ds_read_b128 a[20:23], v212 offset:0
  v_mfma_f32_16x16x32_bf16 v[20:23], a[164:167], a[40:43], v[20:23]
  ds_read_b128 a[24:27], v212 offset:8192
  ds_read_b128 a[28:31], v212 offset:16384
  v_mfma_f32_16x16x32_bf16 v[24:27], a[164:167], a[44:47], v[24:27]
  ds_read_b128 a[32:35], v212 offset:24576
  ds_read_b128 a[36:39], v212 offset:32768
  v_mfma_f32_16x16x32_bf16 v[28:31], a[164:167], a[48:51], v[28:31]
  v_mfma_f32_16x16x32_bf16 v[32:35], a[164:167], a[52:55], v[32:35]
  v_mfma_f32_16x16x32_bf16 v[36:39], a[164:167], a[56:59], v[36:39]
  v_mfma_f32_16x16x32_bf16 v[40:43], a[168:171], a[40:43], v[40:43]
  v_mfma_f32_16x16x32_bf16 v[44:47], a[168:171], a[44:47], v[44:47]
  v_mfma_f32_16x16x32_bf16 v[48:51], a[168:171], a[48:51], v[48:51]
  v_mfma_f32_16x16x32_bf16 v[52:55], a[168:171], a[52:55], v[52:55]
  v_mfma_f32_16x16x32_bf16 v[56:59], a[168:171], a[56:59], v[56:59]
  v_mfma_f32_16x16x32_bf16 v[60:63], a[172:175], a[40:43], v[60:63]
  v_mfma_f32_16x16x32_bf16 v[64:67], a[172:175], a[44:47], v[64:67]
  v_mfma_f32_16x16x32_bf16 v[68:71], a[172:175], a[48:51], v[68:71]
  v_mfma_f32_16x16x32_bf16 v[72:75], a[172:175], a[52:55], v[72:75]
  v_mfma_f32_16x16x32_bf16 v[76:79], a[172:175], a[56:59], v[76:79]
  s_waitcnt lgkmcnt(0)
  s_waitcnt vmcnt(14)
  s_barrier
  v_mfma_f32_16x16x32_bf16 v[80:83], a[176:179], a[40:43], v[80:83]
  ds_read_b64_tr_b16 a[160:161], v203 offset:28672
  s_add_u32 s75, s65, 6
  s_and_b32 s75, s75, 7
  s_mul_i32 s75, s75, 28672
  v_mfma_f32_16x16x32_bf16 v[84:87], a[176:179], a[44:47], v[84:87]
  ds_read_b64_tr_b16 a[162:163], v203 offset:43008
  s_add_u32 s91, s75, s90
  v_mfma_f32_16x16x32_bf16 v[88:91], a[176:179], a[48:51], v[88:91]
  ds_read_b64_tr_b16 a[164:165], v204 offset:28672
  s_add_u32 m0, s90, 0x1a000
  v_mfma_f32_16x16x32_bf16 v[92:95], a[176:179], a[52:55], v[92:95]
  ds_read_b64_tr_b16 a[166:167], v204 offset:43008
  buffer_load_dwordx4 v155, s[24:27], s91 offen lds
  v_mfma_f32_16x16x32_bf16 v[96:99], a[176:179], a[56:59], v[96:99]
  ds_read_b64_tr_b16 a[168:169], v205 offset:28672
  s_add_u32 m0, s90, 0x1a400
  v_mfma_f32_16x16x32_bf16 v[100:103], a[180:183], a[40:43], v[100:103]
  ds_read_b64_tr_b16 a[170:171], v205 offset:43008
  buffer_load_dwordx4 v156, s[24:27], s91 offen lds
  v_mfma_f32_16x16x32_bf16 v[104:107], a[180:183], a[44:47], v[104:107]
  ds_read_b64_tr_b16 a[172:173], v206 offset:28672
  s_add_u32 m0, s90, 0x1a800
  v_mfma_f32_16x16x32_bf16 v[108:111], a[180:183], a[48:51], v[108:111]
  ds_read_b64_tr_b16 a[174:175], v206 offset:43008
  buffer_load_dwordx4 v157, s[24:27], s91 offen lds
  v_mfma_f32_16x16x32_bf16 v[112:115], a[180:183], a[52:55], v[112:115]
  ds_read_b64_tr_b16 a[188:189], v207 offset:28672
  s_add_u32 m0, s90, 0x1ac00
  v_mfma_f32_16x16x32_bf16 v[116:119], a[180:183], a[56:59], v[116:119]
  ds_read_b64_tr_b16 a[190:191], v207 offset:43008
  buffer_load_dwordx4 v158, s[24:27], s91 offen lds
  v_mfma_f32_16x16x32_bf16 v[120:123], a[184:187], a[40:43], v[120:123]
  ds_read_b64_tr_b16 a[192:193], v208 offset:28672
  s_add_u32 m0, s90, 0x1b000
  v_mfma_f32_16x16x32_bf16 v[124:127], a[184:187], a[44:47], v[124:127]
  ds_read_b64_tr_b16 a[194:195], v208 offset:43008
  buffer_load_dwordx4 v159, s[24:27], s91 offen lds
  v_mfma_f32_16x16x32_bf16 v[128:131], a[184:187], a[48:51], v[128:131]
  ds_read_b64_tr_b16 a[196:197], v209 offset:28672
  s_add_u32 m0, s90, 0x1b400
  v_mfma_f32_16x16x32_bf16 v[132:135], a[184:187], a[52:55], v[132:135]
  ds_read_b64_tr_b16 a[198:199], v209 offset:43008
  buffer_load_dwordx4 v251, s[24:27], s91 offen lds
  v_mfma_f32_16x16x32_bf16 v[136:139], a[184:187], a[56:59], v[136:139]
  s_waitcnt lgkmcnt(6)
  v_mfma_f32_16x16x32_bf16 v[0:3], a[160:163], a[60:63], v[0:3]
  s_add_u32 m0, s90, 0x1b800
  v_mfma_f32_16x16x32_bf16 v[4:7], a[160:163], a[64:67], v[4:7]
  buffer_load_dwordx4 v252, s[24:27], s91 offen lds
  v_mfma_f32_16x16x32_bf16 v[8:11], a[160:163], a[68:71], v[8:11]
  s_add_u32 s76, s65, 2
  s_and_b32 s76, s76, 7
  v_mfma_f32_16x16x32_bf16 v[12:15], a[160:163], a[72:75], v[12:15]
  s_lshl_b32 s76, s76, 10
  s_add_u32 s76, s76, 65536
  v_mfma_f32_16x16x32_bf16 v[16:19], a[160:163], a[76:79], v[16:19]
  v_add_u32 v211, s76, v248
  ds_read_b128 a[40:43], v211 offset:0
  v_mfma_f32_16x16x32_bf16 v[20:23], a[164:167], a[60:63], v[20:23]
  ds_read_b128 a[44:47], v211 offset:8192
  ds_read_b128 a[48:51], v211 offset:16384
  v_mfma_f32_16x16x32_bf16 v[24:27], a[164:167], a[64:67], v[24:27]
  ds_read_b128 a[52:55], v211 offset:24576
  ds_read_b128 a[56:59], v211 offset:32768
  v_mfma_f32_16x16x32_bf16 v[28:31], a[164:167], a[68:71], v[28:31]
  v_mfma_f32_16x16x32_bf16 v[32:35], a[164:167], a[72:75], v[32:35]
  v_mfma_f32_16x16x32_bf16 v[36:39], a[164:167], a[76:79], v[36:39]
  v_mfma_f32_16x16x32_bf16 v[40:43], a[168:171], a[60:63], v[40:43]
  v_mfma_f32_16x16x32_bf16 v[44:47], a[168:171], a[64:67], v[44:47]
  v_mfma_f32_16x16x32_bf16 v[48:51], a[168:171], a[68:71], v[48:51]
  v_mfma_f32_16x16x32_bf16 v[52:55], a[168:171], a[72:75], v[52:55]
  v_mfma_f32_16x16x32_bf16 v[56:59], a[168:171], a[76:79], v[56:59]
  v_mfma_f32_16x16x32_bf16 v[60:63], a[172:175], a[60:63], v[60:63]
  v_mfma_f32_16x16x32_bf16 v[64:67], a[172:175], a[64:67], v[64:67]
  v_mfma_f32_16x16x32_bf16 v[68:71], a[172:175], a[68:71], v[68:71]
  v_mfma_f32_16x16x32_bf16 v[72:75], a[172:175], a[72:75], v[72:75]
  v_mfma_f32_16x16x32_bf16 v[76:79], a[172:175], a[76:79], v[76:79]
  s_waitcnt lgkmcnt(0)
  s_waitcnt vmcnt(14)
  s_barrier
  v_mfma_f32_16x16x32_bf16 v[80:83], a[188:191], a[60:63], v[80:83]
  ds_read_b64_tr_b16 a[160:161], v196 offset:0
  s_add_u32 s75, s65, 7
  s_and_b32 s75, s75, 7
  s_mul_i32 s75, s75, 28672
  v_mfma_f32_16x16x32_bf16 v[84:87], a[188:191], a[64:67], v[84:87]
  ds_read_b64_tr_b16 a[162:163], v196 offset:14336
  s_add_u32 s91, s75, s90
  v_mfma_f32_16x16x32_bf16 v[88:91], a[188:191], a[68:71], v[88:91]
  ds_read_b64_tr_b16 a[164:165], v197 offset:0
  s_add_u32 m0, s90, 0x21000
  v_mfma_f32_16x16x32_bf16 v[92:95], a[188:191], a[72:75], v[92:95]
  ds_read_b64_tr_b16 a[166:167], v197 offset:14336
  buffer_load_dwordx4 v155, s[24:27], s91 offen lds
  v_mfma_f32_16x16x32_bf16 v[96:99], a[188:191], a[76:79], v[96:99]
  ds_read_b64_tr_b16 a[168:169], v198 offset:0
  s_add_u32 m0, s90, 0x21400
  v_mfma_f32_16x16x32_bf16 v[100:103], a[192:195], a[60:63], v[100:103]
  ds_read_b64_tr_b16 a[170:171], v198 offset:14336
  buffer_load_dwordx4 v156, s[24:27], s91 offen lds
  v_mfma_f32_16x16x32_bf16 v[104:107], a[192:195], a[64:67], v[104:107]
  ds_read_b64_tr_b16 a[172:173], v199 offset:0
  s_add_u32 m0, s90, 0x21800
  v_mfma_f32_16x16x32_bf16 v[108:111], a[192:195], a[68:71], v[108:111]
  ds_read_b64_tr_b16 a[174:175], v199 offset:14336
  buffer_load_dwordx4 v157, s[24:27], s91 offen lds
  v_mfma_f32_16x16x32_bf16 v[112:115], a[192:195], a[72:75], v[112:115]
  ds_read_b64_tr_b16 a[176:177], v200 offset:0
  s_add_u32 m0, s90, 0x21c00
  v_mfma_f32_16x16x32_bf16 v[116:119], a[192:195], a[76:79], v[116:119]
  ds_read_b64_tr_b16 a[178:179], v200 offset:14336
  buffer_load_dwordx4 v158, s[24:27], s91 offen lds
  v_mfma_f32_16x16x32_bf16 v[120:123], a[196:199], a[60:63], v[120:123]
  ds_read_b64_tr_b16 a[180:181], v201 offset:0
  s_add_u32 m0, s90, 0x22000
  v_mfma_f32_16x16x32_bf16 v[124:127], a[196:199], a[64:67], v[124:127]
  ds_read_b64_tr_b16 a[182:183], v201 offset:14336
  buffer_load_dwordx4 v159, s[24:27], s91 offen lds
  v_mfma_f32_16x16x32_bf16 v[128:131], a[196:199], a[68:71], v[128:131]
  ds_read_b64_tr_b16 a[184:185], v202 offset:0
  s_add_u32 m0, s90, 0x22400
  v_mfma_f32_16x16x32_bf16 v[132:135], a[196:199], a[72:75], v[132:135]
  ds_read_b64_tr_b16 a[186:187], v202 offset:14336
  buffer_load_dwordx4 v251, s[24:27], s91 offen lds
  v_mfma_f32_16x16x32_bf16 v[136:139], a[196:199], a[76:79], v[136:139]
  s_waitcnt lgkmcnt(6)
  v_mfma_f32_16x16x32_bf16 v[0:3], a[160:163], a[80:83], v[0:3]
  s_add_u32 m0, s90, 0x22800
  v_mfma_f32_16x16x32_bf16 v[4:7], a[160:163], a[84:87], v[4:7]
  buffer_load_dwordx4 v252, s[24:27], s91 offen lds
  v_mfma_f32_16x16x32_bf16 v[8:11], a[160:163], a[88:91], v[8:11]
  s_add_u32 s76, s65, 3
  s_and_b32 s76, s76, 7
  v_mfma_f32_16x16x32_bf16 v[12:15], a[160:163], a[92:95], v[12:15]
  s_lshl_b32 s76, s76, 10
  s_add_u32 s76, s76, 65536
  v_mfma_f32_16x16x32_bf16 v[16:19], a[160:163], a[96:99], v[16:19]
  v_add_u32 v212, s76, v248
  ds_read_b128 a[60:63], v212 offset:0
  v_mfma_f32_16x16x32_bf16 v[20:23], a[164:167], a[80:83], v[20:23]
  ds_read_b128 a[64:67], v212 offset:8192
  ds_read_b128 a[68:71], v212 offset:16384
  v_mfma_f32_16x16x32_bf16 v[24:27], a[164:167], a[84:87], v[24:27]
  ds_read_b128 a[72:75], v212 offset:24576
  ds_read_b128 a[76:79], v212 offset:32768
  v_mfma_f32_16x16x32_bf16 v[28:31], a[164:167], a[88:91], v[28:31]
  v_mfma_f32_16x16x32_bf16 v[32:35], a[164:167], a[92:95], v[32:35]
  v_mfma_f32_16x16x32_bf16 v[36:39], a[164:167], a[96:99], v[36:39]
  v_mfma_f32_16x16x32_bf16 v[40:43], a[168:171], a[80:83], v[40:43]
  v_mfma_f32_16x16x32_bf16 v[44:47], a[168:171], a[84:87], v[44:47]
  v_mfma_f32_16x16x32_bf16 v[48:51], a[168:171], a[88:91], v[48:51]
  v_mfma_f32_16x16x32_bf16 v[52:55], a[168:171], a[92:95], v[52:55]
  v_mfma_f32_16x16x32_bf16 v[56:59], a[168:171], a[96:99], v[56:59]
  v_mfma_f32_16x16x32_bf16 v[60:63], a[172:175], a[80:83], v[60:63]
  v_mfma_f32_16x16x32_bf16 v[64:67], a[172:175], a[84:87], v[64:67]
  v_mfma_f32_16x16x32_bf16 v[68:71], a[172:175], a[88:91], v[68:71]
  v_mfma_f32_16x16x32_bf16 v[72:75], a[172:175], a[92:95], v[72:75]
  v_mfma_f32_16x16x32_bf16 v[76:79], a[172:175], a[96:99], v[76:79]
  s_waitcnt lgkmcnt(0)
  s_waitcnt vmcnt(14)
  s_barrier
  v_mfma_f32_16x16x32_bf16 v[80:83], a[176:179], a[80:83], v[80:83]
  ds_read_b64_tr_b16 a[160:161], v196 offset:28672
  s_add_u32 s75, s65, 0
  s_and_b32 s75, s75, 7
  s_add_u32 s75, s75, 8
  v_mfma_f32_16x16x32_bf16 v[84:87], a[176:179], a[84:87], v[84:87]
  ds_read_b64_tr_b16 a[162:163], v196 offset:43008
  s_mul_i32 s75, s75, 28672
  s_add_u32 s91, s75, s90
  v_mfma_f32_16x16x32_bf16 v[88:91], a[176:179], a[88:91], v[88:91]
  ds_read_b64_tr_b16 a[164:165], v197 offset:28672
  s_add_u32 m0, s90, 0x0
  v_mfma_f32_16x16x32_bf16 v[92:95], a[176:179], a[92:95], v[92:95]
  ds_read_b64_tr_b16 a[166:167], v197 offset:43008
  buffer_load_dwordx4 v155, s[24:27], s91 offen lds
  v_mfma_f32_16x16x32_bf16 v[96:99], a[176:179], a[96:99], v[96:99]
  ds_read_b64_tr_b16 a[168:169], v198 offset:28672
  s_add_u32 m0, s90, 0x400
  v_mfma_f32_16x16x32_bf16 v[100:103], a[180:183], a[80:83], v[100:103]
  ds_read_b64_tr_b16 a[170:171], v198 offset:43008
  buffer_load_dwordx4 v156, s[24:27], s91 offen lds
  v_mfma_f32_16x16x32_bf16 v[104:107], a[180:183], a[84:87], v[104:107]
  ds_read_b64_tr_b16 a[172:173], v199 offset:28672
  s_add_u32 m0, s90, 0x800
  v_mfma_f32_16x16x32_bf16 v[108:111], a[180:183], a[88:91], v[108:111]
  ds_read_b64_tr_b16 a[174:175], v199 offset:43008
  buffer_load_dwordx4 v157, s[24:27], s91 offen lds
  v_mfma_f32_16x16x32_bf16 v[112:115], a[180:183], a[92:95], v[112:115]
  ds_read_b64_tr_b16 a[188:189], v200 offset:28672
  s_add_u32 m0, s90, 0xc00
  v_mfma_f32_16x16x32_bf16 v[116:119], a[180:183], a[96:99], v[116:119]
  ds_read_b64_tr_b16 a[190:191], v200 offset:43008
  buffer_load_dwordx4 v158, s[24:27], s91 offen lds
  v_mfma_f32_16x16x32_bf16 v[120:123], a[184:187], a[80:83], v[120:123]
  ds_read_b64_tr_b16 a[192:193], v201 offset:28672
  s_add_u32 m0, s90, 0x1000
  v_mfma_f32_16x16x32_bf16 v[124:127], a[184:187], a[84:87], v[124:127]
  ds_read_b64_tr_b16 a[194:195], v201 offset:43008
  buffer_load_dwordx4 v159, s[24:27], s91 offen lds
  v_mfma_f32_16x16x32_bf16 v[128:131], a[184:187], a[88:91], v[128:131]
  ds_read_b64_tr_b16 a[196:197], v202 offset:28672
  s_add_u32 m0, s90, 0x1400
  v_mfma_f32_16x16x32_bf16 v[132:135], a[184:187], a[92:95], v[132:135]
  ds_read_b64_tr_b16 a[198:199], v202 offset:43008
  buffer_load_dwordx4 v251, s[24:27], s91 offen lds
  v_mfma_f32_16x16x32_bf16 v[136:139], a[184:187], a[96:99], v[136:139]
  s_waitcnt lgkmcnt(6)
  v_mfma_f32_16x16x32_bf16 v[0:3], a[160:163], a[100:103], v[0:3]
  s_add_u32 m0, s90, 0x1800
  v_mfma_f32_16x16x32_bf16 v[4:7], a[160:163], a[104:107], v[4:7]
  buffer_load_dwordx4 v252, s[24:27], s91 offen lds
  v_mfma_f32_16x16x32_bf16 v[8:11], a[160:163], a[108:111], v[8:11]
  s_add_u32 s76, s65, 4
  s_and_b32 s76, s76, 7
  v_mfma_f32_16x16x32_bf16 v[12:15], a[160:163], a[112:115], v[12:15]
  s_lshl_b32 s76, s76, 10
  s_add_u32 s76, s76, 65536
  v_mfma_f32_16x16x32_bf16 v[16:19], a[160:163], a[116:119], v[16:19]
  v_add_u32 v211, s76, v248
  ds_read_b128 a[80:83], v211 offset:0
  v_mfma_f32_16x16x32_bf16 v[20:23], a[164:167], a[100:103], v[20:23]
  ds_read_b128 a[84:87], v211 offset:8192
  ds_read_b128 a[88:91], v211 offset:16384
  v_mfma_f32_16x16x32_bf16 v[24:27], a[164:167], a[104:107], v[24:27]
  ds_read_b128 a[92:95], v211 offset:24576
  ds_read_b128 a[96:99], v211 offset:32768
  v_mfma_f32_16x16x32_bf16 v[28:31], a[164:167], a[108:111], v[28:31]
  v_mfma_f32_16x16x32_bf16 v[32:35], a[164:167], a[112:115], v[32:35]
  v_mfma_f32_16x16x32_bf16 v[36:39], a[164:167], a[116:119], v[36:39]
  v_mfma_f32_16x16x32_bf16 v[40:43], a[168:171], a[100:103], v[40:43]
  v_mfma_f32_16x16x32_bf16 v[44:47], a[168:171], a[104:107], v[44:47]
  v_mfma_f32_16x16x32_bf16 v[48:51], a[168:171], a[108:111], v[48:51]
  v_mfma_f32_16x16x32_bf16 v[52:55], a[168:171], a[112:115], v[52:55]
  v_mfma_f32_16x16x32_bf16 v[56:59], a[168:171], a[116:119], v[56:59]
  v_mfma_f32_16x16x32_bf16 v[60:63], a[172:175], a[100:103], v[60:63]
  v_mfma_f32_16x16x32_bf16 v[64:67], a[172:175], a[104:107], v[64:67]
  v_mfma_f32_16x16x32_bf16 v[68:71], a[172:175], a[108:111], v[68:71]
  v_mfma_f32_16x16x32_bf16 v[72:75], a[172:175], a[112:115], v[72:75]
  v_mfma_f32_16x16x32_bf16 v[76:79], a[172:175], a[116:119], v[76:79]
  s_waitcnt lgkmcnt(0)
  s_waitcnt vmcnt(14)
  s_barrier
  v_mfma_f32_16x16x32_bf16 v[80:83], a[188:191], a[100:103], v[80:83]
  ds_read_b64_tr_b16 a[160:161], v203 offset:0
  s_add_u32 s75, s65, 1
  s_and_b32 s75, s75, 7
  s_add_u32 s75, s75, 8
  v_mfma_f32_16x16x32_bf16 v[84:87], a[188:191], a[104:107], v[84:87]
  ds_read_b64_tr_b16 a[162:163], v203 offset:14336
  s_mul_i32 s75, s75, 28672
  s_add_u32 s91, s75, s90
  v_mfma_f32_16x16x32_bf16 v[88:91], a[188:191], a[108:111], v[88:91]
  ds_read_b64_tr_b16 a[164:165], v204 offset:0
  s_add_u32 m0, s90, 0x7000
  v_mfma_f32_16x16x32_bf16 v[92:95], a[188:191], a[112:115], v[92:95]
  ds_read_b64_tr_b16 a[166:167], v204 offset:14336
  buffer_load_dwordx4 v155, s[24:27], s91 offen lds
  v_mfma_f32_16x16x32_bf16 v[96:99], a[188:191], a[116:119], v[96:99]
  ds_read_b64_tr_b16 a[168:169], v205 offset:0
  s_add_u32 m0, s90, 0x7400
  v_mfma_f32_16x16x32_bf16 v[100:103], a[192:195], a[100:103], v[100:103]
  ds_read_b64_tr_b16 a[170:171], v205 offset:14336
  buffer_load_dwordx4 v156, s[24:27], s91 offen lds
  v_mfma_f32_16x16x32_bf16 v[104:107], a[192:195], a[104:107], v[104:107]
  ds_read_b64_tr_b16 a[172:173], v206 offset:0
  s_add_u32 m0, s90, 0x7800
  v_mfma_f32_16x16x32_bf16 v[108:111], a[192:195], a[108:111], v[108:111]
  ds_read_b64_tr_b16 a[174:175], v206 offset:14336
  buffer_load_dwordx4 v157, s[24:27], s91 offen lds
  v_mfma_f32_16x16x32_bf16 v[112:115], a[192:195], a[112:115], v[112:115]
  ds_read_b64_tr_b16 a[176:177], v207 offset:0
  s_add_u32 m0, s90, 0x7c00
  v_mfma_f32_16x16x32_bf16 v[116:119], a[192:195], a[116:119], v[116:119]
  ds_read_b64_tr_b16 a[178:179], v207 offset:14336
  buffer_load_dwordx4 v158, s[24:27], s91 offen lds
  v_mfma_f32_16x16x32_bf16 v[120:123], a[196:199], a[100:103], v[120:123]
  ds_read_b64_tr_b16 a[180:181], v208 offset:0
  s_add_u32 m0, s90, 0x8000
  v_mfma_f32_16x16x32_bf16 v[124:127], a[196:199], a[104:107], v[124:127]
  ds_read_b64_tr_b16 a[182:183], v208 offset:14336
  buffer_load_dwordx4 v159, s[24:27], s91 offen lds
  v_mfma_f32_16x16x32_bf16 v[128:131], a[196:199], a[108:111], v[128:131]
  ds_read_b64_tr_b16 a[184:185], v209 offset:0
  s_add_u32 m0, s90, 0x8400
  v_mfma_f32_16x16x32_bf16 v[132:135], a[196:199], a[112:115], v[132:135]
  ds_read_b64_tr_b16 a[186:187], v209 offset:14336
  buffer_load_dwordx4 v251, s[24:27], s91 offen lds
  v_mfma_f32_16x16x32_bf16 v[136:139], a[196:199], a[116:119], v[136:139]
  s_waitcnt lgkmcnt(6)
  v_mfma_f32_16x16x32_bf16 v[0:3], a[160:163], a[120:123], v[0:3]
  s_add_u32 m0, s90, 0x8800
  v_mfma_f32_16x16x32_bf16 v[4:7], a[160:163], a[124:127], v[4:7]
  buffer_load_dwordx4 v252, s[24:27], s91 offen lds
  v_mfma_f32_16x16x32_bf16 v[8:11], a[160:163], a[128:131], v[8:11]
  s_add_u32 s76, s65, 5
  s_and_b32 s76, s76, 7
  v_mfma_f32_16x16x32_bf16 v[12:15], a[160:163], a[132:135], v[12:15]
  s_lshl_b32 s76, s76, 10
  s_add_u32 s76, s76, 65536
  v_mfma_f32_16x16x32_bf16 v[16:19], a[160:163], a[136:139], v[16:19]
  v_add_u32 v212, s76, v248
  ds_read_b128 a[100:103], v212 offset:0
  v_mfma_f32_16x16x32_bf16 v[20:23], a[164:167], a[120:123], v[20:23]
  ds_read_b128 a[104:107], v212 offset:8192
  ds_read_b128 a[108:111], v212 offset:16384
  v_mfma_f32_16x16x32_bf16 v[24:27], a[164:167], a[124:127], v[24:27]
  ds_read_b128 a[112:115], v212 offset:24576
  ds_read_b128 a[116:119], v212 offset:32768
  v_mfma_f32_16x16x32_bf16 v[28:31], a[164:167], a[128:131], v[28:31]
  v_mfma_f32_16x16x32_bf16 v[32:35], a[164:167], a[132:135], v[32:35]
  v_mfma_f32_16x16x32_bf16 v[36:39], a[164:167], a[136:139], v[36:39]
  v_mfma_f32_16x16x32_bf16 v[40:43], a[168:171], a[120:123], v[40:43]
  v_mfma_f32_16x16x32_bf16 v[44:47], a[168:171], a[124:127], v[44:47]
  v_mfma_f32_16x16x32_bf16 v[48:51], a[168:171], a[128:131], v[48:51]
  v_mfma_f32_16x16x32_bf16 v[52:55], a[168:171], a[132:135], v[52:55]
  v_mfma_f32_16x16x32_bf16 v[56:59], a[168:171], a[136:139], v[56:59]
  v_mfma_f32_16x16x32_bf16 v[60:63], a[172:175], a[120:123], v[60:63]
  v_mfma_f32_16x16x32_bf16 v[64:67], a[172:175], a[124:127], v[64:67]
  v_mfma_f32_16x16x32_bf16 v[68:71], a[172:175], a[128:131], v[68:71]
  v_mfma_f32_16x16x32_bf16 v[72:75], a[172:175], a[132:135], v[72:75]
  v_mfma_f32_16x16x32_bf16 v[76:79], a[172:175], a[136:139], v[76:79]
  s_waitcnt lgkmcnt(0)
  s_waitcnt vmcnt(14)
  s_barrier
  v_mfma_f32_16x16x32_bf16 v[80:83], a[176:179], a[120:123], v[80:83]
  ds_read_b64_tr_b16 a[160:161], v203 offset:28672
  s_add_u32 s75, s65, 2
  s_and_b32 s75, s75, 7
  s_add_u32 s75, s75, 8
  v_mfma_f32_16x16x32_bf16 v[84:87], a[176:179], a[124:127], v[84:87]
  ds_read_b64_tr_b16 a[162:163], v203 offset:43008
  s_mul_i32 s75, s75, 28672
  s_add_u32 s91, s75, s90
  v_mfma_f32_16x16x32_bf16 v[88:91], a[176:179], a[128:131], v[88:91]
  ds_read_b64_tr_b16 a[164:165], v204 offset:28672
  s_add_u32 m0, s90, 0x1a000
  v_mfma_f32_16x16x32_bf16 v[92:95], a[176:179], a[132:135], v[92:95]
  ds_read_b64_tr_b16 a[166:167], v204 offset:43008
  buffer_load_dwordx4 v155, s[24:27], s91 offen lds
  v_mfma_f32_16x16x32_bf16 v[96:99], a[176:179], a[136:139], v[96:99]
  ds_read_b64_tr_b16 a[168:169], v205 offset:28672
  s_add_u32 m0, s90, 0x1a400
  v_mfma_f32_16x16x32_bf16 v[100:103], a[180:183], a[120:123], v[100:103]
  ds_read_b64_tr_b16 a[170:171], v205 offset:43008
  buffer_load_dwordx4 v156, s[24:27], s91 offen lds
  v_mfma_f32_16x16x32_bf16 v[104:107], a[180:183], a[124:127], v[104:107]
  ds_read_b64_tr_b16 a[172:173], v206 offset:28672
  s_add_u32 m0, s90, 0x1a800
  v_mfma_f32_16x16x32_bf16 v[108:111], a[180:183], a[128:131], v[108:111]
  ds_read_b64_tr_b16 a[174:175], v206 offset:43008
  buffer_load_dwordx4 v157, s[24:27], s91 offen lds
  v_mfma_f32_16x16x32_bf16 v[112:115], a[180:183], a[132:135], v[112:115]
  ds_read_b64_tr_b16 a[188:189], v207 offset:28672
  s_add_u32 m0, s90, 0x1ac00
  v_mfma_f32_16x16x32_bf16 v[116:119], a[180:183], a[136:139], v[116:119]
  ds_read_b64_tr_b16 a[190:191], v207 offset:43008
  buffer_load_dwordx4 v158, s[24:27], s91 offen lds
  v_mfma_f32_16x16x32_bf16 v[120:123], a[184:187], a[120:123], v[120:123]
  ds_read_b64_tr_b16 a[192:193], v208 offset:28672
  s_add_u32 m0, s90, 0x1b000
  v_mfma_f32_16x16x32_bf16 v[124:127], a[184:187], a[124:127], v[124:127]
  ds_read_b64_tr_b16 a[194:195], v208 offset:43008
  buffer_load_dwordx4 v159, s[24:27], s91 offen lds
  v_mfma_f32_16x16x32_bf16 v[128:131], a[184:187], a[128:131], v[128:131]
  ds_read_b64_tr_b16 a[196:197], v209 offset:28672
  s_add_u32 m0, s90, 0x1b400
  v_mfma_f32_16x16x32_bf16 v[132:135], a[184:187], a[132:135], v[132:135]
  ds_read_b64_tr_b16 a[198:199], v209 offset:43008
  buffer_load_dwordx4 v251, s[24:27], s91 offen lds
  v_mfma_f32_16x16x32_bf16 v[136:139], a[184:187], a[136:139], v[136:139]
  s_waitcnt lgkmcnt(6)
  v_mfma_f32_16x16x32_bf16 v[0:3], a[160:163], a[140:143], v[0:3]
  s_add_u32 m0, s90, 0x1b800
  v_mfma_f32_16x16x32_bf16 v[4:7], a[160:163], a[144:147], v[4:7]
  buffer_load_dwordx4 v252, s[24:27], s91 offen lds
  v_mfma_f32_16x16x32_bf16 v[8:11], a[160:163], a[148:151], v[8:11]
  s_add_u32 s76, s65, 6
  s_and_b32 s76, s76, 7
  v_mfma_f32_16x16x32_bf16 v[12:15], a[160:163], a[152:155], v[12:15]
  s_lshl_b32 s76, s76, 10
  s_add_u32 s76, s76, 65536
  v_mfma_f32_16x16x32_bf16 v[16:19], a[160:163], a[156:159], v[16:19]
  v_add_u32 v211, s76, v248
  ds_read_b128 a[120:123], v211 offset:0
  v_mfma_f32_16x16x32_bf16 v[20:23], a[164:167], a[140:143], v[20:23]
  ds_read_b128 a[124:127], v211 offset:8192
  ds_read_b128 a[128:131], v211 offset:16384
  v_mfma_f32_16x16x32_bf16 v[24:27], a[164:167], a[144:147], v[24:27]
  ds_read_b128 a[132:135], v211 offset:24576
  ds_read_b128 a[136:139], v211 offset:32768
  v_mfma_f32_16x16x32_bf16 v[28:31], a[164:167], a[148:151], v[28:31]
  v_mfma_f32_16x16x32_bf16 v[32:35], a[164:167], a[152:155], v[32:35]
  v_mfma_f32_16x16x32_bf16 v[36:39], a[164:167], a[156:159], v[36:39]
  v_mfma_f32_16x16x32_bf16 v[40:43], a[168:171], a[140:143], v[40:43]
  v_mfma_f32_16x16x32_bf16 v[44:47], a[168:171], a[144:147], v[44:47]
  v_mfma_f32_16x16x32_bf16 v[48:51], a[168:171], a[148:151], v[48:51]
  v_mfma_f32_16x16x32_bf16 v[52:55], a[168:171], a[152:155], v[52:55]
  v_mfma_f32_16x16x32_bf16 v[56:59], a[168:171], a[156:159], v[56:59]
  v_mfma_f32_16x16x32_bf16 v[60:63], a[172:175], a[140:143], v[60:63]
  v_mfma_f32_16x16x32_bf16 v[64:67], a[172:175], a[144:147], v[64:67]
  v_mfma_f32_16x16x32_bf16 v[68:71], a[172:175], a[148:151], v[68:71]
  v_mfma_f32_16x16x32_bf16 v[72:75], a[172:175], a[152:155], v[72:75]
  v_mfma_f32_16x16x32_bf16 v[76:79], a[172:175], a[156:159], v[76:79]
  s_waitcnt lgkmcnt(0)
  s_waitcnt vmcnt(14)
  s_barrier
  v_mfma_f32_16x16x32_bf16 v[80:83], a[188:191], a[140:143], v[80:83]
  ds_read_b64_tr_b16 a[160:161], v196 offset:0
  s_add_u32 s75, s65, 3
  s_and_b32 s75, s75, 7
  s_add_u32 s75, s75, 8
  v_mfma_f32_16x16x32_bf16 v[84:87], a[188:191], a[144:147], v[84:87]
  ds_read_b64_tr_b16 a[162:163], v196 offset:14336
  s_mul_i32 s75, s75, 28672
  s_add_u32 s91, s75, s90
  v_mfma_f32_16x16x32_bf16 v[88:91], a[188:191], a[148:151], v[88:91]
  ds_read_b64_tr_b16 a[164:165], v197 offset:0
  s_add_u32 m0, s90, 0x21000
  v_mfma_f32_16x16x32_bf16 v[92:95], a[188:191], a[152:155], v[92:95]
  ds_read_b64_tr_b16 a[166:167], v197 offset:14336
  buffer_load_dwordx4 v155, s[24:27], s91 offen lds
  v_mfma_f32_16x16x32_bf16 v[96:99], a[188:191], a[156:159], v[96:99]
  ds_read_b64_tr_b16 a[168:169], v198 offset:0
  s_add_u32 m0, s90, 0x21400
  v_mfma_f32_16x16x32_bf16 v[100:103], a[192:195], a[140:143], v[100:103]
  ds_read_b64_tr_b16 a[170:171], v198 offset:14336
  buffer_load_dwordx4 v156, s[24:27], s91 offen lds
  v_mfma_f32_16x16x32_bf16 v[104:107], a[192:195], a[144:147], v[104:107]
  ds_read_b64_tr_b16 a[172:173], v199 offset:0
  s_add_u32 m0, s90, 0x21800
  v_mfma_f32_16x16x32_bf16 v[108:111], a[192:195], a[148:151], v[108:111]
  ds_read_b64_tr_b16 a[174:175], v199 offset:14336
  buffer_load_dwordx4 v157, s[24:27], s91 offen lds
  v_mfma_f32_16x16x32_bf16 v[112:115], a[192:195], a[152:155], v[112:115]
  ds_read_b64_tr_b16 a[176:177], v200 offset:0
  s_add_u32 m0, s90, 0x21c00
  v_mfma_f32_16x16x32_bf16 v[116:119], a[192:195], a[156:159], v[116:119]
  ds_read_b64_tr_b16 a[178:179], v200 offset:14336
  buffer_load_dwordx4 v158, s[24:27], s91 offen lds
  v_mfma_f32_16x16x32_bf16 v[120:123], a[196:199], a[140:143], v[120:123]
  ds_read_b64_tr_b16 a[180:181], v201 offset:0
  s_add_u32 m0, s90, 0x22000
  v_mfma_f32_16x16x32_bf16 v[124:127], a[196:199], a[144:147], v[124:127]
  ds_read_b64_tr_b16 a[182:183], v201 offset:14336
  buffer_load_dwordx4 v159, s[24:27], s91 offen lds
  v_mfma_f32_16x16x32_bf16 v[128:131], a[196:199], a[148:151], v[128:131]
  ds_read_b64_tr_b16 a[184:185], v202 offset:0
  s_add_u32 m0, s90, 0x22400
  v_mfma_f32_16x16x32_bf16 v[132:135], a[196:199], a[152:155], v[132:135]
  ds_read_b64_tr_b16 a[186:187], v202 offset:14336
  buffer_load_dwordx4 v251, s[24:27], s91 offen lds
  v_mfma_f32_16x16x32_bf16 v[136:139], a[196:199], a[156:159], v[136:139]
  s_waitcnt lgkmcnt(6)
  v_mfma_f32_16x16x32_bf16 v[0:3], a[160:163], a[0:3], v[0:3]
  s_add_u32 m0, s90, 0x22800
  v_mfma_f32_16x16x32_bf16 v[4:7], a[160:163], a[4:7], v[4:7]
  buffer_load_dwordx4 v252, s[24:27], s91 offen lds
  v_mfma_f32_16x16x32_bf16 v[8:11], a[160:163], a[8:11], v[8:11]
  s_add_u32 s76, s65, 7
  s_and_b32 s76, s76, 7
  v_mfma_f32_16x16x32_bf16 v[12:15], a[160:163], a[12:15], v[12:15]
  s_lshl_b32 s76, s76, 10
  s_add_u32 s76, s76, 65536
  v_mfma_f32_16x16x32_bf16 v[16:19], a[160:163], a[16:19], v[16:19]
  v_add_u32 v212, s76, v248
  ds_read_b128 a[140:143], v212 offset:0
  v_mfma_f32_16x16x32_bf16 v[20:23], a[164:167], a[0:3], v[20:23]
  ds_read_b128 a[144:147], v212 offset:8192
  ds_read_b128 a[148:151], v212 offset:16384
  v_mfma_f32_16x16x32_bf16 v[24:27], a[164:167], a[4:7], v[24:27]
  ds_read_b128 a[152:155], v212 offset:24576
  ds_read_b128 a[156:159], v212 offset:32768
  v_mfma_f32_16x16x32_bf16 v[28:31], a[164:167], a[8:11], v[28:31]
  v_mfma_f32_16x16x32_bf16 v[32:35], a[164:167], a[12:15], v[32:35]
  v_mfma_f32_16x16x32_bf16 v[36:39], a[164:167], a[16:19], v[36:39]
  v_mfma_f32_16x16x32_bf16 v[40:43], a[168:171], a[0:3], v[40:43]
  v_mfma_f32_16x16x32_bf16 v[44:47], a[168:171], a[4:7], v[44:47]
  v_mfma_f32_16x16x32_bf16 v[48:51], a[168:171], a[8:11], v[48:51]
  v_mfma_f32_16x16x32_bf16 v[52:55], a[168:171], a[12:15], v[52:55]
  v_mfma_f32_16x16x32_bf16 v[56:59], a[168:171], a[16:19], v[56:59]
  v_mfma_f32_16x16x32_bf16 v[60:63], a[172:175], a[0:3], v[60:63]
  v_mfma_f32_16x16x32_bf16 v[64:67], a[172:175], a[4:7], v[64:67]
  v_mfma_f32_16x16x32_bf16 v[68:71], a[172:175], a[8:11], v[68:71]
  v_mfma_f32_16x16x32_bf16 v[72:75], a[172:175], a[12:15], v[72:75]
  v_mfma_f32_16x16x32_bf16 v[76:79], a[172:175], a[16:19], v[76:79]
  s_waitcnt lgkmcnt(0)
  s_waitcnt vmcnt(14)
  s_barrier
  v_mfma_f32_16x16x32_bf16 v[80:83], a[176:179], a[0:3], v[80:83]
  ds_read_b64_tr_b16 a[160:161], v196 offset:28672
  s_add_u32 s75, s65, 4
  s_and_b32 s75, s75, 7
  s_add_u32 s75, s75, 8
  v_mfma_f32_16x16x32_bf16 v[84:87], a[176:179], a[4:7], v[84:87]
  ds_read_b64_tr_b16 a[162:163], v196 offset:43008
  s_mul_i32 s75, s75, 28672
  s_add_u32 s91, s75, s90
  v_mfma_f32_16x16x32_bf16 v[88:91], a[176:179], a[8:11], v[88:91]
  ds_read_b64_tr_b16 a[164:165], v197 offset:28672
  s_add_u32 m0, s90, 0x0
  v_mfma_f32_16x16x32_bf16 v[92:95], a[176:179], a[12:15], v[92:95]
  ds_read_b64_tr_b16 a[166:167], v197 offset:43008
  buffer_load_dwordx4 v155, s[24:27], s91 offen lds
  v_mfma_f32_16x16x32_bf16 v[96:99], a[176:179], a[16:19], v[96:99]
  ds_read_b64_tr_b16 a[168:169], v198 offset:28672
  s_add_u32 m0, s90, 0x400
  v_mfma_f32_16x16x32_bf16 v[100:103], a[180:183], a[0:3], v[100:103]
  ds_read_b64_tr_b16 a[170:171], v198 offset:43008
  buffer_load_dwordx4 v156, s[24:27], s91 offen lds
  v_mfma_f32_16x16x32_bf16 v[104:107], a[180:183], a[4:7], v[104:107]
  ds_read_b64_tr_b16 a[172:173], v199 offset:28672
  s_add_u32 m0, s90, 0x800
  v_mfma_f32_16x16x32_bf16 v[108:111], a[180:183], a[8:11], v[108:111]
  ds_read_b64_tr_b16 a[174:175], v199 offset:43008
  buffer_load_dwordx4 v157, s[24:27], s91 offen lds
  v_mfma_f32_16x16x32_bf16 v[112:115], a[180:183], a[12:15], v[112:115]
  ds_read_b64_tr_b16 a[188:189], v200 offset:28672
  s_add_u32 m0, s90, 0xc00
  v_mfma_f32_16x16x32_bf16 v[116:119], a[180:183], a[16:19], v[116:119]
  ds_read_b64_tr_b16 a[190:191], v200 offset:43008
  buffer_load_dwordx4 v158, s[24:27], s91 offen lds
  v_mfma_f32_16x16x32_bf16 v[120:123], a[184:187], a[0:3], v[120:123]
  ds_read_b64_tr_b16 a[192:193], v201 offset:28672
  s_add_u32 m0, s90, 0x1000
  v_mfma_f32_16x16x32_bf16 v[124:127], a[184:187], a[4:7], v[124:127]
  ds_read_b64_tr_b16 a[194:195], v201 offset:43008
  buffer_load_dwordx4 v159, s[24:27], s91 offen lds
  v_mfma_f32_16x16x32_bf16 v[128:131], a[184:187], a[8:11], v[128:131]
  ds_read_b64_tr_b16 a[196:197], v202 offset:28672
  s_add_u32 m0, s90, 0x1400
  v_mfma_f32_16x16x32_bf16 v[132:135], a[184:187], a[12:15], v[132:135]
  ds_read_b64_tr_b16 a[198:199], v202 offset:43008
  buffer_load_dwordx4 v251, s[24:27], s91 offen lds
  v_mfma_f32_16x16x32_bf16 v[136:139], a[184:187], a[16:19], v[136:139]
  s_waitcnt lgkmcnt(6)
  v_mfma_f32_16x16x32_bf16 v[0:3], a[160:163], a[20:23], v[0:3]
  s_add_u32 m0, s90, 0x1800
  v_mfma_f32_16x16x32_bf16 v[4:7], a[160:163], a[24:27], v[4:7]
  buffer_load_dwordx4 v252, s[24:27], s91 offen lds
  v_mfma_f32_16x16x32_bf16 v[8:11], a[160:163], a[28:31], v[8:11]
  v_mfma_f32_16x16x32_bf16 v[12:15], a[160:163], a[32:35], v[12:15]
  v_mfma_f32_16x16x32_bf16 v[16:19], a[160:163], a[36:39], v[16:19]
  v_mfma_f32_16x16x32_bf16 v[20:23], a[164:167], a[20:23], v[20:23]
  v_mfma_f32_16x16x32_bf16 v[24:27], a[164:167], a[24:27], v[24:27]
  v_mfma_f32_16x16x32_bf16 v[28:31], a[164:167], a[28:31], v[28:31]
  v_mfma_f32_16x16x32_bf16 v[32:35], a[164:167], a[32:35], v[32:35]
  v_mfma_f32_16x16x32_bf16 v[36:39], a[164:167], a[36:39], v[36:39]
  v_mfma_f32_16x16x32_bf16 v[40:43], a[168:171], a[20:23], v[40:43]
  v_mfma_f32_16x16x32_bf16 v[44:47], a[168:171], a[24:27], v[44:47]
  v_mfma_f32_16x16x32_bf16 v[48:51], a[168:171], a[28:31], v[48:51]
  v_mfma_f32_16x16x32_bf16 v[52:55], a[168:171], a[32:35], v[52:55]
  v_mfma_f32_16x16x32_bf16 v[56:59], a[168:171], a[36:39], v[56:59]
  v_mfma_f32_16x16x32_bf16 v[60:63], a[172:175], a[20:23], v[60:63]
  v_mfma_f32_16x16x32_bf16 v[64:67], a[172:175], a[24:27], v[64:67]
  v_mfma_f32_16x16x32_bf16 v[68:71], a[172:175], a[28:31], v[68:71]
  v_mfma_f32_16x16x32_bf16 v[72:75], a[172:175], a[32:35], v[72:75]
  v_mfma_f32_16x16x32_bf16 v[76:79], a[172:175], a[36:39], v[76:79]
  s_waitcnt lgkmcnt(0)
  s_waitcnt vmcnt(14)
  s_barrier
  v_mfma_f32_16x16x32_bf16 v[80:83], a[188:191], a[20:23], v[80:83]
  ds_read_b64_tr_b16 a[160:161], v203 offset:0
  s_add_u32 s75, s65, 5
  s_and_b32 s75, s75, 7
  s_add_u32 s75, s75, 8
  v_mfma_f32_16x16x32_bf16 v[84:87], a[188:191], a[24:27], v[84:87]
  ds_read_b64_tr_b16 a[162:163], v203 offset:14336
  s_mul_i32 s75, s75, 28672
  s_add_u32 s91, s75, s90
  v_mfma_f32_16x16x32_bf16 v[88:91], a[188:191], a[28:31], v[88:91]
  ds_read_b64_tr_b16 a[164:165], v204 offset:0
  s_add_u32 m0, s90, 0x7000
  v_mfma_f32_16x16x32_bf16 v[92:95], a[188:191], a[32:35], v[92:95]
  ds_read_b64_tr_b16 a[166:167], v204 offset:14336
  buffer_load_dwordx4 v155, s[24:27], s91 offen lds
  v_mfma_f32_16x16x32_bf16 v[96:99], a[188:191], a[36:39], v[96:99]
  ds_read_b64_tr_b16 a[168:169], v205 offset:0
  s_add_u32 m0, s90, 0x7400
  v_mfma_f32_16x16x32_bf16 v[100:103], a[192:195], a[20:23], v[100:103]
  ds_read_b64_tr_b16 a[170:171], v205 offset:14336
  buffer_load_dwordx4 v156, s[24:27], s91 offen lds
  v_mfma_f32_16x16x32_bf16 v[104:107], a[192:195], a[24:27], v[104:107]
  ds_read_b64_tr_b16 a[172:173], v206 offset:0
  s_add_u32 m0, s90, 0x7800
  v_mfma_f32_16x16x32_bf16 v[108:111], a[192:195], a[28:31], v[108:111]
  ds_read_b64_tr_b16 a[174:175], v206 offset:14336
  buffer_load_dwordx4 v157, s[24:27], s91 offen lds
  v_mfma_f32_16x16x32_bf16 v[112:115], a[192:195], a[32:35], v[112:115]
  ds_read_b64_tr_b16 a[176:177], v207 offset:0
  s_add_u32 m0, s90, 0x7c00
  v_mfma_f32_16x16x32_bf16 v[116:119], a[192:195], a[36:39], v[116:119]
  ds_read_b64_tr_b16 a[178:179], v207 offset:14336
  buffer_load_dwordx4 v158, s[24:27], s91 offen lds
  v_mfma_f32_16x16x32_bf16 v[120:123], a[196:199], a[20:23], v[120:123]
  ds_read_b64_tr_b16 a[180:181], v208 offset:0
  s_add_u32 m0, s90, 0x8000
  v_mfma_f32_16x16x32_bf16 v[124:127], a[196:199], a[24:27], v[124:127]
  ds_read_b64_tr_b16 a[182:183], v208 offset:14336
  buffer_load_dwordx4 v159, s[24:27], s91 offen lds
  v_mfma_f32_16x16x32_bf16 v[128:131], a[196:199], a[28:31], v[128:131]
  ds_read_b64_tr_b16 a[184:185], v209 offset:0
  s_add_u32 m0, s90, 0x8400
  v_mfma_f32_16x16x32_bf16 v[132:135], a[196:199], a[32:35], v[132:135]
  ds_read_b64_tr_b16 a[186:187], v209 offset:14336
  buffer_load_dwordx4 v251, s[24:27], s91 offen lds
  v_mfma_f32_16x16x32_bf16 v[136:139], a[196:199], a[36:39], v[136:139]
  s_waitcnt lgkmcnt(6)
  v_mfma_f32_16x16x32_bf16 v[0:3], a[160:163], a[40:43], v[0:3]
  s_add_u32 m0, s90, 0x8800
  v_mfma_f32_16x16x32_bf16 v[4:7], a[160:163], a[44:47], v[4:7]
  buffer_load_dwordx4 v252, s[24:27], s91 offen lds
  v_mfma_f32_16x16x32_bf16 v[8:11], a[160:163], a[48:51], v[8:11]
  v_mfma_f32_16x16x32_bf16 v[12:15], a[160:163], a[52:55], v[12:15]
  v_mfma_f32_16x16x32_bf16 v[16:19], a[160:163], a[56:59], v[16:19]
  v_mfma_f32_16x16x32_bf16 v[20:23], a[164:167], a[40:43], v[20:23]
  v_mfma_f32_16x16x32_bf16 v[24:27], a[164:167], a[44:47], v[24:27]
  v_mfma_f32_16x16x32_bf16 v[28:31], a[164:167], a[48:51], v[28:31]
  v_mfma_f32_16x16x32_bf16 v[32:35], a[164:167], a[52:55], v[32:35]
  v_mfma_f32_16x16x32_bf16 v[36:39], a[164:167], a[56:59], v[36:39]
  v_mfma_f32_16x16x32_bf16 v[40:43], a[168:171], a[40:43], v[40:43]
  v_mfma_f32_16x16x32_bf16 v[44:47], a[168:171], a[44:47], v[44:47]
  v_mfma_f32_16x16x32_bf16 v[48:51], a[168:171], a[48:51], v[48:51]
  v_mfma_f32_16x16x32_bf16 v[52:55], a[168:171], a[52:55], v[52:55]
  v_mfma_f32_16x16x32_bf16 v[56:59], a[168:171], a[56:59], v[56:59]
  v_mfma_f32_16x16x32_bf16 v[60:63], a[172:175], a[40:43], v[60:63]
  v_mfma_f32_16x16x32_bf16 v[64:67], a[172:175], a[44:47], v[64:67]
  v_mfma_f32_16x16x32_bf16 v[68:71], a[172:175], a[48:51], v[68:71]
  v_mfma_f32_16x16x32_bf16 v[72:75], a[172:175], a[52:55], v[72:75]
  v_mfma_f32_16x16x32_bf16 v[76:79], a[172:175], a[56:59], v[76:79]
  s_waitcnt lgkmcnt(0)
  s_waitcnt vmcnt(14)
  s_barrier
  v_mfma_f32_16x16x32_bf16 v[80:83], a[176:179], a[40:43], v[80:83]
  ds_read_b64_tr_b16 a[160:161], v203 offset:28672
  s_add_u32 s75, s65, 6
  s_and_b32 s75, s75, 7
  s_add_u32 s75, s75, 8
  v_mfma_f32_16x16x32_bf16 v[84:87], a[176:179], a[44:47], v[84:87]
  ds_read_b64_tr_b16 a[162:163], v203 offset:43008
  s_mul_i32 s75, s75, 28672
  s_add_u32 s91, s75, s90
  v_mfma_f32_16x16x32_bf16 v[88:91], a[176:179], a[48:51], v[88:91]
  ds_read_b64_tr_b16 a[164:165], v204 offset:28672
  s_add_u32 m0, s90, 0x1a000
  v_mfma_f32_16x16x32_bf16 v[92:95], a[176:179], a[52:55], v[92:95]
  ds_read_b64_tr_b16 a[166:167], v204 offset:43008
  buffer_load_dwordx4 v155, s[24:27], s91 offen lds
  v_mfma_f32_16x16x32_bf16 v[96:99], a[176:179], a[56:59], v[96:99]
  ds_read_b64_tr_b16 a[168:169], v205 offset:28672
  s_add_u32 m0, s90, 0x1a400
  v_mfma_f32_16x16x32_bf16 v[100:103], a[180:183], a[40:43], v[100:103]
  ds_read_b64_tr_b16 a[170:171], v205 offset:43008
  buffer_load_dwordx4 v156, s[24:27], s91 offen lds
  v_mfma_f32_16x16x32_bf16 v[104:107], a[180:183], a[44:47], v[104:107]
  ds_read_b64_tr_b16 a[172:173], v206 offset:28672
  s_add_u32 m0, s90, 0x1a800
  v_mfma_f32_16x16x32_bf16 v[108:111], a[180:183], a[48:51], v[108:111]
  ds_read_b64_tr_b16 a[174:175], v206 offset:43008
  buffer_load_dwordx4 v157, s[24:27], s91 offen lds
  v_mfma_f32_16x16x32_bf16 v[112:115], a[180:183], a[52:55], v[112:115]
  ds_read_b64_tr_b16 a[188:189], v207 offset:28672
  s_add_u32 m0, s90, 0x1ac00
  v_mfma_f32_16x16x32_bf16 v[116:119], a[180:183], a[56:59], v[116:119]
  ds_read_b64_tr_b16 a[190:191], v207 offset:43008
  buffer_load_dwordx4 v158, s[24:27], s91 offen lds
  v_mfma_f32_16x16x32_bf16 v[120:123], a[184:187], a[40:43], v[120:123]
  ds_read_b64_tr_b16 a[192:193], v208 offset:28672
  s_add_u32 m0, s90, 0x1b000
  v_mfma_f32_16x16x32_bf16 v[124:127], a[184:187], a[44:47], v[124:127]
  ds_read_b64_tr_b16 a[194:195], v208 offset:43008
  buffer_load_dwordx4 v159, s[24:27], s91 offen lds
  v_mfma_f32_16x16x32_bf16 v[128:131], a[184:187], a[48:51], v[128:131]
  ds_read_b64_tr_b16 a[196:197], v209 offset:28672
  s_add_u32 m0, s90, 0x1b400
  v_mfma_f32_16x16x32_bf16 v[132:135], a[184:187], a[52:55], v[132:135]
  ds_read_b64_tr_b16 a[198:199], v209 offset:43008
  buffer_load_dwordx4 v251, s[24:27], s91 offen lds
  v_mfma_f32_16x16x32_bf16 v[136:139], a[184:187], a[56:59], v[136:139]
  s_waitcnt lgkmcnt(6)
  v_mfma_f32_16x16x32_bf16 v[0:3], a[160:163], a[60:63], v[0:3]
  s_add_u32 m0, s90, 0x1b800
  v_mfma_f32_16x16x32_bf16 v[4:7], a[160:163], a[64:67], v[4:7]
  buffer_load_dwordx4 v252, s[24:27], s91 offen lds
  v_mfma_f32_16x16x32_bf16 v[8:11], a[160:163], a[68:71], v[8:11]
  v_mfma_f32_16x16x32_bf16 v[12:15], a[160:163], a[72:75], v[12:15]
  v_mfma_f32_16x16x32_bf16 v[16:19], a[160:163], a[76:79], v[16:19]
  v_mfma_f32_16x16x32_bf16 v[20:23], a[164:167], a[60:63], v[20:23]
  v_mfma_f32_16x16x32_bf16 v[24:27], a[164:167], a[64:67], v[24:27]
  v_mfma_f32_16x16x32_bf16 v[28:31], a[164:167], a[68:71], v[28:31]
  v_mfma_f32_16x16x32_bf16 v[32:35], a[164:167], a[72:75], v[32:35]
  v_mfma_f32_16x16x32_bf16 v[36:39], a[164:167], a[76:79], v[36:39]
  v_mfma_f32_16x16x32_bf16 v[40:43], a[168:171], a[60:63], v[40:43]
  v_mfma_f32_16x16x32_bf16 v[44:47], a[168:171], a[64:67], v[44:47]
  v_mfma_f32_16x16x32_bf16 v[48:51], a[168:171], a[68:71], v[48:51]
  v_mfma_f32_16x16x32_bf16 v[52:55], a[168:171], a[72:75], v[52:55]
  v_mfma_f32_16x16x32_bf16 v[56:59], a[168:171], a[76:79], v[56:59]
  v_mfma_f32_16x16x32_bf16 v[60:63], a[172:175], a[60:63], v[60:63]
  v_mfma_f32_16x16x32_bf16 v[64:67], a[172:175], a[64:67], v[64:67]
  v_mfma_f32_16x16x32_bf16 v[68:71], a[172:175], a[68:71], v[68:71]
  v_mfma_f32_16x16x32_bf16 v[72:75], a[172:175], a[72:75], v[72:75]
  v_mfma_f32_16x16x32_bf16 v[76:79], a[172:175], a[76:79], v[76:79]
  s_waitcnt lgkmcnt(0)
  s_waitcnt vmcnt(14)
  s_barrier
  v_mfma_f32_16x16x32_bf16 v[80:83], a[188:191], a[60:63], v[80:83]
  ds_read_b64_tr_b16 a[160:161], v196 offset:0
  s_add_u32 s75, s65, 7
  s_and_b32 s75, s75, 7
  s_add_u32 s75, s75, 8
  v_mfma_f32_16x16x32_bf16 v[84:87], a[188:191], a[64:67], v[84:87]
  ds_read_b64_tr_b16 a[162:163], v196 offset:14336
  s_mul_i32 s75, s75, 28672
  s_add_u32 s91, s75, s90
  v_mfma_f32_16x16x32_bf16 v[88:91], a[188:191], a[68:71], v[88:91]
  ds_read_b64_tr_b16 a[164:165], v197 offset:0
  s_add_u32 m0, s90, 0x21000
  v_mfma_f32_16x16x32_bf16 v[92:95], a[188:191], a[72:75], v[92:95]
  ds_read_b64_tr_b16 a[166:167], v197 offset:14336
  buffer_load_dwordx4 v155, s[24:27], s91 offen lds
  v_mfma_f32_16x16x32_bf16 v[96:99], a[188:191], a[76:79], v[96:99]
  ds_read_b64_tr_b16 a[168:169], v198 offset:0
  s_add_u32 m0, s90, 0x21400
  v_mfma_f32_16x16x32_bf16 v[100:103], a[192:195], a[60:63], v[100:103]
  ds_read_b64_tr_b16 a[170:171], v198 offset:14336
  buffer_load_dwordx4 v156, s[24:27], s91 offen lds
  v_mfma_f32_16x16x32_bf16 v[104:107], a[192:195], a[64:67], v[104:107]
  ds_read_b64_tr_b16 a[172:173], v199 offset:0
  s_add_u32 m0, s90, 0x21800
  v_mfma_f32_16x16x32_bf16 v[108:111], a[192:195], a[68:71], v[108:111]
  ds_read_b64_tr_b16 a[174:175], v199 offset:14336
  buffer_load_dwordx4 v157, s[24:27], s91 offen lds
  v_mfma_f32_16x16x32_bf16 v[112:115], a[192:195], a[72:75], v[112:115]
  ds_read_b64_tr_b16 a[176:177], v200 offset:0
  s_add_u32 m0, s90, 0x21c00
  v_mfma_f32_16x16x32_bf16 v[116:119], a[192:195], a[76:79], v[116:119]
  ds_read_b64_tr_b16 a[178:179], v200 offset:14336
  buffer_load_dwordx4 v158, s[24:27], s91 offen lds
  v_mfma_f32_16x16x32_bf16 v[120:123], a[196:199], a[60:63], v[120:123]
  ds_read_b64_tr_b16 a[180:181], v201 offset:0
  s_add_u32 m0, s90, 0x22000
  v_mfma_f32_16x16x32_bf16 v[124:127], a[196:199], a[64:67], v[124:127]
  ds_read_b64_tr_b16 a[182:183], v201 offset:14336
  buffer_load_dwordx4 v159, s[24:27], s91 offen lds
  v_mfma_f32_16x16x32_bf16 v[128:131], a[196:199], a[68:71], v[128:131]
  ds_read_b64_tr_b16 a[184:185], v202 offset:0
  s_add_u32 m0, s90, 0x22400
  v_mfma_f32_16x16x32_bf16 v[132:135], a[196:199], a[72:75], v[132:135]
  ds_read_b64_tr_b16 a[186:187], v202 offset:14336
  buffer_load_dwordx4 v251, s[24:27], s91 offen lds
  v_mfma_f32_16x16x32_bf16 v[136:139], a[196:199], a[76:79], v[136:139]
  s_waitcnt lgkmcnt(6)
  v_mfma_f32_16x16x32_bf16 v[0:3], a[160:163], a[80:83], v[0:3]
  s_add_u32 m0, s90, 0x22800
  v_mfma_f32_16x16x32_bf16 v[4:7], a[160:163], a[84:87], v[4:7]
  buffer_load_dwordx4 v252, s[24:27], s91 offen lds
  v_mfma_f32_16x16x32_bf16 v[8:11], a[160:163], a[88:91], v[8:11]
  v_mfma_f32_16x16x32_bf16 v[12:15], a[160:163], a[92:95], v[12:15]
  v_mfma_f32_16x16x32_bf16 v[16:19], a[160:163], a[96:99], v[16:19]
  v_mfma_f32_16x16x32_bf16 v[20:23], a[164:167], a[80:83], v[20:23]
  v_mfma_f32_16x16x32_bf16 v[24:27], a[164:167], a[84:87], v[24:27]
  v_mfma_f32_16x16x32_bf16 v[28:31], a[164:167], a[88:91], v[28:31]
  v_mfma_f32_16x16x32_bf16 v[32:35], a[164:167], a[92:95], v[32:35]
  v_mfma_f32_16x16x32_bf16 v[36:39], a[164:167], a[96:99], v[36:39]
  v_mfma_f32_16x16x32_bf16 v[40:43], a[168:171], a[80:83], v[40:43]
  v_mfma_f32_16x16x32_bf16 v[44:47], a[168:171], a[84:87], v[44:47]
  v_mfma_f32_16x16x32_bf16 v[48:51], a[168:171], a[88:91], v[48:51]
  v_mfma_f32_16x16x32_bf16 v[52:55], a[168:171], a[92:95], v[52:55]
  v_mfma_f32_16x16x32_bf16 v[56:59], a[168:171], a[96:99], v[56:59]
  v_mfma_f32_16x16x32_bf16 v[60:63], a[172:175], a[80:83], v[60:63]
  v_mfma_f32_16x16x32_bf16 v[64:67], a[172:175], a[84:87], v[64:67]
  v_mfma_f32_16x16x32_bf16 v[68:71], a[172:175], a[88:91], v[68:71]
  v_mfma_f32_16x16x32_bf16 v[72:75], a[172:175], a[92:95], v[72:75]
  v_mfma_f32_16x16x32_bf16 v[76:79], a[172:175], a[96:99], v[76:79]
  s_waitcnt lgkmcnt(0)
  s_waitcnt vmcnt(14)
  s_barrier
  v_mfma_f32_16x16x32_bf16 v[80:83], a[176:179], a[80:83], v[80:83]
  ds_read_b64_tr_b16 a[160:161], v196 offset:28672
  v_mfma_f32_16x16x32_bf16 v[84:87], a[176:179], a[84:87], v[84:87]
  ds_read_b64_tr_b16 a[162:163], v196 offset:43008
  v_mfma_f32_16x16x32_bf16 v[88:91], a[176:179], a[88:91], v[88:91]
  ds_read_b64_tr_b16 a[164:165], v197 offset:28672
  v_mfma_f32_16x16x32_bf16 v[92:95], a[176:179], a[92:95], v[92:95]
  ds_read_b64_tr_b16 a[166:167], v197 offset:43008
  v_mfma_f32_16x16x32_bf16 v[96:99], a[176:179], a[96:99], v[96:99]
  ds_read_b64_tr_b16 a[168:169], v198 offset:28672
  v_mfma_f32_16x16x32_bf16 v[100:103], a[180:183], a[80:83], v[100:103]
  ds_read_b64_tr_b16 a[170:171], v198 offset:43008
  v_mfma_f32_16x16x32_bf16 v[104:107], a[180:183], a[84:87], v[104:107]
  ds_read_b64_tr_b16 a[172:173], v199 offset:28672
  v_mfma_f32_16x16x32_bf16 v[108:111], a[180:183], a[88:91], v[108:111]
  ds_read_b64_tr_b16 a[174:175], v199 offset:43008
  v_mfma_f32_16x16x32_bf16 v[112:115], a[180:183], a[92:95], v[112:115]
  ds_read_b64_tr_b16 a[188:189], v200 offset:28672
  v_mfma_f32_16x16x32_bf16 v[116:119], a[180:183], a[96:99], v[116:119]
  ds_read_b64_tr_b16 a[190:191], v200 offset:43008
  v_mfma_f32_16x16x32_bf16 v[120:123], a[184:187], a[80:83], v[120:123]
  ds_read_b64_tr_b16 a[192:193], v201 offset:28672
  v_mfma_f32_16x16x32_bf16 v[124:127], a[184:187], a[84:87], v[124:127]
  ds_read_b64_tr_b16 a[194:195], v201 offset:43008
  v_mfma_f32_16x16x32_bf16 v[128:131], a[184:187], a[88:91], v[128:131]
  ds_read_b64_tr_b16 a[196:197], v202 offset:28672
  v_mfma_f32_16x16x32_bf16 v[132:135], a[184:187], a[92:95], v[132:135]
  ds_read_b64_tr_b16 a[198:199], v202 offset:43008
  v_mfma_f32_16x16x32_bf16 v[136:139], a[184:187], a[96:99], v[136:139]
  s_waitcnt lgkmcnt(6)
  v_mfma_f32_16x16x32_bf16 v[0:3], a[160:163], a[100:103], v[0:3]
  v_mfma_f32_16x16x32_bf16 v[4:7], a[160:163], a[104:107], v[4:7]
  v_mfma_f32_16x16x32_bf16 v[8:11], a[160:163], a[108:111], v[8:11]
  v_mfma_f32_16x16x32_bf16 v[12:15], a[160:163], a[112:115], v[12:15]
  v_mfma_f32_16x16x32_bf16 v[16:19], a[160:163], a[116:119], v[16:19]
  v_mfma_f32_16x16x32_bf16 v[20:23], a[164:167], a[100:103], v[20:23]
  v_mfma_f32_16x16x32_bf16 v[24:27], a[164:167], a[104:107], v[24:27]
  v_mfma_f32_16x16x32_bf16 v[28:31], a[164:167], a[108:111], v[28:31]
  v_mfma_f32_16x16x32_bf16 v[32:35], a[164:167], a[112:115], v[32:35]
  v_mfma_f32_16x16x32_bf16 v[36:39], a[164:167], a[116:119], v[36:39]
  v_mfma_f32_16x16x32_bf16 v[40:43], a[168:171], a[100:103], v[40:43]
  v_mfma_f32_16x16x32_bf16 v[44:47], a[168:171], a[104:107], v[44:47]
  v_mfma_f32_16x16x32_bf16 v[48:51], a[168:171], a[108:111], v[48:51]
  v_mfma_f32_16x16x32_bf16 v[52:55], a[168:171], a[112:115], v[52:55]
  v_mfma_f32_16x16x32_bf16 v[56:59], a[168:171], a[116:119], v[56:59]
  v_mfma_f32_16x16x32_bf16 v[60:63], a[172:175], a[100:103], v[60:63]
  v_mfma_f32_16x16x32_bf16 v[64:67], a[172:175], a[104:107], v[64:67]
  v_mfma_f32_16x16x32_bf16 v[68:71], a[172:175], a[108:111], v[68:71]
  v_mfma_f32_16x16x32_bf16 v[72:75], a[172:175], a[112:115], v[72:75]
  v_mfma_f32_16x16x32_bf16 v[76:79], a[172:175], a[116:119], v[76:79]
  s_waitcnt lgkmcnt(0)
  s_waitcnt vmcnt(7)
  s_barrier
  v_mfma_f32_16x16x32_bf16 v[80:83], a[188:191], a[100:103], v[80:83]
  ds_read_b64_tr_b16 a[160:161], v203 offset:0
  v_mfma_f32_16x16x32_bf16 v[84:87], a[188:191], a[104:107], v[84:87]
  ds_read_b64_tr_b16 a[162:163], v203 offset:14336
  v_mfma_f32_16x16x32_bf16 v[88:91], a[188:191], a[108:111], v[88:91]
  ds_read_b64_tr_b16 a[164:165], v204 offset:0
  v_mfma_f32_16x16x32_bf16 v[92:95], a[188:191], a[112:115], v[92:95]
  ds_read_b64_tr_b16 a[166:167], v204 offset:14336
  v_mfma_f32_16x16x32_bf16 v[96:99], a[188:191], a[116:119], v[96:99]
  ds_read_b64_tr_b16 a[168:169], v205 offset:0
  v_mfma_f32_16x16x32_bf16 v[100:103], a[192:195], a[100:103], v[100:103]
  ds_read_b64_tr_b16 a[170:171], v205 offset:14336
  v_mfma_f32_16x16x32_bf16 v[104:107], a[192:195], a[104:107], v[104:107]
  ds_read_b64_tr_b16 a[172:173], v206 offset:0
  v_mfma_f32_16x16x32_bf16 v[108:111], a[192:195], a[108:111], v[108:111]
  ds_read_b64_tr_b16 a[174:175], v206 offset:14336
  v_mfma_f32_16x16x32_bf16 v[112:115], a[192:195], a[112:115], v[112:115]
  ds_read_b64_tr_b16 a[176:177], v207 offset:0
  v_mfma_f32_16x16x32_bf16 v[116:119], a[192:195], a[116:119], v[116:119]
  ds_read_b64_tr_b16 a[178:179], v207 offset:14336
  v_mfma_f32_16x16x32_bf16 v[120:123], a[196:199], a[100:103], v[120:123]
  ds_read_b64_tr_b16 a[180:181], v208 offset:0
  v_mfma_f32_16x16x32_bf16 v[124:127], a[196:199], a[104:107], v[124:127]
  ds_read_b64_tr_b16 a[182:183], v208 offset:14336
  v_mfma_f32_16x16x32_bf16 v[128:131], a[196:199], a[108:111], v[128:131]
  ds_read_b64_tr_b16 a[184:185], v209 offset:0
  v_mfma_f32_16x16x32_bf16 v[132:135], a[196:199], a[112:115], v[132:135]
  ds_read_b64_tr_b16 a[186:187], v209 offset:14336
  v_mfma_f32_16x16x32_bf16 v[136:139], a[196:199], a[116:119], v[136:139]
  s_waitcnt lgkmcnt(6)
  v_mfma_f32_16x16x32_bf16 v[0:3], a[160:163], a[120:123], v[0:3]
  v_mfma_f32_16x16x32_bf16 v[4:7], a[160:163], a[124:127], v[4:7]
  v_mfma_f32_16x16x32_bf16 v[8:11], a[160:163], a[128:131], v[8:11]
  v_mfma_f32_16x16x32_bf16 v[12:15], a[160:163], a[132:135], v[12:15]
  v_mfma_f32_16x16x32_bf16 v[16:19], a[160:163], a[136:139], v[16:19]
  v_mfma_f32_16x16x32_bf16 v[20:23], a[164:167], a[120:123], v[20:23]
  v_mfma_f32_16x16x32_bf16 v[24:27], a[164:167], a[124:127], v[24:27]
  v_mfma_f32_16x16x32_bf16 v[28:31], a[164:167], a[128:131], v[28:31]
  v_mfma_f32_16x16x32_bf16 v[32:35], a[164:167], a[132:135], v[32:35]
  v_mfma_f32_16x16x32_bf16 v[36:39], a[164:167], a[136:139], v[36:39]
  v_mfma_f32_16x16x32_bf16 v[40:43], a[168:171], a[120:123], v[40:43]
  v_mfma_f32_16x16x32_bf16 v[44:47], a[168:171], a[124:127], v[44:47]
  v_mfma_f32_16x16x32_bf16 v[48:51], a[168:171], a[128:131], v[48:51]
  v_mfma_f32_16x16x32_bf16 v[52:55], a[168:171], a[132:135], v[52:55]
  v_mfma_f32_16x16x32_bf16 v[56:59], a[168:171], a[136:139], v[56:59]
  v_mfma_f32_16x16x32_bf16 v[60:63], a[172:175], a[120:123], v[60:63]
  v_mfma_f32_16x16x32_bf16 v[64:67], a[172:175], a[124:127], v[64:67]
  v_mfma_f32_16x16x32_bf16 v[68:71], a[172:175], a[128:131], v[68:71]
  v_mfma_f32_16x16x32_bf16 v[72:75], a[172:175], a[132:135], v[72:75]
  v_mfma_f32_16x16x32_bf16 v[76:79], a[172:175], a[136:139], v[76:79]
  s_waitcnt lgkmcnt(0)
  s_waitcnt vmcnt(0)
  s_barrier
  v_mfma_f32_16x16x32_bf16 v[80:83], a[176:179], a[120:123], v[80:83]
  ds_read_b64_tr_b16 a[160:161], v203 offset:28672
  v_mfma_f32_16x16x32_bf16 v[84:87], a[176:179], a[124:127], v[84:87]
  ds_read_b64_tr_b16 a[162:163], v203 offset:43008
  v_mfma_f32_16x16x32_bf16 v[88:91], a[176:179], a[128:131], v[88:91]
  ds_read_b64_tr_b16 a[164:165], v204 offset:28672
  v_mfma_f32_16x16x32_bf16 v[92:95], a[176:179], a[132:135], v[92:95]
  ds_read_b64_tr_b16 a[166:167], v204 offset:43008
  v_mfma_f32_16x16x32_bf16 v[96:99], a[176:179], a[136:139], v[96:99]
  ds_read_b64_tr_b16 a[168:169], v205 offset:28672
  v_mfma_f32_16x16x32_bf16 v[100:103], a[180:183], a[120:123], v[100:103]
  ds_read_b64_tr_b16 a[170:171], v205 offset:43008
  v_mfma_f32_16x16x32_bf16 v[104:107], a[180:183], a[124:127], v[104:107]
  ds_read_b64_tr_b16 a[172:173], v206 offset:28672
  v_mfma_f32_16x16x32_bf16 v[108:111], a[180:183], a[128:131], v[108:111]
  ds_read_b64_tr_b16 a[174:175], v206 offset:43008
  v_mfma_f32_16x16x32_bf16 v[112:115], a[180:183], a[132:135], v[112:115]
  ds_read_b64_tr_b16 a[188:189], v207 offset:28672
  v_mfma_f32_16x16x32_bf16 v[116:119], a[180:183], a[136:139], v[116:119]
  ds_read_b64_tr_b16 a[190:191], v207 offset:43008
  v_mfma_f32_16x16x32_bf16 v[120:123], a[184:187], a[120:123], v[120:123]
  ds_read_b64_tr_b16 a[192:193], v208 offset:28672
  v_mfma_f32_16x16x32_bf16 v[124:127], a[184:187], a[124:127], v[124:127]
  ds_read_b64_tr_b16 a[194:195], v208 offset:43008
  v_mfma_f32_16x16x32_bf16 v[128:131], a[184:187], a[128:131], v[128:131]
  ds_read_b64_tr_b16 a[196:197], v209 offset:28672
  v_mfma_f32_16x16x32_bf16 v[132:135], a[184:187], a[132:135], v[132:135]
  ds_read_b64_tr_b16 a[198:199], v209 offset:43008
  v_mfma_f32_16x16x32_bf16 v[136:139], a[184:187], a[136:139], v[136:139]
  s_waitcnt lgkmcnt(6)
  v_mfma_f32_16x16x32_bf16 v[0:3], a[160:163], a[140:143], v[0:3]
  s_mul_i32 s75, s58, 17920
  v_add_u32 v213, s75, v248
  v_mfma_f32_16x16x32_bf16 v[4:7], a[160:163], a[144:147], v[4:7]
  v_lshrrev_b32 v214, 1, v248
  s_add_u32 s75, s75, 17408
  v_mfma_f32_16x16x32_bf16 v[8:11], a[160:163], a[148:151], v[8:11]
  v_add_u32 v214, s75, v214
  v_mfma_f32_16x16x32_bf16 v[12:15], a[160:163], a[152:155], v[12:15]
  v_mfma_f32_16x16x32_bf16 v[16:19], a[160:163], a[156:159], v[16:19]
  v_mfma_f32_16x16x32_bf16 v[20:23], a[164:167], a[140:143], v[20:23]
  v_mfma_f32_16x16x32_bf16 v[24:27], a[164:167], a[144:147], v[24:27]
  v_mfma_f32_16x16x32_bf16 v[28:31], a[164:167], a[148:151], v[28:31]
  v_mfma_f32_16x16x32_bf16 v[32:35], a[164:167], a[152:155], v[32:35]
  v_mfma_f32_16x16x32_bf16 v[36:39], a[164:167], a[156:159], v[36:39]
  v_mfma_f32_16x16x32_bf16 v[40:43], a[168:171], a[140:143], v[40:43]
  v_mfma_f32_16x16x32_bf16 v[44:47], a[168:171], a[144:147], v[44:47]
  v_mfma_f32_16x16x32_bf16 v[48:51], a[168:171], a[148:151], v[48:51]
  v_mfma_f32_16x16x32_bf16 v[52:55], a[168:171], a[152:155], v[52:55]
  v_mfma_f32_16x16x32_bf16 v[56:59], a[168:171], a[156:159], v[56:59]
  v_mfma_f32_16x16x32_bf16 v[60:63], a[172:175], a[140:143], v[60:63]
  v_mfma_f32_16x16x32_bf16 v[64:67], a[172:175], a[144:147], v[64:67]
  v_mfma_f32_16x16x32_bf16 v[68:71], a[172:175], a[148:151], v[68:71]
  v_mfma_f32_16x16x32_bf16 v[72:75], a[172:175], a[152:155], v[72:75]
  v_mfma_f32_16x16x32_bf16 v[76:79], a[172:175], a[156:159], v[76:79]
  s_waitcnt lgkmcnt(0)
  v_mfma_f32_16x16x32_bf16 v[80:83], a[188:191], a[140:143], v[80:83]
  v_mfma_f32_16x16x32_bf16 v[84:87], a[188:191], a[144:147], v[84:87]
  v_cvt_pk_bf16_f32 v0, v0, v1
  v_cvt_pk_bf16_f32 v1, v2, v3
  v_mfma_f32_16x16x32_bf16 v[88:91], a[188:191], a[148:151], v[88:91]
  v_cvt_pk_bf16_f32 v2, v4, v5
  v_cvt_pk_bf16_f32 v3, v6, v7
  v_mfma_f32_16x16x32_bf16 v[92:95], a[188:191], a[152:155], v[92:95]
  s_mov_b32 s76, 0
  buffer_store_dwordx4 v[0:3], v213, s[28:31], s76 offen offset:0 sc1
  v_mfma_f32_16x16x32_bf16 v[96:99], a[188:191], a[156:159], v[96:99]
  v_cvt_pk_bf16_f32 v8, v8, v9
  v_cvt_pk_bf16_f32 v9, v10, v11
  v_mfma_f32_16x16x32_bf16 v[100:103], a[192:195], a[140:143], v[100:103]
  v_cvt_pk_bf16_f32 v10, v12, v13
  v_cvt_pk_bf16_f32 v11, v14, v15
  v_mfma_f32_16x16x32_bf16 v[104:107], a[192:195], a[144:147], v[104:107]
  buffer_store_dwordx4 v[8:11], v213, s[28:31], s76 offen offset:1024 sc1
  v_cvt_pk_bf16_f32 v16, v16, v17
  v_mfma_f32_16x16x32_bf16 v[108:111], a[192:195], a[148:151], v[108:111]
  v_cvt_pk_bf16_f32 v17, v18, v19
  v_cvt_pk_bf16_f32 v18, v20, v21
  v_mfma_f32_16x16x32_bf16 v[112:115], a[192:195], a[152:155], v[112:115]
  v_cvt_pk_bf16_f32 v19, v22, v23
  buffer_store_dwordx4 v[16:19], v213, s[28:31], s76 offen offset:2048 sc1
  v_mfma_f32_16x16x32_bf16 v[116:119], a[192:195], a[156:159], v[116:119]
  v_cvt_pk_bf16_f32 v24, v24, v25
  v_cvt_pk_bf16_f32 v25, v26, v27
  v_mfma_f32_16x16x32_bf16 v[120:123], a[196:199], a[140:143], v[120:123]
  v_cvt_pk_bf16_f32 v26, v28, v29
  v_cvt_pk_bf16_f32 v27, v30, v31
  v_mfma_f32_16x16x32_bf16 v[124:127], a[196:199], a[144:147], v[124:127]
  buffer_store_dwordx4 v[24:27], v213, s[28:31], s76 offen offset:3072 sc1
  v_cvt_pk_bf16_f32 v32, v32, v33
  v_mfma_f32_16x16x32_bf16 v[128:131], a[196:199], a[148:151], v[128:131]
  v_cvt_pk_bf16_f32 v33, v34, v35
  v_cvt_pk_bf16_f32 v34, v36, v37
  v_mfma_f32_16x16x32_bf16 v[132:135], a[196:199], a[152:155], v[132:135]
  v_cvt_pk_bf16_f32 v35, v38, v39
  s_mov_b32 s76, 4096
  v_mfma_f32_16x16x32_bf16 v[136:139], a[196:199], a[156:159], v[136:139]
  buffer_store_dwordx4 v[32:35], v213, s[28:31], s76 offen offset:0 sc1
  v_cvt_pk_bf16_f32 v40, v40, v41
  v_cvt_pk_bf16_f32 v41, v42, v43
  v_cvt_pk_bf16_f32 v42, v44, v45
  v_cvt_pk_bf16_f32 v43, v46, v47
  buffer_store_dwordx4 v[40:43], v213, s[28:31], s76 offen offset:1024 sc1
  v_cvt_pk_bf16_f32 v48, v48, v49
  v_cvt_pk_bf16_f32 v49, v50, v51
  v_cvt_pk_bf16_f32 v50, v52, v53
  v_cvt_pk_bf16_f32 v51, v54, v55
  buffer_store_dwordx4 v[48:51], v213, s[28:31], s76 offen offset:2048 sc1
  v_cvt_pk_bf16_f32 v56, v56, v57
  v_cvt_pk_bf16_f32 v57, v58, v59
  v_cvt_pk_bf16_f32 v58, v60, v61
  v_cvt_pk_bf16_f32 v59, v62, v63
  buffer_store_dwordx4 v[56:59], v213, s[28:31], s76 offen offset:3072 sc1
  v_cvt_pk_bf16_f32 v64, v64, v65
  v_cvt_pk_bf16_f32 v65, v66, v67
  v_cvt_pk_bf16_f32 v66, v68, v69
  v_cvt_pk_bf16_f32 v67, v70, v71
  s_mov_b32 s76, 8192
  buffer_store_dwordx4 v[64:67], v213, s[28:31], s76 offen offset:0 sc1
  v_cvt_pk_bf16_f32 v72, v72, v73
  v_cvt_pk_bf16_f32 v73, v74, v75
  v_cvt_pk_bf16_f32 v74, v76, v77
  v_cvt_pk_bf16_f32 v75, v78, v79
  buffer_store_dwordx4 v[72:75], v213, s[28:31], s76 offen offset:1024 sc1
  s_nop 3
  v_cvt_pk_bf16_f32 v80, v80, v81
  v_cvt_pk_bf16_f32 v81, v82, v83
  v_cvt_pk_bf16_f32 v82, v84, v85
  v_cvt_pk_bf16_f32 v83, v86, v87
  buffer_store_dwordx4 v[80:83], v213, s[28:31], s76 offen offset:2048 sc1
  v_cvt_pk_bf16_f32 v88, v88, v89
  v_cvt_pk_bf16_f32 v89, v90, v91
  v_cvt_pk_bf16_f32 v90, v92, v93
  v_cvt_pk_bf16_f32 v91, v94, v95
  buffer_store_dwordx4 v[88:91], v213, s[28:31], s76 offen offset:3072 sc1
  v_cvt_pk_bf16_f32 v96, v96, v97
  v_cvt_pk_bf16_f32 v97, v98, v99
  v_cvt_pk_bf16_f32 v98, v100, v101
  v_cvt_pk_bf16_f32 v99, v102, v103
  s_mov_b32 s76, 12288
  buffer_store_dwordx4 v[96:99], v213, s[28:31], s76 offen offset:0 sc1
  v_cvt_pk_bf16_f32 v104, v104, v105
  v_cvt_pk_bf16_f32 v105, v106, v107
  v_cvt_pk_bf16_f32 v106, v108, v109
  v_cvt_pk_bf16_f32 v107, v110, v111
  buffer_store_dwordx4 v[104:107], v213, s[28:31], s76 offen offset:1024 sc1
  v_cvt_pk_bf16_f32 v112, v112, v113
  v_cvt_pk_bf16_f32 v113, v114, v115
  v_cvt_pk_bf16_f32 v114, v116, v117
  v_cvt_pk_bf16_f32 v115, v118, v119
  buffer_store_dwordx4 v[112:115], v213, s[28:31], s76 offen offset:2048 sc1
  v_cvt_pk_bf16_f32 v120, v120, v121
  v_cvt_pk_bf16_f32 v121, v122, v123
  v_cvt_pk_bf16_f32 v122, v124, v125
  v_cvt_pk_bf16_f32 v123, v126, v127
  buffer_store_dwordx4 v[120:123], v213, s[28:31], s76 offen offset:3072 sc1
  v_cvt_pk_bf16_f32 v128, v128, v129
  v_cvt_pk_bf16_f32 v129, v130, v131
  v_cvt_pk_bf16_f32 v130, v132, v133
  v_cvt_pk_bf16_f32 v131, v134, v135
  s_mov_b32 s76, 16384
  buffer_store_dwordx4 v[128:131], v213, s[28:31], s76 offen offset:0 sc1
  v_cvt_pk_bf16_f32 v136, v136, v137
  v_cvt_pk_bf16_f32 v137, v138, v139
  buffer_store_dwordx2 v[136:137], v214, s[28:31], 0 offen sc1
  s_mov_b32 s20, s98
  s_mov_b32 s21, s99
  s_mov_b32 s22, 256
  s_mov_b32 s23, 0x20000
  s_mul_i32 s5, s79, 573440
  s_add_u32 s24, s56, s5
  s_addc_u32 s25, s57, 0
  s_mov_b32 s26, 573440
  s_mov_b32 s27, 0x20000
  s_mov_b32 s16, s96
  s_mov_b32 s17, s97
  s_mov_b32 s18, 2293760
  s_mov_b32 s19, 0x20000
  s_lshl_b32 s75, s79, 2
  v_mov_b32 v140, s75
  v_mov_b32 v141, 1
  s_lshl_b32 s76, s79, 10
  v_lshlrev_b32 v150, 3, v248
  v_add_u32 v150, s76, v150
  s_lshl_b32 s77, s62, 7
  s_add_u32 s76, s76, s77
  v_mov_b32 v151, s76
  v_mov_b32 v152, 1
  v_mul_u32_u24 v142, 1792, v249
  v_lshlrev_b32 v143, 3, v250
  v_add_u32 v142, v142, v143
  v_lshrrev_b32 v143, 4, v248
  s_and_b32 s5, s79, 15
  s_mul_i32 s5, s5, 143360
  s_lshr_b32 s6, s79, 4
  s_mul_i32 s6, s6, 896
  s_add_u32 s60, s5, s6
  s_lshl_b32 s61, s62, 2
  s_add_u32 s61, s61, s58
  s_add_u32 s62, s61, 0
  s_mul_i32 s63, s62, 57
  s_lshr_b32 s63, s63, 10
  s_mul_i32 s64, s63, 18
  s_sub_u32 s64, s62, s64
  s_mul_i32 s65, s63, 17920
  s_lshl_b32 s66, s64, 10
  s_add_u32 s65, s65, s66
  s_cmp_eq_u32 s64, 17
  s_cselect_b32 s66, 3, 4
  v_lshlrev_b32 v144, s66, v143
  v_add_u32 v144, s65, v144
  s_mul_i32 s67, s63, 224
  s_add_u32 s67, s67, s60
  s_lshl_b32 s68, s64, 1
  s_mul_i32 s69, s68, 52
  s_lshr_b32 s69, s69, 8
  s_mul_i32 s70, s69, 5
  s_sub_u32 s70, s68, s70
  s_mul_i32 s70, s70, 28672
  s_lshl_b32 s69, s69, 5
  s_add_u32 s70, s70, s69
  s_add_u32 s81, s70, s67
  s_lshl_b32 s68, s64, 1
  s_add_u32 s68, s68, 1
  s_mul_i32 s69, s68, 52
  s_lshr_b32 s69, s69, 8
  s_mul_i32 s70, s69, 5
  s_sub_u32 s70, s68, s70
  s_mul_i32 s70, s70, 28672
  s_lshl_b32 s69, s69, 5
  s_add_u32 s70, s70, s69
  s_add_u32 s82, s70, s67
  s_mov_b32 s87, s64
  s_add_u32 s62, s61, 32
  s_mul_i32 s63, s62, 57
  s_lshr_b32 s63, s63, 10
  s_mul_i32 s64, s63, 18
  s_sub_u32 s64, s62, s64
  s_mul_i32 s65, s63, 17920
  s_lshl_b32 s66, s64, 10
  s_add_u32 s65, s65, s66
  s_cmp_eq_u32 s64, 17
  s_cselect_b32 s66, 3, 4
  v_lshlrev_b32 v145, s66, v143
  v_add_u32 v145, s65, v145
  s_mul_i32 s67, s63, 224
  s_add_u32 s67, s67, s60
  s_lshl_b32 s68, s64, 1
  s_mul_i32 s69, s68, 52
  s_lshr_b32 s69, s69, 8
  s_mul_i32 s70, s69, 5
  s_sub_u32 s70, s68, s70
  s_mul_i32 s70, s70, 28672
  s_lshl_b32 s69, s69, 5
  s_add_u32 s70, s70, s69
  s_add_u32 s83, s70, s67
  s_lshl_b32 s68, s64, 1
  s_add_u32 s68, s68, 1
  s_mul_i32 s69, s68, 52
  s_lshr_b32 s69, s69, 8
  s_mul_i32 s70, s69, 5
  s_sub_u32 s70, s68, s70
  s_mul_i32 s70, s70, 28672
  s_lshl_b32 s69, s69, 5
  s_add_u32 s70, s70, s69
  s_add_u32 s84, s70, s67
  s_mov_b32 s88, s64
  s_add_u32 s62, s61, 64
  s_mul_i32 s63, s62, 57
  s_lshr_b32 s63, s63, 10
  s_mul_i32 s64, s63, 18
  s_sub_u32 s64, s62, s64
  s_mul_i32 s65, s63, 17920
  s_lshl_b32 s66, s64, 10
  s_add_u32 s65, s65, s66
  s_cmp_eq_u32 s64, 17
  s_cselect_b32 s66, 3, 4
  v_lshlrev_b32 v146, s66, v143
  v_add_u32 v146, s65, v146
  s_mul_i32 s67, s63, 224
  s_add_u32 s67, s67, s60
  s_lshl_b32 s68, s64, 1
  s_mul_i32 s69, s68, 52
  s_lshr_b32 s69, s69, 8
  s_mul_i32 s70, s69, 5
  s_sub_u32 s70, s68, s70
  s_mul_i32 s70, s70, 28672
  s_lshl_b32 s69, s69, 5
  s_add_u32 s70, s70, s69
  s_add_u32 s85, s70, s67
  s_lshl_b32 s68, s64, 1
  s_add_u32 s68, s68, 1
  s_mul_i32 s69, s68, 52
  s_lshr_b32 s69, s69, 8
  s_mul_i32 s70, s69, 5
  s_sub_u32 s70, s68, s70
  s_mul_i32 s70, s70, 28672
  s_lshl_b32 s69, s69, 5
  s_add_u32 s70, s70, s69
  s_add_u32 s86, s70, s67
  s_mov_b32 s89, s64
  s_waitcnt vmcnt(0)
  s_barrier
  s_cmp_eq_u32 s58, 0
  s_cbranch_scc0 L_sync_skip
  s_mov_b64 s[4:5], exec
  s_mov_b64 exec, 1
  buffer_atomic_add v141, v140, s[20:23], 0 offen sc0
  s_waitcnt vmcnt(0)
  v_readfirstlane_b32 s6, v141
  s_mov_b32 s7, 0x40000
  s_and_b32 s6, s6, 7
  s_cmp_eq_u32 s6, 7
  s_cbranch_scc0 L_sync_poll
  s_mov_b64 exec, 0xff
  buffer_store_dword v152, v150, s[32:35], 0 offen sc1
  s_branch L_sync_done
L_sync_poll:
  s_sleep 4
  buffer_load_dword v141, v151, s[32:35], 0 offen sc1
  s_waitcnt vmcnt(0)
  v_readfirstlane_b32 s6, v141
  s_sub_u32 s7, s7, 1
  s_cmp_eq_u32 s7, 0
  s_cbranch_scc1 L_sync_done
  s_cmp_eq_u32 s6, 1
  s_cbranch_scc0 L_sync_poll
L_sync_done:
  s_mov_b64 exec, s[4:5]
L_sync_skip:
  s_barrier
  s_mov_b32 s71, 0
  buffer_load_dwordx4 v[0:3], v144, s[24:27], s71 offen sc1
  s_mov_b32 s71, 71680
  buffer_load_dwordx4 v[4:7], v144, s[24:27], s71 offen sc1
  s_mov_b32 s71, 143360
  buffer_load_dwordx4 v[8:11], v144, s[24:27], s71 offen sc1
  s_mov_b32 s71, 215040
  buffer_load_dwordx4 v[12:15], v144, s[24:27], s71 offen sc1
  s_mov_b32 s71, 286720
  buffer_load_dwordx4 v[16:19], v144, s[24:27], s71 offen sc1
  s_mov_b32 s71, 358400
  buffer_load_dwordx4 v[20:23], v144, s[24:27], s71 offen sc1
  s_mov_b32 s71, 430080
  buffer_load_dwordx4 v[24:27], v144, s[24:27], s71 offen sc1
  s_mov_b32 s71, 501760
  buffer_load_dwordx4 v[28:31], v144, s[24:27], s71 offen sc1
  s_mov_b32 s71, 0
  buffer_load_dwordx4 v[32:35], v145, s[24:27], s71 offen sc1
  s_mov_b32 s71, 71680
  buffer_load_dwordx4 v[36:39], v145, s[24:27], s71 offen sc1
  s_mov_b32 s71, 143360
  buffer_load_dwordx4 v[40:43], v145, s[24:27], s71 offen sc1
  s_mov_b32 s71, 215040
  buffer_load_dwordx4 v[44:47], v145, s[24:27], s71 offen sc1
  s_mov_b32 s71, 286720
  buffer_load_dwordx4 v[48:51], v145, s[24:27], s71 offen sc1
  s_mov_b32 s71, 358400
  buffer_load_dwordx4 v[52:55], v145, s[24:27], s71 offen sc1
  s_mov_b32 s71, 430080
  buffer_load_dwordx4 v[56:59], v145, s[24:27], s71 offen sc1
  s_mov_b32 s71, 501760
  buffer_load_dwordx4 v[60:63], v145, s[24:27], s71 offen sc1
  s_cmp_lt_u32 s61, 8
  s_cbranch_scc0 L_two_units
  s_mov_b32 s71, 0
  buffer_load_dwordx4 v[64:67], v146, s[24:27], s71 offen sc1
  s_mov_b32 s71, 71680
  buffer_load_dwordx4 v[68:71], v146, s[24:27], s71 offen sc1
  s_mov_b32 s71, 143360
  buffer_load_dwordx4 v[72:75], v146, s[24:27], s71 offen sc1
  s_mov_b32 s71, 215040
  buffer_load_dwordx4 v[76:79], v146, s[24:27], s71 offen sc1
  s_mov_b32 s71, 286720
  buffer_load_dwordx4 v[80:83], v146, s[24:27], s71 offen sc1
  s_mov_b32 s71, 358400
  buffer_load_dwordx4 v[84:87], v146, s[24:27], s71 offen sc1
  s_mov_b32 s71, 430080
  buffer_load_dwordx4 v[88:91], v146, s[24:27], s71 offen sc1
  s_mov_b32 s71, 501760
  buffer_load_dwordx4 v[92:95], v146, s[24:27], s71 offen sc1
  s_waitcnt vmcnt(23)
  v_lshlrev_b32 v96, 16, v0
  v_and_b32 v97, 0xffff0000, v0
  v_lshlrev_b32 v98, 16, v1
  v_and_b32 v99, 0xffff0000, v1
  v_lshlrev_b32 v100, 16, v2
  v_and_b32 v101, 0xffff0000, v2
  v_lshlrev_b32 v102, 16, v3
  v_and_b32 v103, 0xffff0000, v3
  s_waitcnt vmcnt(22)
  v_lshlrev_b32 v148, 16, v4
  v_and_b32 v149, 0xffff0000, v4
  v_pk_add_f32 v[96:97], v[96:97], v[148:149]
  v_lshlrev_b32 v154, 16, v5
  v_and_b32 v155, 0xffff0000, v5
  v_pk_add_f32 v[98:99], v[98:99], v[154:155]
  v_lshlrev_b32 v148, 16, v6
  v_and_b32 v149, 0xffff0000, v6
  v_pk_add_f32 v[100:101], v[100:101], v[148:149]
  v_lshlrev_b32 v154, 16, v7
  v_and_b32 v155, 0xffff0000, v7
  v_pk_add_f32 v[102:103], v[102:103], v[154:155]
  s_waitcnt vmcnt(21)
  v_lshlrev_b32 v148, 16, v8
  v_and_b32 v149, 0xffff0000, v8
  v_pk_add_f32 v[96:97], v[96:97], v[148:149]
  v_lshlrev_b32 v154, 16, v9
  v_and_b32 v155, 0xffff0000, v9
  v_pk_add_f32 v[98:99], v[98:99], v[154:155]
  v_lshlrev_b32 v148, 16, v10
  v_and_b32 v149, 0xffff0000, v10
  v_pk_add_f32 v[100:101], v[100:101], v[148:149]
  v_lshlrev_b32 v154, 16, v11
  v_and_b32 v155, 0xffff0000, v11
  v_pk_add_f32 v[102:103], v[102:103], v[154:155]
  s_waitcnt vmcnt(20)
  v_lshlrev_b32 v148, 16, v12
  v_and_b32 v149, 0xffff0000, v12
  v_pk_add_f32 v[96:97], v[96:97], v[148:149]
  v_lshlrev_b32 v154, 16, v13
  v_and_b32 v155, 0xffff0000, v13
  v_pk_add_f32 v[98:99], v[98:99], v[154:155]
  v_lshlrev_b32 v148, 16, v14
  v_and_b32 v149, 0xffff0000, v14
  v_pk_add_f32 v[100:101], v[100:101], v[148:149]
  v_lshlrev_b32 v154, 16, v15
  v_and_b32 v155, 0xffff0000, v15
  v_pk_add_f32 v[102:103], v[102:103], v[154:155]
  s_waitcnt vmcnt(19)
  v_lshlrev_b32 v148, 16, v16
  v_and_b32 v149, 0xffff0000, v16
  v_pk_add_f32 v[96:97], v[96:97], v[148:149]
  v_lshlrev_b32 v154, 16, v17
  v_and_b32 v155, 0xffff0000, v17
  v_pk_add_f32 v[98:99], v[98:99], v[154:155]
  v_lshlrev_b32 v148, 16, v18
  v_and_b32 v149, 0xffff0000, v18
  v_pk_add_f32 v[100:101], v[100:101], v[148:149]
  v_lshlrev_b32 v154, 16, v19
  v_and_b32 v155, 0xffff0000, v19
  v_pk_add_f32 v[102:103], v[102:103], v[154:155]
  s_waitcnt vmcnt(18)
  v_lshlrev_b32 v148, 16, v20
  v_and_b32 v149, 0xffff0000, v20
  v_pk_add_f32 v[96:97], v[96:97], v[148:149]
  v_lshlrev_b32 v154, 16, v21
  v_and_b32 v155, 0xffff0000, v21
  v_pk_add_f32 v[98:99], v[98:99], v[154:155]
  v_lshlrev_b32 v148, 16, v22
  v_and_b32 v149, 0xffff0000, v22
  v_pk_add_f32 v[100:101], v[100:101], v[148:149]
  v_lshlrev_b32 v154, 16, v23
  v_and_b32 v155, 0xffff0000, v23
  v_pk_add_f32 v[102:103], v[102:103], v[154:155]
  s_waitcnt vmcnt(17)
  v_lshlrev_b32 v148, 16, v24
  v_and_b32 v149, 0xffff0000, v24
  v_pk_add_f32 v[96:97], v[96:97], v[148:149]
  v_lshlrev_b32 v154, 16, v25
  v_and_b32 v155, 0xffff0000, v25
  v_pk_add_f32 v[98:99], v[98:99], v[154:155]
  v_lshlrev_b32 v148, 16, v26
  v_and_b32 v149, 0xffff0000, v26
  v_pk_add_f32 v[100:101], v[100:101], v[148:149]
  v_lshlrev_b32 v154, 16, v27
  v_and_b32 v155, 0xffff0000, v27
  v_pk_add_f32 v[102:103], v[102:103], v[154:155]
  s_waitcnt vmcnt(16)
  v_lshlrev_b32 v148, 16, v28
  v_and_b32 v149, 0xffff0000, v28
  v_pk_add_f32 v[96:97], v[96:97], v[148:149]
  v_lshlrev_b32 v154, 16, v29
  v_and_b32 v155, 0xffff0000, v29
  v_pk_add_f32 v[98:99], v[98:99], v[154:155]
  v_lshlrev_b32 v148, 16, v30
  v_and_b32 v149, 0xffff0000, v30
  v_pk_add_f32 v[100:101], v[100:101], v[148:149]
  v_lshlrev_b32 v154, 16, v31
  v_and_b32 v155, 0xffff0000, v31
  v_pk_add_f32 v[102:103], v[102:103], v[154:155]
  v_cvt_pk_bf16_f32 v120, v96, v97
  v_cvt_pk_bf16_f32 v121, v98, v99
  v_cvt_pk_bf16_f32 v122, v100, v101
  v_cvt_pk_bf16_f32 v123, v102, v103
  s_waitcnt vmcnt(15)
  v_lshlrev_b32 v104, 16, v32
  v_and_b32 v105, 0xffff0000, v32
  v_lshlrev_b32 v106, 16, v33
  v_and_b32 v107, 0xffff0000, v33
  v_lshlrev_b32 v108, 16, v34
  v_and_b32 v109, 0xffff0000, v34
  v_lshlrev_b32 v110, 16, v35
  v_and_b32 v111, 0xffff0000, v35
  s_waitcnt vmcnt(14)
  v_lshlrev_b32 v148, 16, v36
  v_and_b32 v149, 0xffff0000, v36
  v_pk_add_f32 v[104:105], v[104:105], v[148:149]
  v_lshlrev_b32 v154, 16, v37
  v_and_b32 v155, 0xffff0000, v37
  v_pk_add_f32 v[106:107], v[106:107], v[154:155]
  v_lshlrev_b32 v148, 16, v38
  v_and_b32 v149, 0xffff0000, v38
  v_pk_add_f32 v[108:109], v[108:109], v[148:149]
  v_lshlrev_b32 v154, 16, v39
  v_and_b32 v155, 0xffff0000, v39
  v_pk_add_f32 v[110:111], v[110:111], v[154:155]
  s_waitcnt vmcnt(13)
  v_lshlrev_b32 v148, 16, v40
  v_and_b32 v149, 0xffff0000, v40
  v_pk_add_f32 v[104:105], v[104:105], v[148:149]
  v_lshlrev_b32 v154, 16, v41
  v_and_b32 v155, 0xffff0000, v41
  v_pk_add_f32 v[106:107], v[106:107], v[154:155]
  v_lshlrev_b32 v148, 16, v42
  v_and_b32 v149, 0xffff0000, v42
  v_pk_add_f32 v[108:109], v[108:109], v[148:149]
  v_lshlrev_b32 v154, 16, v43
  v_and_b32 v155, 0xffff0000, v43
  v_pk_add_f32 v[110:111], v[110:111], v[154:155]
  s_waitcnt vmcnt(12)
  v_lshlrev_b32 v148, 16, v44
  v_and_b32 v149, 0xffff0000, v44
  v_pk_add_f32 v[104:105], v[104:105], v[148:149]
  v_lshlrev_b32 v154, 16, v45
  v_and_b32 v155, 0xffff0000, v45
  v_pk_add_f32 v[106:107], v[106:107], v[154:155]
  v_lshlrev_b32 v148, 16, v46
  v_and_b32 v149, 0xffff0000, v46
  v_pk_add_f32 v[108:109], v[108:109], v[148:149]
  v_lshlrev_b32 v154, 16, v47
  v_and_b32 v155, 0xffff0000, v47
  v_pk_add_f32 v[110:111], v[110:111], v[154:155]
  s_waitcnt vmcnt(11)
  v_lshlrev_b32 v148, 16, v48
  v_and_b32 v149, 0xffff0000, v48
  v_pk_add_f32 v[104:105], v[104:105], v[148:149]
  v_lshlrev_b32 v154, 16, v49
  v_and_b32 v155, 0xffff0000, v49
  v_pk_add_f32 v[106:107], v[106:107], v[154:155]
  v_lshlrev_b32 v148, 16, v50
  v_and_b32 v149, 0xffff0000, v50
  v_pk_add_f32 v[108:109], v[108:109], v[148:149]
  v_lshlrev_b32 v154, 16, v51
  v_and_b32 v155, 0xffff0000, v51
  v_pk_add_f32 v[110:111], v[110:111], v[154:155]
  s_waitcnt vmcnt(10)
  v_lshlrev_b32 v148, 16, v52
  v_and_b32 v149, 0xffff0000, v52
  v_pk_add_f32 v[104:105], v[104:105], v[148:149]
  v_lshlrev_b32 v154, 16, v53
  v_and_b32 v155, 0xffff0000, v53
  v_pk_add_f32 v[106:107], v[106:107], v[154:155]
  v_lshlrev_b32 v148, 16, v54
  v_and_b32 v149, 0xffff0000, v54
  v_pk_add_f32 v[108:109], v[108:109], v[148:149]
  v_lshlrev_b32 v154, 16, v55
  v_and_b32 v155, 0xffff0000, v55
  v_pk_add_f32 v[110:111], v[110:111], v[154:155]
  s_waitcnt vmcnt(9)
  v_lshlrev_b32 v148, 16, v56
  v_and_b32 v149, 0xffff0000, v56
  v_pk_add_f32 v[104:105], v[104:105], v[148:149]
  v_lshlrev_b32 v154, 16, v57
  v_and_b32 v155, 0xffff0000, v57
  v_pk_add_f32 v[106:107], v[106:107], v[154:155]
  v_lshlrev_b32 v148, 16, v58
  v_and_b32 v149, 0xffff0000, v58
  v_pk_add_f32 v[108:109], v[108:109], v[148:149]
  v_lshlrev_b32 v154, 16, v59
  v_and_b32 v155, 0xffff0000, v59
  v_pk_add_f32 v[110:111], v[110:111], v[154:155]
  s_waitcnt vmcnt(8)
  v_lshlrev_b32 v148, 16, v60
  v_and_b32 v149, 0xffff0000, v60
  v_pk_add_f32 v[104:105], v[104:105], v[148:149]
  v_lshlrev_b32 v154, 16, v61
  v_and_b32 v155, 0xffff0000, v61
  v_pk_add_f32 v[106:107], v[106:107], v[154:155]
  v_lshlrev_b32 v148, 16, v62
  v_and_b32 v149, 0xffff0000, v62
  v_pk_add_f32 v[108:109], v[108:109], v[148:149]
  v_lshlrev_b32 v154, 16, v63
  v_and_b32 v155, 0xffff0000, v63
  v_pk_add_f32 v[110:111], v[110:111], v[154:155]
  v_cvt_pk_bf16_f32 v124, v104, v105
  v_cvt_pk_bf16_f32 v125, v106, v107
  v_cvt_pk_bf16_f32 v126, v108, v109
  v_cvt_pk_bf16_f32 v127, v110, v111
  s_waitcnt vmcnt(7)
  v_lshlrev_b32 v112, 16, v64
  v_and_b32 v113, 0xffff0000, v64
  v_lshlrev_b32 v114, 16, v65
  v_and_b32 v115, 0xffff0000, v65
  v_lshlrev_b32 v116, 16, v66
  v_and_b32 v117, 0xffff0000, v66
  v_lshlrev_b32 v118, 16, v67
  v_and_b32 v119, 0xffff0000, v67
  s_waitcnt vmcnt(6)
  v_lshlrev_b32 v148, 16, v68
  v_and_b32 v149, 0xffff0000, v68
  v_pk_add_f32 v[112:113], v[112:113], v[148:149]
  v_lshlrev_b32 v154, 16, v69
  v_and_b32 v155, 0xffff0000, v69
  v_pk_add_f32 v[114:115], v[114:115], v[154:155]
  v_lshlrev_b32 v148, 16, v70
  v_and_b32 v149, 0xffff0000, v70
  v_pk_add_f32 v[116:117], v[116:117], v[148:149]
  v_lshlrev_b32 v154, 16, v71
  v_and_b32 v155, 0xffff0000, v71
  v_pk_add_f32 v[118:119], v[118:119], v[154:155]
  s_waitcnt vmcnt(5)
  v_lshlrev_b32 v148, 16, v72
  v_and_b32 v149, 0xffff0000, v72
  v_pk_add_f32 v[112:113], v[112:113], v[148:149]
  v_lshlrev_b32 v154, 16, v73
  v_and_b32 v155, 0xffff0000, v73
  v_pk_add_f32 v[114:115], v[114:115], v[154:155]
  v_lshlrev_b32 v148, 16, v74
  v_and_b32 v149, 0xffff0000, v74
  v_pk_add_f32 v[116:117], v[116:117], v[148:149]
  v_lshlrev_b32 v154, 16, v75
  v_and_b32 v155, 0xffff0000, v75
  v_pk_add_f32 v[118:119], v[118:119], v[154:155]
  s_waitcnt vmcnt(4)
  v_lshlrev_b32 v148, 16, v76
  v_and_b32 v149, 0xffff0000, v76
  v_pk_add_f32 v[112:113], v[112:113], v[148:149]
  v_lshlrev_b32 v154, 16, v77
  v_and_b32 v155, 0xffff0000, v77
  v_pk_add_f32 v[114:115], v[114:115], v[154:155]
  v_lshlrev_b32 v148, 16, v78
  v_and_b32 v149, 0xffff0000, v78
  v_pk_add_f32 v[116:117], v[116:117], v[148:149]
  v_lshlrev_b32 v154, 16, v79
  v_and_b32 v155, 0xffff0000, v79
  v_pk_add_f32 v[118:119], v[118:119], v[154:155]
  s_waitcnt vmcnt(3)
  v_lshlrev_b32 v148, 16, v80
  v_and_b32 v149, 0xffff0000, v80
  v_pk_add_f32 v[112:113], v[112:113], v[148:149]
  v_lshlrev_b32 v154, 16, v81
  v_and_b32 v155, 0xffff0000, v81
  v_pk_add_f32 v[114:115], v[114:115], v[154:155]
  v_lshlrev_b32 v148, 16, v82
  v_and_b32 v149, 0xffff0000, v82
  v_pk_add_f32 v[116:117], v[116:117], v[148:149]
  v_lshlrev_b32 v154, 16, v83
  v_and_b32 v155, 0xffff0000, v83
  v_pk_add_f32 v[118:119], v[118:119], v[154:155]
  s_waitcnt vmcnt(2)
  v_lshlrev_b32 v148, 16, v84
  v_and_b32 v149, 0xffff0000, v84
  v_pk_add_f32 v[112:113], v[112:113], v[148:149]
  v_lshlrev_b32 v154, 16, v85
  v_and_b32 v155, 0xffff0000, v85
  v_pk_add_f32 v[114:115], v[114:115], v[154:155]
  v_lshlrev_b32 v148, 16, v86
  v_and_b32 v149, 0xffff0000, v86
  v_pk_add_f32 v[116:117], v[116:117], v[148:149]
  v_lshlrev_b32 v154, 16, v87
  v_and_b32 v155, 0xffff0000, v87
  v_pk_add_f32 v[118:119], v[118:119], v[154:155]
  s_waitcnt vmcnt(1)
  v_lshlrev_b32 v148, 16, v88
  v_and_b32 v149, 0xffff0000, v88
  v_pk_add_f32 v[112:113], v[112:113], v[148:149]
  v_lshlrev_b32 v154, 16, v89
  v_and_b32 v155, 0xffff0000, v89
  v_pk_add_f32 v[114:115], v[114:115], v[154:155]
  v_lshlrev_b32 v148, 16, v90
  v_and_b32 v149, 0xffff0000, v90
  v_pk_add_f32 v[116:117], v[116:117], v[148:149]
  v_lshlrev_b32 v154, 16, v91
  v_and_b32 v155, 0xffff0000, v91
  v_pk_add_f32 v[118:119], v[118:119], v[154:155]
  s_waitcnt vmcnt(0)
  v_lshlrev_b32 v148, 16, v92
  v_and_b32 v149, 0xffff0000, v92
  v_pk_add_f32 v[112:113], v[112:113], v[148:149]
  v_lshlrev_b32 v154, 16, v93
  v_and_b32 v155, 0xffff0000, v93
  v_pk_add_f32 v[114:115], v[114:115], v[154:155]
  v_lshlrev_b32 v148, 16, v94
  v_and_b32 v149, 0xffff0000, v94
  v_pk_add_f32 v[116:117], v[116:117], v[148:149]
  v_lshlrev_b32 v154, 16, v95
  v_and_b32 v155, 0xffff0000, v95
  v_pk_add_f32 v[118:119], v[118:119], v[154:155]
  v_cvt_pk_bf16_f32 v128, v112, v113
  v_cvt_pk_bf16_f32 v129, v114, v115
  v_cvt_pk_bf16_f32 v130, v116, v117
  v_cvt_pk_bf16_f32 v131, v118, v119
  buffer_store_dwordx2 v[128:129], v142, s[16:19], s85 offen
  s_cmp_eq_u32 s89, 17
  s_cbranch_scc1 L_half_2
  buffer_store_dwordx2 v[130:131], v142, s[16:19], s86 offen
L_half_2:
  s_branch L_units_done
L_two_units:
  s_waitcnt vmcnt(15)
  v_lshlrev_b32 v96, 16, v0
  v_and_b32 v97, 0xffff0000, v0
  v_lshlrev_b32 v98, 16, v1
  v_and_b32 v99, 0xffff0000, v1
  v_lshlrev_b32 v100, 16, v2
  v_and_b32 v101, 0xffff0000, v2
  v_lshlrev_b32 v102, 16, v3
  v_and_b32 v103, 0xffff0000, v3
  s_waitcnt vmcnt(14)
  v_lshlrev_b32 v148, 16, v4
  v_and_b32 v149, 0xffff0000, v4
  v_pk_add_f32 v[96:97], v[96:97], v[148:149]
  v_lshlrev_b32 v154, 16, v5
  v_and_b32 v155, 0xffff0000, v5
  v_pk_add_f32 v[98:99], v[98:99], v[154:155]
  v_lshlrev_b32 v148, 16, v6
  v_and_b32 v149, 0xffff0000, v6
  v_pk_add_f32 v[100:101], v[100:101], v[148:149]
  v_lshlrev_b32 v154, 16, v7
  v_and_b32 v155, 0xffff0000, v7
  v_pk_add_f32 v[102:103], v[102:103], v[154:155]
  s_waitcnt vmcnt(13)
  v_lshlrev_b32 v148, 16, v8
  v_and_b32 v149, 0xffff0000, v8
  v_pk_add_f32 v[96:97], v[96:97], v[148:149]
  v_lshlrev_b32 v154, 16, v9
  v_and_b32 v155, 0xffff0000, v9
  v_pk_add_f32 v[98:99], v[98:99], v[154:155]
  v_lshlrev_b32 v148, 16, v10
  v_and_b32 v149, 0xffff0000, v10
  v_pk_add_f32 v[100:101], v[100:101], v[148:149]
  v_lshlrev_b32 v154, 16, v11
  v_and_b32 v155, 0xffff0000, v11
  v_pk_add_f32 v[102:103], v[102:103], v[154:155]
  s_waitcnt vmcnt(12)
  v_lshlrev_b32 v148, 16, v12
  v_and_b32 v149, 0xffff0000, v12
  v_pk_add_f32 v[96:97], v[96:97], v[148:149]
  v_lshlrev_b32 v154, 16, v13
  v_and_b32 v155, 0xffff0000, v13
  v_pk_add_f32 v[98:99], v[98:99], v[154:155]
  v_lshlrev_b32 v148, 16, v14
  v_and_b32 v149, 0xffff0000, v14
  v_pk_add_f32 v[100:101], v[100:101], v[148:149]
  v_lshlrev_b32 v154, 16, v15
  v_and_b32 v155, 0xffff0000, v15
  v_pk_add_f32 v[102:103], v[102:103], v[154:155]
  s_waitcnt vmcnt(11)
  v_lshlrev_b32 v148, 16, v16
  v_and_b32 v149, 0xffff0000, v16
  v_pk_add_f32 v[96:97], v[96:97], v[148:149]
  v_lshlrev_b32 v154, 16, v17
  v_and_b32 v155, 0xffff0000, v17
  v_pk_add_f32 v[98:99], v[98:99], v[154:155]
  v_lshlrev_b32 v148, 16, v18
  v_and_b32 v149, 0xffff0000, v18
  v_pk_add_f32 v[100:101], v[100:101], v[148:149]
  v_lshlrev_b32 v154, 16, v19
  v_and_b32 v155, 0xffff0000, v19
  v_pk_add_f32 v[102:103], v[102:103], v[154:155]
  s_waitcnt vmcnt(10)
  v_lshlrev_b32 v148, 16, v20
  v_and_b32 v149, 0xffff0000, v20
  v_pk_add_f32 v[96:97], v[96:97], v[148:149]
  v_lshlrev_b32 v154, 16, v21
  v_and_b32 v155, 0xffff0000, v21
  v_pk_add_f32 v[98:99], v[98:99], v[154:155]
  v_lshlrev_b32 v148, 16, v22
  v_and_b32 v149, 0xffff0000, v22
  v_pk_add_f32 v[100:101], v[100:101], v[148:149]
  v_lshlrev_b32 v154, 16, v23
  v_and_b32 v155, 0xffff0000, v23
  v_pk_add_f32 v[102:103], v[102:103], v[154:155]
  s_waitcnt vmcnt(9)
  v_lshlrev_b32 v148, 16, v24
  v_and_b32 v149, 0xffff0000, v24
  v_pk_add_f32 v[96:97], v[96:97], v[148:149]
  v_lshlrev_b32 v154, 16, v25
  v_and_b32 v155, 0xffff0000, v25
  v_pk_add_f32 v[98:99], v[98:99], v[154:155]
  v_lshlrev_b32 v148, 16, v26
  v_and_b32 v149, 0xffff0000, v26
  v_pk_add_f32 v[100:101], v[100:101], v[148:149]
  v_lshlrev_b32 v154, 16, v27
  v_and_b32 v155, 0xffff0000, v27
  v_pk_add_f32 v[102:103], v[102:103], v[154:155]
  s_waitcnt vmcnt(8)
  v_lshlrev_b32 v148, 16, v28
  v_and_b32 v149, 0xffff0000, v28
  v_pk_add_f32 v[96:97], v[96:97], v[148:149]
  v_lshlrev_b32 v154, 16, v29
  v_and_b32 v155, 0xffff0000, v29
  v_pk_add_f32 v[98:99], v[98:99], v[154:155]
  v_lshlrev_b32 v148, 16, v30
  v_and_b32 v149, 0xffff0000, v30
  v_pk_add_f32 v[100:101], v[100:101], v[148:149]
  v_lshlrev_b32 v154, 16, v31
  v_and_b32 v155, 0xffff0000, v31
  v_pk_add_f32 v[102:103], v[102:103], v[154:155]
  v_cvt_pk_bf16_f32 v120, v96, v97
  v_cvt_pk_bf16_f32 v121, v98, v99
  v_cvt_pk_bf16_f32 v122, v100, v101
  v_cvt_pk_bf16_f32 v123, v102, v103
  s_waitcnt vmcnt(7)
  v_lshlrev_b32 v104, 16, v32
  v_and_b32 v105, 0xffff0000, v32
  v_lshlrev_b32 v106, 16, v33
  v_and_b32 v107, 0xffff0000, v33
  v_lshlrev_b32 v108, 16, v34
  v_and_b32 v109, 0xffff0000, v34
  v_lshlrev_b32 v110, 16, v35
  v_and_b32 v111, 0xffff0000, v35
  s_waitcnt vmcnt(6)
  v_lshlrev_b32 v148, 16, v36
  v_and_b32 v149, 0xffff0000, v36
  v_pk_add_f32 v[104:105], v[104:105], v[148:149]
  v_lshlrev_b32 v154, 16, v37
  v_and_b32 v155, 0xffff0000, v37
  v_pk_add_f32 v[106:107], v[106:107], v[154:155]
  v_lshlrev_b32 v148, 16, v38
  v_and_b32 v149, 0xffff0000, v38
  v_pk_add_f32 v[108:109], v[108:109], v[148:149]
  v_lshlrev_b32 v154, 16, v39
  v_and_b32 v155, 0xffff0000, v39
  v_pk_add_f32 v[110:111], v[110:111], v[154:155]
  s_waitcnt vmcnt(5)
  v_lshlrev_b32 v148, 16, v40
  v_and_b32 v149, 0xffff0000, v40
  v_pk_add_f32 v[104:105], v[104:105], v[148:149]
  v_lshlrev_b32 v154, 16, v41
  v_and_b32 v155, 0xffff0000, v41
  v_pk_add_f32 v[106:107], v[106:107], v[154:155]
  v_lshlrev_b32 v148, 16, v42
  v_and_b32 v149, 0xffff0000, v42
  v_pk_add_f32 v[108:109], v[108:109], v[148:149]
  v_lshlrev_b32 v154, 16, v43
  v_and_b32 v155, 0xffff0000, v43
  v_pk_add_f32 v[110:111], v[110:111], v[154:155]
  s_waitcnt vmcnt(4)
  v_lshlrev_b32 v148, 16, v44
  v_and_b32 v149, 0xffff0000, v44
  v_pk_add_f32 v[104:105], v[104:105], v[148:149]
  v_lshlrev_b32 v154, 16, v45
  v_and_b32 v155, 0xffff0000, v45
  v_pk_add_f32 v[106:107], v[106:107], v[154:155]
  v_lshlrev_b32 v148, 16, v46
  v_and_b32 v149, 0xffff0000, v46
  v_pk_add_f32 v[108:109], v[108:109], v[148:149]
  v_lshlrev_b32 v154, 16, v47
  v_and_b32 v155, 0xffff0000, v47
  v_pk_add_f32 v[110:111], v[110:111], v[154:155]
  s_waitcnt vmcnt(3)
  v_lshlrev_b32 v148, 16, v48
  v_and_b32 v149, 0xffff0000, v48
  v_pk_add_f32 v[104:105], v[104:105], v[148:149]
  v_lshlrev_b32 v154, 16, v49
  v_and_b32 v155, 0xffff0000, v49
  v_pk_add_f32 v[106:107], v[106:107], v[154:155]
  v_lshlrev_b32 v148, 16, v50
  v_and_b32 v149, 0xffff0000, v50
  v_pk_add_f32 v[108:109], v[108:109], v[148:149]
  v_lshlrev_b32 v154, 16, v51
  v_and_b32 v155, 0xffff0000, v51
  v_pk_add_f32 v[110:111], v[110:111], v[154:155]
  s_waitcnt vmcnt(2)
  v_lshlrev_b32 v148, 16, v52
  v_and_b32 v149, 0xffff0000, v52
  v_pk_add_f32 v[104:105], v[104:105], v[148:149]
  v_lshlrev_b32 v154, 16, v53
  v_and_b32 v155, 0xffff0000, v53
  v_pk_add_f32 v[106:107], v[106:107], v[154:155]
  v_lshlrev_b32 v148, 16, v54
  v_and_b32 v149, 0xffff0000, v54
  v_pk_add_f32 v[108:109], v[108:109], v[148:149]
  v_lshlrev_b32 v154, 16, v55
  v_and_b32 v155, 0xffff0000, v55
  v_pk_add_f32 v[110:111], v[110:111], v[154:155]
  s_waitcnt vmcnt(1)
  v_lshlrev_b32 v148, 16, v56
  v_and_b32 v149, 0xffff0000, v56
  v_pk_add_f32 v[104:105], v[104:105], v[148:149]
  v_lshlrev_b32 v154, 16, v57
  v_and_b32 v155, 0xffff0000, v57
  v_pk_add_f32 v[106:107], v[106:107], v[154:155]
  v_lshlrev_b32 v148, 16, v58
  v_and_b32 v149, 0xffff0000, v58
  v_pk_add_f32 v[108:109], v[108:109], v[148:149]
  v_lshlrev_b32 v154, 16, v59
  v_and_b32 v155, 0xffff0000, v59
  v_pk_add_f32 v[110:111], v[110:111], v[154:155]
  s_waitcnt vmcnt(0)
  v_lshlrev_b32 v148, 16, v60
  v_and_b32 v149, 0xffff0000, v60
  v_pk_add_f32 v[104:105], v[104:105], v[148:149]
  v_lshlrev_b32 v154, 16, v61
  v_and_b32 v155, 0xffff0000, v61
  v_pk_add_f32 v[106:107], v[106:107], v[154:155]
  v_lshlrev_b32 v148, 16, v62
  v_and_b32 v149, 0xffff0000, v62
  v_pk_add_f32 v[108:109], v[108:109], v[148:149]
  v_lshlrev_b32 v154, 16, v63
  v_and_b32 v155, 0xffff0000, v63
  v_pk_add_f32 v[110:111], v[110:111], v[154:155]
  v_cvt_pk_bf16_f32 v124, v104, v105
  v_cvt_pk_bf16_f32 v125, v106, v107
  v_cvt_pk_bf16_f32 v126, v108, v109
  v_cvt_pk_bf16_f32 v127, v110, v111
L_units_done:
  buffer_store_dwordx2 v[120:121], v142, s[16:19], s81 offen
  s_cmp_eq_u32 s87, 17
  s_cbranch_scc1 L_half_0
  buffer_store_dwordx2 v[122:123], v142, s[16:19], s82 offen
L_half_0:
  buffer_store_dwordx2 v[124:125], v142, s[16:19], s83 offen
  s_cmp_eq_u32 s88, 17
  s_cbranch_scc1 L_half_1
  buffer_store_dwordx2 v[126:127], v142, s[16:19], s84 offen
L_half_1:
L_end:
  s_endpgm
L_rare_b0b_0:
  s_call_b64 s[84:85], L_rescale_0
  s_branch L_back_b0b_0
L_rare_b0b_1:
  s_call_b64 s[84:85], L_rescale_1
  s_branch L_back_b0b_1
L_rare_b0b_2:
  s_call_b64 s[84:85], L_rescale_2
  s_branch L_back_b0b_2
L_rare_b0c_0:
  s_call_b64 s[84:85], L_rescale_0
  s_branch L_back_b0c_0
L_rare_b0c_1:
  s_call_b64 s[84:85], L_rescale_1
  s_branch L_back_b0c_1
L_rare_b0c_2:
  s_call_b64 s[84:85], L_rescale_2
  s_branch L_back_b0c_2
L_rare_b0d_0:
  s_call_b64 s[84:85], L_rescale_0
  s_branch L_back_b0d_0
L_rare_b0d_1:
  s_call_b64 s[84:85], L_rescale_1
  s_branch L_back_b0d_1
L_rare_b0d_2:
  s_call_b64 s[84:85], L_rescale_2
  s_branch L_back_b0d_2
L_rare_b0e_0:
  s_call_b64 s[84:85], L_rescale_0
  s_branch L_back_b0e_0
L_rare_b0e_1:
  s_call_b64 s[84:85], L_rescale_1
  s_branch L_back_b0e_1
L_rare_b0e_2:
  s_call_b64 s[84:85], L_rescale_2
  s_branch L_back_b0e_2
L_rare_b1b_0:
  s_call_b64 s[84:85], L_rescale_0
  s_branch L_back_b1b_0
L_rare_b1b_1:
  s_call_b64 s[84:85], L_rescale_1
  s_branch L_back_b1b_1
L_rare_b1c_0:
  s_call_b64 s[84:85], L_rescale_0
  s_branch L_back_b1c_0
L_rare_b1c_1:
  s_call_b64 s[84:85], L_rescale_1
  s_branch L_back_b1c_1
L_rare_b1d_0:
  s_call_b64 s[84:85], L_rescale_0
  s_branch L_back_b1d_0
L_rare_b1d_1:
  s_call_b64 s[84:85], L_rescale_1
  s_branch L_back_b1d_1
L_rare_b1e_0:
  s_call_b64 s[84:85], L_rescale_0
  s_branch L_back_b1e_0
L_rare_b1e_1:
  s_call_b64 s[84:85], L_rescale_1
  s_branch L_back_b1e_1
L_rescale_0:
  s_nop 7
  v_mov_b32 v150, v147
  s_nop 1
  v_permlane32_swap_b32 v147, v150
  v_max_f32 v147, v147, v150
  v_mov_b32 v150, v147
  s_nop 1
  v_permlane16_swap_b32 v147, v150
  v_max_f32 v147, v147, v150
  v_max_f32 v147, v147, v132
  v_sub_f32 v150, v132, v147
  v_mul_f32 v150, s72, v150
  v_exp_f32 v150, v150
  v_mov_b32 v132, v147
  v_add_f32 v135, s73, v147
  v_mul_f32 v138, s72, v147
  v_sub_f32 v138, 0, v138
  v_mul_f32 v141, v141, v150
  v_mul_f32 v144, v144, v150
  v_accvgpr_read_b32 v151, a0
  v_mul_f32 v151, v151, v150
  v_accvgpr_write_b32 a0, v151
  v_accvgpr_read_b32 v152, a1
  v_mul_f32 v152, v152, v150
  v_accvgpr_write_b32 a1, v152
  v_accvgpr_read_b32 v153, a2
  v_mul_f32 v153, v153, v150
  v_accvgpr_write_b32 a2, v153
  v_accvgpr_read_b32 v154, a3
  v_mul_f32 v154, v154, v150
  v_accvgpr_write_b32 a3, v154
  v_accvgpr_read_b32 v151, a4
  v_mul_f32 v151, v151, v150
  v_accvgpr_write_b32 a4, v151
  v_accvgpr_read_b32 v152, a5
  v_mul_f32 v152, v152, v150
  v_accvgpr_write_b32 a5, v152
  v_accvgpr_read_b32 v153, a6
  v_mul_f32 v153, v153, v150
  v_accvgpr_write_b32 a6, v153
  v_accvgpr_read_b32 v154, a7
  v_mul_f32 v154, v154, v150
  v_accvgpr_write_b32 a7, v154
  v_accvgpr_read_b32 v151, a8
  v_mul_f32 v151, v151, v150
  v_accvgpr_write_b32 a8, v151
  v_accvgpr_read_b32 v152, a9
  v_mul_f32 v152, v152, v150
  v_accvgpr_write_b32 a9, v152
  v_accvgpr_read_b32 v153, a10
  v_mul_f32 v153, v153, v150
  v_accvgpr_write_b32 a10, v153
  v_accvgpr_read_b32 v154, a11
  v_mul_f32 v154, v154, v150
  v_accvgpr_write_b32 a11, v154
  v_accvgpr_read_b32 v151, a12
  v_mul_f32 v151, v151, v150
  v_accvgpr_write_b32 a12, v151
  v_accvgpr_read_b32 v152, a13
  v_mul_f32 v152, v152, v150
  v_accvgpr_write_b32 a13, v152
  v_accvgpr_read_b32 v153, a14
  v_mul_f32 v153, v153, v150
  v_accvgpr_write_b32 a14, v153
  v_accvgpr_read_b32 v154, a15
  v_mul_f32 v154, v154, v150
  v_accvgpr_write_b32 a15, v154
  v_accvgpr_read_b32 v151, a16
  v_mul_f32 v151, v151, v150
  v_accvgpr_write_b32 a16, v151
  v_accvgpr_read_b32 v152, a17
  v_mul_f32 v152, v152, v150
  v_accvgpr_write_b32 a17, v152
  v_accvgpr_read_b32 v153, a18
  v_mul_f32 v153, v153, v150
  v_accvgpr_write_b32 a18, v153
  v_accvgpr_read_b32 v154, a19
  v_mul_f32 v154, v154, v150
  v_accvgpr_write_b32 a19, v154
  v_accvgpr_read_b32 v151, a20
  v_mul_f32 v151, v151, v150
  v_accvgpr_write_b32 a20, v151
  v_accvgpr_read_b32 v152, a21
  v_mul_f32 v152, v152, v150
  v_accvgpr_write_b32 a21, v152
  v_accvgpr_read_b32 v153, a22
  v_mul_f32 v153, v153, v150
  v_accvgpr_write_b32 a22, v153
  v_accvgpr_read_b32 v154, a23
  v_mul_f32 v154, v154, v150
  v_accvgpr_write_b32 a23, v154
  v_accvgpr_read_b32 v151, a24
  v_mul_f32 v151, v151, v150
  v_accvgpr_write_b32 a24, v151
  v_accvgpr_read_b32 v152, a25
  v_mul_f32 v152, v152, v150
  v_accvgpr_write_b32 a25, v152
  v_accvgpr_read_b32 v153, a26
  v_mul_f32 v153, v153, v150
  v_accvgpr_write_b32 a26, v153
  v_accvgpr_read_b32 v154, a27
  v_mul_f32 v154, v154, v150
  v_accvgpr_write_b32 a27, v154
  v_accvgpr_read_b32 v151, a28
  v_mul_f32 v151, v151, v150
  v_accvgpr_write_b32 a28, v151
  v_accvgpr_read_b32 v152, a29
  v_mul_f32 v152, v152, v150
  v_accvgpr_write_b32 a29, v152
  v_accvgpr_read_b32 v153, a30
  v_mul_f32 v153, v153, v150
  v_accvgpr_write_b32 a30, v153
  v_accvgpr_read_b32 v154, a31
  v_mul_f32 v154, v154, v150
  v_accvgpr_write_b32 a31, v154
  v_accvgpr_read_b32 v151, a32
  v_mul_f32 v151, v151, v150
  v_accvgpr_write_b32 a32, v151
  v_accvgpr_read_b32 v152, a33
  v_mul_f32 v152, v152, v150
  v_accvgpr_write_b32 a33, v152
  v_accvgpr_read_b32 v153, a34
  v_mul_f32 v153, v153, v150
  v_accvgpr_write_b32 a34, v153
  v_accvgpr_read_b32 v154, a35
  v_mul_f32 v154, v154, v150
  v_accvgpr_write_b32 a35, v154
  v_accvgpr_read_b32 v151, a36
  v_mul_f32 v151, v151, v150
  v_accvgpr_write_b32 a36, v151
  v_accvgpr_read_b32 v152, a37
  v_mul_f32 v152, v152, v150
  v_accvgpr_write_b32 a37, v152
  v_accvgpr_read_b32 v153, a38
  v_mul_f32 v153, v153, v150
  v_accvgpr_write_b32 a38, v153
  v_accvgpr_read_b32 v154, a39
  v_mul_f32 v154, v154, v150
  v_accvgpr_write_b32 a39, v154
  v_accvgpr_read_b32 v151, a40
  v_mul_f32 v151, v151, v150
  v_accvgpr_write_b32 a40, v151
  v_accvgpr_read_b32 v152, a41
  v_mul_f32 v152, v152, v150
  v_accvgpr_write_b32 a41, v152
  v_accvgpr_read_b32 v153, a42
  v_mul_f32 v153, v153, v150
  v_accvgpr_write_b32 a42, v153
  v_accvgpr_read_b32 v154, a43
  v_mul_f32 v154, v154, v150
  v_accvgpr_write_b32 a43, v154
  v_accvgpr_read_b32 v151, a44
  v_mul_f32 v151, v151, v150
  v_accvgpr_write_b32 a44, v151
  v_accvgpr_read_b32 v152, a45
  v_mul_f32 v152, v152, v150
  v_accvgpr_write_b32 a45, v152
  v_accvgpr_read_b32 v153, a46
  v_mul_f32 v153, v153, v150
  v_accvgpr_write_b32 a46, v153
  v_accvgpr_read_b32 v154, a47
  v_mul_f32 v154, v154, v150
  v_accvgpr_write_b32 a47, v154
  v_accvgpr_read_b32 v151, a48
  v_mul_f32 v151, v151, v150
  v_accvgpr_write_b32 a48, v151
  v_accvgpr_read_b32 v152, a49
  v_mul_f32 v152, v152, v150
  v_accvgpr_write_b32 a49, v152
  v_accvgpr_read_b32 v153, a50
  v_mul_f32 v153, v153, v150
  v_accvgpr_write_b32 a50, v153
  v_accvgpr_read_b32 v154, a51
  v_mul_f32 v154, v154, v150
  v_accvgpr_write_b32 a51, v154
  v_accvgpr_read_b32 v151, a52
  v_mul_f32 v151, v151, v150
  v_accvgpr_write_b32 a52, v151
  v_accvgpr_read_b32 v152, a53
  v_mul_f32 v152, v152, v150
  v_accvgpr_write_b32 a53, v152
  v_accvgpr_read_b32 v153, a54
  v_mul_f32 v153, v153, v150
  v_accvgpr_write_b32 a54, v153
  v_accvgpr_read_b32 v154, a55
  v_mul_f32 v154, v154, v150
  v_accvgpr_write_b32 a55, v154
  v_accvgpr_read_b32 v151, a56
  v_mul_f32 v151, v151, v150
  v_accvgpr_write_b32 a56, v151
  v_accvgpr_read_b32 v152, a57
  v_mul_f32 v152, v152, v150
  v_accvgpr_write_b32 a57, v152
  v_accvgpr_read_b32 v153, a58
  v_mul_f32 v153, v153, v150
  v_accvgpr_write_b32 a58, v153
  v_accvgpr_read_b32 v154, a59
  v_mul_f32 v154, v154, v150
  v_accvgpr_write_b32 a59, v154
  v_accvgpr_read_b32 v151, a60
  v_mul_f32 v151, v151, v150
  v_accvgpr_write_b32 a60, v151
  v_accvgpr_read_b32 v152, a61
  v_mul_f32 v152, v152, v150
  v_accvgpr_write_b32 a61, v152
  v_accvgpr_read_b32 v153, a62
  v_mul_f32 v153, v153, v150
  v_accvgpr_write_b32 a62, v153
  v_accvgpr_read_b32 v154, a63
  v_mul_f32 v154, v154, v150
  v_accvgpr_write_b32 a63, v154
  s_nop 1
  s_setpc_b64 s[84:85]
L_rescale_1:
  s_nop 7
  v_mov_b32 v150, v148
  s_nop 1
  v_permlane32_swap_b32 v148, v150
  v_max_f32 v148, v148, v150
  v_mov_b32 v150, v148
  s_nop 1
  v_permlane16_swap_b32 v148, v150
  v_max_f32 v148, v148, v150
  v_max_f32 v148, v148, v133
  v_sub_f32 v150, v133, v148
  v_mul_f32 v150, s72, v150
  v_exp_f32 v150, v150
  v_mov_b32 v133, v148
  v_add_f32 v136, s73, v148
  v_mul_f32 v139, s72, v148
  v_sub_f32 v139, 0, v139
  v_mul_f32 v142, v142, v150
  v_mul_f32 v145, v145, v150
  v_accvgpr_read_b32 v151, a64
  v_mul_f32 v151, v151, v150
  v_accvgpr_write_b32 a64, v151
  v_accvgpr_read_b32 v152, a65
  v_mul_f32 v152, v152, v150
  v_accvgpr_write_b32 a65, v152
  v_accvgpr_read_b32 v153, a66
  v_mul_f32 v153, v153, v150
  v_accvgpr_write_b32 a66, v153
  v_accvgpr_read_b32 v154, a67
  v_mul_f32 v154, v154, v150
  v_accvgpr_write_b32 a67, v154
  v_accvgpr_read_b32 v151, a68
  v_mul_f32 v151, v151, v150
  v_accvgpr_write_b32 a68, v151
  v_accvgpr_read_b32 v152, a69
  v_mul_f32 v152, v152, v150
  v_accvgpr_write_b32 a69, v152
  v_accvgpr_read_b32 v153, a70
  v_mul_f32 v153, v153, v150
  v_accvgpr_write_b32 a70, v153
  v_accvgpr_read_b32 v154, a71
  v_mul_f32 v154, v154, v150
  v_accvgpr_write_b32 a71, v154
  v_accvgpr_read_b32 v151, a72
  v_mul_f32 v151, v151, v150
  v_accvgpr_write_b32 a72, v151
  v_accvgpr_read_b32 v152, a73
  v_mul_f32 v152, v152, v150
  v_accvgpr_write_b32 a73, v152
  v_accvgpr_read_b32 v153, a74
  v_mul_f32 v153, v153, v150
  v_accvgpr_write_b32 a74, v153
  v_accvgpr_read_b32 v154, a75
  v_mul_f32 v154, v154, v150
  v_accvgpr_write_b32 a75, v154
  v_accvgpr_read_b32 v151, a76
  v_mul_f32 v151, v151, v150
  v_accvgpr_write_b32 a76, v151
  v_accvgpr_read_b32 v152, a77
  v_mul_f32 v152, v152, v150
  v_accvgpr_write_b32 a77, v152
  v_accvgpr_read_b32 v153, a78
  v_mul_f32 v153, v153, v150
  v_accvgpr_write_b32 a78, v153
  v_accvgpr_read_b32 v154, a79
  v_mul_f32 v154, v154, v150
  v_accvgpr_write_b32 a79, v154
  v_accvgpr_read_b32 v151, a80
  v_mul_f32 v151, v151, v150
  v_accvgpr_write_b32 a80, v151
  v_accvgpr_read_b32 v152, a81
  v_mul_f32 v152, v152, v150
  v_accvgpr_write_b32 a81, v152
  v_accvgpr_read_b32 v153, a82
  v_mul_f32 v153, v153, v150
  v_accvgpr_write_b32 a82, v153
  v_accvgpr_read_b32 v154, a83
  v_mul_f32 v154, v154, v150
  v_accvgpr_write_b32 a83, v154
  v_accvgpr_read_b32 v151, a84
  v_mul_f32 v151, v151, v150
  v_accvgpr_write_b32 a84, v151
  v_accvgpr_read_b32 v152, a85
  v_mul_f32 v152, v152, v150
  v_accvgpr_write_b32 a85, v152
  v_accvgpr_read_b32 v153, a86
  v_mul_f32 v153, v153, v150
  v_accvgpr_write_b32 a86, v153
  v_accvgpr_read_b32 v154, a87
  v_mul_f32 v154, v154, v150
  v_accvgpr_write_b32 a87, v154
  v_accvgpr_read_b32 v151, a88
  v_mul_f32 v151, v151, v150
  v_accvgpr_write_b32 a88, v151
  v_accvgpr_read_b32 v152, a89
  v_mul_f32 v152, v152, v150
  v_accvgpr_write_b32 a89, v152
  v_accvgpr_read_b32 v153, a90
  v_mul_f32 v153, v153, v150
  v_accvgpr_write_b32 a90, v153
  v_accvgpr_read_b32 v154, a91
  v_mul_f32 v154, v154, v150
  v_accvgpr_write_b32 a91, v154
  v_accvgpr_read_b32 v151, a92
  v_mul_f32 v151, v151, v150
  v_accvgpr_write_b32 a92, v151
  v_accvgpr_read_b32 v152, a93
  v_mul_f32 v152, v152, v150
  v_accvgpr_write_b32 a93, v152
  v_accvgpr_read_b32 v153, a94
  v_mul_f32 v153, v153, v150
  v_accvgpr_write_b32 a94, v153
  v_accvgpr_read_b32 v154, a95
  v_mul_f32 v154, v154, v150
  v_accvgpr_write_b32 a95, v154
  v_accvgpr_read_b32 v151, a96
  v_mul_f32 v151, v151, v150
  v_accvgpr_write_b32 a96, v151
  v_accvgpr_read_b32 v152, a97
  v_mul_f32 v152, v152, v150
  v_accvgpr_write_b32 a97, v152
  v_accvgpr_read_b32 v153, a98
  v_mul_f32 v153, v153, v150
  v_accvgpr_write_b32 a98, v153
  v_accvgpr_read_b32 v154, a99
  v_mul_f32 v154, v154, v150
  v_accvgpr_write_b32 a99, v154
  v_accvgpr_read_b32 v151, a100
  v_mul_f32 v151, v151, v150
  v_accvgpr_write_b32 a100, v151
  v_accvgpr_read_b32 v152, a101
  v_mul_f32 v152, v152, v150
  v_accvgpr_write_b32 a101, v152
  v_accvgpr_read_b32 v153, a102
  v_mul_f32 v153, v153, v150
  v_accvgpr_write_b32 a102, v153
  v_accvgpr_read_b32 v154, a103
  v_mul_f32 v154, v154, v150
  v_accvgpr_write_b32 a103, v154
  v_accvgpr_read_b32 v151, a104
  v_mul_f32 v151, v151, v150
  v_accvgpr_write_b32 a104, v151
  v_accvgpr_read_b32 v152, a105
  v_mul_f32 v152, v152, v150
  v_accvgpr_write_b32 a105, v152
  v_accvgpr_read_b32 v153, a106
  v_mul_f32 v153, v153, v150
  v_accvgpr_write_b32 a106, v153
  v_accvgpr_read_b32 v154, a107
  v_mul_f32 v154, v154, v150
  v_accvgpr_write_b32 a107, v154
  v_accvgpr_read_b32 v151, a108
  v_mul_f32 v151, v151, v150
  v_accvgpr_write_b32 a108, v151
  v_accvgpr_read_b32 v152, a109
  v_mul_f32 v152, v152, v150
  v_accvgpr_write_b32 a109, v152
  v_accvgpr_read_b32 v153, a110
  v_mul_f32 v153, v153, v150
  v_accvgpr_write_b32 a110, v153
  v_accvgpr_read_b32 v154, a111
  v_mul_f32 v154, v154, v150
  v_accvgpr_write_b32 a111, v154
  v_accvgpr_read_b32 v151, a112
  v_mul_f32 v151, v151, v150
  v_accvgpr_write_b32 a112, v151
  v_accvgpr_read_b32 v152, a113
  v_mul_f32 v152, v152, v150
  v_accvgpr_write_b32 a113, v152
  v_accvgpr_read_b32 v153, a114
  v_mul_f32 v153, v153, v150
  v_accvgpr_write_b32 a114, v153
  v_accvgpr_read_b32 v154, a115
  v_mul_f32 v154, v154, v150
  v_accvgpr_write_b32 a115, v154
  v_accvgpr_read_b32 v151, a116
  v_mul_f32 v151, v151, v150
  v_accvgpr_write_b32 a116, v151
  v_accvgpr_read_b32 v152, a117
  v_mul_f32 v152, v152, v150
  v_accvgpr_write_b32 a117, v152
  v_accvgpr_read_b32 v153, a118
  v_mul_f32 v153, v153, v150
  v_accvgpr_write_b32 a118, v153
  v_accvgpr_read_b32 v154, a119
  v_mul_f32 v154, v154, v150
  v_accvgpr_write_b32 a119, v154
  v_accvgpr_read_b32 v151, a120
  v_mul_f32 v151, v151, v150
  v_accvgpr_write_b32 a120, v151
  v_accvgpr_read_b32 v152, a121
  v_mul_f32 v152, v152, v150
  v_accvgpr_write_b32 a121, v152
  v_accvgpr_read_b32 v153, a122
  v_mul_f32 v153, v153, v150
  v_accvgpr_write_b32 a122, v153
  v_accvgpr_read_b32 v154, a123
  v_mul_f32 v154, v154, v150
  v_accvgpr_write_b32 a123, v154
  v_accvgpr_read_b32 v151, a124
  v_mul_f32 v151, v151, v150
  v_accvgpr_write_b32 a124, v151
  v_accvgpr_read_b32 v152, a125
  v_mul_f32 v152, v152, v150
  v_accvgpr_write_b32 a125, v152
  v_accvgpr_read_b32 v153, a126
  v_mul_f32 v153, v153, v150
  v_accvgpr_write_b32 a126, v153
  v_accvgpr_read_b32 v154, a127
  v_mul_f32 v154, v154, v150
  v_accvgpr_write_b32 a127, v154
  s_nop 1
  s_setpc_b64 s[84:85]
L_rescale_2:
  s_nop 7
  v_mov_b32 v150, v149
  s_nop 1
  v_permlane32_swap_b32 v149, v150
  v_max_f32 v149, v149, v150
  v_mov_b32 v150, v149
  s_nop 1
  v_permlane16_swap_b32 v149, v150
  v_max_f32 v149, v149, v150
  v_max_f32 v149, v149, v134
  v_sub_f32 v150, v134, v149
  v_mul_f32 v150, s72, v150
  v_exp_f32 v150, v150
  v_mov_b32 v134, v149
  v_add_f32 v137, s73, v149
  v_mul_f32 v140, s72, v149
  v_sub_f32 v140, 0, v140
  v_mul_f32 v143, v143, v150
  v_mul_f32 v146, v146, v150
  v_accvgpr_read_b32 v151, a128
  v_mul_f32 v151, v151, v150
  v_accvgpr_write_b32 a128, v151
  v_accvgpr_read_b32 v152, a129
  v_mul_f32 v152, v152, v150
  v_accvgpr_write_b32 a129, v152
  v_accvgpr_read_b32 v153, a130
  v_mul_f32 v153, v153, v150
  v_accvgpr_write_b32 a130, v153
  v_accvgpr_read_b32 v154, a131
  v_mul_f32 v154, v154, v150
  v_accvgpr_write_b32 a131, v154
  v_accvgpr_read_b32 v151, a132
  v_mul_f32 v151, v151, v150
  v_accvgpr_write_b32 a132, v151
  v_accvgpr_read_b32 v152, a133
  v_mul_f32 v152, v152, v150
  v_accvgpr_write_b32 a133, v152
  v_accvgpr_read_b32 v153, a134
  v_mul_f32 v153, v153, v150
  v_accvgpr_write_b32 a134, v153
  v_accvgpr_read_b32 v154, a135
  v_mul_f32 v154, v154, v150
  v_accvgpr_write_b32 a135, v154
  v_accvgpr_read_b32 v151, a136
  v_mul_f32 v151, v151, v150
  v_accvgpr_write_b32 a136, v151
  v_accvgpr_read_b32 v152, a137
  v_mul_f32 v152, v152, v150
  v_accvgpr_write_b32 a137, v152
  v_accvgpr_read_b32 v153, a138
  v_mul_f32 v153, v153, v150
  v_accvgpr_write_b32 a138, v153
  v_accvgpr_read_b32 v154, a139
  v_mul_f32 v154, v154, v150
  v_accvgpr_write_b32 a139, v154
  v_accvgpr_read_b32 v151, a140
  v_mul_f32 v151, v151, v150
  v_accvgpr_write_b32 a140, v151
  v_accvgpr_read_b32 v152, a141
  v_mul_f32 v152, v152, v150
  v_accvgpr_write_b32 a141, v152
  v_accvgpr_read_b32 v153, a142
  v_mul_f32 v153, v153, v150
  v_accvgpr_write_b32 a142, v153
  v_accvgpr_read_b32 v154, a143
  v_mul_f32 v154, v154, v150
  v_accvgpr_write_b32 a143, v154
  v_accvgpr_read_b32 v151, a144
  v_mul_f32 v151, v151, v150
  v_accvgpr_write_b32 a144, v151
  v_accvgpr_read_b32 v152, a145
  v_mul_f32 v152, v152, v150
  v_accvgpr_write_b32 a145, v152
  v_accvgpr_read_b32 v153, a146
  v_mul_f32 v153, v153, v150
  v_accvgpr_write_b32 a146, v153
  v_accvgpr_read_b32 v154, a147
  v_mul_f32 v154, v154, v150
  v_accvgpr_write_b32 a147, v154
  v_accvgpr_read_b32 v151, a148
  v_mul_f32 v151, v151, v150
  v_accvgpr_write_b32 a148, v151
  v_accvgpr_read_b32 v152, a149
  v_mul_f32 v152, v152, v150
  v_accvgpr_write_b32 a149, v152
  v_accvgpr_read_b32 v153, a150
  v_mul_f32 v153, v153, v150
  v_accvgpr_write_b32 a150, v153
  v_accvgpr_read_b32 v154, a151
  v_mul_f32 v154, v154, v150
  v_accvgpr_write_b32 a151, v154
  v_accvgpr_read_b32 v151, a152
  v_mul_f32 v151, v151, v150
  v_accvgpr_write_b32 a152, v151
  v_accvgpr_read_b32 v152, a153
  v_mul_f32 v152, v152, v150
  v_accvgpr_write_b32 a153, v152
  v_accvgpr_read_b32 v153, a154
  v_mul_f32 v153, v153, v150
  v_accvgpr_write_b32 a154, v153
  v_accvgpr_read_b32 v154, a155
  v_mul_f32 v154, v154, v150
  v_accvgpr_write_b32 a155, v154
  v_accvgpr_read_b32 v151, a156
  v_mul_f32 v151, v151, v150
  v_accvgpr_write_b32 a156, v151
  v_accvgpr_read_b32 v152, a157
  v_mul_f32 v152, v152, v150
  v_accvgpr_write_b32 a157, v152
  v_accvgpr_read_b32 v153, a158
  v_mul_f32 v153, v153, v150
  v_accvgpr_write_b32 a158, v153
  v_accvgpr_read_b32 v154, a159
  v_mul_f32 v154, v154, v150
  v_accvgpr_write_b32 a159, v154
  v_accvgpr_read_b32 v151, a160
  v_mul_f32 v151, v151, v150
  v_accvgpr_write_b32 a160, v151
  v_accvgpr_read_b32 v152, a161
  v_mul_f32 v152, v152, v150
  v_accvgpr_write_b32 a161, v152
  v_accvgpr_read_b32 v153, a162
  v_mul_f32 v153, v153, v150
  v_accvgpr_write_b32 a162, v153
  v_accvgpr_read_b32 v154, a163
  v_mul_f32 v154, v154, v150
  v_accvgpr_write_b32 a163, v154
  v_accvgpr_read_b32 v151, a164
  v_mul_f32 v151, v151, v150
  v_accvgpr_write_b32 a164, v151
  v_accvgpr_read_b32 v152, a165
  v_mul_f32 v152, v152, v150
  v_accvgpr_write_b32 a165, v152
  v_accvgpr_read_b32 v153, a166
  v_mul_f32 v153, v153, v150
  v_accvgpr_write_b32 a166, v153
  v_accvgpr_read_b32 v154, a167
  v_mul_f32 v154, v154, v150
  v_accvgpr_write_b32 a167, v154
  v_accvgpr_read_b32 v151, a168
  v_mul_f32 v151, v151, v150
  v_accvgpr_write_b32 a168, v151
  v_accvgpr_read_b32 v152, a169
  v_mul_f32 v152, v152, v150
  v_accvgpr_write_b32 a169, v152
  v_accvgpr_read_b32 v153, a170
  v_mul_f32 v153, v153, v150
  v_accvgpr_write_b32 a170, v153
  v_accvgpr_read_b32 v154, a171
  v_mul_f32 v154, v154, v150
  v_accvgpr_write_b32 a171, v154
  v_accvgpr_read_b32 v151, a172
  v_mul_f32 v151, v151, v150
  v_accvgpr_write_b32 a172, v151
  v_accvgpr_read_b32 v152, a173
  v_mul_f32 v152, v152, v150
  v_accvgpr_write_b32 a173, v152
  v_accvgpr_read_b32 v153, a174
  v_mul_f32 v153, v153, v150
  v_accvgpr_write_b32 a174, v153
  v_accvgpr_read_b32 v154, a175
  v_mul_f32 v154, v154, v150
  v_accvgpr_write_b32 a175, v154
  v_accvgpr_read_b32 v151, a176
  v_mul_f32 v151, v151, v150
  v_accvgpr_write_b32 a176, v151
  v_accvgpr_read_b32 v152, a177
  v_mul_f32 v152, v152, v150
  v_accvgpr_write_b32 a177, v152
  v_accvgpr_read_b32 v153, a178
  v_mul_f32 v153, v153, v150
  v_accvgpr_write_b32 a178, v153
  v_accvgpr_read_b32 v154, a179
  v_mul_f32 v154, v154, v150
  v_accvgpr_write_b32 a179, v154
  v_accvgpr_read_b32 v151, a180
  v_mul_f32 v151, v151, v150
  v_accvgpr_write_b32 a180, v151
  v_accvgpr_read_b32 v152, a181
  v_mul_f32 v152, v152, v150
  v_accvgpr_write_b32 a181, v152
  v_accvgpr_read_b32 v153, a182
  v_mul_f32 v153, v153, v150
  v_accvgpr_write_b32 a182, v153
  v_accvgpr_read_b32 v154, a183
  v_mul_f32 v154, v154, v150
  v_accvgpr_write_b32 a183, v154
  v_accvgpr_read_b32 v151, a184
  v_mul_f32 v151, v151, v150
  v_accvgpr_write_b32 a184, v151
  v_accvgpr_read_b32 v152, a185
  v_mul_f32 v152, v152, v150
  v_accvgpr_write_b32 a185, v152
  v_accvgpr_read_b32 v153, a186
  v_mul_f32 v153, v153, v150
  v_accvgpr_write_b32 a186, v153
  v_accvgpr_read_b32 v154, a187
  v_mul_f32 v154, v154, v150
  v_accvgpr_write_b32 a187, v154
  v_accvgpr_read_b32 v151, a188
  v_mul_f32 v151, v151, v150
  v_accvgpr_write_b32 a188, v151
  v_accvgpr_read_b32 v152, a189
  v_mul_f32 v152, v152, v150
  v_accvgpr_write_b32 a189, v152
  v_accvgpr_read_b32 v153, a190
  v_mul_f32 v153, v153, v150
  v_accvgpr_write_b32 a190, v153
  v_accvgpr_read_b32 v154, a191
  v_mul_f32 v154, v154, v150
  v_accvgpr_write_b32 a191, v154
  s_nop 1
  s_setpc_b64 s[84:85]
L_codeend:
  s_endpgm
.section .rodata,"a"
.p2align 6

.amdhsa_kernel concat_heads__gqa_block_cached__mha_block_cached__near_ridge_kernel
  .amdhsa_next_free_vgpr 512
  .amdhsa_next_free_sgpr 102
  .amdhsa_accum_offset 256
  .amdhsa_group_segment_fixed_size 0
  .amdhsa_kernarg_size 104
  .amdhsa_user_sgpr_count 2
  .amdhsa_user_sgpr_kernarg_segment_ptr 1
  .amdhsa_system_sgpr_workgroup_id_x 1
.end_amdhsa_kernel
```
